```python
import torch

def _softmax(x, axis=-1):
    return torch.softmax(x, dim=axis)
def _gelu(x):
    return torch.nn.functional.gelu(x, approximate="tanh")
def _silu(x):
    return torch.nn.functional.silu(x)
def _sigmoid(x):
    return torch.sigmoid(x)
def _layernorm(x, axis=-1, eps=1e-5):
    m = x.mean(dim=axis, keepdim=True)
    v = x.var(dim=axis, keepdim=True, unbiased=False)
    return (x - m) / torch.sqrt(v + eps)
def _scatter_add(tgt, idx, src, axis=0):
    return tgt.clone().index_add_(axis, idx, src)
def _segment_sum(src, seg, n):
    out = torch.zeros((n,) + src.shape[1:], dtype=src.dtype)
    return out.index_add_(0, seg, src)
def _pad(x, pw):
    flat = tuple(v for pair in reversed(pw) for v in pair)
    return torch.nn.functional.pad(x, flat)

kernel_name = 'recurrent_scan__mha_block_cached__glu_gated_bilinear__prompt'

def setup_inputs():

    _w = (lambda a: (lambda t: t.to(torch.bfloat16) if t.is_floating_point() else t)(torch.as_tensor(a)))
    def _A_setup():
        B, Sq, D = 1, 2048, 576
        H, Sk, Dh = 32, 2048, 128
        return {
            "x": _w((lambda *s: torch.randn(*s, dtype=torch.bfloat16) * 0.05)(B, Sq, D)),
            "k_cache": _w((lambda *s: torch.randn(*s, dtype=torch.bfloat16) * 1.6)(B, H, Sk, Dh)),
            "v_cache": _w((lambda *s: torch.randn(*s, dtype=torch.bfloat16) * 1.6)(B, H, Sk, Dh)),
            "wq": _w((lambda *s: torch.randn(*s, dtype=torch.bfloat16) * 1.6)(D, H * Dh) * (D ** -0.5)),
            "wo": _w((lambda *s: torch.randn(*s, dtype=torch.bfloat16) * 1.6)(H * Dh, D) * ((H * Dh) ** -0.5)),
        }
    _A_in = _A_setup()

    def _B_setup():
        B, S, D, F = 1, 2048, 576, 4608
        return {
            "x": _w((lambda *s: torch.randn(*s, dtype=torch.bfloat16) * 0.05)(B, S, D)),
            "w_gate": _w((lambda *s: torch.randn(*s, dtype=torch.bfloat16) * 0.2)(D, F) * (D ** -0.5)),
            "w_up": _w((lambda *s: torch.randn(*s, dtype=torch.bfloat16) * 0.2)(D, F) * (D ** -0.5)),
            "w_down": _w((lambda *s: torch.randn(*s, dtype=torch.bfloat16) * 0.2)(F, D) * (F ** -0.5)),
        }
    _B_in = _B_setup()

    return {
        "A_x": _A_in["x"],
        "A_k_cache": _A_in["k_cache"],
        "A_v_cache": _A_in["v_cache"],
        "A_wq": _A_in["wq"],
        "A_wo": _A_in["wo"],
        "B_x": _B_in["x"],
        "B_w_gate": _B_in["w_gate"],
        "B_w_up": _B_in["w_up"],
        "B_w_down": _B_in["w_down"],
    }

def reference(A_x, A_k_cache, A_v_cache, A_wq, A_wo, B_x, B_w_gate, B_w_up, B_w_down):
    def _A_ref(x, k_cache, v_cache, wq, wo):
        B, Sq, D = x.shape
        H, Dh = 32, 128
        q = (lambda x, *d: x.permute(*d))((x @ wq).reshape(B, Sq, H, Dh), 0, 2, 1, 3)
        scores = torch.einsum("bhqd,bhkd->bhqk", q, k_cache) * (Dh ** -0.5)
        p = _softmax(scores, axis=-1)
        o = torch.einsum("bhqk,bhkd->bhqd", p, v_cache)
        return (lambda x, *d: x.permute(*d))(o, 0, 2, 1, 3).reshape(B, Sq, H * Dh) @ wo

    def _B_ref(x, w_gate, w_up, w_down):
        g = torch.einsum("bsd,df->bsf", x, w_gate)
        u = torch.einsum("bsd,df->bsf", x, w_up)
        h = g * u
        return torch.einsum("bsf,fd->bsd", h, w_down)

    x = A_x
    xn = _layernorm(x, axis=-1)
    s = _A_ref(xn, A_k_cache, A_v_cache, A_wq, A_wo)
    g = _silu(_B_ref(xn, B_w_gate, B_w_up, B_w_down))
    return x + s * g
```

```asm
; @launch kernel=ln_kernel grid=(256,1,1) block=(192,1,1) lds=0
; @launch kernel=attn_kernel grid=(256,1,1) block=(256,1,1) lds=163840
; @launch kernel=outp_kernel grid=(256,1,1) block=(256,1,1) lds=147456
.amdgcn_target "amdgcn-amd-amdhsa--gfx950"
.text
.globl ln_kernel
.p2align 8
.type ln_kernel,@function
ln_kernel:

    s_cmp_ge_u32 s2, 256
    s_cbranch_scc1 L_k0_done
    s_load_dwordx2 s[4:5], s[0:1], 0
    s_load_dwordx2 s[8:9], s[0:1], 88
    s_load_dwordx2 s[44:45], s[0:1], 24
    s_load_dwordx4 s[48:51], s[0:1], 48
    v_lshrrev_b32 v1, 6, v0
    s_lshl_b32 s3, s2, 3
    v_readfirstlane_b32 s24, v1
    v_lshrrev_b32 v1, 4, v0
    v_and_b32 v2, 15, v0
    s_cmp_eq_u32 s24, 2
    s_cbranch_scc1 L_k0_pf
    v_add_u32 v1, s3, v1
    v_mul_u32_u24 v3, 1152, v1
    v_lshl_add_u32 v3, v2, 3, v3
    s_mov_b32 s6, 2359296
    s_mov_b32 s7, 0x20000
    s_waitcnt lgkmcnt(0)
    s_and_b32 s5, s5, 0xffff
    buffer_load_dwordx2 v[8:9], v3, s[4:7], 0 offen offset:0
    buffer_load_dwordx2 v[10:11], v3, s[4:7], 0 offen offset:128
    buffer_load_dwordx2 v[12:13], v3, s[4:7], 0 offen offset:256
    buffer_load_dwordx2 v[14:15], v3, s[4:7], 0 offen offset:384
    buffer_load_dwordx2 v[16:17], v3, s[4:7], 0 offen offset:512
    buffer_load_dwordx2 v[18:19], v3, s[4:7], 0 offen offset:640
    buffer_load_dwordx2 v[20:21], v3, s[4:7], 0 offen offset:768
    buffer_load_dwordx2 v[22:23], v3, s[4:7], 0 offen offset:896
    buffer_load_dwordx2 v[24:25], v3, s[4:7], 0 offen offset:1024
    v_lshrrev_b32 v4, 4, v1
    v_mul_u32_u24 v4, 18432, v4
    v_and_b32 v5, 15, v1
    v_lshl_add_u32 v4, v5, 4, v4
    v_lshrrev_b32 v5, 1, v2
    v_lshl_add_u32 v4, v5, 8, v4
    v_and_b32 v5, 1, v2
    v_lshl_add_u32 v4, v5, 3, v4
    s_mov_b64 s[46:47], s[8:9]
    s_mov_b32 s10, 2359296
    s_mov_b32 s11, 0x20000
    s_and_b32 s9, s9, 0xffff
    s_mov_b32 s12, 0xffff0000
    s_waitcnt vmcnt(8)
    v_lshlrev_b32 v28, 16, v8
    v_and_b32 v29, s12, v8
    v_lshlrev_b32 v30, 16, v9
    v_and_b32 v31, s12, v9
    v_add_f32 v6, v28, v30
    v_add_f32 v7, v29, v31
    s_waitcnt vmcnt(7)
    v_lshlrev_b32 v32, 16, v10
    v_and_b32 v33, s12, v10
    v_lshlrev_b32 v34, 16, v11
    v_and_b32 v35, s12, v11
    v_add_f32 v6, v6, v32
    v_add_f32 v7, v7, v33
    v_add_f32 v6, v6, v34
    v_add_f32 v7, v7, v35
    s_waitcnt vmcnt(6)
    v_lshlrev_b32 v36, 16, v12
    v_and_b32 v37, s12, v12
    v_lshlrev_b32 v38, 16, v13
    v_and_b32 v39, s12, v13
    v_add_f32 v6, v6, v36
    v_add_f32 v7, v7, v37
    v_add_f32 v6, v6, v38
    v_add_f32 v7, v7, v39
    s_waitcnt vmcnt(5)
    v_lshlrev_b32 v40, 16, v14
    v_and_b32 v41, s12, v14
    v_lshlrev_b32 v42, 16, v15
    v_and_b32 v43, s12, v15
    v_add_f32 v6, v6, v40
    v_add_f32 v7, v7, v41
    v_add_f32 v6, v6, v42
    v_add_f32 v7, v7, v43
    s_waitcnt vmcnt(4)
    v_lshlrev_b32 v44, 16, v16
    v_and_b32 v45, s12, v16
    v_lshlrev_b32 v46, 16, v17
    v_and_b32 v47, s12, v17
    v_add_f32 v6, v6, v44
    v_add_f32 v7, v7, v45
    v_add_f32 v6, v6, v46
    v_add_f32 v7, v7, v47
    s_waitcnt vmcnt(3)
    v_lshlrev_b32 v48, 16, v18
    v_and_b32 v49, s12, v18
    v_lshlrev_b32 v50, 16, v19
    v_and_b32 v51, s12, v19
    v_add_f32 v6, v6, v48
    v_add_f32 v7, v7, v49
    v_add_f32 v6, v6, v50
    v_add_f32 v7, v7, v51
    s_waitcnt vmcnt(2)
    v_lshlrev_b32 v52, 16, v20
    v_and_b32 v53, s12, v20
    v_lshlrev_b32 v54, 16, v21
    v_and_b32 v55, s12, v21
    v_add_f32 v6, v6, v52
    v_add_f32 v7, v7, v53
    v_add_f32 v6, v6, v54
    v_add_f32 v7, v7, v55
    s_waitcnt vmcnt(1)
    v_lshlrev_b32 v56, 16, v22
    v_and_b32 v57, s12, v22
    v_lshlrev_b32 v58, 16, v23
    v_and_b32 v59, s12, v23
    v_add_f32 v6, v6, v56
    v_add_f32 v7, v7, v57
    v_add_f32 v6, v6, v58
    v_add_f32 v7, v7, v59
    s_waitcnt vmcnt(0)
    v_lshlrev_b32 v60, 16, v24
    v_and_b32 v61, s12, v24
    v_lshlrev_b32 v62, 16, v25
    v_and_b32 v63, s12, v25
    v_add_f32 v6, v6, v60
    v_add_f32 v7, v7, v61
    v_add_f32 v6, v6, v62
    v_add_f32 v7, v7, v63
    v_add_f32 v6, v6, v7
    s_nop 1
    v_add_f32_dpp v6, v6, v6 quad_perm:[1,0,3,2] row_mask:0xf bank_mask:0xf
    s_nop 1
    v_add_f32_dpp v6, v6, v6 quad_perm:[2,3,0,1] row_mask:0xf bank_mask:0xf
    s_nop 1
    v_add_f32_dpp v6, v6, v6 row_half_mirror row_mask:0xf bank_mask:0xf
    s_nop 1
    v_add_f32_dpp v6, v6, v6 row_mirror row_mask:0xf bank_mask:0xf
    v_mul_f32 v6, 0x3ae38e39, v6
    v_sub_f32 v64, v28, v6
    v_mul_f32 v7, v64, v64
    v_sub_f32 v65, v29, v6
    v_mul_f32 v5, v65, v65
    v_sub_f32 v66, v30, v6
    v_fmac_f32 v7, v66, v66
    v_sub_f32 v67, v31, v6
    v_fmac_f32 v5, v67, v67
    v_sub_f32 v64, v32, v6
    v_fmac_f32 v7, v64, v64
    v_sub_f32 v65, v33, v6
    v_fmac_f32 v5, v65, v65
    v_sub_f32 v66, v34, v6
    v_fmac_f32 v7, v66, v66
    v_sub_f32 v67, v35, v6
    v_fmac_f32 v5, v67, v67
    v_sub_f32 v64, v36, v6
    v_fmac_f32 v7, v64, v64
    v_sub_f32 v65, v37, v6
    v_fmac_f32 v5, v65, v65
    v_sub_f32 v66, v38, v6
    v_fmac_f32 v7, v66, v66
    v_sub_f32 v67, v39, v6
    v_fmac_f32 v5, v67, v67
    v_sub_f32 v64, v40, v6
    v_fmac_f32 v7, v64, v64
    v_sub_f32 v65, v41, v6
    v_fmac_f32 v5, v65, v65
    v_sub_f32 v66, v42, v6
    v_fmac_f32 v7, v66, v66
    v_sub_f32 v67, v43, v6
    v_fmac_f32 v5, v67, v67
    v_sub_f32 v64, v44, v6
    v_fmac_f32 v7, v64, v64
    v_sub_f32 v65, v45, v6
    v_fmac_f32 v5, v65, v65
    v_sub_f32 v66, v46, v6
    v_fmac_f32 v7, v66, v66
    v_sub_f32 v67, v47, v6
    v_fmac_f32 v5, v67, v67
    v_sub_f32 v64, v48, v6
    v_fmac_f32 v7, v64, v64
    v_sub_f32 v65, v49, v6
    v_fmac_f32 v5, v65, v65
    v_sub_f32 v66, v50, v6
    v_fmac_f32 v7, v66, v66
    v_sub_f32 v67, v51, v6
    v_fmac_f32 v5, v67, v67
    v_sub_f32 v64, v52, v6
    v_fmac_f32 v7, v64, v64
    v_sub_f32 v65, v53, v6
    v_fmac_f32 v5, v65, v65
    v_sub_f32 v66, v54, v6
    v_fmac_f32 v7, v66, v66
    v_sub_f32 v67, v55, v6
    v_fmac_f32 v5, v67, v67
    v_sub_f32 v64, v56, v6
    v_fmac_f32 v7, v64, v64
    v_sub_f32 v65, v57, v6
    v_fmac_f32 v5, v65, v65
    v_sub_f32 v66, v58, v6
    v_fmac_f32 v7, v66, v66
    v_sub_f32 v67, v59, v6
    v_fmac_f32 v5, v67, v67
    v_sub_f32 v64, v60, v6
    v_fmac_f32 v7, v64, v64
    v_sub_f32 v65, v61, v6
    v_fmac_f32 v5, v65, v65
    v_sub_f32 v66, v62, v6
    v_fmac_f32 v7, v66, v66
    v_sub_f32 v67, v63, v6
    v_fmac_f32 v5, v67, v67
    v_add_f32 v7, v7, v5
    s_nop 1
    v_add_f32_dpp v7, v7, v7 quad_perm:[1,0,3,2] row_mask:0xf bank_mask:0xf
    s_nop 1
    v_add_f32_dpp v7, v7, v7 quad_perm:[2,3,0,1] row_mask:0xf bank_mask:0xf
    s_nop 1
    v_add_f32_dpp v7, v7, v7 row_half_mirror row_mask:0xf bank_mask:0xf
    s_nop 1
    v_add_f32_dpp v7, v7, v7 row_mirror row_mask:0xf bank_mask:0xf
    v_mul_f32 v7, 0x3ae38e39, v7
    v_cvt_pk_bf16_f32 v6, v6, v6
    v_lshlrev_b32 v6, 16, v6
    v_cvt_pk_bf16_f32 v7, v7, v7
    v_lshlrev_b32 v7, 16, v7
    v_add_f32 v7, 0x3727c5ac, v7
    v_cvt_pk_bf16_f32 v7, v7, v7
    v_lshlrev_b32 v7, 16, v7
    v_sqrt_f32 v7, v7
    s_nop 0
    v_cvt_pk_bf16_f32 v7, v7, v7
    v_lshlrev_b32 v7, 16, v7
    v_rcp_f32 v7, v7
    s_nop 0
    v_mul_f32 v6, v6, v7
    v_fma_f32 v28, v28, v7, -v6
    v_fma_f32 v29, v29, v7, -v6
    v_cvt_pk_bf16_f32 v8, v28, v29
    v_fma_f32 v30, v30, v7, -v6
    v_fma_f32 v31, v31, v7, -v6
    v_cvt_pk_bf16_f32 v9, v30, v31
    s_mov_b32 s13, 0
    buffer_store_dwordx2 v[8:9], v4, s[8:11], s13 offen offset:0
    v_fma_f32 v32, v32, v7, -v6
    v_fma_f32 v33, v33, v7, -v6
    v_cvt_pk_bf16_f32 v10, v32, v33
    v_fma_f32 v34, v34, v7, -v6
    v_fma_f32 v35, v35, v7, -v6
    v_cvt_pk_bf16_f32 v11, v34, v35
    buffer_store_dwordx2 v[10:11], v4, s[8:11], s13 offen offset:2048
    v_fma_f32 v36, v36, v7, -v6
    v_fma_f32 v37, v37, v7, -v6
    v_cvt_pk_bf16_f32 v12, v36, v37
    v_fma_f32 v38, v38, v7, -v6
    v_fma_f32 v39, v39, v7, -v6
    v_cvt_pk_bf16_f32 v13, v38, v39
    s_mov_b32 s13, 4096
    buffer_store_dwordx2 v[12:13], v4, s[8:11], s13 offen offset:0
    v_fma_f32 v40, v40, v7, -v6
    v_fma_f32 v41, v41, v7, -v6
    v_cvt_pk_bf16_f32 v14, v40, v41
    v_fma_f32 v42, v42, v7, -v6
    v_fma_f32 v43, v43, v7, -v6
    v_cvt_pk_bf16_f32 v15, v42, v43
    buffer_store_dwordx2 v[14:15], v4, s[8:11], s13 offen offset:2048
    v_fma_f32 v44, v44, v7, -v6
    v_fma_f32 v45, v45, v7, -v6
    v_cvt_pk_bf16_f32 v16, v44, v45
    v_fma_f32 v46, v46, v7, -v6
    v_fma_f32 v47, v47, v7, -v6
    v_cvt_pk_bf16_f32 v17, v46, v47
    s_mov_b32 s13, 8192
    buffer_store_dwordx2 v[16:17], v4, s[8:11], s13 offen offset:0
    v_fma_f32 v48, v48, v7, -v6
    v_fma_f32 v49, v49, v7, -v6
    v_cvt_pk_bf16_f32 v18, v48, v49
    v_fma_f32 v50, v50, v7, -v6
    v_fma_f32 v51, v51, v7, -v6
    v_cvt_pk_bf16_f32 v19, v50, v51
    buffer_store_dwordx2 v[18:19], v4, s[8:11], s13 offen offset:2048
    v_fma_f32 v52, v52, v7, -v6
    v_fma_f32 v53, v53, v7, -v6
    v_cvt_pk_bf16_f32 v20, v52, v53
    v_fma_f32 v54, v54, v7, -v6
    v_fma_f32 v55, v55, v7, -v6
    v_cvt_pk_bf16_f32 v21, v54, v55
    s_mov_b32 s13, 12288
    buffer_store_dwordx2 v[20:21], v4, s[8:11], s13 offen offset:0
    v_fma_f32 v56, v56, v7, -v6
    v_fma_f32 v57, v57, v7, -v6
    v_cvt_pk_bf16_f32 v22, v56, v57
    v_fma_f32 v58, v58, v7, -v6
    v_fma_f32 v59, v59, v7, -v6
    v_cvt_pk_bf16_f32 v23, v58, v59
    buffer_store_dwordx2 v[22:23], v4, s[8:11], s13 offen offset:2048
    v_fma_f32 v60, v60, v7, -v6
    v_fma_f32 v61, v61, v7, -v6
    v_cvt_pk_bf16_f32 v24, v60, v61
    v_fma_f32 v62, v62, v7, -v6
    v_fma_f32 v63, v63, v7, -v6
    v_cvt_pk_bf16_f32 v25, v62, v63
    s_mov_b32 s13, 16384
    buffer_store_dwordx2 v[24:25], v4, s[8:11], s13 offen offset:0
L_k0_done:
    s_endpgm
L_k0_pf:
    v_and_b32 v0, 63, v0
    s_getpc_b64 s[16:17]
L_k0_pc:
    s_sub_u32 s20, s16, L_k0_pc-ln_kernel
    s_subb_u32 s21, s17, 0
    v_lshlrev_b32 v28, 6, v0
    v_mov_b32 v29, 0
    v_mov_b32 v30, s20
    v_mov_b32 v31, s21
    v_lshl_add_u64 v[28:29], v[28:29], 0, v[30:31]
    global_load_dword v27, v[28:29], off
    s_lshr_b32 s18, s2, 3
    s_mul_i32 s18, s18, 2048
    v_lshl_add_u32 v16, v0, 4, s18
    v_mov_b32 v18, s16
    v_mov_b32 v19, s17
    s_mov_b32 s19, L_text_end-L_k0_pc-32
    v_mov_b32 v21, 0
    v_min_u32 v20, s19, v16
    v_lshl_add_u64 v[22:23], v[20:21], 0, v[18:19]
    global_load_dword v24, v[22:23], off
    v_add_u32 v16, 1024, v16
    v_min_u32 v20, s19, v16
    v_lshl_add_u64 v[22:23], v[20:21], 0, v[18:19]
    global_load_dword v25, v[22:23], off
    v_add_u32 v16, 1024, v16
    s_and_b32 s20, s2, 7
    s_lshl_b32 s20, s20, 2
    s_bfe_u32 s21, s2, 0x20003
    s_add_u32 s20, s20, s21
    s_lshr_b32 s21, s2, 5
    s_mul_i32 s22, s20, 288
    s_lshl_b32 s23, s20, 8
    v_subrev_u32 v6, 52, v0
    v_subrev_u32 v7, 36, v0
    v_cmp_gt_u32 vcc, 52, v0
    v_mov_b32 v12, 8192
    v_mov_b32 v13, 9216
    v_cndmask_b32 v6, v6, v7, vcc
    v_lshl_add_u32 v6, v6, 4, s23
    v_subrev_u32 v7, 18, v0
    v_cmp_gt_u32 vcc, 18, v0
    s_waitcnt lgkmcnt(0)
    v_mov_b32 v8, s50
    v_cndmask_b32 v7, v7, v0, vcc
    v_lshl_add_u32 v7, v7, 4, s22
    v_mov_b32 v9, s51
    v_mov_b32 v10, s48
    v_mov_b32 v11, s49
    v_cndmask_b32 v8, v8, v10, vcc
    v_cndmask_b32 v9, v9, v11, vcc
    v_cmp_gt_u32 vcc, 36, v0
    v_mov_b32 v10, s44
    v_mov_b32 v11, s45
    v_cndmask_b32 v8, v10, v8, vcc
    v_cndmask_b32 v9, v11, v9, vcc
    v_cndmask_b32 v6, v6, v7, vcc
    v_cndmask_b32 v12, v12, v13, vcc
    v_mul_lo_u32 v13, v12, s21
    v_add_u32 v6, v6, v13
    v_mov_b32 v7, 0
    v_lshl_add_u64 v[2:3], v[6:7], 0, v[8:9]
    v_lshlrev_b32 v4, 3, v12
    v_mov_b32 v5, 0
    global_load_dword v32, v[2:3], off
    v_lshl_add_u64 v[2:3], v[4:5], 0, v[2:3]
    global_load_dword v33, v[2:3], off
    v_lshl_add_u64 v[2:3], v[4:5], 0, v[2:3]
    global_load_dword v34, v[2:3], off
    v_lshl_add_u64 v[2:3], v[4:5], 0, v[2:3]
    global_load_dword v35, v[2:3], off
    v_lshl_add_u64 v[2:3], v[4:5], 0, v[2:3]
    global_load_dword v36, v[2:3], off
    v_lshl_add_u64 v[2:3], v[4:5], 0, v[2:3]
    global_load_dword v37, v[2:3], off
    v_lshl_add_u64 v[2:3], v[4:5], 0, v[2:3]
    global_load_dword v38, v[2:3], off
    v_lshl_add_u64 v[2:3], v[4:5], 0, v[2:3]
    global_load_dword v39, v[2:3], off
    v_lshl_add_u64 v[2:3], v[4:5], 0, v[2:3]
    s_endpgm
.section .rodata,"a"
.p2align 6
.amdhsa_kernel ln_kernel
  .amdhsa_next_free_vgpr 72
  .amdhsa_next_free_sgpr 80
  .amdhsa_accum_offset 72
  .amdhsa_group_segment_fixed_size 0
  .amdhsa_kernarg_size 96
  .amdhsa_user_sgpr_count 2
  .amdhsa_user_sgpr_kernarg_segment_ptr 1
  .amdhsa_system_sgpr_workgroup_id_x 1
  .amdhsa_float_denorm_mode_32 3
.end_amdhsa_kernel
.text

.text
.globl attn_kernel
.p2align 8
.type attn_kernel,@function
attn_kernel:

    s_cmp_ge_u32 s2, 256
    s_cbranch_scc1 L_k1_done
    s_load_dwordx4 s[40:43], s[0:1], 8
    s_load_dwordx2 s[44:45], s[0:1], 24
    s_load_dwordx4 s[48:51], s[0:1], 48
    s_load_dwordx2 s[46:47], s[0:1], 88
    s_load_dwordx2 s[52:53], s[0:1], 64
    s_load_dwordx2 s[56:57], s[0:1], 32
    v_lshrrev_b32 v1, 6, v0
    v_and_b32 v0, 63, v0
    v_readfirstlane_b32 s24, v1
    s_and_b32 s38, s2, 7
    s_lshl_b32 s38, s38, 2
    s_lshr_b32 s39, s2, 3
    s_and_b32 s39, s39, 3
    s_add_u32 s25, s38, s39
    s_lshr_b32 s26, s2, 5
    v_lshlrev_b32 v12, 4, v0
    s_mul_i32 s39, s25, 288
    s_lshl_b32 s27, s25, 8
    v_subrev_u32 v106, 52, v0
    v_subrev_u32 v107, 36, v0
    v_cmp_gt_u32 vcc, 52, v0
    v_mov_b32 v112, 8192
    v_mov_b32 v113, 9216
    v_cndmask_b32 v106, v106, v107, vcc
    v_lshl_add_u32 v106, v106, 4, s27
    v_subrev_u32 v107, 18, v0
    v_cmp_gt_u32 vcc, 18, v0
    s_mul_i32 s36, s24, 1056
    s_add_u32 s36, s36, 28672
    v_cndmask_b32 v107, v107, v0, vcc
    s_and_b32 s35, s25, 1
    s_lshl_b32 s35, s35, 1
    v_add_u32 v107, s35, v107
    v_subrev_u32 v108, 18, v107
    v_min_u32 v107, v107, v108
    v_lshl_add_u32 v107, v107, 4, s39
    s_lshl_b32 s38, s26, 4
    s_lshl_b32 s39, s24, 2
    s_add_u32 s38, s38, s39
    s_mul_i32 s39, s38, 18432
    v_add_u32 v6, s39, v12
    v_add_u32 v7, 18432, v6
    v_add_u32 v8, 36864, v6
    v_add_u32 v9, 55296, v6
    s_waitcnt lgkmcnt(0)
    v_mov_b32 v108, s50
    v_mov_b32 v109, s51
    v_mov_b32 v110, s48
    v_mov_b32 v111, s49
    v_cndmask_b32 v108, v108, v110, vcc
    v_cndmask_b32 v109, v109, v111, vcc
    v_cmp_gt_u32 vcc, 36, v0
    v_mov_b32 v110, s44
    v_mov_b32 v111, s45
    v_cndmask_b32 v108, v110, v108, vcc
    v_cndmask_b32 v109, v111, v109, vcc
    v_cndmask_b32 v106, v106, v107, vcc
    v_cndmask_b32 v112, v112, v113, vcc
    v_mul_lo_u32 v113, v112, s24
    v_add_u32 v106, v106, v113
    v_mov_b32 v107, 0
    v_lshl_add_u64 v[2:3], v[106:107], 0, v[108:109]
    v_lshlrev_b32 v4, 2, v112
    v_mov_b32 v5, 0
    s_add_u32 s12, s46, 0
    s_addc_u32 s13, s47, 0
    s_and_b32 s13, s13, 0xffff
    s_mov_b32 s14, 2359296
    s_mov_b32 s15, 0x20000
    s_mov_b32 s35, 0
    s_add_u32 m0, s36, 67584
    s_nop 0
    global_load_lds_dwordx4 v[2:3], off
    v_lshl_add_u64 v[2:3], v[4:5], 0, v[2:3]
    s_add_u32 m0, s36, 84480
    s_nop 0
    global_load_lds_dwordx4 v[2:3], off
    v_lshl_add_u64 v[2:3], v[4:5], 0, v[2:3]
    s_add_u32 m0, s36, 71808
    s_nop 0
    global_load_lds_dwordx4 v[2:3], off
    v_lshl_add_u64 v[2:3], v[4:5], 0, v[2:3]
    s_add_u32 m0, s36, 88704
    s_nop 0
    global_load_lds_dwordx4 v[2:3], off
    v_lshl_add_u64 v[2:3], v[4:5], 0, v[2:3]
    s_add_u32 m0, s36, 76032
    s_nop 0
    global_load_lds_dwordx4 v[2:3], off
    v_lshl_add_u64 v[2:3], v[4:5], 0, v[2:3]
    s_add_u32 m0, s36, 92928
    s_nop 0
    global_load_lds_dwordx4 v[2:3], off
    v_lshl_add_u64 v[2:3], v[4:5], 0, v[2:3]
    s_add_u32 m0, s36, 80256
    s_nop 0
    global_load_lds_dwordx4 v[2:3], off
    v_lshl_add_u64 v[2:3], v[4:5], 0, v[2:3]
    s_add_u32 m0, s36, 97152
    s_nop 0
    global_load_lds_dwordx4 v[2:3], off
    v_lshl_add_u64 v[2:3], v[4:5], 0, v[2:3]
    buffer_load_dwordx4 v[16:19], v6, s[12:15], s35 offen
    buffer_load_dwordx4 v[20:23], v7, s[12:15], s35 offen
    buffer_load_dwordx4 v[24:27], v8, s[12:15], s35 offen
    buffer_load_dwordx4 v[28:31], v9, s[12:15], s35 offen
    s_add_u32 s35, s35, 1024
    v_lshrrev_b32 v96, 4, v0
    v_and_b32 v97, 15, v0
    v_bfe_u32 v98, v0, 2, 2
    v_and_b32 v99, 3, v0
    v_lshl_add_u32 v100, v96, 2, v98
    v_mul_u32_u24 v100, 1056, v100
    v_lshl_add_u32 v101, v99, 3, v100
    v_lshl_add_u32 v102, v99, 4, v100
    v_add_u32 v64, 28672, v101
    v_add_u32 v68, 29248, v102
    v_add_u32 v65, 62464, v101
    v_add_u32 v69, 63040, v102
    v_add_u32 v66, 96256, v101
    v_add_u32 v70, 96832, v102
    v_add_u32 v67, 130048, v101
    v_add_u32 v71, 130624, v102
    s_getpc_b64 s[64:65]
L_k1_pc:
    s_add_u32 s64, s64, L_trans-L_k1_pc
    s_addc_u32 s65, s65, 0
    v_mov_b32 v104, 163808
    v_mov_b32 v108, 0
    v_mov_b32 v109, 0
    v_mov_b32 v110, 0
    v_mov_b32 v111, 0
    ds_write_b128 v104, v[108:111]
    s_waitcnt vmcnt(0)
    s_barrier
    ds_read_b64_tr_b16 v[48:49], v70 offset:0
    ds_read_b64_tr_b16 v[50:51], v70 offset:16896
    ds_read_b64_tr_b16 v[52:53], v70 offset:8
    ds_read_b64_tr_b16 v[54:55], v70 offset:16904
    ds_read_b64_tr_b16 v[56:57], v70 offset:64
    ds_read_b64_tr_b16 v[58:59], v70 offset:16960
    s_waitcnt lgkmcnt(4)
    v_mfma_f32_16x16x32_bf16 v[128:131], v[48:51], v[16:19], 0
    ds_read_b64_tr_b16 v[60:61], v70 offset:72
    s_lshl_b32 s39, s25, 19
    s_add_u32 s4, s40, s39
    s_addc_u32 s5, s41, 0
    v_mfma_f32_16x16x32_bf16 v[132:135], v[48:51], v[20:23], 0
    s_add_u32 m0, s36, 101376
    ds_read_b64_tr_b16 v[62:63], v70 offset:16968
    s_and_b32 s5, s5, 0xffff
    s_mov_b32 s6, 524288
    v_mfma_f32_16x16x32_bf16 v[136:139], v[48:51], v[24:27], 0
    global_load_lds_dwordx4 v[2:3], off
    v_mfma_f32_16x16x32_bf16 v[140:143], v[48:51], v[28:31], 0
    s_waitcnt lgkmcnt(4)
    v_lshl_add_u64 v[2:3], v[4:5], 0, v[2:3]
    s_mov_b32 s7, 0x20000
    s_add_u32 s8, s42, s39
    s_addc_u32 s9, s43, 0
    v_mfma_f32_16x16x32_bf16 v[144:147], v[52:55], v[16:19], 0
    ds_read_b64_tr_b16 v[48:49], v70 offset:128
    s_and_b32 s9, s9, 0xffff
    s_mov_b32 s10, 524288
    v_mfma_f32_16x16x32_bf16 v[148:151], v[52:55], v[20:23], 0
    s_add_u32 m0, s36, 118272
    ds_read_b64_tr_b16 v[50:51], v70 offset:17024
    s_mov_b32 s11, 0x20000
    s_and_b32 s39, s2, 1
    v_mfma_f32_16x16x32_bf16 v[152:155], v[52:55], v[24:27], 0
    global_load_lds_dwordx4 v[2:3], off
    v_mfma_f32_16x16x32_bf16 v[156:159], v[52:55], v[28:31], 0
    s_waitcnt lgkmcnt(4)
    v_lshl_add_u64 v[2:3], v[4:5], 0, v[2:3]
    s_xor_b32 s39, s39, 1
    s_lshl_b32 s39, s39, 1
    s_bfe_u32 s63, s2, 65538
    v_mfma_f32_16x16x32_bf16 v[160:163], v[56:59], v[16:19], 0
    ds_read_b64_tr_b16 v[52:53], v70 offset:136
    s_add_u32 s63, s63, s39
    s_bfe_u32 s62, s2, 65537
    v_mfma_f32_16x16x32_bf16 v[164:167], v[56:59], v[20:23], 0
    s_add_u32 m0, s36, 105600
    ds_read_b64_tr_b16 v[54:55], v70 offset:17032
    s_and_b32 s62, s63, 1
    s_lshr_b32 s39, s2, 3
    v_mfma_f32_16x16x32_bf16 v[168:171], v[56:59], v[24:27], 0
    global_load_lds_dwordx4 v[2:3], off
    v_mfma_f32_16x16x32_bf16 v[172:175], v[56:59], v[28:31], 0
    s_waitcnt lgkmcnt(4)
    v_lshl_add_u64 v[2:3], v[4:5], 0, v[2:3]
    s_lshl_b32 s62, s62, 5
    s_add_u32 s39, s39, s62
    s_cmp_lt_u32 s63, 2
    s_cselect_b32 s68, 16, 18
    s_cselect_b32 s62, 6291456, 0
    v_mfma_f32_16x16x32_bf16 v[176:179], v[60:63], v[16:19], 0
    ds_read_b64_tr_b16 v[56:57], v70 offset:192
    s_mul_i32 s68, s68, 4608
    s_mul_i32 s39, s39, s68
    v_mfma_f32_16x16x32_bf16 v[180:183], v[60:63], v[20:23], 0
    s_add_u32 m0, s36, 122496
    ds_read_b64_tr_b16 v[58:59], v70 offset:17088
    s_add_u32 s39, s39, s62
    s_add_u32 s39, s39, 46137344
    v_mfma_f32_16x16x32_bf16 v[184:187], v[60:63], v[24:27], 0
    global_load_lds_dwordx4 v[2:3], off
    v_mfma_f32_16x16x32_bf16 v[188:191], v[60:63], v[28:31], 0
    s_waitcnt lgkmcnt(4)
    v_lshl_add_u64 v[2:3], v[4:5], 0, v[2:3]
    s_add_u32 s66, s46, s39
    s_addc_u32 s67, s47, 0
    s_and_b32 s67, s67, 0xffff
    v_mfma_f32_16x16x32_bf16 v[192:195], v[48:51], v[16:19], 0
    ds_read_b64_tr_b16 v[60:61], v70 offset:200
    s_mov_b32 s69, s4
    s_mov_b32 s70, s5
    v_mfma_f32_16x16x32_bf16 v[196:199], v[48:51], v[20:23], 0
    s_add_u32 m0, s36, 109824
    ds_read_b64_tr_b16 v[62:63], v70 offset:17096
    s_mov_b32 s71, s8
    s_mov_b32 s72, s9
    v_mfma_f32_16x16x32_bf16 v[200:203], v[48:51], v[24:27], 0
    global_load_lds_dwordx4 v[2:3], off
    v_mfma_f32_16x16x32_bf16 v[204:207], v[48:51], v[28:31], 0
    s_waitcnt lgkmcnt(4)
    v_lshl_add_u64 v[2:3], v[4:5], 0, v[2:3]
    s_mul_i32 s39, s38, 147456
    s_add_u32 s39, s39, 4194304
    s_add_u32 s16, s46, s39
    s_addc_u32 s17, s47, 0
    v_mfma_f32_16x16x32_bf16 v[208:211], v[52:55], v[16:19], 0
    ds_read_b64_tr_b16 v[48:49], v66 offset:0
    s_and_b32 s17, s17, 0xffff
    s_mov_b32 s18, 589824
    v_mfma_f32_16x16x32_bf16 v[212:215], v[52:55], v[20:23], 0
    s_add_u32 m0, s36, 126720
    ds_read_b64_tr_b16 v[50:51], v66 offset:16896
    s_mov_b32 s19, 0x20000
    s_mul_i32 s39, s38, 131072
    v_mfma_f32_16x16x32_bf16 v[216:219], v[52:55], v[24:27], 0
    global_load_lds_dwordx4 v[2:3], off
    v_mfma_f32_16x16x32_bf16 v[220:223], v[52:55], v[28:31], 0
    s_waitcnt lgkmcnt(4)
    v_lshl_add_u64 v[2:3], v[4:5], 0, v[2:3]
    s_add_u32 s39, s39, 25165824
    s_add_u32 s20, s46, s39
    s_addc_u32 s21, s47, 0
    v_mfma_f32_16x16x32_bf16 v[224:227], v[56:59], v[16:19], 0
    ds_read_b64_tr_b16 v[52:53], v66 offset:288
    s_and_b32 s21, s21, 0xffff
    s_mov_b32 s22, 524288
    v_mfma_f32_16x16x32_bf16 v[228:231], v[56:59], v[20:23], 0
    s_add_u32 m0, s36, 114048
    ds_read_b64_tr_b16 v[54:55], v66 offset:17184
    s_mov_b32 s23, 0x20000
    s_mov_b32 s40, s56
    v_mfma_f32_16x16x32_bf16 v[232:235], v[56:59], v[24:27], 0
    global_load_lds_dwordx4 v[2:3], off
    v_mfma_f32_16x16x32_bf16 v[236:239], v[56:59], v[28:31], 0
    s_waitcnt lgkmcnt(4)
    v_lshl_add_u64 v[2:3], v[4:5], 0, v[2:3]
    s_and_b32 s41, s57, 0xffff
    s_mov_b32 s42, 4718592
    s_and_b32 s53, s53, 0xffff
    v_mfma_f32_16x16x32_bf16 v[240:243], v[60:63], v[16:19], 0
    ds_read_b64_tr_b16 v[56:57], v66 offset:32
    s_mov_b32 s54, 5308416
    s_mov_b32 s55, 0x20000
    v_mfma_f32_16x16x32_bf16 v[244:247], v[60:63], v[20:23], 0
    s_add_u32 m0, s36, 130944
    ds_read_b64_tr_b16 v[58:59], v66 offset:16928
    s_add_u32 s56, s46, 46137344
    s_addc_u32 s57, s47, 0
    v_mfma_f32_16x16x32_bf16 v[248:251], v[60:63], v[24:27], 0
    global_load_lds_dwordx4 v[2:3], off
    v_mfma_f32_16x16x32_bf16 v[252:255], v[60:63], v[28:31], 0
    s_waitcnt lgkmcnt(4)
    v_lshl_add_u64 v[2:3], v[4:5], 0, v[2:3]
    s_and_b32 s57, s57, 0xffff
    s_mov_b32 s58, 11010048
    s_mov_b32 s59, 0x20000
    v_mfma_f32_16x16x32_bf16 a[0:3], v[48:51], v[16:19], 0
    ds_read_b64_tr_b16 v[60:61], v66 offset:320
    s_lshl_b32 s39, s2, 2
    s_add_u32 s39, s39, s24
    v_mfma_f32_16x16x32_bf16 a[4:7], v[48:51], v[20:23], 0
    ds_read_b64_tr_b16 v[62:63], v66 offset:17216
    s_lshl_b32 s61, s39, 11
    s_sub_u32 s61, s61, 2097152
    v_mfma_f32_16x16x32_bf16 a[8:11], v[48:51], v[24:27], 0
    buffer_load_dwordx4 v[32:35], v6, s[12:15], s35 offen
    v_mfma_f32_16x16x32_bf16 a[12:15], v[48:51], v[28:31], 0
    s_waitcnt lgkmcnt(4)
    s_mul_i32 s63, s39, 7168
    s_add_u32 s63, s63, 58720256
    s_add_u32 s48, s46, s63
    s_addc_u32 s49, s47, 0
    v_mfma_f32_16x16x32_bf16 a[16:19], v[52:55], v[16:19], 0
    ds_read_b64_tr_b16 v[48:49], v66 offset:64
    s_and_b32 s49, s49, 0xffff
    s_mov_b32 s50, 7168
    v_mfma_f32_16x16x32_bf16 a[20:23], v[52:55], v[20:23], 0
    ds_read_b64_tr_b16 v[50:51], v66 offset:16960
    s_mov_b32 s51, 0x20000
    s_mov_b32 s45, 2048
    v_mfma_f32_16x16x32_bf16 a[24:27], v[52:55], v[24:27], 0
    buffer_load_dwordx4 v[36:39], v7, s[12:15], s35 offen
    v_mfma_f32_16x16x32_bf16 a[28:31], v[52:55], v[28:31], 0
    s_waitcnt lgkmcnt(4)
    s_mul_i32 s63, s39, 3641
    s_lshr_b32 s63, s63, 16
    s_mul_i32 s3, s63, 18
    v_mfma_f32_16x16x32_bf16 a[32:35], v[56:59], v[16:19], 0
    ds_read_b64_tr_b16 v[52:53], v66 offset:352
    s_sub_u32 s3, s39, s3
    s_mul_i32 s33, s63, 36864
    v_mfma_f32_16x16x32_bf16 a[36:39], v[56:59], v[20:23], 0
    ds_read_b64_tr_b16 v[54:55], v66 offset:17248
    s_lshl_b32 s63, s3, 6
    s_add_u32 s33, s33, s63
    v_mfma_f32_16x16x32_bf16 a[40:43], v[56:59], v[24:27], 0
    buffer_load_dwordx4 v[40:43], v8, s[12:15], s35 offen
    v_mfma_f32_16x16x32_bf16 a[44:47], v[56:59], v[28:31], 0
    s_waitcnt lgkmcnt(4)
    s_mov_b32 s60, s33
    s_mov_b32 s62, s3
    s_lshl_b32 s43, s24, 11
    v_mfma_f32_16x16x32_bf16 a[48:51], v[60:63], v[16:19], 0
    ds_read_b64_tr_b16 v[56:57], v66 offset:96
    s_add_u32 s43, s43, 131072
    v_lshrrev_b32 v100, 2, v0
    v_mfma_f32_16x16x32_bf16 a[52:55], v[60:63], v[20:23], 0
    ds_read_b64_tr_b16 v[58:59], v66 offset:16992
    v_mul_u32_u24 v100, 1152, v100
    v_lshl_add_u32 v13, v99, 4, v100
    v_mfma_f32_16x16x32_bf16 a[56:59], v[60:63], v[24:27], 0
    buffer_load_dwordx4 v[44:47], v9, s[12:15], s35 offen
    v_mfma_f32_16x16x32_bf16 a[60:63], v[60:63], v[28:31], 0
    s_waitcnt lgkmcnt(4)
    v_lshl_add_u32 v100, v96, 2, v98
    v_lshlrev_b32 v100, 6, v100
    v_lshl_add_u32 v100, v99, 3, v100
    v_mfma_f32_16x16x32_bf16 a[64:67], v[48:51], v[16:19], 0
    s_add_u32 s35, s35, 1024
    ds_read_b64_tr_b16 v[60:61], v66 offset:384
    v_add_u32 v14, s43, v100
    s_lshl_b32 s29, s24, 12
    v_mfma_f32_16x16x32_bf16 a[68:71], v[48:51], v[20:23], 0
    s_add_u32 m0, s36, 0
    ds_read_b64_tr_b16 v[62:63], v66 offset:17280
    s_mov_b32 s30, 0x6c800000
    s_mov_b32 s34, 0x3e0293ee
    v_mfma_f32_16x16x32_bf16 a[72:75], v[48:51], v[24:27], 0
    global_load_lds_dwordx4 v[2:3], off
    v_mfma_f32_16x16x32_bf16 a[76:79], v[48:51], v[28:31], 0
    s_waitcnt lgkmcnt(4)
    v_lshl_add_u64 v[2:3], v[4:5], 0, v[2:3]
    s_lshl_b32 s39, s24, 4
    v_add_u32 v100, s39, v96
    v_lshlrev_b32 v100, 8, v100
    v_mfma_f32_16x16x32_bf16 a[80:83], v[52:55], v[16:19], 0
    ds_read_b64_tr_b16 v[48:49], v66 offset:128
    s_lshl_b32 s39, s24, 2
    v_add_u32 v101, s39, v96
    v_mfma_f32_16x16x32_bf16 a[84:87], v[52:55], v[20:23], 0
    s_add_u32 m0, s36, 16896
    ds_read_b64_tr_b16 v[50:51], v66 offset:17024
    v_xor_b32 v101, v101, v97
    v_lshl_add_u32 v10, v101, 4, v100
    v_mfma_f32_16x16x32_bf16 a[88:91], v[52:55], v[24:27], 0
    global_load_lds_dwordx4 v[2:3], off
    v_mfma_f32_16x16x32_bf16 a[92:95], v[52:55], v[28:31], 0
    s_waitcnt lgkmcnt(4)
    v_lshl_add_u64 v[2:3], v[4:5], 0, v[2:3]
    s_and_b32 s39, s24, 1
    s_lshl_b32 s39, s39, 1
    v_lshl_add_u32 v101, v96, 2, s39
    v_mfma_f32_16x16x32_bf16 a[96:99], v[56:59], v[16:19], 0
    ds_read_b64_tr_b16 v[52:53], v66 offset:416
    v_xor_b32 v101, v101, v97
    v_lshl_add_u32 v11, v101, 4, v100
    v_mfma_f32_16x16x32_bf16 a[100:103], v[56:59], v[20:23], 0
    s_add_u32 m0, s36, 4224
    ds_read_b64_tr_b16 v[54:55], v66 offset:17312
    v_lshl_add_u32 v100, v98, 4, v99
    v_lshlrev_b32 v100, 8, v100
    v_mfma_f32_16x16x32_bf16 a[104:107], v[56:59], v[24:27], 0
    global_load_lds_dwordx4 v[2:3], off
    v_mfma_f32_16x16x32_bf16 a[108:111], v[56:59], v[28:31], 0
    s_waitcnt lgkmcnt(4)
    v_lshl_add_u64 v[2:3], v[4:5], 0, v[2:3]
    v_xor_b32 v101, v96, v97
    v_xor_b32 v102, 0, v101
    v_lshl_add_u32 v80, v102, 4, v100
    v_mfma_f32_16x16x32_bf16 a[112:115], v[60:63], v[16:19], 0
    ds_read_b64_tr_b16 v[56:57], v66 offset:160
    v_xor_b32 v102, 4, v101
    v_lshl_add_u32 v81, v102, 4, v100
    v_mfma_f32_16x16x32_bf16 a[116:119], v[60:63], v[20:23], 0
    s_add_u32 m0, s36, 21120
    ds_read_b64_tr_b16 v[58:59], v66 offset:17056
    v_xor_b32 v102, 8, v101
    v_lshl_add_u32 v82, v102, 4, v100
    v_mfma_f32_16x16x32_bf16 a[120:123], v[60:63], v[24:27], 0
    global_load_lds_dwordx4 v[2:3], off
    v_mfma_f32_16x16x32_bf16 a[124:127], v[60:63], v[28:31], 0
    s_waitcnt lgkmcnt(4)
    v_lshl_add_u64 v[2:3], v[4:5], 0, v[2:3]
    v_xor_b32 v102, 12, v101
    v_lshl_add_u32 v83, v102, 4, v100
    v_lshl_add_u32 v100, v96, 4, v98
    v_mfma_f32_16x16x32_bf16 a[128:131], v[48:51], v[16:19], 0
    ds_read_b64_tr_b16 v[60:61], v66 offset:448
    v_lshlrev_b32 v100, 8, v100
    v_lshl_add_u32 v100, v99, 3, v100
    v_mfma_f32_16x16x32_bf16 a[132:135], v[48:51], v[20:23], 0
    s_add_u32 m0, s36, 8448
    ds_read_b64_tr_b16 v[62:63], v66 offset:17344
    v_add_u32 v100, 65536, v100
    v_and_b32 v101, 1, v96
    v_mfma_f32_16x16x32_bf16 a[136:139], v[48:51], v[24:27], 0
    global_load_lds_dwordx4 v[2:3], off
    v_mfma_f32_16x16x32_bf16 a[140:143], v[48:51], v[28:31], 0
    s_waitcnt lgkmcnt(4)
    v_lshl_add_u64 v[2:3], v[4:5], 0, v[2:3]
    v_lshl_add_u32 v101, v98, 1, v101
    v_xor_b32 v102, 0, v101
    v_lshl_add_u32 v84, v102, 5, v100
    v_mfma_f32_16x16x32_bf16 a[144:147], v[52:55], v[16:19], 0
    ds_read_b64_tr_b16 v[48:49], v66 offset:192
    v_xor_b32 v102, 1, v101
    v_lshl_add_u32 v85, v102, 5, v100
    v_mfma_f32_16x16x32_bf16 a[148:151], v[52:55], v[20:23], 0
    s_add_u32 m0, s36, 25344
    ds_read_b64_tr_b16 v[50:51], v66 offset:17088
    v_xor_b32 v102, 2, v101
    v_lshl_add_u32 v86, v102, 5, v100
    v_mfma_f32_16x16x32_bf16 a[152:155], v[52:55], v[24:27], 0
    global_load_lds_dwordx4 v[2:3], off
    v_mfma_f32_16x16x32_bf16 a[156:159], v[52:55], v[28:31], 0
    s_waitcnt lgkmcnt(4)
    v_lshl_add_u64 v[2:3], v[4:5], 0, v[2:3]
    v_xor_b32 v102, 3, v101
    v_lshl_add_u32 v87, v102, 5, v100
    v_xor_b32 v102, 4, v101
    v_mfma_f32_16x16x32_bf16 a[160:163], v[56:59], v[16:19], 0
    ds_read_b64_tr_b16 v[52:53], v66 offset:480
    v_lshl_add_u32 v88, v102, 5, v100
    v_xor_b32 v102, 5, v101
    v_mfma_f32_16x16x32_bf16 a[164:167], v[56:59], v[20:23], 0
    s_add_u32 m0, s36, 12672
    ds_read_b64_tr_b16 v[54:55], v66 offset:17376
    v_lshl_add_u32 v89, v102, 5, v100
    v_xor_b32 v102, 6, v101
    v_mfma_f32_16x16x32_bf16 a[168:171], v[56:59], v[24:27], 0
    global_load_lds_dwordx4 v[2:3], off
    v_mfma_f32_16x16x32_bf16 a[172:175], v[56:59], v[28:31], 0
    s_waitcnt lgkmcnt(4)
    v_lshl_add_u64 v[2:3], v[4:5], 0, v[2:3]
    v_lshl_add_u32 v90, v102, 5, v100
    v_xor_b32 v102, 7, v101
    v_lshl_add_u32 v91, v102, 5, v100
    v_mfma_f32_16x16x32_bf16 a[176:179], v[60:63], v[16:19], 0
    ds_read_b64_tr_b16 v[56:57], v66 offset:224
    v_mov_b32 v92, 0x3f803f80
    v_mov_b32 v93, 0x3f803f80
    v_mfma_f32_16x16x32_bf16 a[180:183], v[60:63], v[20:23], 0
    s_add_u32 m0, s36, 29568
    ds_read_b64_tr_b16 v[58:59], v66 offset:17120
    v_mov_b32 v94, 0x3f803f80
    v_mov_b32 v95, 0x3f803f80
    v_mfma_f32_16x16x32_bf16 a[184:187], v[60:63], v[24:27], 0
    global_load_lds_dwordx4 v[2:3], off
    v_mfma_f32_16x16x32_bf16 a[188:191], v[60:63], v[28:31], 0
    s_waitcnt lgkmcnt(4)
    v_lshl_add_u64 v[2:3], v[4:5], 0, v[2:3]
    v_and_b32 v100, 1, v0
    v_sub_u32 v100, 0, v100
    v_and_b32 v100, 0xaaaaaaaa, v100
    v_mfma_f32_16x16x32_bf16 a[192:195], v[48:51], v[16:19], 0
    ds_read_b64_tr_b16 v[60:61], v66 offset:512
    v_or_b32 v15, 0x44444444, v100
    s_mul_i32 s28, s25, 16384
    v_mfma_f32_16x16x32_bf16 a[196:199], v[48:51], v[20:23], 0
    ds_read_b64_tr_b16 v[62:63], v66 offset:17408
    s_and_b32 s28, s28, 0x7ffff
    s_mov_b32 s37, s28
    v_mfma_f32_16x16x32_bf16 a[200:203], v[48:51], v[24:27], 0
    s_bfe_u32 s44, s2, 0x10003
    s_lshl_b32 s44, s44, 2
    v_mfma_f32_16x16x32_bf16 a[204:207], v[48:51], v[28:31], 0
    s_waitcnt lgkmcnt(4)
    s_add_u32 s44, s44, s24
    s_lshl_b32 s44, s44, 12
    v_lshl_add_u32 v100, v12, 2, s44
    v_mfma_f32_16x16x32_bf16 a[208:211], v[52:55], v[16:19], 0
    ds_read_b64_tr_b16 v[48:49], v66 offset:256
    v_mov_b32 v101, 0
    v_mov_b32 v102, s64
    v_mfma_f32_16x16x32_bf16 a[212:215], v[52:55], v[20:23], 0
    ds_read_b64_tr_b16 v[50:51], v66 offset:17152
    v_mov_b32 v103, s65
    v_lshl_add_u64 v[76:77], v[100:101], 0, v[102:103]
    v_mfma_f32_16x16x32_bf16 a[216:219], v[52:55], v[24:27], 0
    s_mul_i32 s38, s25, 9
    s_and_b32 s39, s25, 1
    v_mfma_f32_16x16x32_bf16 a[220:223], v[52:55], v[28:31], 0
    s_waitcnt lgkmcnt(4)
    s_add_u32 s31, s38, s39
    s_lshl_b32 s31, s31, 9
    s_mul_i32 s39, s39, 5112
    v_mfma_f32_16x16x32_bf16 a[224:227], v[56:59], v[16:19], 0
    ds_read_b64_tr_b16 v[52:53], v66 offset:544
    s_add_u32 s32, s31, 4096
    s_sub_u32 s32, s32, s39
    v_mfma_f32_16x16x32_bf16 a[228:231], v[56:59], v[20:23], 0
    ds_read_b64_tr_b16 v[54:55], v66 offset:17440
    v_mfma_f32_16x16x32_bf16 a[232:235], v[56:59], v[24:27], 0
    s_waitcnt vmcnt(12)
    s_barrier
    v_mfma_f32_16x16x32_bf16 a[236:239], v[56:59], v[28:31], 0
    s_waitcnt lgkmcnt(4)
    v_mfma_f32_16x16x32_bf16 a[240:243], v[60:63], v[16:19], 0
    ds_read_b64_tr_b16 v[56:57], v71 offset:0
    v_mfma_f32_16x16x32_bf16 a[244:247], v[60:63], v[20:23], 0
    ds_read_b64_tr_b16 v[58:59], v71 offset:16896
    v_mfma_f32_16x16x32_bf16 a[248:251], v[60:63], v[24:27], 0
    v_mfma_f32_16x16x32_bf16 a[252:255], v[60:63], v[28:31], 0
    s_waitcnt lgkmcnt(4)
    v_mfma_f32_16x16x32_bf16 v[96:99], v[48:51], v[16:19], 0
    ds_read_b64_tr_b16 v[60:61], v71 offset:8
    v_mfma_f32_16x16x32_bf16 v[100:103], v[48:51], v[20:23], 0
    ds_read_b64_tr_b16 v[62:63], v71 offset:16904
    v_mfma_f32_16x16x32_bf16 v[104:107], v[48:51], v[24:27], 0
    v_mfma_f32_16x16x32_bf16 v[108:111], v[48:51], v[28:31], 0
    s_waitcnt lgkmcnt(4)
    v_mfma_f32_16x16x32_bf16 v[112:115], v[52:55], v[16:19], 0
    ds_read_b64_tr_b16 v[48:49], v71 offset:64
    v_mfma_f32_16x16x32_bf16 v[116:119], v[52:55], v[20:23], 0
    ds_read_b64_tr_b16 v[50:51], v71 offset:16960
    v_mfma_f32_16x16x32_bf16 v[120:123], v[52:55], v[24:27], 0
    s_waitcnt vmcnt(8)
    v_mfma_f32_16x16x32_bf16 v[124:127], v[52:55], v[28:31], 0
    s_waitcnt lgkmcnt(4)
    s_mov_b32 s27, 3
.p2align 6
L_proj:
    v_mfma_f32_16x16x32_bf16 v[128:131], v[56:59], v[32:35], v[128:131]
    ds_read_b64_tr_b16 v[52:53], v71 offset:72
    v_mfma_f32_16x16x32_bf16 v[132:135], v[56:59], v[36:39], v[132:135]
    ds_read_b64_tr_b16 v[54:55], v71 offset:16968
    v_mfma_f32_16x16x32_bf16 v[136:139], v[56:59], v[40:43], v[136:139]
    buffer_load_dwordx4 v[16:19], v6, s[12:15], s35 offen
    v_mfma_f32_16x16x32_bf16 v[140:143], v[56:59], v[44:47], v[140:143]
    s_waitcnt lgkmcnt(4)
    v_mfma_f32_16x16x32_bf16 v[144:147], v[60:63], v[32:35], v[144:147]
    ds_read_b64_tr_b16 v[56:57], v71 offset:128
    v_mfma_f32_16x16x32_bf16 v[148:151], v[60:63], v[36:39], v[148:151]
    ds_read_b64_tr_b16 v[58:59], v71 offset:17024
    v_mfma_f32_16x16x32_bf16 v[152:155], v[60:63], v[40:43], v[152:155]
    buffer_load_dwordx4 v[20:23], v7, s[12:15], s35 offen
    v_mfma_f32_16x16x32_bf16 v[156:159], v[60:63], v[44:47], v[156:159]
    s_waitcnt lgkmcnt(4)
    v_mfma_f32_16x16x32_bf16 v[160:163], v[48:51], v[32:35], v[160:163]
    ds_read_b64_tr_b16 v[60:61], v71 offset:136
    v_mfma_f32_16x16x32_bf16 v[164:167], v[48:51], v[36:39], v[164:167]
    ds_read_b64_tr_b16 v[62:63], v71 offset:17032
    v_mfma_f32_16x16x32_bf16 v[168:171], v[48:51], v[40:43], v[168:171]
    buffer_load_dwordx4 v[24:27], v8, s[12:15], s35 offen
    v_mfma_f32_16x16x32_bf16 v[172:175], v[48:51], v[44:47], v[172:175]
    s_waitcnt lgkmcnt(4)
    v_mfma_f32_16x16x32_bf16 v[176:179], v[52:55], v[32:35], v[176:179]
    ds_read_b64_tr_b16 v[48:49], v71 offset:192
    v_mfma_f32_16x16x32_bf16 v[180:183], v[52:55], v[36:39], v[180:183]
    ds_read_b64_tr_b16 v[50:51], v71 offset:17088
    v_mfma_f32_16x16x32_bf16 v[184:187], v[52:55], v[40:43], v[184:187]
    buffer_load_dwordx4 v[28:31], v9, s[12:15], s35 offen
    v_mfma_f32_16x16x32_bf16 v[188:191], v[52:55], v[44:47], v[188:191]
    s_waitcnt lgkmcnt(4)
    v_mfma_f32_16x16x32_bf16 v[192:195], v[56:59], v[32:35], v[192:195]
    s_add_u32 s35, s35, 1024
    ds_read_b64_tr_b16 v[52:53], v71 offset:200
    v_mfma_f32_16x16x32_bf16 v[196:199], v[56:59], v[36:39], v[196:199]
    s_add_u32 m0, s36, 33792
    ds_read_b64_tr_b16 v[54:55], v71 offset:17096
    v_mfma_f32_16x16x32_bf16 v[200:203], v[56:59], v[40:43], v[200:203]
    global_load_lds_dwordx4 v[2:3], off
    v_mfma_f32_16x16x32_bf16 v[204:207], v[56:59], v[44:47], v[204:207]
    s_waitcnt lgkmcnt(4)
    v_lshl_add_u64 v[2:3], v[4:5], 0, v[2:3]
    v_mfma_f32_16x16x32_bf16 v[208:211], v[60:63], v[32:35], v[208:211]
    ds_read_b64_tr_b16 v[56:57], v67 offset:0
    v_mfma_f32_16x16x32_bf16 v[212:215], v[60:63], v[36:39], v[212:215]
    s_add_u32 m0, s36, 50688
    ds_read_b64_tr_b16 v[58:59], v67 offset:16896
    v_mfma_f32_16x16x32_bf16 v[216:219], v[60:63], v[40:43], v[216:219]
    global_load_lds_dwordx4 v[2:3], off
    v_mfma_f32_16x16x32_bf16 v[220:223], v[60:63], v[44:47], v[220:223]
    s_waitcnt lgkmcnt(4)
    v_lshl_add_u64 v[2:3], v[4:5], 0, v[2:3]
    v_mfma_f32_16x16x32_bf16 v[224:227], v[48:51], v[32:35], v[224:227]
    ds_read_b64_tr_b16 v[60:61], v67 offset:288
    v_mfma_f32_16x16x32_bf16 v[228:231], v[48:51], v[36:39], v[228:231]
    s_add_u32 m0, s36, 38016
    ds_read_b64_tr_b16 v[62:63], v67 offset:17184
    v_mfma_f32_16x16x32_bf16 v[232:235], v[48:51], v[40:43], v[232:235]
    global_load_lds_dwordx4 v[2:3], off
    v_mfma_f32_16x16x32_bf16 v[236:239], v[48:51], v[44:47], v[236:239]
    s_waitcnt lgkmcnt(4)
    v_lshl_add_u64 v[2:3], v[4:5], 0, v[2:3]
    v_mfma_f32_16x16x32_bf16 v[240:243], v[52:55], v[32:35], v[240:243]
    ds_read_b64_tr_b16 v[48:49], v67 offset:32
    v_mfma_f32_16x16x32_bf16 v[244:247], v[52:55], v[36:39], v[244:247]
    s_add_u32 m0, s36, 54912
    ds_read_b64_tr_b16 v[50:51], v67 offset:16928
    v_mfma_f32_16x16x32_bf16 v[248:251], v[52:55], v[40:43], v[248:251]
    global_load_lds_dwordx4 v[2:3], off
    v_mfma_f32_16x16x32_bf16 v[252:255], v[52:55], v[44:47], v[252:255]
    s_waitcnt lgkmcnt(4)
    v_lshl_add_u64 v[2:3], v[4:5], 0, v[2:3]
    v_mfma_f32_16x16x32_bf16 a[0:3], v[56:59], v[32:35], a[0:3]
    ds_read_b64_tr_b16 v[52:53], v67 offset:320
    v_mfma_f32_16x16x32_bf16 a[4:7], v[56:59], v[36:39], a[4:7]
    s_add_u32 m0, s36, 42240
    ds_read_b64_tr_b16 v[54:55], v67 offset:17216
    v_mfma_f32_16x16x32_bf16 a[8:11], v[56:59], v[40:43], a[8:11]
    global_load_lds_dwordx4 v[2:3], off
    v_mfma_f32_16x16x32_bf16 a[12:15], v[56:59], v[44:47], a[12:15]
    s_waitcnt lgkmcnt(4)
    v_lshl_add_u64 v[2:3], v[4:5], 0, v[2:3]
    v_mfma_f32_16x16x32_bf16 a[16:19], v[60:63], v[32:35], a[16:19]
    ds_read_b64_tr_b16 v[56:57], v67 offset:64
    v_mfma_f32_16x16x32_bf16 a[20:23], v[60:63], v[36:39], a[20:23]
    s_add_u32 m0, s36, 59136
    ds_read_b64_tr_b16 v[58:59], v67 offset:16960
    v_mfma_f32_16x16x32_bf16 a[24:27], v[60:63], v[40:43], a[24:27]
    global_load_lds_dwordx4 v[2:3], off
    v_mfma_f32_16x16x32_bf16 a[28:31], v[60:63], v[44:47], a[28:31]
    s_waitcnt lgkmcnt(4)
    v_lshl_add_u64 v[2:3], v[4:5], 0, v[2:3]
    v_mfma_f32_16x16x32_bf16 a[32:35], v[48:51], v[32:35], a[32:35]
    ds_read_b64_tr_b16 v[60:61], v67 offset:352
    v_mfma_f32_16x16x32_bf16 a[36:39], v[48:51], v[36:39], a[36:39]
    s_add_u32 m0, s36, 46464
    ds_read_b64_tr_b16 v[62:63], v67 offset:17248
    v_mfma_f32_16x16x32_bf16 a[40:43], v[48:51], v[40:43], a[40:43]
    global_load_lds_dwordx4 v[2:3], off
    v_mfma_f32_16x16x32_bf16 a[44:47], v[48:51], v[44:47], a[44:47]
    s_waitcnt lgkmcnt(4)
    v_lshl_add_u64 v[2:3], v[4:5], 0, v[2:3]
    v_mfma_f32_16x16x32_bf16 a[48:51], v[52:55], v[32:35], a[48:51]
    ds_read_b64_tr_b16 v[48:49], v67 offset:96
    v_mfma_f32_16x16x32_bf16 a[52:55], v[52:55], v[36:39], a[52:55]
    s_add_u32 m0, s36, 63360
    ds_read_b64_tr_b16 v[50:51], v67 offset:16992
    v_mfma_f32_16x16x32_bf16 a[56:59], v[52:55], v[40:43], a[56:59]
    global_load_lds_dwordx4 v[2:3], off
    v_mfma_f32_16x16x32_bf16 a[60:63], v[52:55], v[44:47], a[60:63]
    s_waitcnt lgkmcnt(4)
    v_lshl_add_u64 v[2:3], v[4:5], 0, v[2:3]
    v_mfma_f32_16x16x32_bf16 a[64:67], v[56:59], v[32:35], a[64:67]
    ds_read_b64_tr_b16 v[52:53], v67 offset:384
    v_mfma_f32_16x16x32_bf16 a[68:71], v[56:59], v[36:39], a[68:71]
    ds_read_b64_tr_b16 v[54:55], v67 offset:17280
    v_mfma_f32_16x16x32_bf16 a[72:75], v[56:59], v[40:43], a[72:75]
    v_mfma_f32_16x16x32_bf16 a[76:79], v[56:59], v[44:47], a[76:79]
    s_waitcnt lgkmcnt(4)
    v_mfma_f32_16x16x32_bf16 a[80:83], v[60:63], v[32:35], a[80:83]
    ds_read_b64_tr_b16 v[56:57], v67 offset:128
    v_mfma_f32_16x16x32_bf16 a[84:87], v[60:63], v[36:39], a[84:87]
    ds_read_b64_tr_b16 v[58:59], v67 offset:17024
    v_mfma_f32_16x16x32_bf16 a[88:91], v[60:63], v[40:43], a[88:91]
    v_mfma_f32_16x16x32_bf16 a[92:95], v[60:63], v[44:47], a[92:95]
    s_waitcnt lgkmcnt(4)
    v_mfma_f32_16x16x32_bf16 a[96:99], v[48:51], v[32:35], a[96:99]
    ds_read_b64_tr_b16 v[60:61], v67 offset:416
    v_mfma_f32_16x16x32_bf16 a[100:103], v[48:51], v[36:39], a[100:103]
    ds_read_b64_tr_b16 v[62:63], v67 offset:17312
    v_mfma_f32_16x16x32_bf16 a[104:107], v[48:51], v[40:43], a[104:107]
    v_mfma_f32_16x16x32_bf16 a[108:111], v[48:51], v[44:47], a[108:111]
    s_waitcnt lgkmcnt(4)
    v_mfma_f32_16x16x32_bf16 a[112:115], v[52:55], v[32:35], a[112:115]
    ds_read_b64_tr_b16 v[48:49], v67 offset:160
    v_mfma_f32_16x16x32_bf16 a[116:119], v[52:55], v[36:39], a[116:119]
    ds_read_b64_tr_b16 v[50:51], v67 offset:17056
    v_mfma_f32_16x16x32_bf16 a[120:123], v[52:55], v[40:43], a[120:123]
    v_mfma_f32_16x16x32_bf16 a[124:127], v[52:55], v[44:47], a[124:127]
    s_waitcnt lgkmcnt(4)
    v_mfma_f32_16x16x32_bf16 a[128:131], v[56:59], v[32:35], a[128:131]
    ds_read_b64_tr_b16 v[52:53], v67 offset:448
    v_mfma_f32_16x16x32_bf16 a[132:135], v[56:59], v[36:39], a[132:135]
    ds_read_b64_tr_b16 v[54:55], v67 offset:17344
    v_mfma_f32_16x16x32_bf16 a[136:139], v[56:59], v[40:43], a[136:139]
    v_mfma_f32_16x16x32_bf16 a[140:143], v[56:59], v[44:47], a[140:143]
    s_waitcnt lgkmcnt(4)
    v_mfma_f32_16x16x32_bf16 a[144:147], v[60:63], v[32:35], a[144:147]
    ds_read_b64_tr_b16 v[56:57], v67 offset:192
    v_mfma_f32_16x16x32_bf16 a[148:151], v[60:63], v[36:39], a[148:151]
    ds_read_b64_tr_b16 v[58:59], v67 offset:17088
    v_mfma_f32_16x16x32_bf16 a[152:155], v[60:63], v[40:43], a[152:155]
    v_mfma_f32_16x16x32_bf16 a[156:159], v[60:63], v[44:47], a[156:159]
    s_waitcnt lgkmcnt(4)
    v_mfma_f32_16x16x32_bf16 a[160:163], v[48:51], v[32:35], a[160:163]
    ds_read_b64_tr_b16 v[60:61], v67 offset:480
    v_mfma_f32_16x16x32_bf16 a[164:167], v[48:51], v[36:39], a[164:167]
    ds_read_b64_tr_b16 v[62:63], v67 offset:17376
    v_mfma_f32_16x16x32_bf16 a[168:171], v[48:51], v[40:43], a[168:171]
    v_mfma_f32_16x16x32_bf16 a[172:175], v[48:51], v[44:47], a[172:175]
    s_waitcnt lgkmcnt(4)
    v_mfma_f32_16x16x32_bf16 a[176:179], v[52:55], v[32:35], a[176:179]
    ds_read_b64_tr_b16 v[48:49], v67 offset:224
    v_mfma_f32_16x16x32_bf16 a[180:183], v[52:55], v[36:39], a[180:183]
    ds_read_b64_tr_b16 v[50:51], v67 offset:17120
    v_mfma_f32_16x16x32_bf16 a[184:187], v[52:55], v[40:43], a[184:187]
    v_mfma_f32_16x16x32_bf16 a[188:191], v[52:55], v[44:47], a[188:191]
    s_waitcnt lgkmcnt(4)
    v_mfma_f32_16x16x32_bf16 a[192:195], v[56:59], v[32:35], a[192:195]
    ds_read_b64_tr_b16 v[52:53], v67 offset:512
    v_mfma_f32_16x16x32_bf16 a[196:199], v[56:59], v[36:39], a[196:199]
    ds_read_b64_tr_b16 v[54:55], v67 offset:17408
    v_mfma_f32_16x16x32_bf16 a[200:203], v[56:59], v[40:43], a[200:203]
    v_mfma_f32_16x16x32_bf16 a[204:207], v[56:59], v[44:47], a[204:207]
    s_waitcnt lgkmcnt(4)
    v_mfma_f32_16x16x32_bf16 a[208:211], v[60:63], v[32:35], a[208:211]
    ds_read_b64_tr_b16 v[56:57], v67 offset:256
    v_mfma_f32_16x16x32_bf16 a[212:215], v[60:63], v[36:39], a[212:215]
    ds_read_b64_tr_b16 v[58:59], v67 offset:17152
    v_mfma_f32_16x16x32_bf16 a[216:219], v[60:63], v[40:43], a[216:219]
    v_mfma_f32_16x16x32_bf16 a[220:223], v[60:63], v[44:47], a[220:223]
    s_waitcnt lgkmcnt(4)
    v_mfma_f32_16x16x32_bf16 a[224:227], v[48:51], v[32:35], a[224:227]
    ds_read_b64_tr_b16 v[60:61], v67 offset:544
    v_mfma_f32_16x16x32_bf16 a[228:231], v[48:51], v[36:39], a[228:231]
    ds_read_b64_tr_b16 v[62:63], v67 offset:17440
    v_mfma_f32_16x16x32_bf16 a[232:235], v[48:51], v[40:43], a[232:235]
    s_waitcnt vmcnt(12)
    s_barrier
    v_mfma_f32_16x16x32_bf16 a[236:239], v[48:51], v[44:47], a[236:239]
    s_waitcnt lgkmcnt(4)
    v_mfma_f32_16x16x32_bf16 a[240:243], v[52:55], v[32:35], a[240:243]
    ds_read_b64_tr_b16 v[48:49], v68 offset:0
    v_mfma_f32_16x16x32_bf16 a[244:247], v[52:55], v[36:39], a[244:247]
    ds_read_b64_tr_b16 v[50:51], v68 offset:16896
    v_mfma_f32_16x16x32_bf16 a[248:251], v[52:55], v[40:43], a[248:251]
    v_mfma_f32_16x16x32_bf16 a[252:255], v[52:55], v[44:47], a[252:255]
    s_waitcnt lgkmcnt(4)
    v_mfma_f32_16x16x32_bf16 v[96:99], v[56:59], v[32:35], v[96:99]
    ds_read_b64_tr_b16 v[52:53], v68 offset:8
    v_mfma_f32_16x16x32_bf16 v[100:103], v[56:59], v[36:39], v[100:103]
    ds_read_b64_tr_b16 v[54:55], v68 offset:16904
    v_mfma_f32_16x16x32_bf16 v[104:107], v[56:59], v[40:43], v[104:107]
    v_mfma_f32_16x16x32_bf16 v[108:111], v[56:59], v[44:47], v[108:111]
    s_waitcnt lgkmcnt(4)
    v_mfma_f32_16x16x32_bf16 v[112:115], v[60:63], v[32:35], v[112:115]
    ds_read_b64_tr_b16 v[56:57], v68 offset:64
    v_mfma_f32_16x16x32_bf16 v[116:119], v[60:63], v[36:39], v[116:119]
    ds_read_b64_tr_b16 v[58:59], v68 offset:16960
    v_mfma_f32_16x16x32_bf16 v[120:123], v[60:63], v[40:43], v[120:123]
    s_waitcnt vmcnt(8)
    v_mfma_f32_16x16x32_bf16 v[124:127], v[60:63], v[44:47], v[124:127]
    s_waitcnt lgkmcnt(4)
    v_mfma_f32_16x16x32_bf16 v[128:131], v[48:51], v[16:19], v[128:131]
    ds_read_b64_tr_b16 v[60:61], v68 offset:72
    v_mfma_f32_16x16x32_bf16 v[132:135], v[48:51], v[20:23], v[132:135]
    ds_read_b64_tr_b16 v[62:63], v68 offset:16968
    v_mfma_f32_16x16x32_bf16 v[136:139], v[48:51], v[24:27], v[136:139]
    buffer_load_dwordx4 v[32:35], v6, s[12:15], s35 offen
    v_mfma_f32_16x16x32_bf16 v[140:143], v[48:51], v[28:31], v[140:143]
    s_waitcnt lgkmcnt(4)
    v_mfma_f32_16x16x32_bf16 v[144:147], v[52:55], v[16:19], v[144:147]
    ds_read_b64_tr_b16 v[48:49], v68 offset:128
    v_mfma_f32_16x16x32_bf16 v[148:151], v[52:55], v[20:23], v[148:151]
    ds_read_b64_tr_b16 v[50:51], v68 offset:17024
    v_mfma_f32_16x16x32_bf16 v[152:155], v[52:55], v[24:27], v[152:155]
    buffer_load_dwordx4 v[36:39], v7, s[12:15], s35 offen
    v_mfma_f32_16x16x32_bf16 v[156:159], v[52:55], v[28:31], v[156:159]
    s_waitcnt lgkmcnt(4)
    v_mfma_f32_16x16x32_bf16 v[160:163], v[56:59], v[16:19], v[160:163]
    ds_read_b64_tr_b16 v[52:53], v68 offset:136
    v_mfma_f32_16x16x32_bf16 v[164:167], v[56:59], v[20:23], v[164:167]
    ds_read_b64_tr_b16 v[54:55], v68 offset:17032
    v_mfma_f32_16x16x32_bf16 v[168:171], v[56:59], v[24:27], v[168:171]
    buffer_load_dwordx4 v[40:43], v8, s[12:15], s35 offen
    v_mfma_f32_16x16x32_bf16 v[172:175], v[56:59], v[28:31], v[172:175]
    s_waitcnt lgkmcnt(4)
    v_mfma_f32_16x16x32_bf16 v[176:179], v[60:63], v[16:19], v[176:179]
    ds_read_b64_tr_b16 v[56:57], v68 offset:192
    v_mfma_f32_16x16x32_bf16 v[180:183], v[60:63], v[20:23], v[180:183]
    ds_read_b64_tr_b16 v[58:59], v68 offset:17088
    v_mfma_f32_16x16x32_bf16 v[184:187], v[60:63], v[24:27], v[184:187]
    buffer_load_dwordx4 v[44:47], v9, s[12:15], s35 offen
    v_mfma_f32_16x16x32_bf16 v[188:191], v[60:63], v[28:31], v[188:191]
    s_waitcnt lgkmcnt(4)
    v_mfma_f32_16x16x32_bf16 v[192:195], v[48:51], v[16:19], v[192:195]
    s_add_u32 s35, s35, 1024
    ds_read_b64_tr_b16 v[60:61], v68 offset:200
    v_mfma_f32_16x16x32_bf16 v[196:199], v[48:51], v[20:23], v[196:199]
    s_add_u32 m0, s36, 67584
    ds_read_b64_tr_b16 v[62:63], v68 offset:17096
    v_mfma_f32_16x16x32_bf16 v[200:203], v[48:51], v[24:27], v[200:203]
    global_load_lds_dwordx4 v[2:3], off
    v_mfma_f32_16x16x32_bf16 v[204:207], v[48:51], v[28:31], v[204:207]
    s_waitcnt lgkmcnt(4)
    v_lshl_add_u64 v[2:3], v[4:5], 0, v[2:3]
    v_mfma_f32_16x16x32_bf16 v[208:211], v[52:55], v[16:19], v[208:211]
    ds_read_b64_tr_b16 v[48:49], v64 offset:0
    v_mfma_f32_16x16x32_bf16 v[212:215], v[52:55], v[20:23], v[212:215]
    s_add_u32 m0, s36, 84480
    ds_read_b64_tr_b16 v[50:51], v64 offset:16896
    v_mfma_f32_16x16x32_bf16 v[216:219], v[52:55], v[24:27], v[216:219]
    global_load_lds_dwordx4 v[2:3], off
    v_mfma_f32_16x16x32_bf16 v[220:223], v[52:55], v[28:31], v[220:223]
    s_waitcnt lgkmcnt(4)
    v_lshl_add_u64 v[2:3], v[4:5], 0, v[2:3]
    v_mfma_f32_16x16x32_bf16 v[224:227], v[56:59], v[16:19], v[224:227]
    ds_read_b64_tr_b16 v[52:53], v64 offset:288
    v_mfma_f32_16x16x32_bf16 v[228:231], v[56:59], v[20:23], v[228:231]
    s_add_u32 m0, s36, 71808
    ds_read_b64_tr_b16 v[54:55], v64 offset:17184
    v_mfma_f32_16x16x32_bf16 v[232:235], v[56:59], v[24:27], v[232:235]
    global_load_lds_dwordx4 v[2:3], off
    v_mfma_f32_16x16x32_bf16 v[236:239], v[56:59], v[28:31], v[236:239]
    s_waitcnt lgkmcnt(4)
    v_lshl_add_u64 v[2:3], v[4:5], 0, v[2:3]
    v_mfma_f32_16x16x32_bf16 v[240:243], v[60:63], v[16:19], v[240:243]
    ds_read_b64_tr_b16 v[56:57], v64 offset:32
    v_mfma_f32_16x16x32_bf16 v[244:247], v[60:63], v[20:23], v[244:247]
    s_add_u32 m0, s36, 88704
    ds_read_b64_tr_b16 v[58:59], v64 offset:16928
    v_mfma_f32_16x16x32_bf16 v[248:251], v[60:63], v[24:27], v[248:251]
    global_load_lds_dwordx4 v[2:3], off
    v_mfma_f32_16x16x32_bf16 v[252:255], v[60:63], v[28:31], v[252:255]
    s_waitcnt lgkmcnt(4)
    v_lshl_add_u64 v[2:3], v[4:5], 0, v[2:3]
    v_mfma_f32_16x16x32_bf16 a[0:3], v[48:51], v[16:19], a[0:3]
    ds_read_b64_tr_b16 v[60:61], v64 offset:320
    v_mfma_f32_16x16x32_bf16 a[4:7], v[48:51], v[20:23], a[4:7]
    s_add_u32 m0, s36, 76032
    ds_read_b64_tr_b16 v[62:63], v64 offset:17216
    v_mfma_f32_16x16x32_bf16 a[8:11], v[48:51], v[24:27], a[8:11]
    global_load_lds_dwordx4 v[2:3], off
    v_mfma_f32_16x16x32_bf16 a[12:15], v[48:51], v[28:31], a[12:15]
    s_waitcnt lgkmcnt(4)
    v_lshl_add_u64 v[2:3], v[4:5], 0, v[2:3]
    v_mfma_f32_16x16x32_bf16 a[16:19], v[52:55], v[16:19], a[16:19]
    ds_read_b64_tr_b16 v[48:49], v64 offset:64
    v_mfma_f32_16x16x32_bf16 a[20:23], v[52:55], v[20:23], a[20:23]
    s_add_u32 m0, s36, 92928
    ds_read_b64_tr_b16 v[50:51], v64 offset:16960
    v_mfma_f32_16x16x32_bf16 a[24:27], v[52:55], v[24:27], a[24:27]
    global_load_lds_dwordx4 v[2:3], off
    v_mfma_f32_16x16x32_bf16 a[28:31], v[52:55], v[28:31], a[28:31]
    s_waitcnt lgkmcnt(4)
    v_lshl_add_u64 v[2:3], v[4:5], 0, v[2:3]
    v_mfma_f32_16x16x32_bf16 a[32:35], v[56:59], v[16:19], a[32:35]
    ds_read_b64_tr_b16 v[52:53], v64 offset:352
    v_mfma_f32_16x16x32_bf16 a[36:39], v[56:59], v[20:23], a[36:39]
    s_add_u32 m0, s36, 80256
    ds_read_b64_tr_b16 v[54:55], v64 offset:17248
    v_mfma_f32_16x16x32_bf16 a[40:43], v[56:59], v[24:27], a[40:43]
    global_load_lds_dwordx4 v[2:3], off
    v_mfma_f32_16x16x32_bf16 a[44:47], v[56:59], v[28:31], a[44:47]
    s_waitcnt lgkmcnt(4)
    v_lshl_add_u64 v[2:3], v[4:5], 0, v[2:3]
    v_mfma_f32_16x16x32_bf16 a[48:51], v[60:63], v[16:19], a[48:51]
    ds_read_b64_tr_b16 v[56:57], v64 offset:96
    v_mfma_f32_16x16x32_bf16 a[52:55], v[60:63], v[20:23], a[52:55]
    s_add_u32 m0, s36, 97152
    ds_read_b64_tr_b16 v[58:59], v64 offset:16992
    v_mfma_f32_16x16x32_bf16 a[56:59], v[60:63], v[24:27], a[56:59]
    global_load_lds_dwordx4 v[2:3], off
    v_mfma_f32_16x16x32_bf16 a[60:63], v[60:63], v[28:31], a[60:63]
    s_waitcnt lgkmcnt(4)
    v_lshl_add_u64 v[2:3], v[4:5], 0, v[2:3]
    v_mfma_f32_16x16x32_bf16 a[64:67], v[48:51], v[16:19], a[64:67]
    ds_read_b64_tr_b16 v[60:61], v64 offset:384
    v_mfma_f32_16x16x32_bf16 a[68:71], v[48:51], v[20:23], a[68:71]
    ds_read_b64_tr_b16 v[62:63], v64 offset:17280
    v_mfma_f32_16x16x32_bf16 a[72:75], v[48:51], v[24:27], a[72:75]
    v_mfma_f32_16x16x32_bf16 a[76:79], v[48:51], v[28:31], a[76:79]
    s_waitcnt lgkmcnt(4)
    v_mfma_f32_16x16x32_bf16 a[80:83], v[52:55], v[16:19], a[80:83]
    ds_read_b64_tr_b16 v[48:49], v64 offset:128
    v_mfma_f32_16x16x32_bf16 a[84:87], v[52:55], v[20:23], a[84:87]
    ds_read_b64_tr_b16 v[50:51], v64 offset:17024
    v_mfma_f32_16x16x32_bf16 a[88:91], v[52:55], v[24:27], a[88:91]
    v_mfma_f32_16x16x32_bf16 a[92:95], v[52:55], v[28:31], a[92:95]
    s_waitcnt lgkmcnt(4)
    v_mfma_f32_16x16x32_bf16 a[96:99], v[56:59], v[16:19], a[96:99]
    ds_read_b64_tr_b16 v[52:53], v64 offset:416
    v_mfma_f32_16x16x32_bf16 a[100:103], v[56:59], v[20:23], a[100:103]
    ds_read_b64_tr_b16 v[54:55], v64 offset:17312
    v_mfma_f32_16x16x32_bf16 a[104:107], v[56:59], v[24:27], a[104:107]
    v_mfma_f32_16x16x32_bf16 a[108:111], v[56:59], v[28:31], a[108:111]
    s_waitcnt lgkmcnt(4)
    v_mfma_f32_16x16x32_bf16 a[112:115], v[60:63], v[16:19], a[112:115]
    ds_read_b64_tr_b16 v[56:57], v64 offset:160
    v_mfma_f32_16x16x32_bf16 a[116:119], v[60:63], v[20:23], a[116:119]
    ds_read_b64_tr_b16 v[58:59], v64 offset:17056
    v_mfma_f32_16x16x32_bf16 a[120:123], v[60:63], v[24:27], a[120:123]
    v_mfma_f32_16x16x32_bf16 a[124:127], v[60:63], v[28:31], a[124:127]
    s_waitcnt lgkmcnt(4)
    v_mfma_f32_16x16x32_bf16 a[128:131], v[48:51], v[16:19], a[128:131]
    ds_read_b64_tr_b16 v[60:61], v64 offset:448
    v_mfma_f32_16x16x32_bf16 a[132:135], v[48:51], v[20:23], a[132:135]
    ds_read_b64_tr_b16 v[62:63], v64 offset:17344
    v_mfma_f32_16x16x32_bf16 a[136:139], v[48:51], v[24:27], a[136:139]
    v_mfma_f32_16x16x32_bf16 a[140:143], v[48:51], v[28:31], a[140:143]
    s_waitcnt lgkmcnt(4)
    v_mfma_f32_16x16x32_bf16 a[144:147], v[52:55], v[16:19], a[144:147]
    ds_read_b64_tr_b16 v[48:49], v64 offset:192
    v_mfma_f32_16x16x32_bf16 a[148:151], v[52:55], v[20:23], a[148:151]
    ds_read_b64_tr_b16 v[50:51], v64 offset:17088
    v_mfma_f32_16x16x32_bf16 a[152:155], v[52:55], v[24:27], a[152:155]
    v_mfma_f32_16x16x32_bf16 a[156:159], v[52:55], v[28:31], a[156:159]
    s_waitcnt lgkmcnt(4)
    v_mfma_f32_16x16x32_bf16 a[160:163], v[56:59], v[16:19], a[160:163]
    ds_read_b64_tr_b16 v[52:53], v64 offset:480
    v_mfma_f32_16x16x32_bf16 a[164:167], v[56:59], v[20:23], a[164:167]
    ds_read_b64_tr_b16 v[54:55], v64 offset:17376
    v_mfma_f32_16x16x32_bf16 a[168:171], v[56:59], v[24:27], a[168:171]
    v_mfma_f32_16x16x32_bf16 a[172:175], v[56:59], v[28:31], a[172:175]
    s_waitcnt lgkmcnt(4)
    v_mfma_f32_16x16x32_bf16 a[176:179], v[60:63], v[16:19], a[176:179]
    ds_read_b64_tr_b16 v[56:57], v64 offset:224
    v_mfma_f32_16x16x32_bf16 a[180:183], v[60:63], v[20:23], a[180:183]
    ds_read_b64_tr_b16 v[58:59], v64 offset:17120
    v_mfma_f32_16x16x32_bf16 a[184:187], v[60:63], v[24:27], a[184:187]
    v_mfma_f32_16x16x32_bf16 a[188:191], v[60:63], v[28:31], a[188:191]
    s_waitcnt lgkmcnt(4)
    v_mfma_f32_16x16x32_bf16 a[192:195], v[48:51], v[16:19], a[192:195]
    ds_read_b64_tr_b16 v[60:61], v64 offset:512
    v_mfma_f32_16x16x32_bf16 a[196:199], v[48:51], v[20:23], a[196:199]
    ds_read_b64_tr_b16 v[62:63], v64 offset:17408
    v_mfma_f32_16x16x32_bf16 a[200:203], v[48:51], v[24:27], a[200:203]
    v_mfma_f32_16x16x32_bf16 a[204:207], v[48:51], v[28:31], a[204:207]
    s_waitcnt lgkmcnt(4)
    v_mfma_f32_16x16x32_bf16 a[208:211], v[52:55], v[16:19], a[208:211]
    ds_read_b64_tr_b16 v[48:49], v64 offset:256
    v_mfma_f32_16x16x32_bf16 a[212:215], v[52:55], v[20:23], a[212:215]
    ds_read_b64_tr_b16 v[50:51], v64 offset:17152
    v_mfma_f32_16x16x32_bf16 a[216:219], v[52:55], v[24:27], a[216:219]
    v_mfma_f32_16x16x32_bf16 a[220:223], v[52:55], v[28:31], a[220:223]
    s_waitcnt lgkmcnt(4)
    v_mfma_f32_16x16x32_bf16 a[224:227], v[56:59], v[16:19], a[224:227]
    ds_read_b64_tr_b16 v[52:53], v64 offset:544
    v_mfma_f32_16x16x32_bf16 a[228:231], v[56:59], v[20:23], a[228:231]
    ds_read_b64_tr_b16 v[54:55], v64 offset:17440
    v_mfma_f32_16x16x32_bf16 a[232:235], v[56:59], v[24:27], a[232:235]
    s_waitcnt vmcnt(12)
    s_barrier
    v_mfma_f32_16x16x32_bf16 a[236:239], v[56:59], v[28:31], a[236:239]
    s_waitcnt lgkmcnt(4)
    v_mfma_f32_16x16x32_bf16 a[240:243], v[60:63], v[16:19], a[240:243]
    ds_read_b64_tr_b16 v[56:57], v69 offset:0
    v_mfma_f32_16x16x32_bf16 a[244:247], v[60:63], v[20:23], a[244:247]
    ds_read_b64_tr_b16 v[58:59], v69 offset:16896
    v_mfma_f32_16x16x32_bf16 a[248:251], v[60:63], v[24:27], a[248:251]
    v_mfma_f32_16x16x32_bf16 a[252:255], v[60:63], v[28:31], a[252:255]
    s_waitcnt lgkmcnt(4)
    v_mfma_f32_16x16x32_bf16 v[96:99], v[48:51], v[16:19], v[96:99]
    ds_read_b64_tr_b16 v[60:61], v69 offset:8
    v_mfma_f32_16x16x32_bf16 v[100:103], v[48:51], v[20:23], v[100:103]
    ds_read_b64_tr_b16 v[62:63], v69 offset:16904
    v_mfma_f32_16x16x32_bf16 v[104:107], v[48:51], v[24:27], v[104:107]
    v_mfma_f32_16x16x32_bf16 v[108:111], v[48:51], v[28:31], v[108:111]
    s_waitcnt lgkmcnt(4)
    v_mfma_f32_16x16x32_bf16 v[112:115], v[52:55], v[16:19], v[112:115]
    ds_read_b64_tr_b16 v[48:49], v69 offset:64
    v_mfma_f32_16x16x32_bf16 v[116:119], v[52:55], v[20:23], v[116:119]
    ds_read_b64_tr_b16 v[50:51], v69 offset:16960
    v_mfma_f32_16x16x32_bf16 v[120:123], v[52:55], v[24:27], v[120:123]
    s_waitcnt vmcnt(8)
    v_mfma_f32_16x16x32_bf16 v[124:127], v[52:55], v[28:31], v[124:127]
    s_waitcnt lgkmcnt(4)
    v_mfma_f32_16x16x32_bf16 v[128:131], v[56:59], v[32:35], v[128:131]
    ds_read_b64_tr_b16 v[52:53], v69 offset:72
    v_mfma_f32_16x16x32_bf16 v[132:135], v[56:59], v[36:39], v[132:135]
    ds_read_b64_tr_b16 v[54:55], v69 offset:16968
    v_mfma_f32_16x16x32_bf16 v[136:139], v[56:59], v[40:43], v[136:139]
    buffer_load_dwordx4 v[16:19], v6, s[12:15], s35 offen
    v_mfma_f32_16x16x32_bf16 v[140:143], v[56:59], v[44:47], v[140:143]
    s_waitcnt lgkmcnt(4)
    v_mfma_f32_16x16x32_bf16 v[144:147], v[60:63], v[32:35], v[144:147]
    ds_read_b64_tr_b16 v[56:57], v69 offset:128
    v_mfma_f32_16x16x32_bf16 v[148:151], v[60:63], v[36:39], v[148:151]
    ds_read_b64_tr_b16 v[58:59], v69 offset:17024
    v_mfma_f32_16x16x32_bf16 v[152:155], v[60:63], v[40:43], v[152:155]
    buffer_load_dwordx4 v[20:23], v7, s[12:15], s35 offen
    v_mfma_f32_16x16x32_bf16 v[156:159], v[60:63], v[44:47], v[156:159]
    s_waitcnt lgkmcnt(4)
    v_mfma_f32_16x16x32_bf16 v[160:163], v[48:51], v[32:35], v[160:163]
    ds_read_b64_tr_b16 v[60:61], v69 offset:136
    v_mfma_f32_16x16x32_bf16 v[164:167], v[48:51], v[36:39], v[164:167]
    ds_read_b64_tr_b16 v[62:63], v69 offset:17032
    v_mfma_f32_16x16x32_bf16 v[168:171], v[48:51], v[40:43], v[168:171]
    buffer_load_dwordx4 v[24:27], v8, s[12:15], s35 offen
    v_mfma_f32_16x16x32_bf16 v[172:175], v[48:51], v[44:47], v[172:175]
    s_waitcnt lgkmcnt(4)
    v_mfma_f32_16x16x32_bf16 v[176:179], v[52:55], v[32:35], v[176:179]
    ds_read_b64_tr_b16 v[48:49], v69 offset:192
    v_mfma_f32_16x16x32_bf16 v[180:183], v[52:55], v[36:39], v[180:183]
    ds_read_b64_tr_b16 v[50:51], v69 offset:17088
    v_mfma_f32_16x16x32_bf16 v[184:187], v[52:55], v[40:43], v[184:187]
    buffer_load_dwordx4 v[28:31], v9, s[12:15], s35 offen
    v_mfma_f32_16x16x32_bf16 v[188:191], v[52:55], v[44:47], v[188:191]
    s_waitcnt lgkmcnt(4)
    v_mfma_f32_16x16x32_bf16 v[192:195], v[56:59], v[32:35], v[192:195]
    s_add_u32 s35, s35, 1024
    ds_read_b64_tr_b16 v[52:53], v69 offset:200
    v_mfma_f32_16x16x32_bf16 v[196:199], v[56:59], v[36:39], v[196:199]
    s_add_u32 m0, s36, 101376
    ds_read_b64_tr_b16 v[54:55], v69 offset:17096
    v_mfma_f32_16x16x32_bf16 v[200:203], v[56:59], v[40:43], v[200:203]
    global_load_lds_dwordx4 v[2:3], off
    v_mfma_f32_16x16x32_bf16 v[204:207], v[56:59], v[44:47], v[204:207]
    s_waitcnt lgkmcnt(4)
    v_lshl_add_u64 v[2:3], v[4:5], 0, v[2:3]
    v_mfma_f32_16x16x32_bf16 v[208:211], v[60:63], v[32:35], v[208:211]
    ds_read_b64_tr_b16 v[56:57], v65 offset:0
    v_mfma_f32_16x16x32_bf16 v[212:215], v[60:63], v[36:39], v[212:215]
    s_add_u32 m0, s36, 118272
    ds_read_b64_tr_b16 v[58:59], v65 offset:16896
    v_mfma_f32_16x16x32_bf16 v[216:219], v[60:63], v[40:43], v[216:219]
    global_load_lds_dwordx4 v[2:3], off
    v_mfma_f32_16x16x32_bf16 v[220:223], v[60:63], v[44:47], v[220:223]
    s_waitcnt lgkmcnt(4)
    v_lshl_add_u64 v[2:3], v[4:5], 0, v[2:3]
    v_mfma_f32_16x16x32_bf16 v[224:227], v[48:51], v[32:35], v[224:227]
    ds_read_b64_tr_b16 v[60:61], v65 offset:288
    v_mfma_f32_16x16x32_bf16 v[228:231], v[48:51], v[36:39], v[228:231]
    s_add_u32 m0, s36, 105600
    ds_read_b64_tr_b16 v[62:63], v65 offset:17184
    v_mfma_f32_16x16x32_bf16 v[232:235], v[48:51], v[40:43], v[232:235]
    global_load_lds_dwordx4 v[2:3], off
    v_mfma_f32_16x16x32_bf16 v[236:239], v[48:51], v[44:47], v[236:239]
    s_waitcnt lgkmcnt(4)
    v_lshl_add_u64 v[2:3], v[4:5], 0, v[2:3]
    v_mfma_f32_16x16x32_bf16 v[240:243], v[52:55], v[32:35], v[240:243]
    ds_read_b64_tr_b16 v[48:49], v65 offset:32
    v_mfma_f32_16x16x32_bf16 v[244:247], v[52:55], v[36:39], v[244:247]
    s_add_u32 m0, s36, 122496
    ds_read_b64_tr_b16 v[50:51], v65 offset:16928
    v_mfma_f32_16x16x32_bf16 v[248:251], v[52:55], v[40:43], v[248:251]
    global_load_lds_dwordx4 v[2:3], off
    v_mfma_f32_16x16x32_bf16 v[252:255], v[52:55], v[44:47], v[252:255]
    s_waitcnt lgkmcnt(4)
    v_lshl_add_u64 v[2:3], v[4:5], 0, v[2:3]
    v_mfma_f32_16x16x32_bf16 a[0:3], v[56:59], v[32:35], a[0:3]
    ds_read_b64_tr_b16 v[52:53], v65 offset:320
    v_mfma_f32_16x16x32_bf16 a[4:7], v[56:59], v[36:39], a[4:7]
    s_add_u32 m0, s36, 109824
    ds_read_b64_tr_b16 v[54:55], v65 offset:17216
    v_mfma_f32_16x16x32_bf16 a[8:11], v[56:59], v[40:43], a[8:11]
    global_load_lds_dwordx4 v[2:3], off
    v_mfma_f32_16x16x32_bf16 a[12:15], v[56:59], v[44:47], a[12:15]
    s_waitcnt lgkmcnt(4)
    v_lshl_add_u64 v[2:3], v[4:5], 0, v[2:3]
    v_mfma_f32_16x16x32_bf16 a[16:19], v[60:63], v[32:35], a[16:19]
    ds_read_b64_tr_b16 v[56:57], v65 offset:64
    v_mfma_f32_16x16x32_bf16 a[20:23], v[60:63], v[36:39], a[20:23]
    s_add_u32 m0, s36, 126720
    ds_read_b64_tr_b16 v[58:59], v65 offset:16960
    v_mfma_f32_16x16x32_bf16 a[24:27], v[60:63], v[40:43], a[24:27]
    global_load_lds_dwordx4 v[2:3], off
    v_mfma_f32_16x16x32_bf16 a[28:31], v[60:63], v[44:47], a[28:31]
    s_waitcnt lgkmcnt(4)
    v_lshl_add_u64 v[2:3], v[4:5], 0, v[2:3]
    v_mfma_f32_16x16x32_bf16 a[32:35], v[48:51], v[32:35], a[32:35]
    ds_read_b64_tr_b16 v[60:61], v65 offset:352
    v_mfma_f32_16x16x32_bf16 a[36:39], v[48:51], v[36:39], a[36:39]
    s_add_u32 m0, s36, 114048
    ds_read_b64_tr_b16 v[62:63], v65 offset:17248
    v_mfma_f32_16x16x32_bf16 a[40:43], v[48:51], v[40:43], a[40:43]
    global_load_lds_dwordx4 v[2:3], off
    v_mfma_f32_16x16x32_bf16 a[44:47], v[48:51], v[44:47], a[44:47]
    s_waitcnt lgkmcnt(4)
    v_lshl_add_u64 v[2:3], v[4:5], 0, v[2:3]
    v_mfma_f32_16x16x32_bf16 a[48:51], v[52:55], v[32:35], a[48:51]
    ds_read_b64_tr_b16 v[48:49], v65 offset:96
    v_mfma_f32_16x16x32_bf16 a[52:55], v[52:55], v[36:39], a[52:55]
    s_add_u32 m0, s36, 130944
    ds_read_b64_tr_b16 v[50:51], v65 offset:16992
    v_mfma_f32_16x16x32_bf16 a[56:59], v[52:55], v[40:43], a[56:59]
    global_load_lds_dwordx4 v[2:3], off
    v_mfma_f32_16x16x32_bf16 a[60:63], v[52:55], v[44:47], a[60:63]
    s_waitcnt lgkmcnt(4)
    v_lshl_add_u64 v[2:3], v[4:5], 0, v[2:3]
    v_mfma_f32_16x16x32_bf16 a[64:67], v[56:59], v[32:35], a[64:67]
    ds_read_b64_tr_b16 v[52:53], v65 offset:384
    v_mfma_f32_16x16x32_bf16 a[68:71], v[56:59], v[36:39], a[68:71]
    ds_read_b64_tr_b16 v[54:55], v65 offset:17280
    v_mfma_f32_16x16x32_bf16 a[72:75], v[56:59], v[40:43], a[72:75]
    v_mfma_f32_16x16x32_bf16 a[76:79], v[56:59], v[44:47], a[76:79]
    s_waitcnt lgkmcnt(4)
    v_mfma_f32_16x16x32_bf16 a[80:83], v[60:63], v[32:35], a[80:83]
    ds_read_b64_tr_b16 v[56:57], v65 offset:128
    v_mfma_f32_16x16x32_bf16 a[84:87], v[60:63], v[36:39], a[84:87]
    ds_read_b64_tr_b16 v[58:59], v65 offset:17024
    v_mfma_f32_16x16x32_bf16 a[88:91], v[60:63], v[40:43], a[88:91]
    v_mfma_f32_16x16x32_bf16 a[92:95], v[60:63], v[44:47], a[92:95]
    s_waitcnt lgkmcnt(4)
    v_mfma_f32_16x16x32_bf16 a[96:99], v[48:51], v[32:35], a[96:99]
    ds_read_b64_tr_b16 v[60:61], v65 offset:416
    v_mfma_f32_16x16x32_bf16 a[100:103], v[48:51], v[36:39], a[100:103]
    ds_read_b64_tr_b16 v[62:63], v65 offset:17312
    v_mfma_f32_16x16x32_bf16 a[104:107], v[48:51], v[40:43], a[104:107]
    v_mfma_f32_16x16x32_bf16 a[108:111], v[48:51], v[44:47], a[108:111]
    s_waitcnt lgkmcnt(4)
    v_mfma_f32_16x16x32_bf16 a[112:115], v[52:55], v[32:35], a[112:115]
    ds_read_b64_tr_b16 v[48:49], v65 offset:160
    v_mfma_f32_16x16x32_bf16 a[116:119], v[52:55], v[36:39], a[116:119]
    ds_read_b64_tr_b16 v[50:51], v65 offset:17056
    v_mfma_f32_16x16x32_bf16 a[120:123], v[52:55], v[40:43], a[120:123]
    v_mfma_f32_16x16x32_bf16 a[124:127], v[52:55], v[44:47], a[124:127]
    s_waitcnt lgkmcnt(4)
    v_mfma_f32_16x16x32_bf16 a[128:131], v[56:59], v[32:35], a[128:131]
    ds_read_b64_tr_b16 v[52:53], v65 offset:448
    v_mfma_f32_16x16x32_bf16 a[132:135], v[56:59], v[36:39], a[132:135]
    ds_read_b64_tr_b16 v[54:55], v65 offset:17344
    v_mfma_f32_16x16x32_bf16 a[136:139], v[56:59], v[40:43], a[136:139]
    v_mfma_f32_16x16x32_bf16 a[140:143], v[56:59], v[44:47], a[140:143]
    s_waitcnt lgkmcnt(4)
    v_mfma_f32_16x16x32_bf16 a[144:147], v[60:63], v[32:35], a[144:147]
    ds_read_b64_tr_b16 v[56:57], v65 offset:192
    v_mfma_f32_16x16x32_bf16 a[148:151], v[60:63], v[36:39], a[148:151]
    ds_read_b64_tr_b16 v[58:59], v65 offset:17088
    v_mfma_f32_16x16x32_bf16 a[152:155], v[60:63], v[40:43], a[152:155]
    v_mfma_f32_16x16x32_bf16 a[156:159], v[60:63], v[44:47], a[156:159]
    s_waitcnt lgkmcnt(4)
    v_mfma_f32_16x16x32_bf16 a[160:163], v[48:51], v[32:35], a[160:163]
    ds_read_b64_tr_b16 v[60:61], v65 offset:480
    v_mfma_f32_16x16x32_bf16 a[164:167], v[48:51], v[36:39], a[164:167]
    ds_read_b64_tr_b16 v[62:63], v65 offset:17376
    v_mfma_f32_16x16x32_bf16 a[168:171], v[48:51], v[40:43], a[168:171]
    v_mfma_f32_16x16x32_bf16 a[172:175], v[48:51], v[44:47], a[172:175]
    s_waitcnt lgkmcnt(4)
    v_mfma_f32_16x16x32_bf16 a[176:179], v[52:55], v[32:35], a[176:179]
    ds_read_b64_tr_b16 v[48:49], v65 offset:224
    v_mfma_f32_16x16x32_bf16 a[180:183], v[52:55], v[36:39], a[180:183]
    ds_read_b64_tr_b16 v[50:51], v65 offset:17120
    v_mfma_f32_16x16x32_bf16 a[184:187], v[52:55], v[40:43], a[184:187]
    v_mfma_f32_16x16x32_bf16 a[188:191], v[52:55], v[44:47], a[188:191]
    s_waitcnt lgkmcnt(4)
    v_mfma_f32_16x16x32_bf16 a[192:195], v[56:59], v[32:35], a[192:195]
    ds_read_b64_tr_b16 v[52:53], v65 offset:512
    v_mfma_f32_16x16x32_bf16 a[196:199], v[56:59], v[36:39], a[196:199]
    ds_read_b64_tr_b16 v[54:55], v65 offset:17408
    v_mfma_f32_16x16x32_bf16 a[200:203], v[56:59], v[40:43], a[200:203]
    v_mfma_f32_16x16x32_bf16 a[204:207], v[56:59], v[44:47], a[204:207]
    s_waitcnt lgkmcnt(4)
    v_mfma_f32_16x16x32_bf16 a[208:211], v[60:63], v[32:35], a[208:211]
    ds_read_b64_tr_b16 v[56:57], v65 offset:256
    v_mfma_f32_16x16x32_bf16 a[212:215], v[60:63], v[36:39], a[212:215]
    ds_read_b64_tr_b16 v[58:59], v65 offset:17152
    v_mfma_f32_16x16x32_bf16 a[216:219], v[60:63], v[40:43], a[216:219]
    v_mfma_f32_16x16x32_bf16 a[220:223], v[60:63], v[44:47], a[220:223]
    s_waitcnt lgkmcnt(4)
    v_mfma_f32_16x16x32_bf16 a[224:227], v[48:51], v[32:35], a[224:227]
    ds_read_b64_tr_b16 v[60:61], v65 offset:544
    v_mfma_f32_16x16x32_bf16 a[228:231], v[48:51], v[36:39], a[228:231]
    ds_read_b64_tr_b16 v[62:63], v65 offset:17440
    v_mfma_f32_16x16x32_bf16 a[232:235], v[48:51], v[40:43], a[232:235]
    s_waitcnt vmcnt(12)
    s_barrier
    v_mfma_f32_16x16x32_bf16 a[236:239], v[48:51], v[44:47], a[236:239]
    s_waitcnt lgkmcnt(4)
    v_mfma_f32_16x16x32_bf16 a[240:243], v[52:55], v[32:35], a[240:243]
    ds_read_b64_tr_b16 v[48:49], v70 offset:0
    v_mfma_f32_16x16x32_bf16 a[244:247], v[52:55], v[36:39], a[244:247]
    ds_read_b64_tr_b16 v[50:51], v70 offset:16896
    v_mfma_f32_16x16x32_bf16 a[248:251], v[52:55], v[40:43], a[248:251]
    v_mfma_f32_16x16x32_bf16 a[252:255], v[52:55], v[44:47], a[252:255]
    s_waitcnt lgkmcnt(4)
    v_mfma_f32_16x16x32_bf16 v[96:99], v[56:59], v[32:35], v[96:99]
    ds_read_b64_tr_b16 v[52:53], v70 offset:8
    v_mfma_f32_16x16x32_bf16 v[100:103], v[56:59], v[36:39], v[100:103]
    ds_read_b64_tr_b16 v[54:55], v70 offset:16904
    v_mfma_f32_16x16x32_bf16 v[104:107], v[56:59], v[40:43], v[104:107]
    v_mfma_f32_16x16x32_bf16 v[108:111], v[56:59], v[44:47], v[108:111]
    s_waitcnt lgkmcnt(4)
    v_mfma_f32_16x16x32_bf16 v[112:115], v[60:63], v[32:35], v[112:115]
    ds_read_b64_tr_b16 v[56:57], v70 offset:64
    v_mfma_f32_16x16x32_bf16 v[116:119], v[60:63], v[36:39], v[116:119]
    ds_read_b64_tr_b16 v[58:59], v70 offset:16960
    v_mfma_f32_16x16x32_bf16 v[120:123], v[60:63], v[40:43], v[120:123]
    s_waitcnt vmcnt(8)
    v_mfma_f32_16x16x32_bf16 v[124:127], v[60:63], v[44:47], v[124:127]
    s_waitcnt lgkmcnt(4)
    v_mfma_f32_16x16x32_bf16 v[128:131], v[48:51], v[16:19], v[128:131]
    ds_read_b64_tr_b16 v[60:61], v70 offset:72
    v_mfma_f32_16x16x32_bf16 v[132:135], v[48:51], v[20:23], v[132:135]
    ds_read_b64_tr_b16 v[62:63], v70 offset:16968
    v_mfma_f32_16x16x32_bf16 v[136:139], v[48:51], v[24:27], v[136:139]
    buffer_load_dwordx4 v[32:35], v6, s[12:15], s35 offen
    v_mfma_f32_16x16x32_bf16 v[140:143], v[48:51], v[28:31], v[140:143]
    s_waitcnt lgkmcnt(4)
    v_mfma_f32_16x16x32_bf16 v[144:147], v[52:55], v[16:19], v[144:147]
    ds_read_b64_tr_b16 v[48:49], v70 offset:128
    v_mfma_f32_16x16x32_bf16 v[148:151], v[52:55], v[20:23], v[148:151]
    ds_read_b64_tr_b16 v[50:51], v70 offset:17024
    v_mfma_f32_16x16x32_bf16 v[152:155], v[52:55], v[24:27], v[152:155]
    buffer_load_dwordx4 v[36:39], v7, s[12:15], s35 offen
    v_mfma_f32_16x16x32_bf16 v[156:159], v[52:55], v[28:31], v[156:159]
    s_waitcnt lgkmcnt(4)
    v_mfma_f32_16x16x32_bf16 v[160:163], v[56:59], v[16:19], v[160:163]
    ds_read_b64_tr_b16 v[52:53], v70 offset:136
    v_mfma_f32_16x16x32_bf16 v[164:167], v[56:59], v[20:23], v[164:167]
    ds_read_b64_tr_b16 v[54:55], v70 offset:17032
    v_mfma_f32_16x16x32_bf16 v[168:171], v[56:59], v[24:27], v[168:171]
    buffer_load_dwordx4 v[40:43], v8, s[12:15], s35 offen
    v_mfma_f32_16x16x32_bf16 v[172:175], v[56:59], v[28:31], v[172:175]
    s_waitcnt lgkmcnt(4)
    v_mfma_f32_16x16x32_bf16 v[176:179], v[60:63], v[16:19], v[176:179]
    ds_read_b64_tr_b16 v[56:57], v70 offset:192
    v_mfma_f32_16x16x32_bf16 v[180:183], v[60:63], v[20:23], v[180:183]
    ds_read_b64_tr_b16 v[58:59], v70 offset:17088
    v_mfma_f32_16x16x32_bf16 v[184:187], v[60:63], v[24:27], v[184:187]
    buffer_load_dwordx4 v[44:47], v9, s[12:15], s35 offen
    v_mfma_f32_16x16x32_bf16 v[188:191], v[60:63], v[28:31], v[188:191]
    s_waitcnt lgkmcnt(4)
    v_mfma_f32_16x16x32_bf16 v[192:195], v[48:51], v[16:19], v[192:195]
    s_add_u32 s35, s35, 1024
    ds_read_b64_tr_b16 v[60:61], v70 offset:200
    v_mfma_f32_16x16x32_bf16 v[196:199], v[48:51], v[20:23], v[196:199]
    s_add_u32 m0, s36, 0
    ds_read_b64_tr_b16 v[62:63], v70 offset:17096
    v_mfma_f32_16x16x32_bf16 v[200:203], v[48:51], v[24:27], v[200:203]
    global_load_lds_dwordx4 v[2:3], off
    v_mfma_f32_16x16x32_bf16 v[204:207], v[48:51], v[28:31], v[204:207]
    s_waitcnt lgkmcnt(4)
    v_lshl_add_u64 v[2:3], v[4:5], 0, v[2:3]
    v_mfma_f32_16x16x32_bf16 v[208:211], v[52:55], v[16:19], v[208:211]
    ds_read_b64_tr_b16 v[48:49], v66 offset:0
    v_mfma_f32_16x16x32_bf16 v[212:215], v[52:55], v[20:23], v[212:215]
    s_add_u32 m0, s36, 16896
    ds_read_b64_tr_b16 v[50:51], v66 offset:16896
    v_mfma_f32_16x16x32_bf16 v[216:219], v[52:55], v[24:27], v[216:219]
    global_load_lds_dwordx4 v[2:3], off
    v_mfma_f32_16x16x32_bf16 v[220:223], v[52:55], v[28:31], v[220:223]
    s_waitcnt lgkmcnt(4)
    v_lshl_add_u64 v[2:3], v[4:5], 0, v[2:3]
    v_mfma_f32_16x16x32_bf16 v[224:227], v[56:59], v[16:19], v[224:227]
    ds_read_b64_tr_b16 v[52:53], v66 offset:288
    v_mfma_f32_16x16x32_bf16 v[228:231], v[56:59], v[20:23], v[228:231]
    s_add_u32 m0, s36, 4224
    ds_read_b64_tr_b16 v[54:55], v66 offset:17184
    v_mfma_f32_16x16x32_bf16 v[232:235], v[56:59], v[24:27], v[232:235]
    global_load_lds_dwordx4 v[2:3], off
    v_mfma_f32_16x16x32_bf16 v[236:239], v[56:59], v[28:31], v[236:239]
    s_waitcnt lgkmcnt(4)
    v_lshl_add_u64 v[2:3], v[4:5], 0, v[2:3]
    v_mfma_f32_16x16x32_bf16 v[240:243], v[60:63], v[16:19], v[240:243]
    ds_read_b64_tr_b16 v[56:57], v66 offset:32
    v_mfma_f32_16x16x32_bf16 v[244:247], v[60:63], v[20:23], v[244:247]
    s_add_u32 m0, s36, 21120
    ds_read_b64_tr_b16 v[58:59], v66 offset:16928
    v_mfma_f32_16x16x32_bf16 v[248:251], v[60:63], v[24:27], v[248:251]
    global_load_lds_dwordx4 v[2:3], off
    v_mfma_f32_16x16x32_bf16 v[252:255], v[60:63], v[28:31], v[252:255]
    s_waitcnt lgkmcnt(4)
    v_lshl_add_u64 v[2:3], v[4:5], 0, v[2:3]
    v_mfma_f32_16x16x32_bf16 a[0:3], v[48:51], v[16:19], a[0:3]
    ds_read_b64_tr_b16 v[60:61], v66 offset:320
    v_mfma_f32_16x16x32_bf16 a[4:7], v[48:51], v[20:23], a[4:7]
    s_add_u32 m0, s36, 8448
    ds_read_b64_tr_b16 v[62:63], v66 offset:17216
    v_mfma_f32_16x16x32_bf16 a[8:11], v[48:51], v[24:27], a[8:11]
    global_load_lds_dwordx4 v[2:3], off
    v_mfma_f32_16x16x32_bf16 a[12:15], v[48:51], v[28:31], a[12:15]
    s_waitcnt lgkmcnt(4)
    v_lshl_add_u64 v[2:3], v[4:5], 0, v[2:3]
    v_mfma_f32_16x16x32_bf16 a[16:19], v[52:55], v[16:19], a[16:19]
    ds_read_b64_tr_b16 v[48:49], v66 offset:64
    v_mfma_f32_16x16x32_bf16 a[20:23], v[52:55], v[20:23], a[20:23]
    s_add_u32 m0, s36, 25344
    ds_read_b64_tr_b16 v[50:51], v66 offset:16960
    v_mfma_f32_16x16x32_bf16 a[24:27], v[52:55], v[24:27], a[24:27]
    global_load_lds_dwordx4 v[2:3], off
    v_mfma_f32_16x16x32_bf16 a[28:31], v[52:55], v[28:31], a[28:31]
    s_waitcnt lgkmcnt(4)
    v_lshl_add_u64 v[2:3], v[4:5], 0, v[2:3]
    v_mfma_f32_16x16x32_bf16 a[32:35], v[56:59], v[16:19], a[32:35]
    ds_read_b64_tr_b16 v[52:53], v66 offset:352
    v_mfma_f32_16x16x32_bf16 a[36:39], v[56:59], v[20:23], a[36:39]
    s_add_u32 m0, s36, 12672
    ds_read_b64_tr_b16 v[54:55], v66 offset:17248
    v_mfma_f32_16x16x32_bf16 a[40:43], v[56:59], v[24:27], a[40:43]
    global_load_lds_dwordx4 v[2:3], off
    v_mfma_f32_16x16x32_bf16 a[44:47], v[56:59], v[28:31], a[44:47]
    s_waitcnt lgkmcnt(4)
    v_lshl_add_u64 v[2:3], v[4:5], 0, v[2:3]
    v_mfma_f32_16x16x32_bf16 a[48:51], v[60:63], v[16:19], a[48:51]
    ds_read_b64_tr_b16 v[56:57], v66 offset:96
    v_mfma_f32_16x16x32_bf16 a[52:55], v[60:63], v[20:23], a[52:55]
    s_add_u32 m0, s36, 29568
    ds_read_b64_tr_b16 v[58:59], v66 offset:16992
    v_mfma_f32_16x16x32_bf16 a[56:59], v[60:63], v[24:27], a[56:59]
    global_load_lds_dwordx4 v[2:3], off
    v_mfma_f32_16x16x32_bf16 a[60:63], v[60:63], v[28:31], a[60:63]
    s_waitcnt lgkmcnt(4)
    v_lshl_add_u64 v[2:3], v[4:5], 0, v[2:3]
    v_mfma_f32_16x16x32_bf16 a[64:67], v[48:51], v[16:19], a[64:67]
    ds_read_b64_tr_b16 v[60:61], v66 offset:384
    v_mfma_f32_16x16x32_bf16 a[68:71], v[48:51], v[20:23], a[68:71]
    ds_read_b64_tr_b16 v[62:63], v66 offset:17280
    v_mfma_f32_16x16x32_bf16 a[72:75], v[48:51], v[24:27], a[72:75]
    v_mfma_f32_16x16x32_bf16 a[76:79], v[48:51], v[28:31], a[76:79]
    s_waitcnt lgkmcnt(4)
    v_mfma_f32_16x16x32_bf16 a[80:83], v[52:55], v[16:19], a[80:83]
    ds_read_b64_tr_b16 v[48:49], v66 offset:128
    v_mfma_f32_16x16x32_bf16 a[84:87], v[52:55], v[20:23], a[84:87]
    ds_read_b64_tr_b16 v[50:51], v66 offset:17024
    v_mfma_f32_16x16x32_bf16 a[88:91], v[52:55], v[24:27], a[88:91]
    v_mfma_f32_16x16x32_bf16 a[92:95], v[52:55], v[28:31], a[92:95]
    s_waitcnt lgkmcnt(4)
    v_mfma_f32_16x16x32_bf16 a[96:99], v[56:59], v[16:19], a[96:99]
    ds_read_b64_tr_b16 v[52:53], v66 offset:416
    v_mfma_f32_16x16x32_bf16 a[100:103], v[56:59], v[20:23], a[100:103]
    ds_read_b64_tr_b16 v[54:55], v66 offset:17312
    v_mfma_f32_16x16x32_bf16 a[104:107], v[56:59], v[24:27], a[104:107]
    v_mfma_f32_16x16x32_bf16 a[108:111], v[56:59], v[28:31], a[108:111]
    s_waitcnt lgkmcnt(4)
    v_mfma_f32_16x16x32_bf16 a[112:115], v[60:63], v[16:19], a[112:115]
    ds_read_b64_tr_b16 v[56:57], v66 offset:160
    v_mfma_f32_16x16x32_bf16 a[116:119], v[60:63], v[20:23], a[116:119]
    ds_read_b64_tr_b16 v[58:59], v66 offset:17056
    v_mfma_f32_16x16x32_bf16 a[120:123], v[60:63], v[24:27], a[120:123]
    v_mfma_f32_16x16x32_bf16 a[124:127], v[60:63], v[28:31], a[124:127]
    s_waitcnt lgkmcnt(4)
    v_mfma_f32_16x16x32_bf16 a[128:131], v[48:51], v[16:19], a[128:131]
    ds_read_b64_tr_b16 v[60:61], v66 offset:448
    v_mfma_f32_16x16x32_bf16 a[132:135], v[48:51], v[20:23], a[132:135]
    ds_read_b64_tr_b16 v[62:63], v66 offset:17344
    v_mfma_f32_16x16x32_bf16 a[136:139], v[48:51], v[24:27], a[136:139]
    v_mfma_f32_16x16x32_bf16 a[140:143], v[48:51], v[28:31], a[140:143]
    s_waitcnt lgkmcnt(4)
    v_mfma_f32_16x16x32_bf16 a[144:147], v[52:55], v[16:19], a[144:147]
    ds_read_b64_tr_b16 v[48:49], v66 offset:192
    v_mfma_f32_16x16x32_bf16 a[148:151], v[52:55], v[20:23], a[148:151]
    ds_read_b64_tr_b16 v[50:51], v66 offset:17088
    v_mfma_f32_16x16x32_bf16 a[152:155], v[52:55], v[24:27], a[152:155]
    v_mfma_f32_16x16x32_bf16 a[156:159], v[52:55], v[28:31], a[156:159]
    s_waitcnt lgkmcnt(4)
    v_mfma_f32_16x16x32_bf16 a[160:163], v[56:59], v[16:19], a[160:163]
    ds_read_b64_tr_b16 v[52:53], v66 offset:480
    v_mfma_f32_16x16x32_bf16 a[164:167], v[56:59], v[20:23], a[164:167]
    ds_read_b64_tr_b16 v[54:55], v66 offset:17376
    v_mfma_f32_16x16x32_bf16 a[168:171], v[56:59], v[24:27], a[168:171]
    v_mfma_f32_16x16x32_bf16 a[172:175], v[56:59], v[28:31], a[172:175]
    s_waitcnt lgkmcnt(4)
    v_mfma_f32_16x16x32_bf16 a[176:179], v[60:63], v[16:19], a[176:179]
    ds_read_b64_tr_b16 v[56:57], v66 offset:224
    v_mfma_f32_16x16x32_bf16 a[180:183], v[60:63], v[20:23], a[180:183]
    ds_read_b64_tr_b16 v[58:59], v66 offset:17120
    v_mfma_f32_16x16x32_bf16 a[184:187], v[60:63], v[24:27], a[184:187]
    v_mfma_f32_16x16x32_bf16 a[188:191], v[60:63], v[28:31], a[188:191]
    s_waitcnt lgkmcnt(4)
    v_mfma_f32_16x16x32_bf16 a[192:195], v[48:51], v[16:19], a[192:195]
    ds_read_b64_tr_b16 v[60:61], v66 offset:512
    v_mfma_f32_16x16x32_bf16 a[196:199], v[48:51], v[20:23], a[196:199]
    ds_read_b64_tr_b16 v[62:63], v66 offset:17408
    v_mfma_f32_16x16x32_bf16 a[200:203], v[48:51], v[24:27], a[200:203]
    v_mfma_f32_16x16x32_bf16 a[204:207], v[48:51], v[28:31], a[204:207]
    s_waitcnt lgkmcnt(4)
    v_mfma_f32_16x16x32_bf16 a[208:211], v[52:55], v[16:19], a[208:211]
    ds_read_b64_tr_b16 v[48:49], v66 offset:256
    v_mfma_f32_16x16x32_bf16 a[212:215], v[52:55], v[20:23], a[212:215]
    ds_read_b64_tr_b16 v[50:51], v66 offset:17152
    v_mfma_f32_16x16x32_bf16 a[216:219], v[52:55], v[24:27], a[216:219]
    v_mfma_f32_16x16x32_bf16 a[220:223], v[52:55], v[28:31], a[220:223]
    s_waitcnt lgkmcnt(4)
    v_mfma_f32_16x16x32_bf16 a[224:227], v[56:59], v[16:19], a[224:227]
    ds_read_b64_tr_b16 v[52:53], v66 offset:544
    v_mfma_f32_16x16x32_bf16 a[228:231], v[56:59], v[20:23], a[228:231]
    ds_read_b64_tr_b16 v[54:55], v66 offset:17440
    v_mfma_f32_16x16x32_bf16 a[232:235], v[56:59], v[24:27], a[232:235]
    s_waitcnt vmcnt(12)
    s_barrier
    v_mfma_f32_16x16x32_bf16 a[236:239], v[56:59], v[28:31], a[236:239]
    s_waitcnt lgkmcnt(4)
    v_mfma_f32_16x16x32_bf16 a[240:243], v[60:63], v[16:19], a[240:243]
    ds_read_b64_tr_b16 v[56:57], v71 offset:0
    v_mfma_f32_16x16x32_bf16 a[244:247], v[60:63], v[20:23], a[244:247]
    ds_read_b64_tr_b16 v[58:59], v71 offset:16896
    v_mfma_f32_16x16x32_bf16 a[248:251], v[60:63], v[24:27], a[248:251]
    v_mfma_f32_16x16x32_bf16 a[252:255], v[60:63], v[28:31], a[252:255]
    s_waitcnt lgkmcnt(4)
    v_mfma_f32_16x16x32_bf16 v[96:99], v[48:51], v[16:19], v[96:99]
    ds_read_b64_tr_b16 v[60:61], v71 offset:8
    v_mfma_f32_16x16x32_bf16 v[100:103], v[48:51], v[20:23], v[100:103]
    ds_read_b64_tr_b16 v[62:63], v71 offset:16904
    v_mfma_f32_16x16x32_bf16 v[104:107], v[48:51], v[24:27], v[104:107]
    v_mfma_f32_16x16x32_bf16 v[108:111], v[48:51], v[28:31], v[108:111]
    s_waitcnt lgkmcnt(4)
    v_mfma_f32_16x16x32_bf16 v[112:115], v[52:55], v[16:19], v[112:115]
    ds_read_b64_tr_b16 v[48:49], v71 offset:64
    v_mfma_f32_16x16x32_bf16 v[116:119], v[52:55], v[20:23], v[116:119]
    ds_read_b64_tr_b16 v[50:51], v71 offset:16960
    v_mfma_f32_16x16x32_bf16 v[120:123], v[52:55], v[24:27], v[120:123]
    s_waitcnt vmcnt(8)
    v_mfma_f32_16x16x32_bf16 v[124:127], v[52:55], v[28:31], v[124:127]
    s_waitcnt lgkmcnt(4)
    s_sub_u32 s27, s27, 1
    s_cmp_lg_u32 s27, 0
    s_cbranch_scc1 L_proj
    v_mfma_f32_16x16x32_bf16 v[128:131], v[56:59], v[32:35], v[128:131]
    ds_read_b64_tr_b16 v[52:53], v71 offset:72
    v_mfma_f32_16x16x32_bf16 v[132:135], v[56:59], v[36:39], v[132:135]
    ds_read_b64_tr_b16 v[54:55], v71 offset:16968
    v_mfma_f32_16x16x32_bf16 v[136:139], v[56:59], v[40:43], v[136:139]
    buffer_load_dwordx4 v[16:19], v6, s[12:15], s35 offen
    v_mfma_f32_16x16x32_bf16 v[140:143], v[56:59], v[44:47], v[140:143]
    s_waitcnt lgkmcnt(4)
    v_mfma_f32_16x16x32_bf16 v[144:147], v[60:63], v[32:35], v[144:147]
    ds_read_b64_tr_b16 v[56:57], v71 offset:128
    v_mfma_f32_16x16x32_bf16 v[148:151], v[60:63], v[36:39], v[148:151]
    ds_read_b64_tr_b16 v[58:59], v71 offset:17024
    v_mfma_f32_16x16x32_bf16 v[152:155], v[60:63], v[40:43], v[152:155]
    buffer_load_dwordx4 v[20:23], v7, s[12:15], s35 offen
    v_mfma_f32_16x16x32_bf16 v[156:159], v[60:63], v[44:47], v[156:159]
    s_waitcnt lgkmcnt(4)
    v_mfma_f32_16x16x32_bf16 v[160:163], v[48:51], v[32:35], v[160:163]
    ds_read_b64_tr_b16 v[60:61], v71 offset:136
    v_mfma_f32_16x16x32_bf16 v[164:167], v[48:51], v[36:39], v[164:167]
    ds_read_b64_tr_b16 v[62:63], v71 offset:17032
    v_mfma_f32_16x16x32_bf16 v[168:171], v[48:51], v[40:43], v[168:171]
    buffer_load_dwordx4 v[24:27], v8, s[12:15], s35 offen
    v_mfma_f32_16x16x32_bf16 v[172:175], v[48:51], v[44:47], v[172:175]
    s_waitcnt lgkmcnt(4)
    v_mfma_f32_16x16x32_bf16 v[176:179], v[52:55], v[32:35], v[176:179]
    ds_read_b64_tr_b16 v[48:49], v71 offset:192
    v_mfma_f32_16x16x32_bf16 v[180:183], v[52:55], v[36:39], v[180:183]
    ds_read_b64_tr_b16 v[50:51], v71 offset:17088
    v_mfma_f32_16x16x32_bf16 v[184:187], v[52:55], v[40:43], v[184:187]
    buffer_load_dwordx4 v[28:31], v9, s[12:15], s35 offen
    v_mfma_f32_16x16x32_bf16 v[188:191], v[52:55], v[44:47], v[188:191]
    s_waitcnt lgkmcnt(4)
    v_mfma_f32_16x16x32_bf16 v[192:195], v[56:59], v[32:35], v[192:195]
    s_add_u32 s35, s35, 1024
    ds_read_b64_tr_b16 v[52:53], v71 offset:200
    v_mfma_f32_16x16x32_bf16 v[196:199], v[56:59], v[36:39], v[196:199]
    s_add_u32 m0, s36, 33792
    ds_read_b64_tr_b16 v[54:55], v71 offset:17096
    v_mfma_f32_16x16x32_bf16 v[200:203], v[56:59], v[40:43], v[200:203]
    global_load_lds_dwordx4 v[2:3], off
    v_mfma_f32_16x16x32_bf16 v[204:207], v[56:59], v[44:47], v[204:207]
    s_waitcnt lgkmcnt(4)
    v_lshl_add_u64 v[2:3], v[4:5], 0, v[2:3]
    v_mfma_f32_16x16x32_bf16 v[208:211], v[60:63], v[32:35], v[208:211]
    ds_read_b64_tr_b16 v[56:57], v67 offset:0
    v_mfma_f32_16x16x32_bf16 v[212:215], v[60:63], v[36:39], v[212:215]
    s_add_u32 m0, s36, 50688
    ds_read_b64_tr_b16 v[58:59], v67 offset:16896
    v_mfma_f32_16x16x32_bf16 v[216:219], v[60:63], v[40:43], v[216:219]
    global_load_lds_dwordx4 v[2:3], off
    v_mfma_f32_16x16x32_bf16 v[220:223], v[60:63], v[44:47], v[220:223]
    s_waitcnt lgkmcnt(4)
    v_lshl_add_u64 v[2:3], v[4:5], 0, v[2:3]
    v_mfma_f32_16x16x32_bf16 v[224:227], v[48:51], v[32:35], v[224:227]
    ds_read_b64_tr_b16 v[60:61], v67 offset:288
    v_mfma_f32_16x16x32_bf16 v[228:231], v[48:51], v[36:39], v[228:231]
    s_add_u32 m0, s36, 38016
    ds_read_b64_tr_b16 v[62:63], v67 offset:17184
    v_mfma_f32_16x16x32_bf16 v[232:235], v[48:51], v[40:43], v[232:235]
    global_load_lds_dwordx4 v[2:3], off
    v_mfma_f32_16x16x32_bf16 v[236:239], v[48:51], v[44:47], v[236:239]
    s_waitcnt lgkmcnt(4)
    v_lshl_add_u64 v[2:3], v[4:5], 0, v[2:3]
    v_mfma_f32_16x16x32_bf16 v[240:243], v[52:55], v[32:35], v[240:243]
    ds_read_b64_tr_b16 v[48:49], v67 offset:32
    v_mfma_f32_16x16x32_bf16 v[244:247], v[52:55], v[36:39], v[244:247]
    s_add_u32 m0, s36, 54912
    ds_read_b64_tr_b16 v[50:51], v67 offset:16928
    v_mfma_f32_16x16x32_bf16 v[248:251], v[52:55], v[40:43], v[248:251]
    global_load_lds_dwordx4 v[2:3], off
    v_mfma_f32_16x16x32_bf16 v[252:255], v[52:55], v[44:47], v[252:255]
    s_waitcnt lgkmcnt(4)
    v_lshl_add_u64 v[2:3], v[4:5], 0, v[2:3]
    v_mfma_f32_16x16x32_bf16 a[0:3], v[56:59], v[32:35], a[0:3]
    ds_read_b64_tr_b16 v[52:53], v67 offset:320
    v_mfma_f32_16x16x32_bf16 a[4:7], v[56:59], v[36:39], a[4:7]
    s_add_u32 m0, s36, 42240
    ds_read_b64_tr_b16 v[54:55], v67 offset:17216
    v_mfma_f32_16x16x32_bf16 a[8:11], v[56:59], v[40:43], a[8:11]
    global_load_lds_dwordx4 v[2:3], off
    v_mfma_f32_16x16x32_bf16 a[12:15], v[56:59], v[44:47], a[12:15]
    s_waitcnt lgkmcnt(4)
    v_lshl_add_u64 v[2:3], v[4:5], 0, v[2:3]
    v_mfma_f32_16x16x32_bf16 a[16:19], v[60:63], v[32:35], a[16:19]
    ds_read_b64_tr_b16 v[56:57], v67 offset:64
    v_mfma_f32_16x16x32_bf16 a[20:23], v[60:63], v[36:39], a[20:23]
    s_add_u32 m0, s36, 59136
    ds_read_b64_tr_b16 v[58:59], v67 offset:16960
    v_mfma_f32_16x16x32_bf16 a[24:27], v[60:63], v[40:43], a[24:27]
    global_load_lds_dwordx4 v[2:3], off
    v_mfma_f32_16x16x32_bf16 a[28:31], v[60:63], v[44:47], a[28:31]
    s_waitcnt lgkmcnt(4)
    v_lshl_add_u64 v[2:3], v[4:5], 0, v[2:3]
    v_mfma_f32_16x16x32_bf16 a[32:35], v[48:51], v[32:35], a[32:35]
    ds_read_b64_tr_b16 v[60:61], v67 offset:352
    v_mfma_f32_16x16x32_bf16 a[36:39], v[48:51], v[36:39], a[36:39]
    s_add_u32 m0, s36, 46464
    ds_read_b64_tr_b16 v[62:63], v67 offset:17248
    v_mfma_f32_16x16x32_bf16 a[40:43], v[48:51], v[40:43], a[40:43]
    global_load_lds_dwordx4 v[2:3], off
    v_mfma_f32_16x16x32_bf16 a[44:47], v[48:51], v[44:47], a[44:47]
    s_waitcnt lgkmcnt(4)
    v_lshl_add_u64 v[2:3], v[4:5], 0, v[2:3]
    v_mfma_f32_16x16x32_bf16 a[48:51], v[52:55], v[32:35], a[48:51]
    ds_read_b64_tr_b16 v[48:49], v67 offset:96
    v_mfma_f32_16x16x32_bf16 a[52:55], v[52:55], v[36:39], a[52:55]
    s_add_u32 m0, s36, 63360
    ds_read_b64_tr_b16 v[50:51], v67 offset:16992
    v_mfma_f32_16x16x32_bf16 a[56:59], v[52:55], v[40:43], a[56:59]
    global_load_lds_dwordx4 v[2:3], off
    v_mfma_f32_16x16x32_bf16 a[60:63], v[52:55], v[44:47], a[60:63]
    s_waitcnt lgkmcnt(4)
    v_lshl_add_u64 v[2:3], v[4:5], 0, v[2:3]
    v_mfma_f32_16x16x32_bf16 a[64:67], v[56:59], v[32:35], a[64:67]
    ds_read_b64_tr_b16 v[52:53], v67 offset:384
    v_mfma_f32_16x16x32_bf16 a[68:71], v[56:59], v[36:39], a[68:71]
    ds_read_b64_tr_b16 v[54:55], v67 offset:17280
    v_mfma_f32_16x16x32_bf16 a[72:75], v[56:59], v[40:43], a[72:75]
    v_mfma_f32_16x16x32_bf16 a[76:79], v[56:59], v[44:47], a[76:79]
    s_waitcnt lgkmcnt(4)
    v_mfma_f32_16x16x32_bf16 a[80:83], v[60:63], v[32:35], a[80:83]
    ds_read_b64_tr_b16 v[56:57], v67 offset:128
    v_mfma_f32_16x16x32_bf16 a[84:87], v[60:63], v[36:39], a[84:87]
    ds_read_b64_tr_b16 v[58:59], v67 offset:17024
    v_mfma_f32_16x16x32_bf16 a[88:91], v[60:63], v[40:43], a[88:91]
    v_mfma_f32_16x16x32_bf16 a[92:95], v[60:63], v[44:47], a[92:95]
    s_waitcnt lgkmcnt(4)
    v_mfma_f32_16x16x32_bf16 a[96:99], v[48:51], v[32:35], a[96:99]
    ds_read_b64_tr_b16 v[60:61], v67 offset:416
    v_mfma_f32_16x16x32_bf16 a[100:103], v[48:51], v[36:39], a[100:103]
    ds_read_b64_tr_b16 v[62:63], v67 offset:17312
    v_mfma_f32_16x16x32_bf16 a[104:107], v[48:51], v[40:43], a[104:107]
    v_mfma_f32_16x16x32_bf16 a[108:111], v[48:51], v[44:47], a[108:111]
    s_waitcnt lgkmcnt(4)
    v_mfma_f32_16x16x32_bf16 a[112:115], v[52:55], v[32:35], a[112:115]
    ds_read_b64_tr_b16 v[48:49], v67 offset:160
    v_mfma_f32_16x16x32_bf16 a[116:119], v[52:55], v[36:39], a[116:119]
    ds_read_b64_tr_b16 v[50:51], v67 offset:17056
    v_mfma_f32_16x16x32_bf16 a[120:123], v[52:55], v[40:43], a[120:123]
    v_mfma_f32_16x16x32_bf16 a[124:127], v[52:55], v[44:47], a[124:127]
    s_waitcnt lgkmcnt(4)
    v_mfma_f32_16x16x32_bf16 a[128:131], v[56:59], v[32:35], a[128:131]
    ds_read_b64_tr_b16 v[52:53], v67 offset:448
    v_mfma_f32_16x16x32_bf16 a[132:135], v[56:59], v[36:39], a[132:135]
    ds_read_b64_tr_b16 v[54:55], v67 offset:17344
    v_mfma_f32_16x16x32_bf16 a[136:139], v[56:59], v[40:43], a[136:139]
    v_mfma_f32_16x16x32_bf16 a[140:143], v[56:59], v[44:47], a[140:143]
    s_waitcnt lgkmcnt(4)
    v_mfma_f32_16x16x32_bf16 a[144:147], v[60:63], v[32:35], a[144:147]
    ds_read_b64_tr_b16 v[56:57], v67 offset:192
    v_mfma_f32_16x16x32_bf16 a[148:151], v[60:63], v[36:39], a[148:151]
    ds_read_b64_tr_b16 v[58:59], v67 offset:17088
    v_mfma_f32_16x16x32_bf16 a[152:155], v[60:63], v[40:43], a[152:155]
    v_mfma_f32_16x16x32_bf16 a[156:159], v[60:63], v[44:47], a[156:159]
    s_waitcnt lgkmcnt(4)
    v_mfma_f32_16x16x32_bf16 a[160:163], v[48:51], v[32:35], a[160:163]
    ds_read_b64_tr_b16 v[60:61], v67 offset:480
    v_mfma_f32_16x16x32_bf16 a[164:167], v[48:51], v[36:39], a[164:167]
    ds_read_b64_tr_b16 v[62:63], v67 offset:17376
    v_mfma_f32_16x16x32_bf16 a[168:171], v[48:51], v[40:43], a[168:171]
    v_mfma_f32_16x16x32_bf16 a[172:175], v[48:51], v[44:47], a[172:175]
    s_waitcnt lgkmcnt(4)
    v_mfma_f32_16x16x32_bf16 a[176:179], v[52:55], v[32:35], a[176:179]
    ds_read_b64_tr_b16 v[48:49], v67 offset:224
    v_mfma_f32_16x16x32_bf16 a[180:183], v[52:55], v[36:39], a[180:183]
    ds_read_b64_tr_b16 v[50:51], v67 offset:17120
    v_mfma_f32_16x16x32_bf16 a[184:187], v[52:55], v[40:43], a[184:187]
    v_mfma_f32_16x16x32_bf16 a[188:191], v[52:55], v[44:47], a[188:191]
    s_waitcnt lgkmcnt(4)
    v_mfma_f32_16x16x32_bf16 a[192:195], v[56:59], v[32:35], a[192:195]
    ds_read_b64_tr_b16 v[52:53], v67 offset:512
    v_mfma_f32_16x16x32_bf16 a[196:199], v[56:59], v[36:39], a[196:199]
    ds_read_b64_tr_b16 v[54:55], v67 offset:17408
    v_mfma_f32_16x16x32_bf16 a[200:203], v[56:59], v[40:43], a[200:203]
    v_mfma_f32_16x16x32_bf16 a[204:207], v[56:59], v[44:47], a[204:207]
    s_waitcnt lgkmcnt(4)
    v_mfma_f32_16x16x32_bf16 a[208:211], v[60:63], v[32:35], a[208:211]
    ds_read_b64_tr_b16 v[56:57], v67 offset:256
    v_mfma_f32_16x16x32_bf16 a[212:215], v[60:63], v[36:39], a[212:215]
    ds_read_b64_tr_b16 v[58:59], v67 offset:17152
    v_mfma_f32_16x16x32_bf16 a[216:219], v[60:63], v[40:43], a[216:219]
    v_mfma_f32_16x16x32_bf16 a[220:223], v[60:63], v[44:47], a[220:223]
    s_waitcnt lgkmcnt(4)
    v_mfma_f32_16x16x32_bf16 a[224:227], v[48:51], v[32:35], a[224:227]
    ds_read_b64_tr_b16 v[60:61], v67 offset:544
    v_mfma_f32_16x16x32_bf16 a[228:231], v[48:51], v[36:39], a[228:231]
    ds_read_b64_tr_b16 v[62:63], v67 offset:17440
    v_mfma_f32_16x16x32_bf16 a[232:235], v[48:51], v[40:43], a[232:235]
    s_waitcnt vmcnt(12)
    s_barrier
    v_mfma_f32_16x16x32_bf16 a[236:239], v[48:51], v[44:47], a[236:239]
    s_waitcnt lgkmcnt(4)
    v_mfma_f32_16x16x32_bf16 a[240:243], v[52:55], v[32:35], a[240:243]
    ds_read_b64_tr_b16 v[48:49], v68 offset:0
    v_mfma_f32_16x16x32_bf16 a[244:247], v[52:55], v[36:39], a[244:247]
    ds_read_b64_tr_b16 v[50:51], v68 offset:16896
    v_mfma_f32_16x16x32_bf16 a[248:251], v[52:55], v[40:43], a[248:251]
    v_mfma_f32_16x16x32_bf16 a[252:255], v[52:55], v[44:47], a[252:255]
    s_waitcnt lgkmcnt(4)
    v_mfma_f32_16x16x32_bf16 v[96:99], v[56:59], v[32:35], v[96:99]
    ds_read_b64_tr_b16 v[52:53], v68 offset:8
    v_mfma_f32_16x16x32_bf16 v[100:103], v[56:59], v[36:39], v[100:103]
    ds_read_b64_tr_b16 v[54:55], v68 offset:16904
    v_mfma_f32_16x16x32_bf16 v[104:107], v[56:59], v[40:43], v[104:107]
    v_mfma_f32_16x16x32_bf16 v[108:111], v[56:59], v[44:47], v[108:111]
    s_waitcnt lgkmcnt(4)
    v_mfma_f32_16x16x32_bf16 v[112:115], v[60:63], v[32:35], v[112:115]
    ds_read_b64_tr_b16 v[56:57], v68 offset:64
    v_mfma_f32_16x16x32_bf16 v[116:119], v[60:63], v[36:39], v[116:119]
    ds_read_b64_tr_b16 v[58:59], v68 offset:16960
    v_mfma_f32_16x16x32_bf16 v[120:123], v[60:63], v[40:43], v[120:123]
    s_waitcnt vmcnt(8)
    v_mfma_f32_16x16x32_bf16 v[124:127], v[60:63], v[44:47], v[124:127]
    s_waitcnt lgkmcnt(4)
    v_mfma_f32_16x16x32_bf16 v[128:131], v[48:51], v[16:19], v[128:131]
    ds_read_b64_tr_b16 v[60:61], v68 offset:72
    v_mfma_f32_16x16x32_bf16 v[132:135], v[48:51], v[20:23], v[132:135]
    ds_read_b64_tr_b16 v[62:63], v68 offset:16968
    v_mfma_f32_16x16x32_bf16 v[136:139], v[48:51], v[24:27], v[136:139]
    buffer_load_dwordx4 v[32:35], v6, s[12:15], s35 offen
    v_mfma_f32_16x16x32_bf16 v[140:143], v[48:51], v[28:31], v[140:143]
    s_waitcnt lgkmcnt(4)
    v_mfma_f32_16x16x32_bf16 v[144:147], v[52:55], v[16:19], v[144:147]
    ds_read_b64_tr_b16 v[48:49], v68 offset:128
    v_mfma_f32_16x16x32_bf16 v[148:151], v[52:55], v[20:23], v[148:151]
    ds_read_b64_tr_b16 v[50:51], v68 offset:17024
    v_mfma_f32_16x16x32_bf16 v[152:155], v[52:55], v[24:27], v[152:155]
    buffer_load_dwordx4 v[36:39], v7, s[12:15], s35 offen
    v_mfma_f32_16x16x32_bf16 v[156:159], v[52:55], v[28:31], v[156:159]
    s_waitcnt lgkmcnt(4)
    v_mfma_f32_16x16x32_bf16 v[160:163], v[56:59], v[16:19], v[160:163]
    ds_read_b64_tr_b16 v[52:53], v68 offset:136
    v_mfma_f32_16x16x32_bf16 v[164:167], v[56:59], v[20:23], v[164:167]
    ds_read_b64_tr_b16 v[54:55], v68 offset:17032
    v_mfma_f32_16x16x32_bf16 v[168:171], v[56:59], v[24:27], v[168:171]
    buffer_load_dwordx4 v[40:43], v8, s[12:15], s35 offen
    v_mfma_f32_16x16x32_bf16 v[172:175], v[56:59], v[28:31], v[172:175]
    s_waitcnt lgkmcnt(4)
    v_mfma_f32_16x16x32_bf16 v[176:179], v[60:63], v[16:19], v[176:179]
    ds_read_b64_tr_b16 v[56:57], v68 offset:192
    v_mfma_f32_16x16x32_bf16 v[180:183], v[60:63], v[20:23], v[180:183]
    ds_read_b64_tr_b16 v[58:59], v68 offset:17088
    v_mfma_f32_16x16x32_bf16 v[184:187], v[60:63], v[24:27], v[184:187]
    buffer_load_dwordx4 v[44:47], v9, s[12:15], s35 offen
    v_mfma_f32_16x16x32_bf16 v[188:191], v[60:63], v[28:31], v[188:191]
    s_waitcnt lgkmcnt(4)
    v_mfma_f32_16x16x32_bf16 v[192:195], v[48:51], v[16:19], v[192:195]
    s_add_u32 s35, s35, 1024
    ds_read_b64_tr_b16 v[60:61], v68 offset:200
    v_mfma_f32_16x16x32_bf16 v[196:199], v[48:51], v[20:23], v[196:199]
    s_add_u32 m0, s36, 67584
    ds_read_b64_tr_b16 v[62:63], v68 offset:17096
    v_mfma_f32_16x16x32_bf16 v[200:203], v[48:51], v[24:27], v[200:203]
    global_load_lds_dwordx4 v[2:3], off
    v_mfma_f32_16x16x32_bf16 v[204:207], v[48:51], v[28:31], v[204:207]
    s_waitcnt lgkmcnt(4)
    v_lshl_add_u64 v[2:3], v[4:5], 0, v[2:3]
    v_mfma_f32_16x16x32_bf16 v[208:211], v[52:55], v[16:19], v[208:211]
    ds_read_b64_tr_b16 v[48:49], v64 offset:0
    v_mfma_f32_16x16x32_bf16 v[212:215], v[52:55], v[20:23], v[212:215]
    s_add_u32 m0, s36, 84480
    ds_read_b64_tr_b16 v[50:51], v64 offset:16896
    v_mfma_f32_16x16x32_bf16 v[216:219], v[52:55], v[24:27], v[216:219]
    global_load_lds_dwordx4 v[2:3], off
    v_mfma_f32_16x16x32_bf16 v[220:223], v[52:55], v[28:31], v[220:223]
    s_waitcnt lgkmcnt(4)
    v_lshl_add_u64 v[2:3], v[4:5], 0, v[2:3]
    v_mfma_f32_16x16x32_bf16 v[224:227], v[56:59], v[16:19], v[224:227]
    ds_read_b64_tr_b16 v[52:53], v64 offset:288
    v_mfma_f32_16x16x32_bf16 v[228:231], v[56:59], v[20:23], v[228:231]
    s_add_u32 m0, s36, 71808
    ds_read_b64_tr_b16 v[54:55], v64 offset:17184
    v_mfma_f32_16x16x32_bf16 v[232:235], v[56:59], v[24:27], v[232:235]
    global_load_lds_dwordx4 v[2:3], off
    v_mfma_f32_16x16x32_bf16 v[236:239], v[56:59], v[28:31], v[236:239]
    s_waitcnt lgkmcnt(4)
    v_lshl_add_u64 v[2:3], v[4:5], 0, v[2:3]
    v_mfma_f32_16x16x32_bf16 v[240:243], v[60:63], v[16:19], v[240:243]
    ds_read_b64_tr_b16 v[56:57], v64 offset:32
    v_mfma_f32_16x16x32_bf16 v[244:247], v[60:63], v[20:23], v[244:247]
    s_add_u32 m0, s36, 88704
    ds_read_b64_tr_b16 v[58:59], v64 offset:16928
    v_mfma_f32_16x16x32_bf16 v[248:251], v[60:63], v[24:27], v[248:251]
    global_load_lds_dwordx4 v[2:3], off
    v_mfma_f32_16x16x32_bf16 v[252:255], v[60:63], v[28:31], v[252:255]
    s_waitcnt lgkmcnt(4)
    v_lshl_add_u64 v[2:3], v[4:5], 0, v[2:3]
    v_mfma_f32_16x16x32_bf16 a[0:3], v[48:51], v[16:19], a[0:3]
    ds_read_b64_tr_b16 v[60:61], v64 offset:320
    v_mfma_f32_16x16x32_bf16 a[4:7], v[48:51], v[20:23], a[4:7]
    s_add_u32 m0, s36, 76032
    ds_read_b64_tr_b16 v[62:63], v64 offset:17216
    v_mfma_f32_16x16x32_bf16 a[8:11], v[48:51], v[24:27], a[8:11]
    global_load_lds_dwordx4 v[2:3], off
    v_mfma_f32_16x16x32_bf16 a[12:15], v[48:51], v[28:31], a[12:15]
    s_waitcnt lgkmcnt(4)
    v_lshl_add_u64 v[2:3], v[4:5], 0, v[2:3]
    v_mfma_f32_16x16x32_bf16 a[16:19], v[52:55], v[16:19], a[16:19]
    ds_read_b64_tr_b16 v[48:49], v64 offset:64
    v_mfma_f32_16x16x32_bf16 a[20:23], v[52:55], v[20:23], a[20:23]
    s_add_u32 m0, s36, 92928
    ds_read_b64_tr_b16 v[50:51], v64 offset:16960
    v_mfma_f32_16x16x32_bf16 a[24:27], v[52:55], v[24:27], a[24:27]
    global_load_lds_dwordx4 v[2:3], off
    v_mfma_f32_16x16x32_bf16 a[28:31], v[52:55], v[28:31], a[28:31]
    s_waitcnt lgkmcnt(4)
    v_lshl_add_u64 v[2:3], v[4:5], 0, v[2:3]
    v_mfma_f32_16x16x32_bf16 a[32:35], v[56:59], v[16:19], a[32:35]
    ds_read_b64_tr_b16 v[52:53], v64 offset:352
    v_mfma_f32_16x16x32_bf16 a[36:39], v[56:59], v[20:23], a[36:39]
    s_add_u32 m0, s36, 80256
    ds_read_b64_tr_b16 v[54:55], v64 offset:17248
    v_mfma_f32_16x16x32_bf16 a[40:43], v[56:59], v[24:27], a[40:43]
    global_load_lds_dwordx4 v[2:3], off
    v_mfma_f32_16x16x32_bf16 a[44:47], v[56:59], v[28:31], a[44:47]
    s_waitcnt lgkmcnt(4)
    v_lshl_add_u64 v[2:3], v[4:5], 0, v[2:3]
    v_mfma_f32_16x16x32_bf16 a[48:51], v[60:63], v[16:19], a[48:51]
    ds_read_b64_tr_b16 v[56:57], v64 offset:96
    v_mfma_f32_16x16x32_bf16 a[52:55], v[60:63], v[20:23], a[52:55]
    s_add_u32 m0, s36, 97152
    ds_read_b64_tr_b16 v[58:59], v64 offset:16992
    v_mfma_f32_16x16x32_bf16 a[56:59], v[60:63], v[24:27], a[56:59]
    global_load_lds_dwordx4 v[2:3], off
    v_mfma_f32_16x16x32_bf16 a[60:63], v[60:63], v[28:31], a[60:63]
    s_waitcnt lgkmcnt(4)
    v_lshl_add_u64 v[2:3], v[4:5], 0, v[2:3]
    v_mfma_f32_16x16x32_bf16 a[64:67], v[48:51], v[16:19], a[64:67]
    ds_read_b64_tr_b16 v[60:61], v64 offset:384
    v_mfma_f32_16x16x32_bf16 a[68:71], v[48:51], v[20:23], a[68:71]
    s_add_u32 m0, s29, 0
    ds_read_b64_tr_b16 v[62:63], v64 offset:17280
    v_mfma_f32_16x16x32_bf16 a[72:75], v[48:51], v[24:27], a[72:75]
    buffer_load_dwordx4 v10, s[4:7], s28 offen offset:0 lds
    v_mfma_f32_16x16x32_bf16 a[76:79], v[48:51], v[28:31], a[76:79]
    s_waitcnt lgkmcnt(4)
    v_mfma_f32_16x16x32_bf16 a[80:83], v[52:55], v[16:19], a[80:83]
    ds_read_b64_tr_b16 v[48:49], v64 offset:128
    v_mfma_f32_16x16x32_bf16 a[84:87], v[52:55], v[20:23], a[84:87]
    ds_read_b64_tr_b16 v[50:51], v64 offset:17024
    v_mfma_f32_16x16x32_bf16 a[88:91], v[52:55], v[24:27], a[88:91]
    buffer_load_dwordx4 v10, s[4:7], s28 offen offset:1024 lds
    v_mfma_f32_16x16x32_bf16 a[92:95], v[52:55], v[28:31], a[92:95]
    s_waitcnt lgkmcnt(4)
    v_mfma_f32_16x16x32_bf16 a[96:99], v[56:59], v[16:19], a[96:99]
    ds_read_b64_tr_b16 v[52:53], v64 offset:416
    v_mfma_f32_16x16x32_bf16 a[100:103], v[56:59], v[20:23], a[100:103]
    ds_read_b64_tr_b16 v[54:55], v64 offset:17312
    v_mfma_f32_16x16x32_bf16 a[104:107], v[56:59], v[24:27], a[104:107]
    buffer_load_dwordx4 v10, s[4:7], s28 offen offset:2048 lds
    v_mfma_f32_16x16x32_bf16 a[108:111], v[56:59], v[28:31], a[108:111]
    s_waitcnt lgkmcnt(4)
    v_mfma_f32_16x16x32_bf16 a[112:115], v[60:63], v[16:19], a[112:115]
    ds_read_b64_tr_b16 v[56:57], v64 offset:160
    v_mfma_f32_16x16x32_bf16 a[116:119], v[60:63], v[20:23], a[116:119]
    ds_read_b64_tr_b16 v[58:59], v64 offset:17056
    v_mfma_f32_16x16x32_bf16 a[120:123], v[60:63], v[24:27], a[120:123]
    buffer_load_dwordx4 v10, s[4:7], s28 offen offset:3072 lds
    v_mfma_f32_16x16x32_bf16 a[124:127], v[60:63], v[28:31], a[124:127]
    s_waitcnt lgkmcnt(4)
    v_mfma_f32_16x16x32_bf16 a[128:131], v[48:51], v[16:19], a[128:131]
    ds_read_b64_tr_b16 v[60:61], v64 offset:448
    v_mfma_f32_16x16x32_bf16 a[132:135], v[48:51], v[20:23], a[132:135]
    s_add_u32 s28, s28, 16384
    ds_read_b64_tr_b16 v[62:63], v64 offset:17344
    v_mfma_f32_16x16x32_bf16 a[136:139], v[48:51], v[24:27], a[136:139]
    s_bitset0_b32 s28, 19
    v_mfma_f32_16x16x32_bf16 a[140:143], v[48:51], v[28:31], a[140:143]
    s_waitcnt lgkmcnt(4)
    v_mfma_f32_16x16x32_bf16 a[144:147], v[52:55], v[16:19], a[144:147]
    ds_read_b64_tr_b16 v[48:49], v64 offset:192
    v_mfma_f32_16x16x32_bf16 a[148:151], v[52:55], v[20:23], a[148:151]
    ds_read_b64_tr_b16 v[50:51], v64 offset:17088
    v_mfma_f32_16x16x32_bf16 a[152:155], v[52:55], v[24:27], a[152:155]
    v_mfma_f32_16x16x32_bf16 a[156:159], v[52:55], v[28:31], a[156:159]
    s_waitcnt lgkmcnt(4)
    v_mfma_f32_16x16x32_bf16 a[160:163], v[56:59], v[16:19], a[160:163]
    ds_read_b64_tr_b16 v[52:53], v64 offset:480
    v_mfma_f32_16x16x32_bf16 a[164:167], v[56:59], v[20:23], a[164:167]
    ds_read_b64_tr_b16 v[54:55], v64 offset:17376
    v_mfma_f32_16x16x32_bf16 a[168:171], v[56:59], v[24:27], a[168:171]
    v_mfma_f32_16x16x32_bf16 a[172:175], v[56:59], v[28:31], a[172:175]
    s_waitcnt lgkmcnt(4)
    v_mfma_f32_16x16x32_bf16 a[176:179], v[60:63], v[16:19], a[176:179]
    ds_read_b64_tr_b16 v[56:57], v64 offset:224
    v_mfma_f32_16x16x32_bf16 a[180:183], v[60:63], v[20:23], a[180:183]
    ds_read_b64_tr_b16 v[58:59], v64 offset:17120
    v_mfma_f32_16x16x32_bf16 a[184:187], v[60:63], v[24:27], a[184:187]
    v_mfma_f32_16x16x32_bf16 a[188:191], v[60:63], v[28:31], a[188:191]
    s_waitcnt lgkmcnt(4)
    v_mfma_f32_16x16x32_bf16 a[192:195], v[48:51], v[16:19], a[192:195]
    ds_read_b64_tr_b16 v[60:61], v64 offset:512
    v_mfma_f32_16x16x32_bf16 a[196:199], v[48:51], v[20:23], a[196:199]
    ds_read_b64_tr_b16 v[62:63], v64 offset:17408
    v_mfma_f32_16x16x32_bf16 a[200:203], v[48:51], v[24:27], a[200:203]
    v_mfma_f32_16x16x32_bf16 a[204:207], v[48:51], v[28:31], a[204:207]
    s_waitcnt lgkmcnt(4)
    v_mfma_f32_16x16x32_bf16 a[208:211], v[52:55], v[16:19], a[208:211]
    ds_read_b64_tr_b16 v[48:49], v64 offset:256
    v_mfma_f32_16x16x32_bf16 a[212:215], v[52:55], v[20:23], a[212:215]
    ds_read_b64_tr_b16 v[50:51], v64 offset:17152
    v_mfma_f32_16x16x32_bf16 a[216:219], v[52:55], v[24:27], a[216:219]
    v_mfma_f32_16x16x32_bf16 a[220:223], v[52:55], v[28:31], a[220:223]
    s_waitcnt lgkmcnt(4)
    v_mfma_f32_16x16x32_bf16 a[224:227], v[56:59], v[16:19], a[224:227]
    ds_read_b64_tr_b16 v[52:53], v64 offset:544
    v_mfma_f32_16x16x32_bf16 a[228:231], v[56:59], v[20:23], a[228:231]
    ds_read_b64_tr_b16 v[54:55], v64 offset:17440
    v_mfma_f32_16x16x32_bf16 a[232:235], v[56:59], v[24:27], a[232:235]
    s_waitcnt vmcnt(16)
    s_barrier
    v_mfma_f32_16x16x32_bf16 a[236:239], v[56:59], v[28:31], a[236:239]
    s_waitcnt lgkmcnt(4)
    v_mfma_f32_16x16x32_bf16 a[240:243], v[60:63], v[16:19], a[240:243]
    ds_read_b64_tr_b16 v[56:57], v69 offset:0
    v_mfma_f32_16x16x32_bf16 a[244:247], v[60:63], v[20:23], a[244:247]
    ds_read_b64_tr_b16 v[58:59], v69 offset:16896
    v_mfma_f32_16x16x32_bf16 a[248:251], v[60:63], v[24:27], a[248:251]
    v_mfma_f32_16x16x32_bf16 a[252:255], v[60:63], v[28:31], a[252:255]
    s_waitcnt lgkmcnt(4)
    v_mfma_f32_16x16x32_bf16 v[96:99], v[48:51], v[16:19], v[96:99]
    ds_read_b64_tr_b16 v[60:61], v69 offset:8
    v_mfma_f32_16x16x32_bf16 v[100:103], v[48:51], v[20:23], v[100:103]
    ds_read_b64_tr_b16 v[62:63], v69 offset:16904
    v_mfma_f32_16x16x32_bf16 v[104:107], v[48:51], v[24:27], v[104:107]
    v_mfma_f32_16x16x32_bf16 v[108:111], v[48:51], v[28:31], v[108:111]
    s_waitcnt lgkmcnt(4)
    v_mfma_f32_16x16x32_bf16 v[112:115], v[52:55], v[16:19], v[112:115]
    ds_read_b64_tr_b16 v[48:49], v69 offset:64
    v_mfma_f32_16x16x32_bf16 v[116:119], v[52:55], v[20:23], v[116:119]
    ds_read_b64_tr_b16 v[50:51], v69 offset:16960
    v_mfma_f32_16x16x32_bf16 v[120:123], v[52:55], v[24:27], v[120:123]
    s_waitcnt vmcnt(12)
    v_mfma_f32_16x16x32_bf16 v[124:127], v[52:55], v[28:31], v[124:127]
    s_waitcnt lgkmcnt(4)
    v_mfma_f32_16x16x32_bf16 v[128:131], v[56:59], v[32:35], v[128:131]
    ds_read_b64_tr_b16 v[52:53], v69 offset:72
    v_mfma_f32_16x16x32_bf16 v[132:135], v[56:59], v[36:39], v[132:135]
    ds_read_b64_tr_b16 v[54:55], v69 offset:16968
    v_mfma_f32_16x16x32_bf16 v[136:139], v[56:59], v[40:43], v[136:139]
    buffer_load_dwordx4 v[16:19], v6, s[12:15], s35 offen
    v_mfma_f32_16x16x32_bf16 v[140:143], v[56:59], v[44:47], v[140:143]
    s_waitcnt lgkmcnt(4)
    v_mfma_f32_16x16x32_bf16 v[144:147], v[60:63], v[32:35], v[144:147]
    ds_read_b64_tr_b16 v[56:57], v69 offset:128
    v_mfma_f32_16x16x32_bf16 v[148:151], v[60:63], v[36:39], v[148:151]
    ds_read_b64_tr_b16 v[58:59], v69 offset:17024
    v_mfma_f32_16x16x32_bf16 v[152:155], v[60:63], v[40:43], v[152:155]
    buffer_load_dwordx4 v[20:23], v7, s[12:15], s35 offen
    v_mfma_f32_16x16x32_bf16 v[156:159], v[60:63], v[44:47], v[156:159]
    s_waitcnt lgkmcnt(4)
    v_mfma_f32_16x16x32_bf16 v[160:163], v[48:51], v[32:35], v[160:163]
    ds_read_b64_tr_b16 v[60:61], v69 offset:136
    v_mfma_f32_16x16x32_bf16 v[164:167], v[48:51], v[36:39], v[164:167]
    ds_read_b64_tr_b16 v[62:63], v69 offset:17032
    v_mfma_f32_16x16x32_bf16 v[168:171], v[48:51], v[40:43], v[168:171]
    buffer_load_dwordx4 v[24:27], v8, s[12:15], s35 offen
    v_mfma_f32_16x16x32_bf16 v[172:175], v[48:51], v[44:47], v[172:175]
    s_waitcnt lgkmcnt(4)
    v_mfma_f32_16x16x32_bf16 v[176:179], v[52:55], v[32:35], v[176:179]
    ds_read_b64_tr_b16 v[48:49], v69 offset:192
    v_mfma_f32_16x16x32_bf16 v[180:183], v[52:55], v[36:39], v[180:183]
    ds_read_b64_tr_b16 v[50:51], v69 offset:17088
    v_mfma_f32_16x16x32_bf16 v[184:187], v[52:55], v[40:43], v[184:187]
    buffer_load_dwordx4 v[28:31], v9, s[12:15], s35 offen
    v_mfma_f32_16x16x32_bf16 v[188:191], v[52:55], v[44:47], v[188:191]
    s_waitcnt lgkmcnt(4)
    v_mfma_f32_16x16x32_bf16 v[192:195], v[56:59], v[32:35], v[192:195]
    s_add_u32 s35, s35, 1024
    ds_read_b64_tr_b16 v[52:53], v69 offset:200
    v_mfma_f32_16x16x32_bf16 v[196:199], v[56:59], v[36:39], v[196:199]
    s_add_u32 m0, s36, 101376
    ds_read_b64_tr_b16 v[54:55], v69 offset:17096
    v_mfma_f32_16x16x32_bf16 v[200:203], v[56:59], v[40:43], v[200:203]
    global_load_lds_dwordx4 v[2:3], off
    v_mfma_f32_16x16x32_bf16 v[204:207], v[56:59], v[44:47], v[204:207]
    s_waitcnt lgkmcnt(4)
    v_lshl_add_u64 v[2:3], v[4:5], 0, v[2:3]
    v_mfma_f32_16x16x32_bf16 v[208:211], v[60:63], v[32:35], v[208:211]
    ds_read_b64_tr_b16 v[56:57], v65 offset:0
    v_mfma_f32_16x16x32_bf16 v[212:215], v[60:63], v[36:39], v[212:215]
    s_add_u32 m0, s36, 118272
    ds_read_b64_tr_b16 v[58:59], v65 offset:16896
    v_mfma_f32_16x16x32_bf16 v[216:219], v[60:63], v[40:43], v[216:219]
    global_load_lds_dwordx4 v[2:3], off
    v_mfma_f32_16x16x32_bf16 v[220:223], v[60:63], v[44:47], v[220:223]
    s_waitcnt lgkmcnt(4)
    v_lshl_add_u64 v[2:3], v[4:5], 0, v[2:3]
    v_mfma_f32_16x16x32_bf16 v[224:227], v[48:51], v[32:35], v[224:227]
    ds_read_b64_tr_b16 v[60:61], v65 offset:288
    v_mfma_f32_16x16x32_bf16 v[228:231], v[48:51], v[36:39], v[228:231]
    s_add_u32 m0, s36, 105600
    ds_read_b64_tr_b16 v[62:63], v65 offset:17184
    v_mfma_f32_16x16x32_bf16 v[232:235], v[48:51], v[40:43], v[232:235]
    global_load_lds_dwordx4 v[2:3], off
    v_mfma_f32_16x16x32_bf16 v[236:239], v[48:51], v[44:47], v[236:239]
    s_waitcnt lgkmcnt(4)
    v_lshl_add_u64 v[2:3], v[4:5], 0, v[2:3]
    v_mfma_f32_16x16x32_bf16 v[240:243], v[52:55], v[32:35], v[240:243]
    ds_read_b64_tr_b16 v[48:49], v65 offset:32
    v_mfma_f32_16x16x32_bf16 v[244:247], v[52:55], v[36:39], v[244:247]
    s_add_u32 m0, s36, 122496
    ds_read_b64_tr_b16 v[50:51], v65 offset:16928
    v_mfma_f32_16x16x32_bf16 v[248:251], v[52:55], v[40:43], v[248:251]
    global_load_lds_dwordx4 v[2:3], off
    v_mfma_f32_16x16x32_bf16 v[252:255], v[52:55], v[44:47], v[252:255]
    s_waitcnt lgkmcnt(4)
    v_lshl_add_u64 v[2:3], v[4:5], 0, v[2:3]
    v_mfma_f32_16x16x32_bf16 a[0:3], v[56:59], v[32:35], a[0:3]
    ds_read_b64_tr_b16 v[52:53], v65 offset:320
    v_mfma_f32_16x16x32_bf16 a[4:7], v[56:59], v[36:39], a[4:7]
    s_add_u32 m0, s36, 109824
    ds_read_b64_tr_b16 v[54:55], v65 offset:17216
    v_mfma_f32_16x16x32_bf16 a[8:11], v[56:59], v[40:43], a[8:11]
    global_load_lds_dwordx4 v[2:3], off
    v_mfma_f32_16x16x32_bf16 a[12:15], v[56:59], v[44:47], a[12:15]
    s_waitcnt lgkmcnt(4)
    v_lshl_add_u64 v[2:3], v[4:5], 0, v[2:3]
    v_mfma_f32_16x16x32_bf16 a[16:19], v[60:63], v[32:35], a[16:19]
    ds_read_b64_tr_b16 v[56:57], v65 offset:64
    v_mfma_f32_16x16x32_bf16 a[20:23], v[60:63], v[36:39], a[20:23]
    s_add_u32 m0, s36, 126720
    ds_read_b64_tr_b16 v[58:59], v65 offset:16960
    v_mfma_f32_16x16x32_bf16 a[24:27], v[60:63], v[40:43], a[24:27]
    global_load_lds_dwordx4 v[2:3], off
    v_mfma_f32_16x16x32_bf16 a[28:31], v[60:63], v[44:47], a[28:31]
    s_waitcnt lgkmcnt(4)
    v_lshl_add_u64 v[2:3], v[4:5], 0, v[2:3]
    v_mfma_f32_16x16x32_bf16 a[32:35], v[48:51], v[32:35], a[32:35]
    ds_read_b64_tr_b16 v[60:61], v65 offset:352
    v_mfma_f32_16x16x32_bf16 a[36:39], v[48:51], v[36:39], a[36:39]
    s_add_u32 m0, s36, 114048
    ds_read_b64_tr_b16 v[62:63], v65 offset:17248
    v_mfma_f32_16x16x32_bf16 a[40:43], v[48:51], v[40:43], a[40:43]
    global_load_lds_dwordx4 v[2:3], off
    v_mfma_f32_16x16x32_bf16 a[44:47], v[48:51], v[44:47], a[44:47]
    s_waitcnt lgkmcnt(4)
    v_lshl_add_u64 v[2:3], v[4:5], 0, v[2:3]
    v_mfma_f32_16x16x32_bf16 a[48:51], v[52:55], v[32:35], a[48:51]
    ds_read_b64_tr_b16 v[48:49], v65 offset:96
    v_mfma_f32_16x16x32_bf16 a[52:55], v[52:55], v[36:39], a[52:55]
    s_add_u32 m0, s36, 130944
    ds_read_b64_tr_b16 v[50:51], v65 offset:16992
    v_mfma_f32_16x16x32_bf16 a[56:59], v[52:55], v[40:43], a[56:59]
    global_load_lds_dwordx4 v[2:3], off
    v_mfma_f32_16x16x32_bf16 a[60:63], v[52:55], v[44:47], a[60:63]
    s_waitcnt lgkmcnt(4)
    v_lshl_add_u64 v[2:3], v[4:5], 0, v[2:3]
    v_mfma_f32_16x16x32_bf16 a[64:67], v[56:59], v[32:35], a[64:67]
    ds_read_b64_tr_b16 v[52:53], v65 offset:384
    v_mfma_f32_16x16x32_bf16 a[68:71], v[56:59], v[36:39], a[68:71]
    ds_read_b64_tr_b16 v[54:55], v65 offset:17280
    v_mfma_f32_16x16x32_bf16 a[72:75], v[56:59], v[40:43], a[72:75]
    v_mfma_f32_16x16x32_bf16 a[76:79], v[56:59], v[44:47], a[76:79]
    s_waitcnt lgkmcnt(4)
    v_mfma_f32_16x16x32_bf16 a[80:83], v[60:63], v[32:35], a[80:83]
    ds_read_b64_tr_b16 v[56:57], v65 offset:128
    v_mfma_f32_16x16x32_bf16 a[84:87], v[60:63], v[36:39], a[84:87]
    ds_read_b64_tr_b16 v[58:59], v65 offset:17024
    v_mfma_f32_16x16x32_bf16 a[88:91], v[60:63], v[40:43], a[88:91]
    global_load_dword v78, v[76:77], off
    v_mfma_f32_16x16x32_bf16 a[92:95], v[60:63], v[44:47], a[92:95]
    s_waitcnt lgkmcnt(4)
    v_mfma_f32_16x16x32_bf16 a[96:99], v[48:51], v[32:35], a[96:99]
    ds_read_b64_tr_b16 v[60:61], v65 offset:416
    v_mfma_f32_16x16x32_bf16 a[100:103], v[48:51], v[36:39], a[100:103]
    ds_read_b64_tr_b16 v[62:63], v65 offset:17312
    v_mfma_f32_16x16x32_bf16 a[104:107], v[48:51], v[40:43], a[104:107]
    v_mfma_f32_16x16x32_bf16 a[108:111], v[48:51], v[44:47], a[108:111]
    s_waitcnt lgkmcnt(4)
    v_mfma_f32_16x16x32_bf16 a[112:115], v[52:55], v[32:35], a[112:115]
    ds_read_b64_tr_b16 v[48:49], v65 offset:160
    v_mfma_f32_16x16x32_bf16 a[116:119], v[52:55], v[36:39], a[116:119]
    ds_read_b64_tr_b16 v[50:51], v65 offset:17056
    v_mfma_f32_16x16x32_bf16 a[120:123], v[52:55], v[40:43], a[120:123]
    v_mfma_f32_16x16x32_bf16 a[124:127], v[52:55], v[44:47], a[124:127]
    s_waitcnt lgkmcnt(4)
    v_mfma_f32_16x16x32_bf16 a[128:131], v[56:59], v[32:35], a[128:131]
    ds_read_b64_tr_b16 v[52:53], v65 offset:448
    v_mfma_f32_16x16x32_bf16 a[132:135], v[56:59], v[36:39], a[132:135]
    ds_read_b64_tr_b16 v[54:55], v65 offset:17344
    v_mfma_f32_16x16x32_bf16 a[136:139], v[56:59], v[40:43], a[136:139]
    v_mfma_f32_16x16x32_bf16 a[140:143], v[56:59], v[44:47], a[140:143]
    s_waitcnt lgkmcnt(4)
    v_mfma_f32_16x16x32_bf16 a[144:147], v[60:63], v[32:35], a[144:147]
    ds_read_b64_tr_b16 v[56:57], v65 offset:192
    v_mfma_f32_16x16x32_bf16 a[148:151], v[60:63], v[36:39], a[148:151]
    ds_read_b64_tr_b16 v[58:59], v65 offset:17088
    v_mfma_f32_16x16x32_bf16 a[152:155], v[60:63], v[40:43], a[152:155]
    v_mfma_f32_16x16x32_bf16 a[156:159], v[60:63], v[44:47], a[156:159]
    s_waitcnt lgkmcnt(4)
    v_mfma_f32_16x16x32_bf16 a[160:163], v[48:51], v[32:35], a[160:163]
    ds_read_b64_tr_b16 v[60:61], v65 offset:480
    v_mfma_f32_16x16x32_bf16 a[164:167], v[48:51], v[36:39], a[164:167]
    ds_read_b64_tr_b16 v[62:63], v65 offset:17376
    v_mfma_f32_16x16x32_bf16 a[168:171], v[48:51], v[40:43], a[168:171]
    v_mfma_f32_16x16x32_bf16 a[172:175], v[48:51], v[44:47], a[172:175]
    s_waitcnt lgkmcnt(4)
    v_mfma_f32_16x16x32_bf16 a[176:179], v[52:55], v[32:35], a[176:179]
    ds_read_b64_tr_b16 v[48:49], v65 offset:224
    v_mfma_f32_16x16x32_bf16 a[180:183], v[52:55], v[36:39], a[180:183]
    ds_read_b64_tr_b16 v[50:51], v65 offset:17120
    v_mfma_f32_16x16x32_bf16 a[184:187], v[52:55], v[40:43], a[184:187]
    v_mfma_f32_16x16x32_bf16 a[188:191], v[52:55], v[44:47], a[188:191]
    s_waitcnt lgkmcnt(4)
    v_mfma_f32_16x16x32_bf16 a[192:195], v[56:59], v[32:35], a[192:195]
    ds_read_b64_tr_b16 v[52:53], v65 offset:512
    v_mfma_f32_16x16x32_bf16 a[196:199], v[56:59], v[36:39], a[196:199]
    ds_read_b64_tr_b16 v[54:55], v65 offset:17408
    v_mfma_f32_16x16x32_bf16 a[200:203], v[56:59], v[40:43], a[200:203]
    v_mfma_f32_16x16x32_bf16 a[204:207], v[56:59], v[44:47], a[204:207]
    s_waitcnt lgkmcnt(4)
    v_mfma_f32_16x16x32_bf16 a[208:211], v[60:63], v[32:35], a[208:211]
    ds_read_b64_tr_b16 v[56:57], v65 offset:256
    v_mfma_f32_16x16x32_bf16 a[212:215], v[60:63], v[36:39], a[212:215]
    ds_read_b64_tr_b16 v[58:59], v65 offset:17152
    v_mfma_f32_16x16x32_bf16 a[216:219], v[60:63], v[40:43], a[216:219]
    v_mfma_f32_16x16x32_bf16 a[220:223], v[60:63], v[44:47], a[220:223]
    s_waitcnt lgkmcnt(4)
    v_mfma_f32_16x16x32_bf16 a[224:227], v[48:51], v[32:35], a[224:227]
    ds_read_b64_tr_b16 v[60:61], v65 offset:544
    v_mfma_f32_16x16x32_bf16 a[228:231], v[48:51], v[36:39], a[228:231]
    ds_read_b64_tr_b16 v[62:63], v65 offset:17440
    v_mfma_f32_16x16x32_bf16 a[232:235], v[48:51], v[40:43], a[232:235]
    s_waitcnt vmcnt(17)
    s_barrier
    v_mfma_f32_16x16x32_bf16 a[236:239], v[48:51], v[44:47], a[236:239]
    s_waitcnt lgkmcnt(4)
    v_mfma_f32_16x16x32_bf16 a[240:243], v[52:55], v[32:35], a[240:243]
    ds_read_b64_tr_b16 v[48:49], v70 offset:0
    v_mfma_f32_16x16x32_bf16 a[244:247], v[52:55], v[36:39], a[244:247]
    ds_read_b64_tr_b16 v[50:51], v70 offset:16896
    v_mfma_f32_16x16x32_bf16 a[248:251], v[52:55], v[40:43], a[248:251]
    v_mfma_f32_16x16x32_bf16 a[252:255], v[52:55], v[44:47], a[252:255]
    s_waitcnt lgkmcnt(4)
    v_mfma_f32_16x16x32_bf16 v[96:99], v[56:59], v[32:35], v[96:99]
    ds_read_b64_tr_b16 v[52:53], v70 offset:8
    v_mfma_f32_16x16x32_bf16 v[100:103], v[56:59], v[36:39], v[100:103]
    ds_read_b64_tr_b16 v[54:55], v70 offset:16904
    v_mfma_f32_16x16x32_bf16 v[104:107], v[56:59], v[40:43], v[104:107]
    v_mfma_f32_16x16x32_bf16 v[108:111], v[56:59], v[44:47], v[108:111]
    s_waitcnt lgkmcnt(4)
    v_mfma_f32_16x16x32_bf16 v[112:115], v[60:63], v[32:35], v[112:115]
    ds_read_b64_tr_b16 v[56:57], v70 offset:64
    v_mfma_f32_16x16x32_bf16 v[116:119], v[60:63], v[36:39], v[116:119]
    ds_read_b64_tr_b16 v[58:59], v70 offset:16960
    v_mfma_f32_16x16x32_bf16 v[120:123], v[60:63], v[40:43], v[120:123]
    s_waitcnt vmcnt(9)
    v_mfma_f32_16x16x32_bf16 v[124:127], v[60:63], v[44:47], v[124:127]
    s_waitcnt lgkmcnt(4)
    v_mfma_f32_16x16x32_bf16 v[128:131], v[48:51], v[16:19], v[128:131]
    ds_read_b64_tr_b16 v[60:61], v70 offset:72
    v_mfma_f32_16x16x32_bf16 v[132:135], v[48:51], v[20:23], v[132:135]
    ds_read_b64_tr_b16 v[62:63], v70 offset:16968
    v_mfma_f32_16x16x32_bf16 v[136:139], v[48:51], v[24:27], v[136:139]
    buffer_load_dwordx4 v[32:35], v6, s[12:15], s35 offen
    v_mfma_f32_16x16x32_bf16 v[140:143], v[48:51], v[28:31], v[140:143]
    s_waitcnt lgkmcnt(4)
    v_mfma_f32_16x16x32_bf16 v[144:147], v[52:55], v[16:19], v[144:147]
    ds_read_b64_tr_b16 v[48:49], v70 offset:128
    v_mfma_f32_16x16x32_bf16 v[148:151], v[52:55], v[20:23], v[148:151]
    ds_read_b64_tr_b16 v[50:51], v70 offset:17024
    v_mfma_f32_16x16x32_bf16 v[152:155], v[52:55], v[24:27], v[152:155]
    buffer_load_dwordx4 v[36:39], v7, s[12:15], s35 offen
    v_mfma_f32_16x16x32_bf16 v[156:159], v[52:55], v[28:31], v[156:159]
    s_waitcnt lgkmcnt(4)
    v_mfma_f32_16x16x32_bf16 v[160:163], v[56:59], v[16:19], v[160:163]
    ds_read_b64_tr_b16 v[52:53], v70 offset:136
    v_mfma_f32_16x16x32_bf16 v[164:167], v[56:59], v[20:23], v[164:167]
    ds_read_b64_tr_b16 v[54:55], v70 offset:17032
    v_mfma_f32_16x16x32_bf16 v[168:171], v[56:59], v[24:27], v[168:171]
    buffer_load_dwordx4 v[40:43], v8, s[12:15], s35 offen
    v_mfma_f32_16x16x32_bf16 v[172:175], v[56:59], v[28:31], v[172:175]
    s_waitcnt lgkmcnt(4)
    v_mfma_f32_16x16x32_bf16 v[176:179], v[60:63], v[16:19], v[176:179]
    ds_read_b64_tr_b16 v[56:57], v70 offset:192
    v_mfma_f32_16x16x32_bf16 v[180:183], v[60:63], v[20:23], v[180:183]
    ds_read_b64_tr_b16 v[58:59], v70 offset:17088
    v_mfma_f32_16x16x32_bf16 v[184:187], v[60:63], v[24:27], v[184:187]
    buffer_load_dwordx4 v[44:47], v9, s[12:15], s35 offen
    v_mfma_f32_16x16x32_bf16 v[188:191], v[60:63], v[28:31], v[188:191]
    s_waitcnt lgkmcnt(4)
    v_mfma_f32_16x16x32_bf16 v[192:195], v[48:51], v[16:19], v[192:195]
    s_add_u32 s35, s35, 1024
    ds_read_b64_tr_b16 v[60:61], v70 offset:200
    v_mfma_f32_16x16x32_bf16 v[196:199], v[48:51], v[20:23], v[196:199]
    ds_read_b64_tr_b16 v[62:63], v70 offset:17096
    v_mfma_f32_16x16x32_bf16 v[200:203], v[48:51], v[24:27], v[200:203]
    v_mfma_f32_16x16x32_bf16 v[204:207], v[48:51], v[28:31], v[204:207]
    s_waitcnt lgkmcnt(4)
    v_mfma_f32_16x16x32_bf16 v[208:211], v[52:55], v[16:19], v[208:211]
    ds_read_b64_tr_b16 v[48:49], v66 offset:0
    v_mfma_f32_16x16x32_bf16 v[212:215], v[52:55], v[20:23], v[212:215]
    ds_read_b64_tr_b16 v[50:51], v66 offset:16896
    v_mfma_f32_16x16x32_bf16 v[216:219], v[52:55], v[24:27], v[216:219]
    v_mfma_f32_16x16x32_bf16 v[220:223], v[52:55], v[28:31], v[220:223]
    s_waitcnt lgkmcnt(4)
    v_mfma_f32_16x16x32_bf16 v[224:227], v[56:59], v[16:19], v[224:227]
    ds_read_b64_tr_b16 v[52:53], v66 offset:288
    v_mfma_f32_16x16x32_bf16 v[228:231], v[56:59], v[20:23], v[228:231]
    ds_read_b64_tr_b16 v[54:55], v66 offset:17184
    v_mfma_f32_16x16x32_bf16 v[232:235], v[56:59], v[24:27], v[232:235]
    v_mfma_f32_16x16x32_bf16 v[236:239], v[56:59], v[28:31], v[236:239]
    s_waitcnt lgkmcnt(4)
    v_mfma_f32_16x16x32_bf16 v[240:243], v[60:63], v[16:19], v[240:243]
    ds_read_b64_tr_b16 v[56:57], v66 offset:32
    v_mfma_f32_16x16x32_bf16 v[244:247], v[60:63], v[20:23], v[244:247]
    ds_read_b64_tr_b16 v[58:59], v66 offset:16928
    v_mfma_f32_16x16x32_bf16 v[248:251], v[60:63], v[24:27], v[248:251]
    v_mfma_f32_16x16x32_bf16 v[252:255], v[60:63], v[28:31], v[252:255]
    s_waitcnt lgkmcnt(4)
    v_mfma_f32_16x16x32_bf16 a[0:3], v[48:51], v[16:19], a[0:3]
    ds_read_b64_tr_b16 v[60:61], v66 offset:320
    v_mfma_f32_16x16x32_bf16 a[4:7], v[48:51], v[20:23], a[4:7]
    ds_read_b64_tr_b16 v[62:63], v66 offset:17216
    v_mfma_f32_16x16x32_bf16 a[8:11], v[48:51], v[24:27], a[8:11]
    v_mfma_f32_16x16x32_bf16 a[12:15], v[48:51], v[28:31], a[12:15]
    s_waitcnt lgkmcnt(4)
    v_mfma_f32_16x16x32_bf16 a[16:19], v[52:55], v[16:19], a[16:19]
    ds_read_b64_tr_b16 v[48:49], v66 offset:64
    v_mfma_f32_16x16x32_bf16 a[20:23], v[52:55], v[20:23], a[20:23]
    ds_read_b64_tr_b16 v[50:51], v66 offset:16960
    v_mfma_f32_16x16x32_bf16 a[24:27], v[52:55], v[24:27], a[24:27]
    v_mfma_f32_16x16x32_bf16 a[28:31], v[52:55], v[28:31], a[28:31]
    s_waitcnt lgkmcnt(4)
    v_mfma_f32_16x16x32_bf16 a[32:35], v[56:59], v[16:19], a[32:35]
    ds_read_b64_tr_b16 v[52:53], v66 offset:352
    v_mfma_f32_16x16x32_bf16 a[36:39], v[56:59], v[20:23], a[36:39]
    ds_read_b64_tr_b16 v[54:55], v66 offset:17248
    v_mfma_f32_16x16x32_bf16 a[40:43], v[56:59], v[24:27], a[40:43]
    v_mfma_f32_16x16x32_bf16 a[44:47], v[56:59], v[28:31], a[44:47]
    s_waitcnt lgkmcnt(4)
    v_mfma_f32_16x16x32_bf16 a[48:51], v[60:63], v[16:19], a[48:51]
    ds_read_b64_tr_b16 v[56:57], v66 offset:96
    v_mfma_f32_16x16x32_bf16 a[52:55], v[60:63], v[20:23], a[52:55]
    ds_read_b64_tr_b16 v[58:59], v66 offset:16992
    v_mfma_f32_16x16x32_bf16 a[56:59], v[60:63], v[24:27], a[56:59]
    v_mfma_f32_16x16x32_bf16 a[60:63], v[60:63], v[28:31], a[60:63]
    s_waitcnt lgkmcnt(4)
    v_mfma_f32_16x16x32_bf16 a[64:67], v[48:51], v[16:19], a[64:67]
    ds_read_b64_tr_b16 v[60:61], v66 offset:384
    v_mfma_f32_16x16x32_bf16 a[68:71], v[48:51], v[20:23], a[68:71]
    ds_read_b64_tr_b16 v[62:63], v66 offset:17280
    v_mfma_f32_16x16x32_bf16 a[72:75], v[48:51], v[24:27], a[72:75]
    v_add_u32 v6, 0, v12
    v_add_u32 v7, 147456, v12
    v_mfma_f32_16x16x32_bf16 a[76:79], v[48:51], v[28:31], a[76:79]
    s_waitcnt lgkmcnt(4)
    v_add_u32 v8, 294912, v12
    v_add_u32 v9, 442368, v12
    v_mfma_f32_16x16x32_bf16 a[80:83], v[52:55], v[16:19], a[80:83]
    ds_read_b64_tr_b16 v[48:49], v66 offset:128
    v_mfma_f32_16x16x32_bf16 a[84:87], v[52:55], v[20:23], a[84:87]
    ds_read_b64_tr_b16 v[50:51], v66 offset:17024
    v_mfma_f32_16x16x32_bf16 a[88:91], v[52:55], v[24:27], a[88:91]
    v_mfma_f32_16x16x32_bf16 a[92:95], v[52:55], v[28:31], a[92:95]
    s_waitcnt lgkmcnt(4)
    v_mfma_f32_16x16x32_bf16 a[96:99], v[56:59], v[16:19], a[96:99]
    ds_read_b64_tr_b16 v[52:53], v66 offset:416
    v_mfma_f32_16x16x32_bf16 a[100:103], v[56:59], v[20:23], a[100:103]
    ds_read_b64_tr_b16 v[54:55], v66 offset:17312
    v_mfma_f32_16x16x32_bf16 a[104:107], v[56:59], v[24:27], a[104:107]
    v_mfma_f32_16x16x32_bf16 a[108:111], v[56:59], v[28:31], a[108:111]
    s_waitcnt lgkmcnt(4)
    v_mfma_f32_16x16x32_bf16 a[112:115], v[60:63], v[16:19], a[112:115]
    ds_read_b64_tr_b16 v[56:57], v66 offset:160
    v_mfma_f32_16x16x32_bf16 a[116:119], v[60:63], v[20:23], a[116:119]
    ds_read_b64_tr_b16 v[58:59], v66 offset:17056
    v_mfma_f32_16x16x32_bf16 a[120:123], v[60:63], v[24:27], a[120:123]
    v_mfma_f32_16x16x32_bf16 a[124:127], v[60:63], v[28:31], a[124:127]
    s_waitcnt lgkmcnt(4)
    v_mfma_f32_16x16x32_bf16 a[128:131], v[48:51], v[16:19], a[128:131]
    ds_read_b64_tr_b16 v[60:61], v66 offset:448
    v_mfma_f32_16x16x32_bf16 a[132:135], v[48:51], v[20:23], a[132:135]
    ds_read_b64_tr_b16 v[62:63], v66 offset:17344
    v_mfma_f32_16x16x32_bf16 a[136:139], v[48:51], v[24:27], a[136:139]
    v_mfma_f32_16x16x32_bf16 a[140:143], v[48:51], v[28:31], a[140:143]
    s_waitcnt lgkmcnt(4)
    v_mfma_f32_16x16x32_bf16 a[144:147], v[52:55], v[16:19], a[144:147]
    ds_read_b64_tr_b16 v[48:49], v66 offset:192
    v_mfma_f32_16x16x32_bf16 a[148:151], v[52:55], v[20:23], a[148:151]
    ds_read_b64_tr_b16 v[50:51], v66 offset:17088
    v_mfma_f32_16x16x32_bf16 a[152:155], v[52:55], v[24:27], a[152:155]
    v_mfma_f32_16x16x32_bf16 a[156:159], v[52:55], v[28:31], a[156:159]
    s_waitcnt lgkmcnt(4)
    v_mfma_f32_16x16x32_bf16 a[160:163], v[56:59], v[16:19], a[160:163]
    ds_read_b64_tr_b16 v[52:53], v66 offset:480
    v_mfma_f32_16x16x32_bf16 a[164:167], v[56:59], v[20:23], a[164:167]
    ds_read_b64_tr_b16 v[54:55], v66 offset:17376
    v_mfma_f32_16x16x32_bf16 a[168:171], v[56:59], v[24:27], a[168:171]
    v_mfma_f32_16x16x32_bf16 a[172:175], v[56:59], v[28:31], a[172:175]
    s_waitcnt lgkmcnt(4)
    v_mfma_f32_16x16x32_bf16 a[176:179], v[60:63], v[16:19], a[176:179]
    ds_read_b64_tr_b16 v[56:57], v66 offset:224
    v_mfma_f32_16x16x32_bf16 a[180:183], v[60:63], v[20:23], a[180:183]
    ds_read_b64_tr_b16 v[58:59], v66 offset:17120
    v_mfma_f32_16x16x32_bf16 a[184:187], v[60:63], v[24:27], a[184:187]
    v_mfma_f32_16x16x32_bf16 a[188:191], v[60:63], v[28:31], a[188:191]
    s_waitcnt lgkmcnt(4)
    v_mfma_f32_16x16x32_bf16 a[192:195], v[48:51], v[16:19], a[192:195]
    ds_read_b64_tr_b16 v[60:61], v66 offset:512
    v_mfma_f32_16x16x32_bf16 a[196:199], v[48:51], v[20:23], a[196:199]
    ds_read_b64_tr_b16 v[62:63], v66 offset:17408
    v_mfma_f32_16x16x32_bf16 a[200:203], v[48:51], v[24:27], a[200:203]
    v_mfma_f32_16x16x32_bf16 a[204:207], v[48:51], v[28:31], a[204:207]
    s_waitcnt lgkmcnt(4)
    v_mfma_f32_16x16x32_bf16 a[208:211], v[52:55], v[16:19], a[208:211]
    ds_read_b64_tr_b16 v[48:49], v66 offset:256
    v_mfma_f32_16x16x32_bf16 a[212:215], v[52:55], v[20:23], a[212:215]
    ds_read_b64_tr_b16 v[50:51], v66 offset:17152
    v_mfma_f32_16x16x32_bf16 a[216:219], v[52:55], v[24:27], a[216:219]
    v_mfma_f32_16x16x32_bf16 a[220:223], v[52:55], v[28:31], a[220:223]
    s_waitcnt lgkmcnt(4)
    v_mfma_f32_16x16x32_bf16 a[224:227], v[56:59], v[16:19], a[224:227]
    ds_read_b64_tr_b16 v[52:53], v66 offset:544
    v_mfma_f32_16x16x32_bf16 a[228:231], v[56:59], v[20:23], a[228:231]
    ds_read_b64_tr_b16 v[54:55], v66 offset:17440
    v_mfma_f32_16x16x32_bf16 a[232:235], v[56:59], v[24:27], a[232:235]
    s_waitcnt vmcnt(5)
    s_barrier
    v_mfma_f32_16x16x32_bf16 a[236:239], v[56:59], v[28:31], a[236:239]
    s_waitcnt lgkmcnt(4)
    v_mfma_f32_16x16x32_bf16 a[240:243], v[60:63], v[16:19], a[240:243]
    ds_read_b64_tr_b16 v[56:57], v71 offset:0
    v_mfma_f32_16x16x32_bf16 a[244:247], v[60:63], v[20:23], a[244:247]
    ds_read_b64_tr_b16 v[58:59], v71 offset:16896
    v_mfma_f32_16x16x32_bf16 a[248:251], v[60:63], v[24:27], a[248:251]
    v_mfma_f32_16x16x32_bf16 a[252:255], v[60:63], v[28:31], a[252:255]
    s_waitcnt lgkmcnt(4)
    v_mfma_f32_16x16x32_bf16 v[96:99], v[48:51], v[16:19], v[96:99]
    ds_read_b64_tr_b16 v[60:61], v71 offset:8
    v_mfma_f32_16x16x32_bf16 v[100:103], v[48:51], v[20:23], v[100:103]
    ds_read_b64_tr_b16 v[62:63], v71 offset:16904
    v_mfma_f32_16x16x32_bf16 v[104:107], v[48:51], v[24:27], v[104:107]
    v_mfma_f32_16x16x32_bf16 v[108:111], v[48:51], v[28:31], v[108:111]
    s_waitcnt lgkmcnt(4)
    v_mfma_f32_16x16x32_bf16 v[112:115], v[52:55], v[16:19], v[112:115]
    ds_read_b64_tr_b16 v[48:49], v71 offset:64
    v_mfma_f32_16x16x32_bf16 v[116:119], v[52:55], v[20:23], v[116:119]
    ds_read_b64_tr_b16 v[50:51], v71 offset:16960
    v_mfma_f32_16x16x32_bf16 v[120:123], v[52:55], v[24:27], v[120:123]
    s_waitcnt vmcnt(0)
    v_mfma_f32_16x16x32_bf16 v[124:127], v[52:55], v[28:31], v[124:127]
    s_waitcnt lgkmcnt(4)
L_trans:
    v_mfma_f32_16x16x32_bf16 v[128:131], v[56:59], v[32:35], v[128:131]
    ds_read_b64_tr_b16 v[52:53], v71 offset:72
    v_mfma_f32_16x16x32_bf16 v[132:135], v[56:59], v[36:39], v[132:135]
    s_add_u32 m0, s29, 16384
    ds_read_b64_tr_b16 v[54:55], v71 offset:16968
    v_mfma_f32_16x16x32_bf16 v[136:139], v[56:59], v[40:43], v[136:139]
    buffer_load_dwordx4 v10, s[4:7], s28 offen offset:0 lds
    v_mfma_f32_16x16x32_bf16 v[140:143], v[56:59], v[44:47], v[140:143]
    s_waitcnt lgkmcnt(4)
    v_mfma_f32_16x16x32_bf16 v[144:147], v[60:63], v[32:35], v[144:147]
    ds_read_b64_tr_b16 v[56:57], v71 offset:128
    v_mfma_f32_16x16x32_bf16 v[148:151], v[60:63], v[36:39], v[148:151]
    ds_read_b64_tr_b16 v[58:59], v71 offset:17024
    v_mfma_f32_16x16x32_bf16 v[152:155], v[60:63], v[40:43], v[152:155]
    buffer_load_dwordx4 v10, s[4:7], s28 offen offset:1024 lds
    v_mfma_f32_16x16x32_bf16 v[156:159], v[60:63], v[44:47], v[156:159]
    s_waitcnt lgkmcnt(4)
    v_mfma_f32_16x16x32_bf16 v[160:163], v[48:51], v[32:35], v[160:163]
    ds_read_b64_tr_b16 v[60:61], v71 offset:136
    v_mfma_f32_16x16x32_bf16 v[164:167], v[48:51], v[36:39], v[164:167]
    ds_read_b64_tr_b16 v[62:63], v71 offset:17032
    v_mfma_f32_16x16x32_bf16 v[168:171], v[48:51], v[40:43], v[168:171]
    buffer_load_dwordx4 v10, s[4:7], s28 offen offset:2048 lds
    v_mfma_f32_16x16x32_bf16 v[172:175], v[48:51], v[44:47], v[172:175]
    s_waitcnt lgkmcnt(4)
    v_mul_f32 v128, s34, v128
    v_mul_f32 v129, s34, v129
    v_mul_f32 v130, s34, v130
    v_mul_f32 v131, s34, v131
    v_cvt_pk_bf16_f32 v128, v128, v129
    v_mfma_f32_16x16x32_bf16 v[176:179], v[52:55], v[32:35], v[176:179]
    ds_read_b64_tr_b16 v[48:49], v71 offset:192
    v_cvt_pk_bf16_f32 v129, v130, v131
    v_mul_f32 v144, s34, v144
    v_mul_f32 v145, s34, v145
    v_mul_f32 v146, s34, v146
    v_mul_f32 v147, s34, v147
    v_mfma_f32_16x16x32_bf16 v[180:183], v[52:55], v[36:39], v[180:183]
    ds_read_b64_tr_b16 v[50:51], v71 offset:17088
    v_cvt_pk_bf16_f32 v130, v144, v145
    v_cvt_pk_bf16_f32 v131, v146, v147
    v_mul_f32 v132, s34, v132
    v_mul_f32 v133, s34, v133
    v_mul_f32 v134, s34, v134
    v_mfma_f32_16x16x32_bf16 v[184:187], v[52:55], v[40:43], v[184:187]
    buffer_load_dwordx4 v10, s[4:7], s28 offen offset:3072 lds
    v_mul_f32 v135, s34, v135
    v_cvt_pk_bf16_f32 v132, v132, v133
    v_cvt_pk_bf16_f32 v133, v134, v135
    v_mfma_f32_16x16x32_bf16 v[188:191], v[52:55], v[44:47], v[188:191]
    s_waitcnt lgkmcnt(4)
    s_add_u32 s28, s28, 16384
    s_bitset0_b32 s28, 19
    v_mul_f32 v148, s34, v148
    v_mul_f32 v149, s34, v149
    v_mul_f32 v150, s34, v150
    v_mul_f32 v151, s34, v151
    v_cvt_pk_bf16_f32 v134, v148, v149
    v_mfma_f32_16x16x32_bf16 v[192:195], v[56:59], v[32:35], v[192:195]
    ds_read_b64_tr_b16 v[52:53], v71 offset:200
    v_cvt_pk_bf16_f32 v135, v150, v151
    v_mul_f32 v136, s34, v136
    v_mul_f32 v137, s34, v137
    v_mul_f32 v138, s34, v138
    v_mul_f32 v139, s34, v139
    v_mfma_f32_16x16x32_bf16 v[196:199], v[56:59], v[36:39], v[196:199]
    s_add_u32 m0, s29, 65536
    ds_read_b64_tr_b16 v[54:55], v71 offset:17096
    v_cvt_pk_bf16_f32 v136, v136, v137
    v_cvt_pk_bf16_f32 v137, v138, v139
    v_mul_f32 v152, s34, v152
    v_mul_f32 v153, s34, v153
    v_mul_f32 v154, s34, v154
    v_mfma_f32_16x16x32_bf16 v[200:203], v[56:59], v[40:43], v[200:203]
    buffer_load_dwordx4 v11, s[8:11], s37 offen offset:0 lds
    v_mul_f32 v155, s34, v155
    v_cvt_pk_bf16_f32 v138, v152, v153
    v_cvt_pk_bf16_f32 v139, v154, v155
    v_mfma_f32_16x16x32_bf16 v[204:207], v[56:59], v[44:47], v[204:207]
    s_waitcnt lgkmcnt(4)
    v_mul_f32 v140, s34, v140
    v_mul_f32 v141, s34, v141
    v_mul_f32 v142, s34, v142
    v_mul_f32 v143, s34, v143
    v_cvt_pk_bf16_f32 v140, v140, v141
    v_mfma_f32_16x16x32_bf16 v[208:211], v[60:63], v[32:35], v[208:211]
    ds_read_b64_tr_b16 v[56:57], v67 offset:0
    v_cvt_pk_bf16_f32 v141, v142, v143
    v_mul_f32 v156, s34, v156
    v_mul_f32 v157, s34, v157
    v_mul_f32 v158, s34, v158
    v_mul_f32 v159, s34, v159
    v_mfma_f32_16x16x32_bf16 v[212:215], v[60:63], v[36:39], v[212:215]
    ds_read_b64_tr_b16 v[58:59], v67 offset:16896
    v_cvt_pk_bf16_f32 v142, v156, v157
    v_cvt_pk_bf16_f32 v143, v158, v159
    v_mul_f32 v160, s34, v160
    v_mul_f32 v161, s34, v161
    v_mul_f32 v162, s34, v162
    v_mfma_f32_16x16x32_bf16 v[216:219], v[60:63], v[40:43], v[216:219]
    buffer_load_dwordx4 v11, s[8:11], s37 offen offset:1024 lds
    v_mul_f32 v163, s34, v163
    v_cvt_pk_bf16_f32 v144, v160, v161
    v_cvt_pk_bf16_f32 v145, v162, v163
    v_mfma_f32_16x16x32_bf16 v[220:223], v[60:63], v[44:47], v[220:223]
    s_waitcnt lgkmcnt(4)
    v_mul_f32 v176, s34, v176
    v_mul_f32 v177, s34, v177
    v_mul_f32 v178, s34, v178
    v_mul_f32 v179, s34, v179
    v_cvt_pk_bf16_f32 v146, v176, v177
    v_mfma_f32_16x16x32_bf16 v[224:227], v[48:51], v[32:35], v[224:227]
    ds_read_b64_tr_b16 v[60:61], v67 offset:288
    v_cvt_pk_bf16_f32 v147, v178, v179
    v_mul_f32 v164, s34, v164
    v_mul_f32 v165, s34, v165
    v_mul_f32 v166, s34, v166
    v_mul_f32 v167, s34, v167
    v_mfma_f32_16x16x32_bf16 v[228:231], v[48:51], v[36:39], v[228:231]
    ds_read_b64_tr_b16 v[62:63], v67 offset:17184
    v_cvt_pk_bf16_f32 v148, v164, v165
    v_cvt_pk_bf16_f32 v149, v166, v167
    v_mul_f32 v180, s34, v180
    v_mul_f32 v181, s34, v181
    v_mul_f32 v182, s34, v182
    v_mfma_f32_16x16x32_bf16 v[232:235], v[48:51], v[40:43], v[232:235]
    buffer_load_dwordx4 v11, s[8:11], s37 offen offset:2048 lds
    v_mul_f32 v183, s34, v183
    v_cvt_pk_bf16_f32 v150, v180, v181
    v_cvt_pk_bf16_f32 v151, v182, v183
    v_mfma_f32_16x16x32_bf16 v[236:239], v[48:51], v[44:47], v[236:239]
    s_waitcnt lgkmcnt(4)
    v_mul_f32 v168, s34, v168
    v_mul_f32 v169, s34, v169
    v_mul_f32 v170, s34, v170
    v_mul_f32 v171, s34, v171
    v_cvt_pk_bf16_f32 v152, v168, v169
    v_mfma_f32_16x16x32_bf16 v[240:243], v[52:55], v[32:35], v[240:243]
    ds_read_b64_tr_b16 v[48:49], v67 offset:32
    v_cvt_pk_bf16_f32 v153, v170, v171
    v_mul_f32 v184, s34, v184
    v_mul_f32 v185, s34, v185
    v_mul_f32 v186, s34, v186
    v_mul_f32 v187, s34, v187
    v_mfma_f32_16x16x32_bf16 v[244:247], v[52:55], v[36:39], v[244:247]
    ds_read_b64_tr_b16 v[50:51], v67 offset:16928
    v_cvt_pk_bf16_f32 v154, v184, v185
    v_cvt_pk_bf16_f32 v155, v186, v187
    v_mul_f32 v172, s34, v172
    v_mul_f32 v173, s34, v173
    v_mul_f32 v174, s34, v174
    v_mfma_f32_16x16x32_bf16 v[248:251], v[52:55], v[40:43], v[248:251]
    buffer_load_dwordx4 v11, s[8:11], s37 offen offset:3072 lds
    v_mul_f32 v175, s34, v175
    v_cvt_pk_bf16_f32 v156, v172, v173
    v_cvt_pk_bf16_f32 v157, v174, v175
    v_mfma_f32_16x16x32_bf16 v[252:255], v[52:55], v[44:47], v[252:255]
    s_waitcnt lgkmcnt(4)
    s_add_u32 s37, s37, 16384
    s_bitset0_b32 s37, 19
    v_mul_f32 v188, s34, v188
    v_mul_f32 v189, s34, v189
    v_mul_f32 v190, s34, v190
    v_mul_f32 v191, s34, v191
    v_cvt_pk_bf16_f32 v158, v188, v189
    v_mfma_f32_16x16x32_bf16 a[0:3], v[56:59], v[32:35], a[0:3]
    ds_read_b64_tr_b16 v[52:53], v67 offset:320
    v_cvt_pk_bf16_f32 v159, v190, v191
    v_mul_f32 v192, s34, v192
    v_mul_f32 v193, s34, v193
    v_mul_f32 v194, s34, v194
    v_mul_f32 v195, s34, v195
    v_mfma_f32_16x16x32_bf16 a[4:7], v[56:59], v[36:39], a[4:7]
    s_add_u32 m0, s29, 32768
    ds_read_b64_tr_b16 v[54:55], v67 offset:17216
    v_cvt_pk_bf16_f32 v160, v192, v193
    v_cvt_pk_bf16_f32 v161, v194, v195
    v_mul_f32 v208, s34, v208
    v_mul_f32 v209, s34, v209
    v_mul_f32 v210, s34, v210
    v_mfma_f32_16x16x32_bf16 a[8:11], v[56:59], v[40:43], a[8:11]
    buffer_load_dwordx4 v10, s[4:7], s28 offen offset:0 lds
    v_mul_f32 v211, s34, v211
    v_cvt_pk_bf16_f32 v162, v208, v209
    v_cvt_pk_bf16_f32 v163, v210, v211
    v_mfma_f32_16x16x32_bf16 a[12:15], v[56:59], v[44:47], a[12:15]
    s_waitcnt lgkmcnt(4)
    v_mul_f32 v196, s34, v196
    v_mul_f32 v197, s34, v197
    v_mul_f32 v198, s34, v198
    v_mul_f32 v199, s34, v199
    v_cvt_pk_bf16_f32 v164, v196, v197
    v_mfma_f32_16x16x32_bf16 a[16:19], v[60:63], v[32:35], a[16:19]
    ds_read_b64_tr_b16 v[56:57], v67 offset:64
    v_cvt_pk_bf16_f32 v165, v198, v199
    v_mul_f32 v212, s34, v212
    v_mul_f32 v213, s34, v213
    v_mul_f32 v214, s34, v214
    v_mul_f32 v215, s34, v215
    v_mfma_f32_16x16x32_bf16 a[20:23], v[60:63], v[36:39], a[20:23]
    ds_read_b64_tr_b16 v[58:59], v67 offset:16960
    v_cvt_pk_bf16_f32 v166, v212, v213
    v_cvt_pk_bf16_f32 v167, v214, v215
    v_mul_f32 v200, s34, v200
    v_mul_f32 v201, s34, v201
    v_mul_f32 v202, s34, v202
    v_mfma_f32_16x16x32_bf16 a[24:27], v[60:63], v[40:43], a[24:27]
    buffer_load_dwordx4 v10, s[4:7], s28 offen offset:1024 lds
    v_mul_f32 v203, s34, v203
    v_cvt_pk_bf16_f32 v168, v200, v201
    v_cvt_pk_bf16_f32 v169, v202, v203
    v_mfma_f32_16x16x32_bf16 a[28:31], v[60:63], v[44:47], a[28:31]
    s_waitcnt lgkmcnt(4)
    v_mul_f32 v216, s34, v216
    v_mul_f32 v217, s34, v217
    v_mul_f32 v218, s34, v218
    v_mul_f32 v219, s34, v219
    v_cvt_pk_bf16_f32 v170, v216, v217
    v_mfma_f32_16x16x32_bf16 a[32:35], v[48:51], v[32:35], a[32:35]
    ds_read_b64_tr_b16 v[60:61], v67 offset:352
    v_cvt_pk_bf16_f32 v171, v218, v219
    v_mul_f32 v204, s34, v204
    v_mul_f32 v205, s34, v205
    v_mul_f32 v206, s34, v206
    v_mul_f32 v207, s34, v207
    v_mfma_f32_16x16x32_bf16 a[36:39], v[48:51], v[36:39], a[36:39]
    ds_read_b64_tr_b16 v[62:63], v67 offset:17248
    v_cvt_pk_bf16_f32 v172, v204, v205
    v_cvt_pk_bf16_f32 v173, v206, v207
    v_mul_f32 v220, s34, v220
    v_mul_f32 v221, s34, v221
    v_mul_f32 v222, s34, v222
    v_mfma_f32_16x16x32_bf16 a[40:43], v[48:51], v[40:43], a[40:43]
    buffer_load_dwordx4 v10, s[4:7], s28 offen offset:2048 lds
    v_mul_f32 v223, s34, v223
    v_cvt_pk_bf16_f32 v174, v220, v221
    v_cvt_pk_bf16_f32 v175, v222, v223
    v_mfma_f32_16x16x32_bf16 a[44:47], v[48:51], v[44:47], a[44:47]
    s_waitcnt lgkmcnt(4)
    v_mul_f32 v224, s34, v224
    v_mul_f32 v225, s34, v225
    v_mul_f32 v226, s34, v226
    v_mul_f32 v227, s34, v227
    v_cvt_pk_bf16_f32 v176, v224, v225
    v_mfma_f32_16x16x32_bf16 a[48:51], v[52:55], v[32:35], a[48:51]
    ds_read_b64_tr_b16 v[48:49], v67 offset:96
    v_cvt_pk_bf16_f32 v177, v226, v227
    v_mul_f32 v240, s34, v240
    v_mul_f32 v241, s34, v241
    v_mul_f32 v242, s34, v242
    v_mul_f32 v243, s34, v243
    v_mfma_f32_16x16x32_bf16 a[52:55], v[52:55], v[36:39], a[52:55]
    ds_read_b64_tr_b16 v[50:51], v67 offset:16992
    v_cvt_pk_bf16_f32 v178, v240, v241
    v_cvt_pk_bf16_f32 v179, v242, v243
    v_mul_f32 v228, s34, v228
    v_mul_f32 v229, s34, v229
    v_mul_f32 v230, s34, v230
    v_mfma_f32_16x16x32_bf16 a[56:59], v[52:55], v[40:43], a[56:59]
    buffer_load_dwordx4 v10, s[4:7], s28 offen offset:3072 lds
    v_mul_f32 v231, s34, v231
    v_cvt_pk_bf16_f32 v180, v228, v229
    v_cvt_pk_bf16_f32 v181, v230, v231
    v_mfma_f32_16x16x32_bf16 a[60:63], v[52:55], v[44:47], a[60:63]
    s_waitcnt lgkmcnt(4)
    s_add_u32 s28, s28, 16384
    s_bitset0_b32 s28, 19
    v_mul_f32 v244, s34, v244
    v_mul_f32 v245, s34, v245
    v_mul_f32 v246, s34, v246
    v_mul_f32 v247, s34, v247
    v_cvt_pk_bf16_f32 v182, v244, v245
    v_mfma_f32_16x16x32_bf16 a[64:67], v[56:59], v[32:35], a[64:67]
    ds_read_b64_tr_b16 v[52:53], v67 offset:384
    v_cvt_pk_bf16_f32 v183, v246, v247
    v_mul_f32 v232, s34, v232
    v_mul_f32 v233, s34, v233
    v_mul_f32 v234, s34, v234
    v_mul_f32 v235, s34, v235
    v_mfma_f32_16x16x32_bf16 a[68:71], v[56:59], v[36:39], a[68:71]
    s_add_u32 m0, s29, 49152
    ds_read_b64_tr_b16 v[54:55], v67 offset:17280
    v_cvt_pk_bf16_f32 v184, v232, v233
    v_cvt_pk_bf16_f32 v185, v234, v235
    v_mul_f32 v248, s34, v248
    v_mul_f32 v249, s34, v249
    v_mul_f32 v250, s34, v250
    v_mfma_f32_16x16x32_bf16 a[72:75], v[56:59], v[40:43], a[72:75]
    buffer_load_dwordx4 v10, s[4:7], s28 offen offset:0 lds
    v_mul_f32 v251, s34, v251
    v_cvt_pk_bf16_f32 v186, v248, v249
    v_cvt_pk_bf16_f32 v187, v250, v251
    v_mfma_f32_16x16x32_bf16 a[76:79], v[56:59], v[44:47], a[76:79]
    s_waitcnt lgkmcnt(4)
    v_mul_f32 v236, s34, v236
    v_mul_f32 v237, s34, v237
    v_mul_f32 v238, s34, v238
    v_mul_f32 v239, s34, v239
    v_cvt_pk_bf16_f32 v188, v236, v237
    v_mfma_f32_16x16x32_bf16 a[80:83], v[60:63], v[32:35], a[80:83]
    ds_read_b64_tr_b16 v[56:57], v67 offset:128
    v_cvt_pk_bf16_f32 v189, v238, v239
    v_mul_f32 v252, s34, v252
    v_mul_f32 v253, s34, v253
    v_mul_f32 v254, s34, v254
    v_mul_f32 v255, s34, v255
    v_mfma_f32_16x16x32_bf16 a[84:87], v[60:63], v[36:39], a[84:87]
    ds_read_b64_tr_b16 v[58:59], v67 offset:17024
    v_cvt_pk_bf16_f32 v190, v252, v253
    v_cvt_pk_bf16_f32 v191, v254, v255
    v_accvgpr_read_b32 v240, a0
    v_accvgpr_read_b32 v241, a1
    v_accvgpr_read_b32 v242, a2
    v_mfma_f32_16x16x32_bf16 a[88:91], v[60:63], v[40:43], a[88:91]
    buffer_load_dwordx4 v10, s[4:7], s28 offen offset:1024 lds
    v_accvgpr_read_b32 v243, a3
    v_accvgpr_read_b32 v244, a16
    v_accvgpr_read_b32 v245, a17
    v_mfma_f32_16x16x32_bf16 a[92:95], v[60:63], v[44:47], a[92:95]
    s_waitcnt lgkmcnt(4)
    v_accvgpr_read_b32 v246, a18
    v_accvgpr_read_b32 v247, a19
    v_mul_f32 v240, v240, v244
    v_mul_f32 v241, v241, v245
    v_mul_f32 v242, v242, v246
    v_mfma_f32_16x16x32_bf16 a[96:99], v[48:51], v[32:35], a[96:99]
    ds_read_b64_tr_b16 v[60:61], v67 offset:416
    v_mul_f32 v243, v243, v247
    v_cvt_pk_bf16_f32 v248, v240, v241
    v_cvt_pk_bf16_f32 v249, v242, v243
    v_accvgpr_read_b32 v240, a32
    v_accvgpr_read_b32 v241, a33
    v_mfma_f32_16x16x32_bf16 a[100:103], v[48:51], v[36:39], a[100:103]
    ds_read_b64_tr_b16 v[62:63], v67 offset:17312
    v_accvgpr_read_b32 v242, a34
    v_accvgpr_read_b32 v243, a35
    v_accvgpr_read_b32 v244, a48
    v_accvgpr_read_b32 v245, a49
    v_accvgpr_read_b32 v246, a50
    v_mfma_f32_16x16x32_bf16 a[104:107], v[48:51], v[40:43], a[104:107]
    buffer_load_dwordx4 v10, s[4:7], s28 offen offset:2048 lds
    v_accvgpr_read_b32 v247, a51
    v_mul_f32 v240, v240, v244
    v_mul_f32 v241, v241, v245
    v_mfma_f32_16x16x32_bf16 a[108:111], v[48:51], v[44:47], a[108:111]
    s_waitcnt lgkmcnt(4)
    v_mul_f32 v242, v242, v246
    v_mul_f32 v243, v243, v247
    v_cvt_pk_bf16_f32 v250, v240, v241
    v_cvt_pk_bf16_f32 v251, v242, v243
    buffer_store_dwordx4 v[248:251], v6, s[16:19], s31 offen offset:0
    v_mfma_f32_16x16x32_bf16 a[112:115], v[52:55], v[32:35], a[112:115]
    ds_read_b64_tr_b16 v[48:49], v67 offset:160
    v_accvgpr_read_b32 v240, a4
    v_accvgpr_read_b32 v241, a5
    v_accvgpr_read_b32 v242, a6
    v_accvgpr_read_b32 v243, a7
    v_accvgpr_read_b32 v244, a20
    v_mfma_f32_16x16x32_bf16 a[116:119], v[52:55], v[36:39], a[116:119]
    ds_read_b64_tr_b16 v[50:51], v67 offset:17056
    v_accvgpr_read_b32 v245, a21
    v_accvgpr_read_b32 v246, a22
    v_accvgpr_read_b32 v247, a23
    v_mul_f32 v240, v240, v244
    v_mul_f32 v241, v241, v245
    v_mfma_f32_16x16x32_bf16 a[120:123], v[52:55], v[40:43], a[120:123]
    buffer_load_dwordx4 v10, s[4:7], s28 offen offset:3072 lds
    v_mul_f32 v242, v242, v246
    v_mul_f32 v243, v243, v247
    v_cvt_pk_bf16_f32 v252, v240, v241
    v_mfma_f32_16x16x32_bf16 a[124:127], v[52:55], v[44:47], a[124:127]
    s_waitcnt lgkmcnt(4)
    s_add_u32 s28, s28, 16384
    s_bitset0_b32 s28, 19
    v_cvt_pk_bf16_f32 v253, v242, v243
    v_accvgpr_read_b32 v240, a36
    v_accvgpr_read_b32 v241, a37
    v_accvgpr_read_b32 v242, a38
    v_accvgpr_read_b32 v243, a39
    v_mfma_f32_16x16x32_bf16 a[128:131], v[56:59], v[32:35], a[128:131]
    ds_read_b64_tr_b16 v[52:53], v67 offset:448
    v_accvgpr_read_b32 v244, a52
    v_accvgpr_read_b32 v245, a53
    v_accvgpr_read_b32 v246, a54
    v_accvgpr_read_b32 v247, a55
    v_mul_f32 v240, v240, v244
    v_mfma_f32_16x16x32_bf16 a[132:135], v[56:59], v[36:39], a[132:135]
    ds_read_b64_tr_b16 v[54:55], v67 offset:17344
    v_mul_f32 v241, v241, v245
    v_mul_f32 v242, v242, v246
    v_mul_f32 v243, v243, v247
    v_cvt_pk_bf16_f32 v254, v240, v241
    v_cvt_pk_bf16_f32 v255, v242, v243
    v_mfma_f32_16x16x32_bf16 a[136:139], v[56:59], v[40:43], a[136:139]
    buffer_store_dwordx4 v[252:255], v7, s[16:19], s31 offen offset:0
    v_accvgpr_read_b32 v240, a8
    v_accvgpr_read_b32 v241, a9
    v_accvgpr_read_b32 v242, a10
    v_accvgpr_read_b32 v243, a11
    v_mfma_f32_16x16x32_bf16 a[140:143], v[56:59], v[44:47], a[140:143]
    s_waitcnt lgkmcnt(4)
    v_accvgpr_read_b32 v244, a24
    v_accvgpr_read_b32 v245, a25
    v_accvgpr_read_b32 v246, a26
    v_accvgpr_read_b32 v247, a27
    v_mul_f32 v240, v240, v244
    v_mfma_f32_16x16x32_bf16 a[144:147], v[60:63], v[32:35], a[144:147]
    ds_read_b64_tr_b16 v[56:57], v67 offset:192
    v_mul_f32 v241, v241, v245
    v_mul_f32 v242, v242, v246
    v_mul_f32 v243, v243, v247
    v_cvt_pk_bf16_f32 v248, v240, v241
    v_cvt_pk_bf16_f32 v249, v242, v243
    v_mfma_f32_16x16x32_bf16 a[148:151], v[60:63], v[36:39], a[148:151]
    ds_read_b64_tr_b16 v[58:59], v67 offset:17088
    v_accvgpr_read_b32 v240, a40
    v_accvgpr_read_b32 v241, a41
    v_accvgpr_read_b32 v242, a42
    v_accvgpr_read_b32 v243, a43
    v_accvgpr_read_b32 v244, a56
    v_mfma_f32_16x16x32_bf16 a[152:155], v[60:63], v[40:43], a[152:155]
    v_accvgpr_read_b32 v245, a57
    v_accvgpr_read_b32 v246, a58
    v_accvgpr_read_b32 v247, a59
    v_mul_f32 v240, v240, v244
    v_mul_f32 v241, v241, v245
    v_mfma_f32_16x16x32_bf16 a[156:159], v[60:63], v[44:47], a[156:159]
    s_waitcnt lgkmcnt(4)
    v_mul_f32 v242, v242, v246
    v_mul_f32 v243, v243, v247
    v_cvt_pk_bf16_f32 v250, v240, v241
    v_cvt_pk_bf16_f32 v251, v242, v243
    buffer_store_dwordx4 v[248:251], v8, s[16:19], s31 offen offset:0
    v_mfma_f32_16x16x32_bf16 a[160:163], v[48:51], v[32:35], a[160:163]
    ds_read_b64_tr_b16 v[60:61], v67 offset:480
    v_accvgpr_read_b32 v240, a12
    v_accvgpr_read_b32 v241, a13
    v_accvgpr_read_b32 v242, a14
    v_accvgpr_read_b32 v243, a15
    v_accvgpr_read_b32 v244, a28
    v_mfma_f32_16x16x32_bf16 a[164:167], v[48:51], v[36:39], a[164:167]
    ds_read_b64_tr_b16 v[62:63], v67 offset:17376
    v_accvgpr_read_b32 v245, a29
    v_accvgpr_read_b32 v246, a30
    v_accvgpr_read_b32 v247, a31
    v_mul_f32 v240, v240, v244
    v_mul_f32 v241, v241, v245
    v_mfma_f32_16x16x32_bf16 a[168:171], v[48:51], v[40:43], a[168:171]
    v_mul_f32 v242, v242, v246
    v_mul_f32 v243, v243, v247
    v_cvt_pk_bf16_f32 v252, v240, v241
    v_cvt_pk_bf16_f32 v253, v242, v243
    v_accvgpr_read_b32 v240, a44
    v_mfma_f32_16x16x32_bf16 a[172:175], v[48:51], v[44:47], a[172:175]
    s_waitcnt lgkmcnt(4)
    v_accvgpr_read_b32 v241, a45
    v_accvgpr_read_b32 v242, a46
    v_accvgpr_read_b32 v243, a47
    v_accvgpr_read_b32 v244, a60
    v_accvgpr_read_b32 v245, a61
    v_mfma_f32_16x16x32_bf16 a[176:179], v[52:55], v[32:35], a[176:179]
    ds_read_b64_tr_b16 v[48:49], v67 offset:224
    v_accvgpr_read_b32 v246, a62
    v_accvgpr_read_b32 v247, a63
    v_mul_f32 v240, v240, v244
    v_mul_f32 v241, v241, v245
    v_mul_f32 v242, v242, v246
    v_mfma_f32_16x16x32_bf16 a[180:183], v[52:55], v[36:39], a[180:183]
    ds_read_b64_tr_b16 v[50:51], v67 offset:17120
    v_mul_f32 v243, v243, v247
    v_cvt_pk_bf16_f32 v254, v240, v241
    v_cvt_pk_bf16_f32 v255, v242, v243
    buffer_store_dwordx4 v[252:255], v9, s[16:19], s31 offen offset:0
    v_accvgpr_read_b32 v240, a64
    v_mfma_f32_16x16x32_bf16 a[184:187], v[52:55], v[40:43], a[184:187]
    v_accvgpr_read_b32 v241, a65
    v_accvgpr_read_b32 v242, a66
    v_accvgpr_read_b32 v243, a67
    v_accvgpr_read_b32 v244, a80
    v_accvgpr_read_b32 v245, a81
    v_mfma_f32_16x16x32_bf16 a[188:191], v[52:55], v[44:47], a[188:191]
    s_waitcnt lgkmcnt(4)
    v_accvgpr_read_b32 v246, a82
    v_accvgpr_read_b32 v247, a83
    v_mul_f32 v240, v240, v244
    v_mul_f32 v241, v241, v245
    v_mul_f32 v242, v242, v246
    v_mfma_f32_16x16x32_bf16 a[192:195], v[56:59], v[32:35], a[192:195]
    ds_read_b64_tr_b16 v[52:53], v67 offset:512
    v_mul_f32 v243, v243, v247
    v_cvt_pk_bf16_f32 v248, v240, v241
    v_cvt_pk_bf16_f32 v249, v242, v243
    v_accvgpr_read_b32 v240, a96
    v_accvgpr_read_b32 v241, a97
    v_mfma_f32_16x16x32_bf16 a[196:199], v[56:59], v[36:39], a[196:199]
    ds_read_b64_tr_b16 v[54:55], v67 offset:17408
    v_accvgpr_read_b32 v242, a98
    v_accvgpr_read_b32 v243, a99
    v_accvgpr_read_b32 v244, a112
    v_accvgpr_read_b32 v245, a113
    v_accvgpr_read_b32 v246, a114
    v_mfma_f32_16x16x32_bf16 a[200:203], v[56:59], v[40:43], a[200:203]
    v_accvgpr_read_b32 v247, a115
    v_mul_f32 v240, v240, v244
    v_mul_f32 v241, v241, v245
    v_mul_f32 v242, v242, v246
    v_mul_f32 v243, v243, v247
    v_mfma_f32_16x16x32_bf16 a[204:207], v[56:59], v[44:47], a[204:207]
    s_waitcnt lgkmcnt(4)
    v_cvt_pk_bf16_f32 v250, v240, v241
    v_cvt_pk_bf16_f32 v251, v242, v243
    buffer_store_dwordx4 v[248:251], v6, s[16:19], s31 offen offset:1024
    v_accvgpr_read_b32 v240, a68
    v_accvgpr_read_b32 v241, a69
    v_mfma_f32_16x16x32_bf16 a[208:211], v[60:63], v[32:35], a[208:211]
    ds_read_b64_tr_b16 v[56:57], v67 offset:256
    v_accvgpr_read_b32 v242, a70
    v_accvgpr_read_b32 v243, a71
    v_accvgpr_read_b32 v244, a84
    v_accvgpr_read_b32 v245, a85
    v_accvgpr_read_b32 v246, a86
    v_mfma_f32_16x16x32_bf16 a[212:215], v[60:63], v[36:39], a[212:215]
    ds_read_b64_tr_b16 v[58:59], v67 offset:17152
    v_accvgpr_read_b32 v247, a87
    v_mul_f32 v240, v240, v244
    v_mul_f32 v241, v241, v245
    v_mul_f32 v242, v242, v246
    v_mul_f32 v243, v243, v247
    v_mfma_f32_16x16x32_bf16 a[216:219], v[60:63], v[40:43], a[216:219]
    v_cvt_pk_bf16_f32 v252, v240, v241
    v_cvt_pk_bf16_f32 v253, v242, v243
    v_accvgpr_read_b32 v240, a100
    v_accvgpr_read_b32 v241, a101
    v_accvgpr_read_b32 v242, a102
    v_mfma_f32_16x16x32_bf16 a[220:223], v[60:63], v[44:47], a[220:223]
    s_waitcnt lgkmcnt(4)
    v_accvgpr_read_b32 v243, a103
    v_accvgpr_read_b32 v244, a116
    v_accvgpr_read_b32 v245, a117
    v_accvgpr_read_b32 v246, a118
    v_accvgpr_read_b32 v247, a119
    v_mfma_f32_16x16x32_bf16 a[224:227], v[48:51], v[32:35], a[224:227]
    ds_read_b64_tr_b16 v[60:61], v67 offset:544
    v_mul_f32 v240, v240, v244
    v_mul_f32 v241, v241, v245
    v_mul_f32 v242, v242, v246
    v_mul_f32 v243, v243, v247
    v_cvt_pk_bf16_f32 v254, v240, v241
    v_mfma_f32_16x16x32_bf16 a[228:231], v[48:51], v[36:39], a[228:231]
    ds_read_b64_tr_b16 v[62:63], v67 offset:17440
    v_cvt_pk_bf16_f32 v255, v242, v243
    buffer_store_dwordx4 v[252:255], v7, s[16:19], s31 offen offset:1024
    v_accvgpr_read_b32 v240, a72
    v_accvgpr_read_b32 v241, a73
    v_accvgpr_read_b32 v242, a74
    v_mfma_f32_16x16x32_bf16 a[232:235], v[48:51], v[40:43], a[232:235]
    v_accvgpr_read_b32 v243, a75
    v_accvgpr_read_b32 v244, a88
    v_accvgpr_read_b32 v245, a89
    v_accvgpr_read_b32 v246, a90
    v_accvgpr_read_b32 v247, a91
    v_mfma_f32_16x16x32_bf16 a[236:239], v[48:51], v[44:47], a[236:239]
    s_waitcnt lgkmcnt(4)
    v_mul_f32 v240, v240, v244
    v_mul_f32 v241, v241, v245
    v_mul_f32 v242, v242, v246
    v_mul_f32 v243, v243, v247
    v_cvt_pk_bf16_f32 v248, v240, v241
    v_mfma_f32_16x16x32_bf16 a[240:243], v[52:55], v[32:35], a[240:243]
    ds_read_b128 v[16:19], v80 offset:0
    v_cvt_pk_bf16_f32 v249, v242, v243
    v_accvgpr_read_b32 v240, a104
    v_accvgpr_read_b32 v241, a105
    v_accvgpr_read_b32 v242, a106
    v_accvgpr_read_b32 v243, a107
    v_mfma_f32_16x16x32_bf16 a[244:247], v[52:55], v[36:39], a[244:247]
    ds_read_b128 v[20:23], v81 offset:0
    v_accvgpr_read_b32 v244, a120
    v_accvgpr_read_b32 v245, a121
    v_accvgpr_read_b32 v246, a122
    v_accvgpr_read_b32 v247, a123
    v_mul_f32 v240, v240, v244
    v_mfma_f32_16x16x32_bf16 a[248:251], v[52:55], v[40:43], a[248:251]
    v_mul_f32 v241, v241, v245
    v_mul_f32 v242, v242, v246
    v_mul_f32 v243, v243, v247
    v_cvt_pk_bf16_f32 v250, v240, v241
    v_cvt_pk_bf16_f32 v251, v242, v243
    v_mfma_f32_16x16x32_bf16 a[252:255], v[52:55], v[44:47], a[252:255]
    s_waitcnt lgkmcnt(4)
    buffer_store_dwordx4 v[248:251], v8, s[16:19], s31 offen offset:1024
    v_accvgpr_read_b32 v240, a76
    v_accvgpr_read_b32 v241, a77
    v_accvgpr_read_b32 v242, a78
    v_accvgpr_read_b32 v243, a79
    v_mfma_f32_16x16x32_bf16 v[96:99], v[56:59], v[32:35], v[96:99]
    ds_read_b128 v[24:27], v82 offset:0
    v_accvgpr_read_b32 v244, a92
    v_accvgpr_read_b32 v245, a93
    v_accvgpr_read_b32 v246, a94
    v_accvgpr_read_b32 v247, a95
    v_mul_f32 v240, v240, v244
    v_mfma_f32_16x16x32_bf16 v[100:103], v[56:59], v[36:39], v[100:103]
    ds_read_b128 v[28:31], v83 offset:0
    v_mul_f32 v241, v241, v245
    v_mul_f32 v242, v242, v246
    v_mul_f32 v243, v243, v247
    v_cvt_pk_bf16_f32 v252, v240, v241
    v_cvt_pk_bf16_f32 v253, v242, v243
    v_mfma_f32_16x16x32_bf16 v[104:107], v[56:59], v[40:43], v[104:107]
    v_accvgpr_read_b32 v240, a108
    v_accvgpr_read_b32 v241, a109
    v_accvgpr_read_b32 v242, a110
    v_accvgpr_read_b32 v243, a111
    v_accvgpr_read_b32 v244, a124
    v_mfma_f32_16x16x32_bf16 v[108:111], v[56:59], v[44:47], v[108:111]
    s_waitcnt lgkmcnt(4)
    v_accvgpr_read_b32 v245, a125
    v_accvgpr_read_b32 v246, a126
    v_accvgpr_read_b32 v247, a127
    v_mul_f32 v240, v240, v244
    v_mul_f32 v241, v241, v245
    v_mfma_f32_16x16x32_bf16 v[112:115], v[60:63], v[32:35], v[112:115]
    v_mul_f32 v242, v242, v246
    v_mul_f32 v243, v243, v247
    v_cvt_pk_bf16_f32 v254, v240, v241
    v_cvt_pk_bf16_f32 v255, v242, v243
    buffer_store_dwordx4 v[252:255], v9, s[16:19], s31 offen offset:1024
    v_mfma_f32_16x16x32_bf16 v[116:119], v[60:63], v[36:39], v[116:119]
    v_accvgpr_read_b32 v240, a128
    v_accvgpr_read_b32 v241, a129
    v_accvgpr_read_b32 v242, a130
    v_accvgpr_read_b32 v243, a131
    v_accvgpr_read_b32 v244, a144
    v_mfma_f32_16x16x32_bf16 v[120:123], v[60:63], v[40:43], v[120:123]
    v_accvgpr_read_b32 v245, a145
    v_accvgpr_read_b32 v246, a146
    v_accvgpr_read_b32 v247, a147
    v_mul_f32 v240, v240, v244
    v_mul_f32 v241, v241, v245
    v_mfma_f32_16x16x32_bf16 v[124:127], v[60:63], v[44:47], v[124:127]
    v_mul_f32 v242, v242, v246
    v_mul_f32 v243, v243, v247
    v_cvt_pk_bf16_f32 v248, v240, v241
    v_cvt_pk_bf16_f32 v249, v242, v243
    v_accvgpr_read_b32 v240, a160
    s_waitcnt lgkmcnt(0)
    s_nop 1
    v_mfma_f32_16x16x32_bf16 v[192:195], v[16:19], v[128:131], 0
    ds_read_b128 v[32:35], v80 offset:1024
    v_accvgpr_read_b32 v241, a161
    v_accvgpr_read_b32 v242, a162
    v_accvgpr_read_b32 v243, a163
    v_accvgpr_read_b32 v244, a176
    v_accvgpr_read_b32 v245, a177
    v_mfma_f32_16x16x32_bf16 v[192:195], v[20:23], v[144:147], v[192:195]
    ds_read_b128 v[36:39], v81 offset:1024
    v_accvgpr_read_b32 v246, a178
    v_accvgpr_read_b32 v247, a179
    v_mul_f32 v240, v240, v244
    v_mul_f32 v241, v241, v245
    v_mul_f32 v242, v242, v246
    v_mfma_f32_16x16x32_bf16 v[192:195], v[24:27], v[160:163], v[192:195]
    ds_read_b128 v[40:43], v82 offset:1024
    v_mul_f32 v243, v243, v247
    v_cvt_pk_bf16_f32 v250, v240, v241
    v_cvt_pk_bf16_f32 v251, v242, v243
    buffer_store_dwordx4 v[248:251], v6, s[16:19], s31 offen offset:2048
    v_accvgpr_read_b32 v240, a132
    v_mfma_f32_16x16x32_bf16 v[192:195], v[28:31], v[176:179], v[192:195]
    ds_read_b128 v[44:47], v83 offset:1024
    v_accvgpr_read_b32 v241, a133
    v_accvgpr_read_b32 v242, a134
    v_accvgpr_read_b32 v243, a135
    v_accvgpr_read_b32 v244, a148
    v_accvgpr_read_b32 v245, a149
    v_mfma_f32_16x16x32_bf16 v[196:199], v[16:19], v[132:135], 0
    v_accvgpr_read_b32 v246, a150
    v_accvgpr_read_b32 v247, a151
    v_mul_f32 v240, v240, v244
    v_mul_f32 v241, v241, v245
    v_mul_f32 v242, v242, v246
    v_mfma_f32_16x16x32_bf16 v[196:199], v[20:23], v[148:151], v[196:199]
    v_mul_f32 v243, v243, v247
    v_cvt_pk_bf16_f32 v252, v240, v241
    v_cvt_pk_bf16_f32 v253, v242, v243
    v_accvgpr_read_b32 v240, a164
    v_accvgpr_read_b32 v241, a165
    v_mfma_f32_16x16x32_bf16 v[196:199], v[24:27], v[164:167], v[196:199]
    v_accvgpr_read_b32 v242, a166
    v_accvgpr_read_b32 v243, a167
    v_accvgpr_read_b32 v244, a180
    v_accvgpr_read_b32 v245, a181
    v_accvgpr_read_b32 v246, a182
    v_mfma_f32_16x16x32_bf16 v[196:199], v[28:31], v[180:183], v[196:199]
    v_accvgpr_read_b32 v247, a183
    v_mul_f32 v240, v240, v244
    v_mul_f32 v241, v241, v245
    v_mul_f32 v242, v242, v246
    v_mul_f32 v243, v243, v247
    v_mfma_f32_16x16x32_bf16 v[200:203], v[16:19], v[136:139], 0
    v_cvt_pk_bf16_f32 v254, v240, v241
    v_cvt_pk_bf16_f32 v255, v242, v243
    buffer_store_dwordx4 v[252:255], v7, s[16:19], s31 offen offset:2048
    v_accvgpr_read_b32 v240, a136
    v_accvgpr_read_b32 v241, a137
    v_mfma_f32_16x16x32_bf16 v[200:203], v[20:23], v[152:155], v[200:203]
    v_accvgpr_read_b32 v242, a138
    v_accvgpr_read_b32 v243, a139
    v_accvgpr_read_b32 v244, a152
    v_accvgpr_read_b32 v245, a153
    v_accvgpr_read_b32 v246, a154
    v_mfma_f32_16x16x32_bf16 v[200:203], v[24:27], v[168:171], v[200:203]
    v_accvgpr_read_b32 v247, a155
    v_mul_f32 v240, v240, v244
    v_mul_f32 v241, v241, v245
    v_mul_f32 v242, v242, v246
    v_mul_f32 v243, v243, v247
    v_mfma_f32_16x16x32_bf16 v[200:203], v[28:31], v[184:187], v[200:203]
    v_cvt_pk_bf16_f32 v248, v240, v241
    v_cvt_pk_bf16_f32 v249, v242, v243
    v_accvgpr_read_b32 v240, a168
    v_accvgpr_read_b32 v241, a169
    v_accvgpr_read_b32 v242, a170
    v_mfma_f32_16x16x32_bf16 v[204:207], v[16:19], v[140:143], 0
    v_accvgpr_read_b32 v243, a171
    v_accvgpr_read_b32 v244, a184
    v_accvgpr_read_b32 v245, a185
    v_accvgpr_read_b32 v246, a186
    v_accvgpr_read_b32 v247, a187
    v_mfma_f32_16x16x32_bf16 v[204:207], v[20:23], v[156:159], v[204:207]
    v_mul_f32 v240, v240, v244
    v_mul_f32 v241, v241, v245
    v_mul_f32 v242, v242, v246
    v_mul_f32 v243, v243, v247
    v_cvt_pk_bf16_f32 v250, v240, v241
    v_mfma_f32_16x16x32_bf16 v[204:207], v[24:27], v[172:175], v[204:207]
    v_cvt_pk_bf16_f32 v251, v242, v243
    buffer_store_dwordx4 v[248:251], v8, s[16:19], s31 offen offset:2048
    v_accvgpr_read_b32 v240, a140
    v_accvgpr_read_b32 v241, a141
    v_accvgpr_read_b32 v242, a142
    v_mfma_f32_16x16x32_bf16 v[204:207], v[28:31], v[188:191], v[204:207]
    v_accvgpr_read_b32 v243, a143
    v_accvgpr_read_b32 v244, a156
    v_accvgpr_read_b32 v245, a157
    v_accvgpr_read_b32 v246, a158
    v_accvgpr_read_b32 v247, a159
    v_mul_f32 v240, v240, v244
    v_mul_f32 v241, v241, v245
    v_mul_f32 v242, v242, v246
    v_mul_f32 v243, v243, v247
    v_cvt_pk_bf16_f32 v252, v240, v241
    v_cvt_pk_bf16_f32 v253, v242, v243
    v_accvgpr_read_b32 v240, a172
    v_accvgpr_read_b32 v241, a173
    v_max3_f32 v225, v192, v193, v194
    v_max_f32 v225, v225, v195
    v_max3_f32 v229, v196, v197, v198
    v_max_f32 v229, v229, v199
    v_max3_f32 v233, v200, v201, v202
    v_max_f32 v233, v233, v203
    v_max3_f32 v237, v204, v205, v206
    v_max_f32 v237, v237, v207
    v_mov_b32 v226, v225
    v_mov_b32 v230, v229
    v_mov_b32 v234, v233
    v_mov_b32 v238, v237
    v_permlane16_swap_b32 v226, v225
    v_permlane16_swap_b32 v230, v229
    v_permlane16_swap_b32 v234, v233
    v_permlane16_swap_b32 v238, v237
    v_max_f32 v225, v225, v226
    v_max_f32 v229, v229, v230
    v_max_f32 v233, v233, v234
    v_max_f32 v237, v237, v238
    v_mov_b32 v226, v225
    v_mov_b32 v230, v229
    v_mov_b32 v234, v233
    v_mov_b32 v238, v237
    v_permlane32_swap_b32 v226, v225
    v_permlane32_swap_b32 v230, v229
    v_permlane32_swap_b32 v234, v233
    v_permlane32_swap_b32 v238, v237
    v_max_f32 v225, v225, v226
    v_max_f32 v229, v229, v230
    v_max_f32 v233, v233, v234
    v_max_f32 v237, v237, v238
    v_sub_f32 v224, 0, v225
    v_sub_f32 v226, 0, v225
    v_sub_f32 v227, 0, v225
    v_sub_f32 v225, 0, v225
    v_sub_f32 v228, 0, v229
    v_sub_f32 v230, 0, v229
    v_sub_f32 v231, 0, v229
    v_sub_f32 v229, 0, v229
    v_sub_f32 v232, 0, v233
    v_sub_f32 v234, 0, v233
    v_sub_f32 v235, 0, v233
    v_sub_f32 v233, 0, v233
    v_sub_f32 v236, 0, v237
    v_sub_f32 v238, 0, v237
    v_sub_f32 v239, 0, v237
    v_sub_f32 v237, 0, v237
    s_waitcnt lgkmcnt(0)
    s_nop 1
    v_mfma_f32_16x16x32_bf16 v[192:195], v[16:19], v[128:131], v[224:227]
    v_accvgpr_read_b32 v242, a174
    v_accvgpr_read_b32 v243, a175
    v_accvgpr_read_b32 v244, a188
    v_accvgpr_read_b32 v245, a189
    v_accvgpr_read_b32 v246, a190
    v_mfma_f32_16x16x32_bf16 v[192:195], v[20:23], v[144:147], v[192:195]
    v_accvgpr_read_b32 v247, a191
    v_mul_f32 v240, v240, v244
    v_mul_f32 v241, v241, v245
    v_mul_f32 v242, v242, v246
    v_mul_f32 v243, v243, v247
    v_mfma_f32_16x16x32_bf16 v[192:195], v[24:27], v[160:163], v[192:195]
    v_cvt_pk_bf16_f32 v254, v240, v241
    v_cvt_pk_bf16_f32 v255, v242, v243
    buffer_store_dwordx4 v[252:255], v9, s[16:19], s31 offen offset:2048
    v_accvgpr_read_b32 v240, a192
    v_accvgpr_read_b32 v241, a193
    v_mfma_f32_16x16x32_bf16 v[192:195], v[28:31], v[176:179], v[192:195]
    v_accvgpr_read_b32 v242, a194
    v_accvgpr_read_b32 v243, a195
    v_accvgpr_read_b32 v244, a208
    v_accvgpr_read_b32 v245, a209
    v_accvgpr_read_b32 v246, a210
    v_mfma_f32_16x16x32_bf16 v[196:199], v[16:19], v[132:135], v[228:231]
    v_accvgpr_read_b32 v247, a211
    v_mul_f32 v240, v240, v244
    v_mul_f32 v241, v241, v245
    v_mul_f32 v242, v242, v246
    v_mul_f32 v243, v243, v247
    v_mfma_f32_16x16x32_bf16 v[196:199], v[20:23], v[148:151], v[196:199]
    v_cvt_pk_bf16_f32 v248, v240, v241
    v_cvt_pk_bf16_f32 v249, v242, v243
    v_accvgpr_read_b32 v240, a224
    v_accvgpr_read_b32 v241, a225
    v_accvgpr_read_b32 v242, a226
    v_mfma_f32_16x16x32_bf16 v[196:199], v[24:27], v[164:167], v[196:199]
    v_accvgpr_read_b32 v243, a227
    v_accvgpr_read_b32 v244, a240
    v_accvgpr_read_b32 v245, a241
    v_accvgpr_read_b32 v246, a242
    v_accvgpr_read_b32 v247, a243
    v_mfma_f32_16x16x32_bf16 v[196:199], v[28:31], v[180:183], v[196:199]
    v_mul_f32 v240, v240, v244
    v_mul_f32 v241, v241, v245
    v_mul_f32 v242, v242, v246
    v_mul_f32 v243, v243, v247
    v_cvt_pk_bf16_f32 v250, v240, v241
    v_mfma_f32_16x16x32_bf16 v[200:203], v[16:19], v[136:139], v[232:235]
    v_cvt_pk_bf16_f32 v251, v242, v243
    buffer_store_dwordx4 v[248:251], v6, s[16:19], s31 offen offset:3072
    v_accvgpr_read_b32 v240, a196
    v_accvgpr_read_b32 v241, a197
    v_accvgpr_read_b32 v242, a198
    v_mfma_f32_16x16x32_bf16 v[200:203], v[20:23], v[152:155], v[200:203]
    v_accvgpr_read_b32 v243, a199
    v_accvgpr_read_b32 v244, a212
    v_accvgpr_read_b32 v245, a213
    v_accvgpr_read_b32 v246, a214
    v_accvgpr_read_b32 v247, a215
    v_mfma_f32_16x16x32_bf16 v[200:203], v[24:27], v[168:171], v[200:203]
    v_mul_f32 v240, v240, v244
    v_mul_f32 v241, v241, v245
    v_mul_f32 v242, v242, v246
    v_mul_f32 v243, v243, v247
    v_cvt_pk_bf16_f32 v252, v240, v241
    v_mfma_f32_16x16x32_bf16 v[200:203], v[28:31], v[184:187], v[200:203]
    v_cvt_pk_bf16_f32 v253, v242, v243
    v_accvgpr_read_b32 v240, a228
    v_accvgpr_read_b32 v241, a229
    v_accvgpr_read_b32 v242, a230
    v_accvgpr_read_b32 v243, a231
    v_mfma_f32_16x16x32_bf16 v[204:207], v[16:19], v[140:143], v[236:239]
    v_accvgpr_read_b32 v244, a244
    v_accvgpr_read_b32 v245, a245
    v_accvgpr_read_b32 v246, a246
    v_accvgpr_read_b32 v247, a247
    v_mul_f32 v240, v240, v244
    v_mfma_f32_16x16x32_bf16 v[204:207], v[20:23], v[156:159], v[204:207]
    v_mul_f32 v241, v241, v245
    v_mul_f32 v242, v242, v246
    v_mul_f32 v243, v243, v247
    v_cvt_pk_bf16_f32 v254, v240, v241
    v_cvt_pk_bf16_f32 v255, v242, v243
    v_mfma_f32_16x16x32_bf16 v[204:207], v[24:27], v[172:175], v[204:207]
    buffer_store_dwordx4 v[252:255], v7, s[16:19], s31 offen offset:3072
    v_accvgpr_read_b32 v240, a200
    v_accvgpr_read_b32 v241, a201
    v_accvgpr_read_b32 v242, a202
    v_accvgpr_read_b32 v243, a203
    v_mfma_f32_16x16x32_bf16 v[204:207], v[28:31], v[188:191], v[204:207]
    v_accvgpr_read_b32 v244, a216
    v_accvgpr_read_b32 v245, a217
    v_accvgpr_read_b32 v246, a218
    v_accvgpr_read_b32 v247, a219
    v_mul_f32 v240, v240, v244
    v_mfma_f32_16x16x32_bf16 v[208:211], v[32:35], v[128:131], v[224:227]
    ds_read_b128 a[0:3], v80 offset:2048
    v_mul_f32 v241, v241, v245
    v_mul_f32 v242, v242, v246
    v_mul_f32 v243, v243, v247
    v_cvt_pk_bf16_f32 v248, v240, v241
    v_cvt_pk_bf16_f32 v249, v242, v243
    v_mfma_f32_16x16x32_bf16 v[208:211], v[36:39], v[144:147], v[208:211]
    ds_read_b128 a[4:7], v81 offset:2048
    v_accvgpr_read_b32 v240, a232
    v_accvgpr_read_b32 v241, a233
    v_accvgpr_read_b32 v242, a234
    v_accvgpr_read_b32 v243, a235
    v_accvgpr_read_b32 v244, a248
    v_mfma_f32_16x16x32_bf16 v[208:211], v[40:43], v[160:163], v[208:211]
    ds_read_b128 a[8:11], v82 offset:2048
    v_accvgpr_read_b32 v245, a249
    v_accvgpr_read_b32 v246, a250
    v_accvgpr_read_b32 v247, a251
    v_mul_f32 v240, v240, v244
    v_mul_f32 v241, v241, v245
    v_mfma_f32_16x16x32_bf16 v[208:211], v[44:47], v[176:179], v[208:211]
    ds_read_b128 a[12:15], v83 offset:2048
    v_mul_f32 v242, v242, v246
    v_mul_f32 v243, v243, v247
    v_cvt_pk_bf16_f32 v250, v240, v241
    v_cvt_pk_bf16_f32 v251, v242, v243
    buffer_store_dwordx4 v[248:251], v8, s[16:19], s31 offen offset:3072
    v_mfma_f32_16x16x32_bf16 v[212:215], v[32:35], v[132:135], v[228:231]
    ds_read_b128 a[16:19], v80 offset:3072
    v_accvgpr_read_b32 v240, a204
    v_accvgpr_read_b32 v241, a205
    v_accvgpr_read_b32 v242, a206
    v_accvgpr_read_b32 v243, a207
    v_accvgpr_read_b32 v244, a220
    v_mfma_f32_16x16x32_bf16 v[212:215], v[36:39], v[148:151], v[212:215]
    ds_read_b128 a[20:23], v81 offset:3072
    v_accvgpr_read_b32 v245, a221
    v_accvgpr_read_b32 v246, a222
    v_accvgpr_read_b32 v247, a223
    v_mul_f32 v240, v240, v244
    v_mul_f32 v241, v241, v245
    v_mfma_f32_16x16x32_bf16 v[212:215], v[40:43], v[164:167], v[212:215]
    ds_read_b128 a[24:27], v82 offset:3072
    v_mul_f32 v242, v242, v246
    v_mul_f32 v243, v243, v247
    v_cvt_pk_bf16_f32 v252, v240, v241
    v_cvt_pk_bf16_f32 v253, v242, v243
    v_accvgpr_read_b32 v240, a236
    v_mfma_f32_16x16x32_bf16 v[212:215], v[44:47], v[180:183], v[212:215]
    ds_read_b128 a[28:31], v83 offset:3072
    v_accvgpr_read_b32 v241, a237
    v_accvgpr_read_b32 v242, a238
    v_accvgpr_read_b32 v243, a239
    v_accvgpr_read_b32 v244, a252
    v_accvgpr_read_b32 v245, a253
    v_mfma_f32_16x16x32_bf16 v[216:219], v[32:35], v[136:139], v[232:235]
    v_accvgpr_read_b32 v246, a254
    v_accvgpr_read_b32 v247, a255
    v_mul_f32 v240, v240, v244
    v_mul_f32 v241, v241, v245
    v_mul_f32 v242, v242, v246
    v_mfma_f32_16x16x32_bf16 v[216:219], v[36:39], v[152:155], v[216:219]
    v_mul_f32 v243, v243, v247
    v_cvt_pk_bf16_f32 v254, v240, v241
    v_cvt_pk_bf16_f32 v255, v242, v243
    buffer_store_dwordx4 v[252:255], v9, s[16:19], s31 offen offset:3072
    v_mul_f32 v96, v96, v112
    v_mfma_f32_16x16x32_bf16 v[216:219], v[40:43], v[168:171], v[216:219]
    v_mul_f32 v97, v97, v113
    v_mul_f32 v98, v98, v114
    v_mul_f32 v99, v99, v115
    v_cvt_pk_bf16_f32 v112, v96, v97
    v_cvt_pk_bf16_f32 v113, v98, v99
    v_mfma_f32_16x16x32_bf16 v[216:219], v[44:47], v[184:187], v[216:219]
    buffer_store_dwordx2 v[112:113], v6, s[16:19], s32 offen
    v_mul_f32 v100, v100, v116
    v_mul_f32 v101, v101, v117
    v_mul_f32 v102, v102, v118
    v_mul_f32 v103, v103, v119
    v_mfma_f32_16x16x32_bf16 v[220:223], v[32:35], v[140:143], v[236:239]
    v_cvt_pk_bf16_f32 v116, v100, v101
    v_cvt_pk_bf16_f32 v117, v102, v103
    buffer_store_dwordx2 v[116:117], v7, s[16:19], s32 offen
    v_mul_f32 v104, v104, v120
    v_mul_f32 v105, v105, v121
    v_mfma_f32_16x16x32_bf16 v[220:223], v[36:39], v[156:159], v[220:223]
    v_mul_f32 v106, v106, v122
    v_mul_f32 v107, v107, v123
    v_cvt_pk_bf16_f32 v120, v104, v105
    v_cvt_pk_bf16_f32 v121, v106, v107
    buffer_store_dwordx2 v[120:121], v8, s[16:19], s32 offen
    v_mfma_f32_16x16x32_bf16 v[220:223], v[40:43], v[172:175], v[220:223]
    v_mul_f32 v108, v108, v124
    v_mul_f32 v109, v109, v125
    v_mul_f32 v110, v110, v126
    v_mul_f32 v111, v111, v127
    v_cvt_pk_bf16_f32 v124, v108, v109
    v_mfma_f32_16x16x32_bf16 v[220:223], v[44:47], v[188:191], v[220:223]
    v_cvt_pk_bf16_f32 v125, v110, v111
    buffer_store_dwordx2 v[124:125], v9, s[16:19], s32 offen
    s_waitcnt lgkmcnt(4)
    v_accvgpr_write_b32 a192, 0
    v_accvgpr_write_b32 a193, 0
    v_accvgpr_write_b32 a194, 0
    v_accvgpr_write_b32 a195, 0
    v_accvgpr_write_b32 a196, 0
    v_accvgpr_write_b32 a197, 0
    v_accvgpr_write_b32 a198, 0
    v_accvgpr_write_b32 a199, 0
    v_accvgpr_write_b32 a200, 0
    v_accvgpr_write_b32 a201, 0
    v_accvgpr_write_b32 a202, 0
    v_accvgpr_write_b32 a203, 0
    v_accvgpr_write_b32 a204, 0
    v_accvgpr_write_b32 a205, 0
    v_accvgpr_write_b32 a206, 0
    v_accvgpr_write_b32 a207, 0
    v_mov_b32 v110, L_attn_tail-L_trans
    v_mov_b32 v111, 0
    v_lshl_add_u64 v[108:109], v[110:111], 0, v[76:77]
    v_mov_b32 v1, 163816
    v_add_u32 v0, s24, v1
    v_mov_b32 v110, 0
    v_mfma_f32_16x16x32_bf16 v[16:19], a[0:3], v[128:131], v[224:227]
    v_exp_f32 v192, v192
    v_mfma_f32_16x16x32_bf16 v[16:19], a[4:7], v[144:147], v[16:19]
    v_exp_f32 v193, v193
    v_mfma_f32_16x16x32_bf16 v[16:19], a[8:11], v[160:163], v[16:19]
    v_cvt_pk_bf16_f32 v48, v192, v193
    v_exp_f32 v194, v194
    v_mfma_f32_16x16x32_bf16 v[16:19], a[12:15], v[176:179], v[16:19]
    v_exp_f32 v195, v195
    v_mfma_f32_16x16x32_bf16 v[20:23], a[0:3], v[132:135], v[228:231]
    v_cvt_pk_bf16_f32 v49, v194, v195
    v_exp_f32 v208, v208
    v_mfma_f32_16x16x32_bf16 v[20:23], a[4:7], v[148:151], v[20:23]
    v_exp_f32 v209, v209
    v_mfma_f32_16x16x32_bf16 v[20:23], a[8:11], v[164:167], v[20:23]
    v_cvt_pk_bf16_f32 v50, v208, v209
    v_exp_f32 v210, v210
    v_mfma_f32_16x16x32_bf16 v[20:23], a[12:15], v[180:183], v[20:23]
    v_exp_f32 v211, v211
    v_mfma_f32_16x16x32_bf16 v[24:27], a[0:3], v[136:139], v[232:235]
    v_cvt_pk_bf16_f32 v51, v210, v211
    v_exp_f32 v196, v196
    v_mfma_f32_16x16x32_bf16 v[24:27], a[4:7], v[152:155], v[24:27]
    v_exp_f32 v197, v197
    v_mfma_f32_16x16x32_bf16 v[24:27], a[8:11], v[168:171], v[24:27]
    v_cvt_pk_bf16_f32 v56, v196, v197
    v_exp_f32 v198, v198
    v_mfma_f32_16x16x32_bf16 v[24:27], a[12:15], v[184:187], v[24:27]
    v_exp_f32 v199, v199
    v_mfma_f32_16x16x32_bf16 v[28:31], a[0:3], v[140:143], v[236:239]
    v_cvt_pk_bf16_f32 v57, v198, v199
    v_exp_f32 v212, v212
    v_mfma_f32_16x16x32_bf16 v[28:31], a[4:7], v[156:159], v[28:31]
    v_exp_f32 v213, v213
    v_mfma_f32_16x16x32_bf16 v[28:31], a[8:11], v[172:175], v[28:31]
    v_cvt_pk_bf16_f32 v58, v212, v213
    v_exp_f32 v214, v214
    v_mfma_f32_16x16x32_bf16 v[28:31], a[12:15], v[188:191], v[28:31]
    s_waitcnt vmcnt(28) lgkmcnt(0)
    s_barrier
    s_add_u32 m0, s29, 81920
    s_nop 0
    buffer_load_dwordx4 v11, s[8:11], s37 offen offset:0 lds
    buffer_load_dwordx4 v11, s[8:11], s37 offen offset:1024 lds
    buffer_load_dwordx4 v11, s[8:11], s37 offen offset:2048 lds
    buffer_load_dwordx4 v11, s[8:11], s37 offen offset:3072 lds
    s_add_u32 s37, s37, 16384
    s_bitset0_b32 s37, 19
    v_exp_f32 v215, v215
    v_mfma_f32_16x16x32_bf16 v[32:35], a[16:19], v[128:131], v[224:227]
    v_cvt_pk_bf16_f32 v59, v214, v215
    v_exp_f32 v200, v200
    v_mfma_f32_16x16x32_bf16 v[32:35], a[20:23], v[144:147], v[32:35]
    ds_read_b128 a[0:3], v80 offset:16384
    v_exp_f32 v201, v201
    v_mfma_f32_16x16x32_bf16 v[32:35], a[24:27], v[160:163], v[32:35]
    v_cvt_pk_bf16_f32 v64, v200, v201
    v_exp_f32 v202, v202
    v_mfma_f32_16x16x32_bf16 v[32:35], a[28:31], v[176:179], v[32:35]
    ds_read_b128 a[4:7], v81 offset:16384
    v_exp_f32 v203, v203
    v_mfma_f32_16x16x32_bf16 v[36:39], a[16:19], v[132:135], v[228:231]
    v_cvt_pk_bf16_f32 v65, v202, v203
    v_exp_f32 v216, v216
    v_mfma_f32_16x16x32_bf16 v[36:39], a[20:23], v[148:151], v[36:39]
    ds_read_b128 a[8:11], v82 offset:16384
    v_exp_f32 v217, v217
    v_mfma_f32_16x16x32_bf16 v[36:39], a[24:27], v[164:167], v[36:39]
    v_cvt_pk_bf16_f32 v66, v216, v217
    v_exp_f32 v218, v218
    v_mfma_f32_16x16x32_bf16 v[36:39], a[28:31], v[180:183], v[36:39]
    ds_read_b128 a[12:15], v83 offset:16384
    v_exp_f32 v219, v219
    v_mfma_f32_16x16x32_bf16 v[40:43], a[16:19], v[136:139], v[232:235]
    s_add_u32 m0, s29, 98304
    v_cvt_pk_bf16_f32 v67, v218, v219
    v_exp_f32 v204, v204
    v_mfma_f32_16x16x32_bf16 v[40:43], a[20:23], v[152:155], v[40:43]
    buffer_load_dwordx4 v11, s[8:11], s37 offen offset:0 lds
    v_exp_f32 v205, v205
    v_mfma_f32_16x16x32_bf16 v[40:43], a[24:27], v[168:171], v[40:43]
    v_cvt_pk_bf16_f32 v72, v204, v205
    v_exp_f32 v206, v206
    v_mfma_f32_16x16x32_bf16 v[40:43], a[28:31], v[184:187], v[40:43]
    buffer_load_dwordx4 v11, s[8:11], s37 offen offset:1024 lds
    v_exp_f32 v207, v207
    v_mfma_f32_16x16x32_bf16 v[44:47], a[16:19], v[140:143], v[236:239]
    v_cvt_pk_bf16_f32 v73, v206, v207
    v_exp_f32 v220, v220
    v_mfma_f32_16x16x32_bf16 v[44:47], a[20:23], v[156:159], v[44:47]
    buffer_load_dwordx4 v11, s[8:11], s37 offen offset:2048 lds
    v_exp_f32 v221, v221
    v_mfma_f32_16x16x32_bf16 v[44:47], a[24:27], v[172:175], v[44:47]
    v_cvt_pk_bf16_f32 v74, v220, v221
    v_exp_f32 v222, v222
    v_mfma_f32_16x16x32_bf16 v[44:47], a[28:31], v[188:191], v[44:47]
    buffer_load_dwordx4 v11, s[8:11], s37 offen offset:3072 lds
    v_exp_f32 v223, v223
    s_nop 0
    v_cvt_pk_bf16_f32 v75, v222, v223
    s_add_u32 s37, s37, 16384
    s_bitset0_b32 s37, 19
    ds_read_b128 a[16:19], v80 offset:17408
    ds_read_b128 a[20:23], v81 offset:17408
    ds_read_b128 a[24:27], v82 offset:17408
    ds_read_b128 a[28:31], v83 offset:17408
    s_waitcnt lgkmcnt(4)
    v_mfma_f32_16x16x32_bf16 v[192:195], a[0:3], v[128:131], v[224:227]
    v_exp_f32 v16, v16
    v_mfma_f32_16x16x32_bf16 v[192:195], a[4:7], v[144:147], v[192:195]
    v_exp_f32 v17, v17
    v_mfma_f32_16x16x32_bf16 v[192:195], a[8:11], v[160:163], v[192:195]
    v_cvt_pk_bf16_f32 v52, v16, v17
    v_exp_f32 v18, v18
    v_mfma_f32_16x16x32_bf16 v[192:195], a[12:15], v[176:179], v[192:195]
    v_exp_f32 v19, v19
    v_mfma_f32_16x16x32_bf16 v[196:199], a[0:3], v[132:135], v[228:231]
    v_cvt_pk_bf16_f32 v53, v18, v19
    v_exp_f32 v32, v32
    v_mfma_f32_16x16x32_bf16 v[196:199], a[4:7], v[148:151], v[196:199]
    v_exp_f32 v33, v33
    v_mfma_f32_16x16x32_bf16 v[196:199], a[8:11], v[164:167], v[196:199]
    v_cvt_pk_bf16_f32 v54, v32, v33
    v_exp_f32 v34, v34
    v_mfma_f32_16x16x32_bf16 v[196:199], a[12:15], v[180:183], v[196:199]
    v_exp_f32 v35, v35
    v_mfma_f32_16x16x32_bf16 v[200:203], a[0:3], v[136:139], v[232:235]
    v_cvt_pk_bf16_f32 v55, v34, v35
    v_exp_f32 v20, v20
    v_mfma_f32_16x16x32_bf16 v[200:203], a[4:7], v[152:155], v[200:203]
    v_exp_f32 v21, v21
    v_mfma_f32_16x16x32_bf16 v[200:203], a[8:11], v[168:171], v[200:203]
    v_cvt_pk_bf16_f32 v60, v20, v21
    v_exp_f32 v22, v22
    v_mfma_f32_16x16x32_bf16 v[200:203], a[12:15], v[184:187], v[200:203]
    v_exp_f32 v23, v23
    v_mfma_f32_16x16x32_bf16 v[204:207], a[0:3], v[140:143], v[236:239]
    v_cvt_pk_bf16_f32 v61, v22, v23
    v_exp_f32 v36, v36
    v_mfma_f32_16x16x32_bf16 v[204:207], a[4:7], v[156:159], v[204:207]
    v_exp_f32 v37, v37
    v_mfma_f32_16x16x32_bf16 v[204:207], a[8:11], v[172:175], v[204:207]
    v_cvt_pk_bf16_f32 v62, v36, v37
    v_exp_f32 v38, v38
    v_mfma_f32_16x16x32_bf16 v[204:207], a[12:15], v[188:191], v[204:207]
    s_waitcnt lgkmcnt(0)
    v_exp_f32 v39, v39
    v_mfma_f32_16x16x32_bf16 v[208:211], a[16:19], v[128:131], v[224:227]
    v_cvt_pk_bf16_f32 v63, v38, v39
    v_exp_f32 v24, v24
    v_mfma_f32_16x16x32_bf16 v[208:211], a[20:23], v[144:147], v[208:211]
    ds_read_b128 a[0:3], v80 offset:18432
    v_exp_f32 v25, v25
    v_mfma_f32_16x16x32_bf16 v[208:211], a[24:27], v[160:163], v[208:211]
    v_cvt_pk_bf16_f32 v68, v24, v25
    v_exp_f32 v26, v26
    v_mfma_f32_16x16x32_bf16 v[208:211], a[28:31], v[176:179], v[208:211]
    ds_read_b128 a[4:7], v81 offset:18432
    v_exp_f32 v27, v27
    v_mfma_f32_16x16x32_bf16 v[212:215], a[16:19], v[132:135], v[228:231]
    v_cvt_pk_bf16_f32 v69, v26, v27
    v_exp_f32 v40, v40
    v_mfma_f32_16x16x32_bf16 v[212:215], a[20:23], v[148:151], v[212:215]
    ds_read_b128 a[8:11], v82 offset:18432
    v_exp_f32 v41, v41
    v_mfma_f32_16x16x32_bf16 v[212:215], a[24:27], v[164:167], v[212:215]
    v_cvt_pk_bf16_f32 v70, v40, v41
    v_exp_f32 v42, v42
    v_mfma_f32_16x16x32_bf16 v[212:215], a[28:31], v[180:183], v[212:215]
    ds_read_b128 a[12:15], v83 offset:18432
    v_exp_f32 v43, v43
    v_mfma_f32_16x16x32_bf16 v[216:219], a[16:19], v[136:139], v[232:235]
    s_add_u32 m0, s29, 0
    v_cvt_pk_bf16_f32 v71, v42, v43
    v_exp_f32 v28, v28
    v_mfma_f32_16x16x32_bf16 v[216:219], a[20:23], v[152:155], v[216:219]
    buffer_load_dwordx4 v10, s[4:7], s28 offen offset:0 lds
    v_exp_f32 v29, v29
    v_mfma_f32_16x16x32_bf16 v[216:219], a[24:27], v[168:171], v[216:219]
    v_cvt_pk_bf16_f32 v76, v28, v29
    v_exp_f32 v30, v30
    v_mfma_f32_16x16x32_bf16 v[216:219], a[28:31], v[184:187], v[216:219]
    buffer_load_dwordx4 v10, s[4:7], s28 offen offset:1024 lds
    v_exp_f32 v31, v31
    v_mfma_f32_16x16x32_bf16 v[220:223], a[16:19], v[140:143], v[236:239]
    v_cvt_pk_bf16_f32 v77, v30, v31
    v_exp_f32 v44, v44
    v_mfma_f32_16x16x32_bf16 v[220:223], a[20:23], v[156:159], v[220:223]
    buffer_load_dwordx4 v10, s[4:7], s28 offen offset:2048 lds
    v_exp_f32 v45, v45
    v_mfma_f32_16x16x32_bf16 v[220:223], a[24:27], v[172:175], v[220:223]
    v_cvt_pk_bf16_f32 v78, v44, v45
    v_exp_f32 v46, v46
    v_mfma_f32_16x16x32_bf16 v[220:223], a[28:31], v[188:191], v[220:223]
    buffer_load_dwordx4 v10, s[4:7], s28 offen offset:3072 lds
    v_exp_f32 v47, v47
    s_nop 0
    v_cvt_pk_bf16_f32 v79, v46, v47
    s_add_u32 s28, s28, 16384
    s_bitset0_b32 s28, 19
    ds_read_b128 a[16:19], v80 offset:19456
    ds_read_b128 a[20:23], v81 offset:19456
    ds_read_b128 a[24:27], v82 offset:19456
    ds_read_b128 a[28:31], v83 offset:19456
    s_waitcnt lgkmcnt(4)
    v_mfma_f32_16x16x32_bf16 v[16:19], a[0:3], v[128:131], v[224:227]
    v_exp_f32 v192, v192
    v_mfma_f32_16x16x32_bf16 v[16:19], a[4:7], v[144:147], v[16:19]
    ds_read_b64_tr_b16 a[32:33], v84 offset:0
    v_mfma_f32_16x16x32_bf16 v[16:19], a[8:11], v[160:163], v[16:19]
    v_exp_f32 v193, v193
    v_mfma_f32_16x16x32_bf16 v[16:19], a[12:15], v[176:179], v[16:19]
    ds_read_b64_tr_b16 a[34:35], v84 offset:1024
    v_cvt_pk_bf16_f32 v240, v192, v193
    v_mfma_f32_16x16x32_bf16 v[20:23], a[0:3], v[132:135], v[228:231]
    v_exp_f32 v194, v194
    v_mfma_f32_16x16x32_bf16 v[20:23], a[4:7], v[148:151], v[20:23]
    ds_read_b64_tr_b16 a[36:37], v84 offset:2048
    v_mfma_f32_16x16x32_bf16 v[20:23], a[8:11], v[164:167], v[20:23]
    v_exp_f32 v195, v195
    v_mfma_f32_16x16x32_bf16 v[20:23], a[12:15], v[180:183], v[20:23]
    ds_read_b64_tr_b16 a[38:39], v84 offset:3072
    v_cvt_pk_bf16_f32 v241, v194, v195
    v_mfma_f32_16x16x32_bf16 v[24:27], a[0:3], v[136:139], v[232:235]
    v_exp_f32 v208, v208
    v_mfma_f32_16x16x32_bf16 v[24:27], a[4:7], v[152:155], v[24:27]
    ds_read_b64_tr_b16 a[40:41], v85 offset:0
    v_mfma_f32_16x16x32_bf16 v[24:27], a[8:11], v[168:171], v[24:27]
    v_exp_f32 v209, v209
    v_mfma_f32_16x16x32_bf16 v[24:27], a[12:15], v[184:187], v[24:27]
    ds_read_b64_tr_b16 a[42:43], v85 offset:1024
    v_cvt_pk_bf16_f32 v242, v208, v209
    v_mfma_f32_16x16x32_bf16 v[28:31], a[0:3], v[140:143], v[236:239]
    v_exp_f32 v210, v210
    v_mfma_f32_16x16x32_bf16 v[28:31], a[4:7], v[156:159], v[28:31]
    ds_read_b64_tr_b16 a[44:45], v85 offset:2048
    v_mfma_f32_16x16x32_bf16 v[28:31], a[8:11], v[172:175], v[28:31]
    s_waitcnt lgkmcnt(7)
    v_exp_f32 v211, v211
    v_mfma_f32_16x16x32_bf16 v[28:31], a[12:15], v[188:191], v[28:31]
    ds_read_b64_tr_b16 a[46:47], v85 offset:3072
    v_cvt_pk_bf16_f32 v243, v210, v211
    v_mfma_f32_16x16x32_bf16 v[32:35], a[16:19], v[128:131], v[224:227]
    v_exp_f32 v196, v196
    v_mfma_f32_16x16x32_bf16 v[32:35], a[20:23], v[144:147], v[32:35]
    ds_read_b64_tr_b16 a[48:49], v86 offset:0
    v_mfma_f32_16x16x32_bf16 v[32:35], a[24:27], v[160:163], v[32:35]
    v_exp_f32 v197, v197
    v_mfma_f32_16x16x32_bf16 v[32:35], a[28:31], v[176:179], v[32:35]
    ds_read_b64_tr_b16 a[50:51], v86 offset:1024
    v_cvt_pk_bf16_f32 v248, v196, v197
    v_mfma_f32_16x16x32_bf16 v[36:39], a[16:19], v[132:135], v[228:231]
    v_exp_f32 v198, v198
    v_mfma_f32_16x16x32_bf16 v[36:39], a[20:23], v[148:151], v[36:39]
    ds_read_b64_tr_b16 a[52:53], v86 offset:2048
    v_mfma_f32_16x16x32_bf16 v[36:39], a[24:27], v[164:167], v[36:39]
    v_exp_f32 v199, v199
    v_mfma_f32_16x16x32_bf16 v[36:39], a[28:31], v[180:183], v[36:39]
    ds_read_b64_tr_b16 a[54:55], v86 offset:3072
    v_cvt_pk_bf16_f32 v249, v198, v199
    v_mfma_f32_16x16x32_bf16 v[40:43], a[16:19], v[136:139], v[232:235]
    v_exp_f32 v212, v212
    v_mfma_f32_16x16x32_bf16 v[40:43], a[20:23], v[152:155], v[40:43]
    ds_read_b64_tr_b16 a[56:57], v87 offset:0
    v_mfma_f32_16x16x32_bf16 v[40:43], a[24:27], v[168:171], v[40:43]
    v_exp_f32 v213, v213
    v_mfma_f32_16x16x32_bf16 v[40:43], a[28:31], v[184:187], v[40:43]
    ds_read_b64_tr_b16 a[58:59], v87 offset:1024
    v_cvt_pk_bf16_f32 v250, v212, v213
    v_mfma_f32_16x16x32_bf16 v[44:47], a[16:19], v[140:143], v[236:239]
    v_exp_f32 v214, v214
    v_mfma_f32_16x16x32_bf16 v[44:47], a[20:23], v[156:159], v[44:47]
    ds_read_b64_tr_b16 a[60:61], v87 offset:2048
    v_mfma_f32_16x16x32_bf16 v[44:47], a[24:27], v[172:175], v[44:47]
    s_waitcnt lgkmcnt(11)
    v_exp_f32 v215, v215
    v_mfma_f32_16x16x32_bf16 v[44:47], a[28:31], v[188:191], v[44:47]
    ds_read_b64_tr_b16 a[62:63], v87 offset:3072
    v_cvt_pk_bf16_f32 v251, v214, v215
    v_mfma_f32_16x16x32_bf16 a[64:67], a[32:35], v[48:51], 0
    s_waitcnt vmcnt(8)
    v_exp_f32 v200, v200
    v_mfma_f32_16x16x32_bf16 a[64:67], a[36:39], v[52:55], a[64:67]
    s_barrier
    v_mfma_f32_16x16x32_bf16 a[96:99], a[32:35], v[56:59], 0
    v_exp_f32 v201, v201
    v_mfma_f32_16x16x32_bf16 a[96:99], a[36:39], v[60:63], a[96:99]
    ds_read_b128 a[0:3], v80 offset:32768
    v_cvt_pk_bf16_f32 v112, v200, v201
    v_mfma_f32_16x16x32_bf16 a[128:131], a[32:35], v[64:67], 0
    s_add_u32 m0, s29, 114688
    v_exp_f32 v202, v202
    v_mfma_f32_16x16x32_bf16 a[128:131], a[36:39], v[68:71], a[128:131]
    buffer_load_dwordx4 v11, s[8:11], s37 offen offset:0 lds
    v_mfma_f32_16x16x32_bf16 a[160:163], a[32:35], v[72:75], 0
    s_waitcnt lgkmcnt(9)
    v_exp_f32 v203, v203
    v_mfma_f32_16x16x32_bf16 a[160:163], a[36:39], v[76:79], a[160:163]
    ds_read_b128 a[4:7], v81 offset:32768
    v_cvt_pk_bf16_f32 v113, v202, v203
    v_mfma_f32_16x16x32_bf16 a[68:71], a[40:43], v[48:51], 0
    v_exp_f32 v216, v216
    v_mfma_f32_16x16x32_bf16 a[68:71], a[44:47], v[52:55], a[68:71]
    buffer_load_dwordx4 v11, s[8:11], s37 offen offset:1024 lds
    v_mfma_f32_16x16x32_bf16 a[100:103], a[40:43], v[56:59], 0
    v_exp_f32 v217, v217
    v_mfma_f32_16x16x32_bf16 a[100:103], a[44:47], v[60:63], a[100:103]
    ds_read_b128 a[8:11], v82 offset:32768
    v_cvt_pk_bf16_f32 v114, v216, v217
    v_mfma_f32_16x16x32_bf16 a[132:135], a[40:43], v[64:67], 0
    v_exp_f32 v218, v218
    v_mfma_f32_16x16x32_bf16 a[132:135], a[44:47], v[68:71], a[132:135]
    buffer_load_dwordx4 v11, s[8:11], s37 offen offset:2048 lds
    v_mfma_f32_16x16x32_bf16 a[164:167], a[40:43], v[72:75], 0
    s_waitcnt lgkmcnt(7)
    v_exp_f32 v219, v219
    v_mfma_f32_16x16x32_bf16 a[164:167], a[44:47], v[76:79], a[164:167]
    ds_read_b128 a[12:15], v83 offset:32768
    v_cvt_pk_bf16_f32 v115, v218, v219
    v_mfma_f32_16x16x32_bf16 a[72:75], a[48:51], v[48:51], 0
    v_exp_f32 v204, v204
    v_mfma_f32_16x16x32_bf16 a[72:75], a[52:55], v[52:55], a[72:75]
    buffer_load_dwordx4 v11, s[8:11], s37 offen offset:3072 lds
    v_mfma_f32_16x16x32_bf16 a[104:107], a[48:51], v[56:59], 0
    s_add_u32 s37, s37, 16384
    v_exp_f32 v205, v205
    v_mfma_f32_16x16x32_bf16 a[104:107], a[52:55], v[60:63], a[104:107]
    ds_read_b128 a[16:19], v80 offset:33792
    v_cvt_pk_bf16_f32 v120, v204, v205
    v_mfma_f32_16x16x32_bf16 a[136:139], a[48:51], v[64:67], 0
    v_exp_f32 v206, v206
    v_mfma_f32_16x16x32_bf16 a[136:139], a[52:55], v[68:71], a[136:139]
    v_mov_b32 v104, -1
    v_mov_b32 v105, -1
    v_mfma_f32_16x16x32_bf16 a[168:171], a[48:51], v[72:75], 0
    s_waitcnt lgkmcnt(5)
    v_exp_f32 v207, v207
    v_mfma_f32_16x16x32_bf16 a[168:171], a[52:55], v[76:79], a[168:171]
    ds_read_b128 a[20:23], v81 offset:33792
    v_cvt_pk_bf16_f32 v121, v206, v207
    v_mfma_f32_16x16x32_bf16 a[76:79], a[56:59], v[48:51], 0
    v_exp_f32 v220, v220
    v_mfma_f32_16x16x32_bf16 a[76:79], a[60:63], v[52:55], a[76:79]
    v_mov_b32 v106, -1
    v_mov_b32 v107, -1
    v_mfma_f32_16x16x32_bf16 a[108:111], a[56:59], v[56:59], 0
    v_exp_f32 v221, v221
    v_mfma_f32_16x16x32_bf16 a[108:111], a[60:63], v[60:63], a[108:111]
    ds_read_b128 a[24:27], v82 offset:33792
    v_cvt_pk_bf16_f32 v122, v220, v221
    v_mfma_f32_16x16x32_bf16 a[140:143], a[56:59], v[64:67], 0
    s_bitset0_b32 s37, 19
    v_exp_f32 v222, v222
    v_mfma_f32_16x16x32_bf16 a[140:143], a[60:63], v[68:71], a[140:143]
    v_mfma_f32_16x16x32_bf16 a[172:175], a[56:59], v[72:75], 0
    v_exp_f32 v223, v223
    v_mfma_f32_16x16x32_bf16 a[172:175], a[60:63], v[76:79], a[172:175]
    ds_read_b128 a[28:31], v83 offset:33792
    v_cvt_pk_bf16_f32 v123, v222, v223
    v_smfmac_f32_16x16x64_bf16 a[192:195], v[92:95], v[48:55], v15
    v_smfmac_f32_16x16x64_bf16 a[196:199], v[92:95], v[56:63], v15
    s_waitcnt lgkmcnt(4)
    v_mfma_f32_16x16x32_bf16 v[192:195], a[0:3], v[128:131], v[224:227]
    v_exp_f32 v16, v16
    v_mfma_f32_16x16x32_bf16 v[192:195], a[4:7], v[144:147], v[192:195]
    ds_read_b64_tr_b16 a[32:33], v88 offset:0
    v_mfma_f32_16x16x32_bf16 v[192:195], a[8:11], v[160:163], v[192:195]
    v_exp_f32 v17, v17
    v_mfma_f32_16x16x32_bf16 v[192:195], a[12:15], v[176:179], v[192:195]
    ds_read_b64_tr_b16 a[34:35], v88 offset:1024
    v_cvt_pk_bf16_f32 v244, v16, v17
    v_mfma_f32_16x16x32_bf16 v[196:199], a[0:3], v[132:135], v[228:231]
    v_exp_f32 v18, v18
    v_mfma_f32_16x16x32_bf16 v[196:199], a[4:7], v[148:151], v[196:199]
    ds_read_b64_tr_b16 a[36:37], v88 offset:2048
    v_mfma_f32_16x16x32_bf16 v[196:199], a[8:11], v[164:167], v[196:199]
    v_exp_f32 v19, v19
    v_mfma_f32_16x16x32_bf16 v[196:199], a[12:15], v[180:183], v[196:199]
    ds_read_b64_tr_b16 a[38:39], v88 offset:3072
    v_cvt_pk_bf16_f32 v245, v18, v19
    v_mfma_f32_16x16x32_bf16 v[200:203], a[0:3], v[136:139], v[232:235]
    v_exp_f32 v32, v32
    v_mfma_f32_16x16x32_bf16 v[200:203], a[4:7], v[152:155], v[200:203]
    ds_read_b64_tr_b16 a[40:41], v89 offset:0
    v_mfma_f32_16x16x32_bf16 v[200:203], a[8:11], v[168:171], v[200:203]
    v_exp_f32 v33, v33
    v_mfma_f32_16x16x32_bf16 v[200:203], a[12:15], v[184:187], v[200:203]
    ds_read_b64_tr_b16 a[42:43], v89 offset:1024
    v_cvt_pk_bf16_f32 v246, v32, v33
    v_mfma_f32_16x16x32_bf16 v[204:207], a[0:3], v[140:143], v[236:239]
    v_exp_f32 v34, v34
    v_mfma_f32_16x16x32_bf16 v[204:207], a[4:7], v[156:159], v[204:207]
    ds_read_b64_tr_b16 a[44:45], v89 offset:2048
    v_mfma_f32_16x16x32_bf16 v[204:207], a[8:11], v[172:175], v[204:207]
    s_waitcnt lgkmcnt(7)
    v_exp_f32 v35, v35
    v_mfma_f32_16x16x32_bf16 v[204:207], a[12:15], v[188:191], v[204:207]
    ds_read_b64_tr_b16 a[46:47], v89 offset:3072
    v_cvt_pk_bf16_f32 v247, v34, v35
    v_mfma_f32_16x16x32_bf16 v[208:211], a[16:19], v[128:131], v[224:227]
    v_exp_f32 v20, v20
    v_mfma_f32_16x16x32_bf16 v[208:211], a[20:23], v[144:147], v[208:211]
    ds_read_b64_tr_b16 a[48:49], v90 offset:0
    v_mfma_f32_16x16x32_bf16 v[208:211], a[24:27], v[160:163], v[208:211]
    v_exp_f32 v21, v21
    v_mfma_f32_16x16x32_bf16 v[208:211], a[28:31], v[176:179], v[208:211]
    ds_read_b64_tr_b16 a[50:51], v90 offset:1024
    v_cvt_pk_bf16_f32 v252, v20, v21
    v_mfma_f32_16x16x32_bf16 v[212:215], a[16:19], v[132:135], v[228:231]
    v_exp_f32 v22, v22
    v_mfma_f32_16x16x32_bf16 v[212:215], a[20:23], v[148:151], v[212:215]
    ds_read_b64_tr_b16 a[52:53], v90 offset:2048
    v_mfma_f32_16x16x32_bf16 v[212:215], a[24:27], v[164:167], v[212:215]
    v_exp_f32 v23, v23
    v_mfma_f32_16x16x32_bf16 v[212:215], a[28:31], v[180:183], v[212:215]
    ds_read_b64_tr_b16 a[54:55], v90 offset:3072
    v_cvt_pk_bf16_f32 v253, v22, v23
    v_mfma_f32_16x16x32_bf16 v[216:219], a[16:19], v[136:139], v[232:235]
    v_exp_f32 v36, v36
    v_mfma_f32_16x16x32_bf16 v[216:219], a[20:23], v[152:155], v[216:219]
    ds_read_b64_tr_b16 a[56:57], v91 offset:0
    v_mfma_f32_16x16x32_bf16 v[216:219], a[24:27], v[168:171], v[216:219]
    v_exp_f32 v37, v37
    v_mfma_f32_16x16x32_bf16 v[216:219], a[28:31], v[184:187], v[216:219]
    ds_read_b64_tr_b16 a[58:59], v91 offset:1024
    v_cvt_pk_bf16_f32 v254, v36, v37
    v_mfma_f32_16x16x32_bf16 v[220:223], a[16:19], v[140:143], v[236:239]
    v_exp_f32 v38, v38
    v_mfma_f32_16x16x32_bf16 v[220:223], a[20:23], v[156:159], v[220:223]
    ds_read_b64_tr_b16 a[60:61], v91 offset:2048
    v_mfma_f32_16x16x32_bf16 v[220:223], a[24:27], v[172:175], v[220:223]
    s_waitcnt lgkmcnt(11)
    v_exp_f32 v39, v39
    v_mfma_f32_16x16x32_bf16 v[220:223], a[28:31], v[188:191], v[220:223]
    ds_read_b64_tr_b16 a[62:63], v91 offset:3072
    v_cvt_pk_bf16_f32 v255, v38, v39
    v_mfma_f32_16x16x32_bf16 a[80:83], a[32:35], v[48:51], 0
    v_exp_f32 v24, v24
    v_mfma_f32_16x16x32_bf16 a[80:83], a[36:39], v[52:55], a[80:83]
    v_mfma_f32_16x16x32_bf16 a[112:115], a[32:35], v[56:59], 0
    v_exp_f32 v25, v25
    v_mfma_f32_16x16x32_bf16 a[112:115], a[36:39], v[60:63], a[112:115]
    ds_read_b128 a[0:3], v80 offset:34816
    v_cvt_pk_bf16_f32 v116, v24, v25
    v_mfma_f32_16x16x32_bf16 a[144:147], a[32:35], v[64:67], 0
    s_add_u32 m0, s29, 16384
    v_exp_f32 v26, v26
    v_mfma_f32_16x16x32_bf16 a[144:147], a[36:39], v[68:71], a[144:147]
    buffer_load_dwordx4 v10, s[4:7], s28 offen offset:0 lds
    v_mfma_f32_16x16x32_bf16 a[176:179], a[32:35], v[72:75], 0
    s_waitcnt lgkmcnt(9)
    v_exp_f32 v27, v27
    v_mfma_f32_16x16x32_bf16 a[176:179], a[36:39], v[76:79], a[176:179]
    ds_read_b128 a[4:7], v81 offset:34816
    v_cvt_pk_bf16_f32 v117, v26, v27
    v_mfma_f32_16x16x32_bf16 a[84:87], a[40:43], v[48:51], 0
    v_exp_f32 v40, v40
    v_mfma_f32_16x16x32_bf16 a[84:87], a[44:47], v[52:55], a[84:87]
    buffer_load_dwordx4 v10, s[4:7], s28 offen offset:1024 lds
    v_mfma_f32_16x16x32_bf16 a[116:119], a[40:43], v[56:59], 0
    v_exp_f32 v41, v41
    v_mfma_f32_16x16x32_bf16 a[116:119], a[44:47], v[60:63], a[116:119]
    ds_read_b128 a[8:11], v82 offset:34816
    v_cvt_pk_bf16_f32 v118, v40, v41
    v_mfma_f32_16x16x32_bf16 a[148:151], a[40:43], v[64:67], 0
    v_exp_f32 v42, v42
    v_mfma_f32_16x16x32_bf16 a[148:151], a[44:47], v[68:71], a[148:151]
    buffer_load_dwordx4 v10, s[4:7], s28 offen offset:2048 lds
    v_mfma_f32_16x16x32_bf16 a[180:183], a[40:43], v[72:75], 0
    s_waitcnt lgkmcnt(7)
    v_exp_f32 v43, v43
    v_mfma_f32_16x16x32_bf16 a[180:183], a[44:47], v[76:79], a[180:183]
    ds_read_b128 a[12:15], v83 offset:34816
    v_cvt_pk_bf16_f32 v119, v42, v43
    v_mfma_f32_16x16x32_bf16 a[88:91], a[48:51], v[48:51], 0
    v_exp_f32 v28, v28
    v_mfma_f32_16x16x32_bf16 a[88:91], a[52:55], v[52:55], a[88:91]
    buffer_load_dwordx4 v10, s[4:7], s28 offen offset:3072 lds
    v_mfma_f32_16x16x32_bf16 a[120:123], a[48:51], v[56:59], 0
    s_add_u32 s28, s28, 16384
    v_exp_f32 v29, v29
    v_mfma_f32_16x16x32_bf16 a[120:123], a[52:55], v[60:63], a[120:123]
    ds_read_b128 a[16:19], v80 offset:35840
    v_cvt_pk_bf16_f32 v124, v28, v29
    v_mfma_f32_16x16x32_bf16 a[152:155], a[48:51], v[64:67], 0
    v_exp_f32 v30, v30
    v_mfma_f32_16x16x32_bf16 a[152:155], a[52:55], v[68:71], a[152:155]
    buffer_store_dwordx4 v[104:107], v12, s[48:51], 0 offen offset:0 sc1
    v_mfma_f32_16x16x32_bf16 a[184:187], a[48:51], v[72:75], 0
    s_waitcnt lgkmcnt(5)
    v_exp_f32 v31, v31
    v_mfma_f32_16x16x32_bf16 a[184:187], a[52:55], v[76:79], a[184:187]
    ds_read_b128 a[20:23], v81 offset:35840
    v_cvt_pk_bf16_f32 v125, v30, v31
    v_mfma_f32_16x16x32_bf16 a[92:95], a[56:59], v[48:51], 0
    v_exp_f32 v44, v44
    v_mfma_f32_16x16x32_bf16 a[92:95], a[60:63], v[52:55], a[92:95]
    v_mfma_f32_16x16x32_bf16 a[124:127], a[56:59], v[56:59], 0
    v_exp_f32 v45, v45
    v_mfma_f32_16x16x32_bf16 a[124:127], a[60:63], v[60:63], a[124:127]
    ds_read_b128 a[24:27], v82 offset:35840
    v_cvt_pk_bf16_f32 v126, v44, v45
    v_mfma_f32_16x16x32_bf16 a[156:159], a[56:59], v[64:67], 0
    s_bitset0_b32 s28, 19
    v_exp_f32 v46, v46
    v_mfma_f32_16x16x32_bf16 a[156:159], a[60:63], v[68:71], a[156:159]
    buffer_store_dwordx4 v[104:107], v12, s[48:51], 0 offen offset:1024 sc1
    v_mfma_f32_16x16x32_bf16 a[188:191], a[56:59], v[72:75], 0
    v_exp_f32 v47, v47
    v_mfma_f32_16x16x32_bf16 a[188:191], a[60:63], v[76:79], a[188:191]
    ds_read_b128 a[28:31], v83 offset:35840
    v_cvt_pk_bf16_f32 v127, v46, v47
    v_smfmac_f32_16x16x64_bf16 a[200:203], v[92:95], v[64:71], v15
    v_smfmac_f32_16x16x64_bf16 a[204:207], v[92:95], v[72:79], v15
    s_waitcnt lgkmcnt(4)
    s_mov_b32 s27, 7
.p2align 6
L_attn:
    v_mfma_f32_16x16x32_bf16 v[16:19], a[0:3], v[128:131], v[224:227]
    v_exp_f32 v192, v192
    v_mfma_f32_16x16x32_bf16 v[16:19], a[4:7], v[144:147], v[16:19]
    ds_read_b64_tr_b16 a[32:33], v84 offset:16384
    v_mfma_f32_16x16x32_bf16 v[16:19], a[8:11], v[160:163], v[16:19]
    v_exp_f32 v193, v193
    v_mfma_f32_16x16x32_bf16 v[16:19], a[12:15], v[176:179], v[16:19]
    ds_read_b64_tr_b16 a[34:35], v84 offset:17408
    v_cvt_pk_bf16_f32 v48, v192, v193
    v_mfma_f32_16x16x32_bf16 v[20:23], a[0:3], v[132:135], v[228:231]
    v_exp_f32 v194, v194
    v_mfma_f32_16x16x32_bf16 v[20:23], a[4:7], v[148:151], v[20:23]
    ds_read_b64_tr_b16 a[36:37], v84 offset:18432
    v_mfma_f32_16x16x32_bf16 v[20:23], a[8:11], v[164:167], v[20:23]
    v_exp_f32 v195, v195
    v_mfma_f32_16x16x32_bf16 v[20:23], a[12:15], v[180:183], v[20:23]
    ds_read_b64_tr_b16 a[38:39], v84 offset:19456
    v_cvt_pk_bf16_f32 v49, v194, v195
    v_mfma_f32_16x16x32_bf16 v[24:27], a[0:3], v[136:139], v[232:235]
    v_exp_f32 v208, v208
    v_mfma_f32_16x16x32_bf16 v[24:27], a[4:7], v[152:155], v[24:27]
    ds_read_b64_tr_b16 a[40:41], v85 offset:16384
    v_mfma_f32_16x16x32_bf16 v[24:27], a[8:11], v[168:171], v[24:27]
    v_exp_f32 v209, v209
    v_mfma_f32_16x16x32_bf16 v[24:27], a[12:15], v[184:187], v[24:27]
    ds_read_b64_tr_b16 a[42:43], v85 offset:17408
    v_cvt_pk_bf16_f32 v50, v208, v209
    v_mfma_f32_16x16x32_bf16 v[28:31], a[0:3], v[140:143], v[236:239]
    v_exp_f32 v210, v210
    v_mfma_f32_16x16x32_bf16 v[28:31], a[4:7], v[156:159], v[28:31]
    ds_read_b64_tr_b16 a[44:45], v85 offset:18432
    v_mfma_f32_16x16x32_bf16 v[28:31], a[8:11], v[172:175], v[28:31]
    s_waitcnt lgkmcnt(7)
    v_exp_f32 v211, v211
    v_mfma_f32_16x16x32_bf16 v[28:31], a[12:15], v[188:191], v[28:31]
    ds_read_b64_tr_b16 a[46:47], v85 offset:19456
    v_cvt_pk_bf16_f32 v51, v210, v211
    v_mfma_f32_16x16x32_bf16 v[32:35], a[16:19], v[128:131], v[224:227]
    v_exp_f32 v196, v196
    v_mfma_f32_16x16x32_bf16 v[32:35], a[20:23], v[144:147], v[32:35]
    ds_read_b64_tr_b16 a[48:49], v86 offset:16384
    v_mfma_f32_16x16x32_bf16 v[32:35], a[24:27], v[160:163], v[32:35]
    v_exp_f32 v197, v197
    v_mfma_f32_16x16x32_bf16 v[32:35], a[28:31], v[176:179], v[32:35]
    ds_read_b64_tr_b16 a[50:51], v86 offset:17408
    v_cvt_pk_bf16_f32 v56, v196, v197
    v_mfma_f32_16x16x32_bf16 v[36:39], a[16:19], v[132:135], v[228:231]
    v_exp_f32 v198, v198
    v_mfma_f32_16x16x32_bf16 v[36:39], a[20:23], v[148:151], v[36:39]
    ds_read_b64_tr_b16 a[52:53], v86 offset:18432
    v_mfma_f32_16x16x32_bf16 v[36:39], a[24:27], v[164:167], v[36:39]
    v_exp_f32 v199, v199
    v_mfma_f32_16x16x32_bf16 v[36:39], a[28:31], v[180:183], v[36:39]
    ds_read_b64_tr_b16 a[54:55], v86 offset:19456
    v_cvt_pk_bf16_f32 v57, v198, v199
    v_mfma_f32_16x16x32_bf16 v[40:43], a[16:19], v[136:139], v[232:235]
    v_exp_f32 v212, v212
    v_mfma_f32_16x16x32_bf16 v[40:43], a[20:23], v[152:155], v[40:43]
    ds_read_b64_tr_b16 a[56:57], v87 offset:16384
    v_mfma_f32_16x16x32_bf16 v[40:43], a[24:27], v[168:171], v[40:43]
    v_exp_f32 v213, v213
    v_mfma_f32_16x16x32_bf16 v[40:43], a[28:31], v[184:187], v[40:43]
    ds_read_b64_tr_b16 a[58:59], v87 offset:17408
    v_cvt_pk_bf16_f32 v58, v212, v213
    v_mfma_f32_16x16x32_bf16 v[44:47], a[16:19], v[140:143], v[236:239]
    v_exp_f32 v214, v214
    v_mfma_f32_16x16x32_bf16 v[44:47], a[20:23], v[156:159], v[44:47]
    ds_read_b64_tr_b16 a[60:61], v87 offset:18432
    v_mfma_f32_16x16x32_bf16 v[44:47], a[24:27], v[172:175], v[44:47]
    s_waitcnt lgkmcnt(11)
    v_exp_f32 v215, v215
    v_mfma_f32_16x16x32_bf16 v[44:47], a[28:31], v[188:191], v[44:47]
    ds_read_b64_tr_b16 a[62:63], v87 offset:19456
    v_cvt_pk_bf16_f32 v59, v214, v215
    v_mfma_f32_16x16x32_bf16 a[64:67], a[32:35], v[240:243], a[64:67]
    s_waitcnt vmcnt(14)
    v_exp_f32 v200, v200
    v_mfma_f32_16x16x32_bf16 a[64:67], a[36:39], v[244:247], a[64:67]
    s_barrier
    v_mfma_f32_16x16x32_bf16 a[96:99], a[32:35], v[248:251], a[96:99]
    v_exp_f32 v201, v201
    v_mfma_f32_16x16x32_bf16 a[96:99], a[36:39], v[252:255], a[96:99]
    ds_read_b128 a[0:3], v80 offset:49152
    v_cvt_pk_bf16_f32 v64, v200, v201
    v_mfma_f32_16x16x32_bf16 a[128:131], a[32:35], v[112:115], a[128:131]
    s_add_u32 m0, s29, 65536
    v_exp_f32 v202, v202
    v_mfma_f32_16x16x32_bf16 a[128:131], a[36:39], v[116:119], a[128:131]
    buffer_load_dwordx4 v11, s[8:11], s37 offen offset:0 lds
    v_mfma_f32_16x16x32_bf16 a[160:163], a[32:35], v[120:123], a[160:163]
    s_waitcnt lgkmcnt(9)
    v_exp_f32 v203, v203
    v_mfma_f32_16x16x32_bf16 a[160:163], a[36:39], v[124:127], a[160:163]
    ds_read_b128 a[4:7], v81 offset:49152
    v_cvt_pk_bf16_f32 v65, v202, v203
    v_mfma_f32_16x16x32_bf16 a[68:71], a[40:43], v[240:243], a[68:71]
    v_exp_f32 v216, v216
    v_mfma_f32_16x16x32_bf16 a[68:71], a[44:47], v[244:247], a[68:71]
    buffer_load_dwordx4 v11, s[8:11], s37 offen offset:1024 lds
    v_mfma_f32_16x16x32_bf16 a[100:103], a[40:43], v[248:251], a[100:103]
    v_exp_f32 v217, v217
    v_mfma_f32_16x16x32_bf16 a[100:103], a[44:47], v[252:255], a[100:103]
    ds_read_b128 a[8:11], v82 offset:49152
    v_cvt_pk_bf16_f32 v66, v216, v217
    v_mfma_f32_16x16x32_bf16 a[132:135], a[40:43], v[112:115], a[132:135]
    v_exp_f32 v218, v218
    v_mfma_f32_16x16x32_bf16 a[132:135], a[44:47], v[116:119], a[132:135]
    buffer_load_dwordx4 v11, s[8:11], s37 offen offset:2048 lds
    v_mfma_f32_16x16x32_bf16 a[164:167], a[40:43], v[120:123], a[164:167]
    s_waitcnt lgkmcnt(7)
    v_exp_f32 v219, v219
    v_mfma_f32_16x16x32_bf16 a[164:167], a[44:47], v[124:127], a[164:167]
    ds_read_b128 a[12:15], v83 offset:49152
    v_cvt_pk_bf16_f32 v67, v218, v219
    v_mfma_f32_16x16x32_bf16 a[72:75], a[48:51], v[240:243], a[72:75]
    v_exp_f32 v204, v204
    v_mfma_f32_16x16x32_bf16 a[72:75], a[52:55], v[244:247], a[72:75]
    buffer_load_dwordx4 v11, s[8:11], s37 offen offset:3072 lds
    v_mfma_f32_16x16x32_bf16 a[104:107], a[48:51], v[248:251], a[104:107]
    s_add_u32 s37, s37, 16384
    v_exp_f32 v205, v205
    v_mfma_f32_16x16x32_bf16 a[104:107], a[52:55], v[252:255], a[104:107]
    ds_read_b128 a[16:19], v80 offset:50176
    v_cvt_pk_bf16_f32 v72, v204, v205
    v_mfma_f32_16x16x32_bf16 a[136:139], a[48:51], v[112:115], a[136:139]
    s_mov_b32 m0, s43
    v_exp_f32 v206, v206
    v_mfma_f32_16x16x32_bf16 a[136:139], a[52:55], v[116:119], a[136:139]
    buffer_load_dwordx4 v13, s[52:55], s60 offen offset:0 lds
    v_mfma_f32_16x16x32_bf16 a[168:171], a[48:51], v[120:123], a[168:171]
    s_waitcnt lgkmcnt(5)
    v_exp_f32 v207, v207
    v_mfma_f32_16x16x32_bf16 a[168:171], a[52:55], v[124:127], a[168:171]
    ds_read_b128 a[20:23], v81 offset:50176
    v_cvt_pk_bf16_f32 v73, v206, v207
    v_mfma_f32_16x16x32_bf16 a[76:79], a[56:59], v[240:243], a[76:79]
    s_add_u32 s63, s60, 17408
    v_exp_f32 v220, v220
    v_mfma_f32_16x16x32_bf16 a[76:79], a[60:63], v[244:247], a[76:79]
    buffer_load_dwordx4 v13, s[52:55], s63 offen offset:1024 lds
    v_mfma_f32_16x16x32_bf16 a[108:111], a[56:59], v[248:251], a[108:111]
    v_exp_f32 v221, v221
    v_mfma_f32_16x16x32_bf16 a[108:111], a[60:63], v[252:255], a[108:111]
    ds_read_b128 a[24:27], v82 offset:50176
    v_cvt_pk_bf16_f32 v74, v220, v221
    v_mfma_f32_16x16x32_bf16 a[140:143], a[56:59], v[112:115], a[140:143]
    s_bitset0_b32 s37, 19
    v_exp_f32 v222, v222
    v_mfma_f32_16x16x32_bf16 a[140:143], a[60:63], v[116:119], a[140:143]
    v_mfma_f32_16x16x32_bf16 a[172:175], a[56:59], v[120:123], a[172:175]
    v_exp_f32 v223, v223
    v_mfma_f32_16x16x32_bf16 a[172:175], a[60:63], v[124:127], a[172:175]
    ds_read_b128 a[28:31], v83 offset:50176
    v_cvt_pk_bf16_f32 v75, v222, v223
    v_smfmac_f32_16x16x64_bf16 a[192:195], v[92:95], v[240:247], v15
    v_smfmac_f32_16x16x64_bf16 a[196:199], v[92:95], v[248:255], v15
    s_waitcnt lgkmcnt(4)
    v_mfma_f32_16x16x32_bf16 v[192:195], a[0:3], v[128:131], v[224:227]
    v_exp_f32 v16, v16
    v_mfma_f32_16x16x32_bf16 v[192:195], a[4:7], v[144:147], v[192:195]
    ds_read_b64_tr_b16 a[32:33], v88 offset:16384
    v_mfma_f32_16x16x32_bf16 v[192:195], a[8:11], v[160:163], v[192:195]
    v_exp_f32 v17, v17
    v_mfma_f32_16x16x32_bf16 v[192:195], a[12:15], v[176:179], v[192:195]
    ds_read_b64_tr_b16 a[34:35], v88 offset:17408
    v_cvt_pk_bf16_f32 v52, v16, v17
    v_mfma_f32_16x16x32_bf16 v[196:199], a[0:3], v[132:135], v[228:231]
    v_exp_f32 v18, v18
    v_mfma_f32_16x16x32_bf16 v[196:199], a[4:7], v[148:151], v[196:199]
    ds_read_b64_tr_b16 a[36:37], v88 offset:18432
    v_mfma_f32_16x16x32_bf16 v[196:199], a[8:11], v[164:167], v[196:199]
    v_exp_f32 v19, v19
    v_mfma_f32_16x16x32_bf16 v[196:199], a[12:15], v[180:183], v[196:199]
    ds_read_b64_tr_b16 a[38:39], v88 offset:19456
    v_cvt_pk_bf16_f32 v53, v18, v19
    v_mfma_f32_16x16x32_bf16 v[200:203], a[0:3], v[136:139], v[232:235]
    v_exp_f32 v32, v32
    v_mfma_f32_16x16x32_bf16 v[200:203], a[4:7], v[152:155], v[200:203]
    ds_read_b64_tr_b16 a[40:41], v89 offset:16384
    v_mfma_f32_16x16x32_bf16 v[200:203], a[8:11], v[168:171], v[200:203]
    v_exp_f32 v33, v33
    v_mfma_f32_16x16x32_bf16 v[200:203], a[12:15], v[184:187], v[200:203]
    ds_read_b64_tr_b16 a[42:43], v89 offset:17408
    v_cvt_pk_bf16_f32 v54, v32, v33
    v_mfma_f32_16x16x32_bf16 v[204:207], a[0:3], v[140:143], v[236:239]
    v_exp_f32 v34, v34
    v_mfma_f32_16x16x32_bf16 v[204:207], a[4:7], v[156:159], v[204:207]
    ds_read_b64_tr_b16 a[44:45], v89 offset:18432
    v_mfma_f32_16x16x32_bf16 v[204:207], a[8:11], v[172:175], v[204:207]
    s_waitcnt lgkmcnt(7)
    v_exp_f32 v35, v35
    v_mfma_f32_16x16x32_bf16 v[204:207], a[12:15], v[188:191], v[204:207]
    ds_read_b64_tr_b16 a[46:47], v89 offset:19456
    v_cvt_pk_bf16_f32 v55, v34, v35
    v_mfma_f32_16x16x32_bf16 v[208:211], a[16:19], v[128:131], v[224:227]
    v_exp_f32 v20, v20
    v_mfma_f32_16x16x32_bf16 v[208:211], a[20:23], v[144:147], v[208:211]
    ds_read_b64_tr_b16 a[48:49], v90 offset:16384
    v_mfma_f32_16x16x32_bf16 v[208:211], a[24:27], v[160:163], v[208:211]
    v_exp_f32 v21, v21
    v_mfma_f32_16x16x32_bf16 v[208:211], a[28:31], v[176:179], v[208:211]
    ds_read_b64_tr_b16 a[50:51], v90 offset:17408
    v_cvt_pk_bf16_f32 v60, v20, v21
    v_mfma_f32_16x16x32_bf16 v[212:215], a[16:19], v[132:135], v[228:231]
    v_exp_f32 v22, v22
    v_mfma_f32_16x16x32_bf16 v[212:215], a[20:23], v[148:151], v[212:215]
    ds_read_b64_tr_b16 a[52:53], v90 offset:18432
    v_mfma_f32_16x16x32_bf16 v[212:215], a[24:27], v[164:167], v[212:215]
    v_exp_f32 v23, v23
    v_mfma_f32_16x16x32_bf16 v[212:215], a[28:31], v[180:183], v[212:215]
    ds_read_b64_tr_b16 a[54:55], v90 offset:19456
    v_cvt_pk_bf16_f32 v61, v22, v23
    v_mfma_f32_16x16x32_bf16 v[216:219], a[16:19], v[136:139], v[232:235]
    v_exp_f32 v36, v36
    v_mfma_f32_16x16x32_bf16 v[216:219], a[20:23], v[152:155], v[216:219]
    ds_read_b64_tr_b16 a[56:57], v91 offset:16384
    v_mfma_f32_16x16x32_bf16 v[216:219], a[24:27], v[168:171], v[216:219]
    v_exp_f32 v37, v37
    v_mfma_f32_16x16x32_bf16 v[216:219], a[28:31], v[184:187], v[216:219]
    ds_read_b64_tr_b16 a[58:59], v91 offset:17408
    v_cvt_pk_bf16_f32 v62, v36, v37
    v_mfma_f32_16x16x32_bf16 v[220:223], a[16:19], v[140:143], v[236:239]
    v_exp_f32 v38, v38
    v_mfma_f32_16x16x32_bf16 v[220:223], a[20:23], v[156:159], v[220:223]
    ds_read_b64_tr_b16 a[60:61], v91 offset:18432
    v_mfma_f32_16x16x32_bf16 v[220:223], a[24:27], v[172:175], v[220:223]
    s_waitcnt lgkmcnt(11)
    v_exp_f32 v39, v39
    v_mfma_f32_16x16x32_bf16 v[220:223], a[28:31], v[188:191], v[220:223]
    ds_read_b64_tr_b16 a[62:63], v91 offset:19456
    v_cvt_pk_bf16_f32 v63, v38, v39
    v_mfma_f32_16x16x32_bf16 a[80:83], a[32:35], v[240:243], a[80:83]
    v_exp_f32 v24, v24
    v_mfma_f32_16x16x32_bf16 a[80:83], a[36:39], v[244:247], a[80:83]
    v_mfma_f32_16x16x32_bf16 a[112:115], a[32:35], v[248:251], a[112:115]
    v_exp_f32 v25, v25
    v_mfma_f32_16x16x32_bf16 a[112:115], a[36:39], v[252:255], a[112:115]
    ds_read_b128 a[0:3], v80 offset:51200
    v_cvt_pk_bf16_f32 v68, v24, v25
    v_mfma_f32_16x16x32_bf16 a[144:147], a[32:35], v[112:115], a[144:147]
    s_add_u32 m0, s29, 32768
    v_exp_f32 v26, v26
    v_mfma_f32_16x16x32_bf16 a[144:147], a[36:39], v[116:119], a[144:147]
    buffer_load_dwordx4 v10, s[4:7], s28 offen offset:0 lds
    v_mfma_f32_16x16x32_bf16 a[176:179], a[32:35], v[120:123], a[176:179]
    s_waitcnt lgkmcnt(9)
    v_exp_f32 v27, v27
    v_mfma_f32_16x16x32_bf16 a[176:179], a[36:39], v[124:127], a[176:179]
    ds_read_b128 a[4:7], v81 offset:51200
    v_cvt_pk_bf16_f32 v69, v26, v27
    v_mfma_f32_16x16x32_bf16 a[84:87], a[40:43], v[240:243], a[84:87]
    v_exp_f32 v40, v40
    v_mfma_f32_16x16x32_bf16 a[84:87], a[44:47], v[244:247], a[84:87]
    buffer_load_dwordx4 v10, s[4:7], s28 offen offset:1024 lds
    v_mfma_f32_16x16x32_bf16 a[116:119], a[40:43], v[248:251], a[116:119]
    v_exp_f32 v41, v41
    v_mfma_f32_16x16x32_bf16 a[116:119], a[44:47], v[252:255], a[116:119]
    ds_read_b128 a[8:11], v82 offset:51200
    v_cvt_pk_bf16_f32 v70, v40, v41
    v_mfma_f32_16x16x32_bf16 a[148:151], a[40:43], v[112:115], a[148:151]
    v_exp_f32 v42, v42
    v_mfma_f32_16x16x32_bf16 a[148:151], a[44:47], v[116:119], a[148:151]
    buffer_load_dwordx4 v10, s[4:7], s28 offen offset:2048 lds
    v_mfma_f32_16x16x32_bf16 a[180:183], a[40:43], v[120:123], a[180:183]
    s_waitcnt lgkmcnt(7)
    v_exp_f32 v43, v43
    v_mfma_f32_16x16x32_bf16 a[180:183], a[44:47], v[124:127], a[180:183]
    ds_read_b128 a[12:15], v83 offset:51200
    v_cvt_pk_bf16_f32 v71, v42, v43
    v_mfma_f32_16x16x32_bf16 a[88:91], a[48:51], v[240:243], a[88:91]
    v_exp_f32 v28, v28
    v_mfma_f32_16x16x32_bf16 a[88:91], a[52:55], v[244:247], a[88:91]
    buffer_load_dwordx4 v10, s[4:7], s28 offen offset:3072 lds
    v_mfma_f32_16x16x32_bf16 a[120:123], a[48:51], v[248:251], a[120:123]
    s_add_u32 s28, s28, 16384
    v_exp_f32 v29, v29
    v_mfma_f32_16x16x32_bf16 a[120:123], a[52:55], v[252:255], a[120:123]
    ds_read_b128 a[16:19], v80 offset:52224
    v_cvt_pk_bf16_f32 v76, v28, v29
    v_mfma_f32_16x16x32_bf16 a[152:155], a[48:51], v[112:115], a[152:155]
    v_exp_f32 v30, v30
    v_mfma_f32_16x16x32_bf16 a[152:155], a[52:55], v[116:119], a[152:155]
    v_mfma_f32_16x16x32_bf16 a[184:187], a[48:51], v[120:123], a[184:187]
    s_waitcnt lgkmcnt(5)
    v_exp_f32 v31, v31
    v_mfma_f32_16x16x32_bf16 a[184:187], a[52:55], v[124:127], a[184:187]
    ds_read_b128 a[20:23], v81 offset:52224
    v_cvt_pk_bf16_f32 v77, v30, v31
    v_mfma_f32_16x16x32_bf16 a[92:95], a[56:59], v[240:243], a[92:95]
    v_exp_f32 v44, v44
    v_mfma_f32_16x16x32_bf16 a[92:95], a[60:63], v[244:247], a[92:95]
    v_mfma_f32_16x16x32_bf16 a[124:127], a[56:59], v[248:251], a[124:127]
    v_exp_f32 v45, v45
    v_mfma_f32_16x16x32_bf16 a[124:127], a[60:63], v[252:255], a[124:127]
    ds_read_b128 a[24:27], v82 offset:52224
    v_cvt_pk_bf16_f32 v78, v44, v45
    v_mfma_f32_16x16x32_bf16 a[156:159], a[56:59], v[112:115], a[156:159]
    s_bitset0_b32 s28, 19
    v_exp_f32 v46, v46
    v_mfma_f32_16x16x32_bf16 a[156:159], a[60:63], v[116:119], a[156:159]
    v_mfma_f32_16x16x32_bf16 a[188:191], a[56:59], v[120:123], a[188:191]
    v_exp_f32 v47, v47
    v_mfma_f32_16x16x32_bf16 a[188:191], a[60:63], v[124:127], a[188:191]
    ds_read_b128 a[28:31], v83 offset:52224
    v_cvt_pk_bf16_f32 v79, v46, v47
    v_smfmac_f32_16x16x64_bf16 a[200:203], v[92:95], v[112:119], v15
    v_smfmac_f32_16x16x64_bf16 a[204:207], v[92:95], v[120:127], v15
    s_waitcnt lgkmcnt(4)
    s_cmp_eq_u32 s27, 0
    s_cbranch_scc1 L_attn_tail
    v_mfma_f32_16x16x32_bf16 v[16:19], a[0:3], v[128:131], v[224:227]
    v_exp_f32 v192, v192
    v_mfma_f32_16x16x32_bf16 v[16:19], a[4:7], v[144:147], v[16:19]
    ds_read_b64_tr_b16 a[32:33], v84 offset:32768
    v_mfma_f32_16x16x32_bf16 v[16:19], a[8:11], v[160:163], v[16:19]
    v_exp_f32 v193, v193
    v_mfma_f32_16x16x32_bf16 v[16:19], a[12:15], v[176:179], v[16:19]
    ds_read_b64_tr_b16 a[34:35], v84 offset:33792
    v_cvt_pk_bf16_f32 v240, v192, v193
    v_mfma_f32_16x16x32_bf16 v[20:23], a[0:3], v[132:135], v[228:231]
    v_exp_f32 v194, v194
    v_mfma_f32_16x16x32_bf16 v[20:23], a[4:7], v[148:151], v[20:23]
    ds_read_b64_tr_b16 a[36:37], v84 offset:34816
    v_mfma_f32_16x16x32_bf16 v[20:23], a[8:11], v[164:167], v[20:23]
    v_exp_f32 v195, v195
    v_mfma_f32_16x16x32_bf16 v[20:23], a[12:15], v[180:183], v[20:23]
    ds_read_b64_tr_b16 a[38:39], v84 offset:35840
    v_cvt_pk_bf16_f32 v241, v194, v195
    v_mfma_f32_16x16x32_bf16 v[24:27], a[0:3], v[136:139], v[232:235]
    v_exp_f32 v208, v208
    v_mfma_f32_16x16x32_bf16 v[24:27], a[4:7], v[152:155], v[24:27]
    ds_read_b64_tr_b16 a[40:41], v85 offset:32768
    v_mfma_f32_16x16x32_bf16 v[24:27], a[8:11], v[168:171], v[24:27]
    v_exp_f32 v209, v209
    v_mfma_f32_16x16x32_bf16 v[24:27], a[12:15], v[184:187], v[24:27]
    ds_read_b64_tr_b16 a[42:43], v85 offset:33792
    v_cvt_pk_bf16_f32 v242, v208, v209
    v_mfma_f32_16x16x32_bf16 v[28:31], a[0:3], v[140:143], v[236:239]
    v_exp_f32 v210, v210
    v_mfma_f32_16x16x32_bf16 v[28:31], a[4:7], v[156:159], v[28:31]
    ds_read_b64_tr_b16 a[44:45], v85 offset:34816
    v_mfma_f32_16x16x32_bf16 v[28:31], a[8:11], v[172:175], v[28:31]
    s_waitcnt lgkmcnt(7)
    v_exp_f32 v211, v211
    v_mfma_f32_16x16x32_bf16 v[28:31], a[12:15], v[188:191], v[28:31]
    ds_read_b64_tr_b16 a[46:47], v85 offset:35840
    v_cvt_pk_bf16_f32 v243, v210, v211
    v_mfma_f32_16x16x32_bf16 v[32:35], a[16:19], v[128:131], v[224:227]
    v_exp_f32 v196, v196
    v_mfma_f32_16x16x32_bf16 v[32:35], a[20:23], v[144:147], v[32:35]
    ds_read_b64_tr_b16 a[48:49], v86 offset:32768
    v_mfma_f32_16x16x32_bf16 v[32:35], a[24:27], v[160:163], v[32:35]
    v_exp_f32 v197, v197
    v_mfma_f32_16x16x32_bf16 v[32:35], a[28:31], v[176:179], v[32:35]
    ds_read_b64_tr_b16 a[50:51], v86 offset:33792
    v_cvt_pk_bf16_f32 v248, v196, v197
    v_mfma_f32_16x16x32_bf16 v[36:39], a[16:19], v[132:135], v[228:231]
    v_exp_f32 v198, v198
    v_mfma_f32_16x16x32_bf16 v[36:39], a[20:23], v[148:151], v[36:39]
    ds_read_b64_tr_b16 a[52:53], v86 offset:34816
    v_mfma_f32_16x16x32_bf16 v[36:39], a[24:27], v[164:167], v[36:39]
    v_exp_f32 v199, v199
    v_mfma_f32_16x16x32_bf16 v[36:39], a[28:31], v[180:183], v[36:39]
    ds_read_b64_tr_b16 a[54:55], v86 offset:35840
    v_cvt_pk_bf16_f32 v249, v198, v199
    v_mfma_f32_16x16x32_bf16 v[40:43], a[16:19], v[136:139], v[232:235]
    v_exp_f32 v212, v212
    v_mfma_f32_16x16x32_bf16 v[40:43], a[20:23], v[152:155], v[40:43]
    ds_read_b64_tr_b16 a[56:57], v87 offset:32768
    v_mfma_f32_16x16x32_bf16 v[40:43], a[24:27], v[168:171], v[40:43]
    v_exp_f32 v213, v213
    v_mfma_f32_16x16x32_bf16 v[40:43], a[28:31], v[184:187], v[40:43]
    ds_read_b64_tr_b16 a[58:59], v87 offset:33792
    v_cvt_pk_bf16_f32 v250, v212, v213
    v_mfma_f32_16x16x32_bf16 v[44:47], a[16:19], v[140:143], v[236:239]
    v_exp_f32 v214, v214
    v_mfma_f32_16x16x32_bf16 v[44:47], a[20:23], v[156:159], v[44:47]
    ds_read_b64_tr_b16 a[60:61], v87 offset:34816
    v_mfma_f32_16x16x32_bf16 v[44:47], a[24:27], v[172:175], v[44:47]
    s_waitcnt lgkmcnt(11)
    v_exp_f32 v215, v215
    v_mfma_f32_16x16x32_bf16 v[44:47], a[28:31], v[188:191], v[44:47]
    ds_read_b64_tr_b16 a[62:63], v87 offset:35840
    v_cvt_pk_bf16_f32 v251, v214, v215
    v_mfma_f32_16x16x32_bf16 a[64:67], a[32:35], v[48:51], a[64:67]
    s_waitcnt vmcnt(14)
    v_exp_f32 v200, v200
    v_mfma_f32_16x16x32_bf16 a[64:67], a[36:39], v[52:55], a[64:67]
    s_barrier
    v_mfma_f32_16x16x32_bf16 a[96:99], a[32:35], v[56:59], a[96:99]
    v_exp_f32 v201, v201
    v_mfma_f32_16x16x32_bf16 a[96:99], a[36:39], v[60:63], a[96:99]
    ds_read_b128 a[0:3], v80 offset:0
    v_cvt_pk_bf16_f32 v112, v200, v201
    v_mfma_f32_16x16x32_bf16 a[128:131], a[32:35], v[64:67], a[128:131]
    s_add_u32 m0, s29, 81920
    v_exp_f32 v202, v202
    v_mfma_f32_16x16x32_bf16 a[128:131], a[36:39], v[68:71], a[128:131]
    buffer_load_dwordx4 v11, s[8:11], s37 offen offset:0 lds
    v_mfma_f32_16x16x32_bf16 a[160:163], a[32:35], v[72:75], a[160:163]
    s_waitcnt lgkmcnt(9)
    v_exp_f32 v203, v203
    v_mfma_f32_16x16x32_bf16 a[160:163], a[36:39], v[76:79], a[160:163]
    ds_read_b128 a[4:7], v81 offset:0
    v_cvt_pk_bf16_f32 v113, v202, v203
    v_mfma_f32_16x16x32_bf16 a[68:71], a[40:43], v[48:51], a[68:71]
    v_exp_f32 v216, v216
    v_mfma_f32_16x16x32_bf16 a[68:71], a[44:47], v[52:55], a[68:71]
    buffer_load_dwordx4 v11, s[8:11], s37 offen offset:1024 lds
    v_mfma_f32_16x16x32_bf16 a[100:103], a[40:43], v[56:59], a[100:103]
    v_exp_f32 v217, v217
    v_mfma_f32_16x16x32_bf16 a[100:103], a[44:47], v[60:63], a[100:103]
    ds_read_b128 a[8:11], v82 offset:0
    v_cvt_pk_bf16_f32 v114, v216, v217
    v_mfma_f32_16x16x32_bf16 a[132:135], a[40:43], v[64:67], a[132:135]
    v_exp_f32 v218, v218
    v_mfma_f32_16x16x32_bf16 a[132:135], a[44:47], v[68:71], a[132:135]
    buffer_load_dwordx4 v11, s[8:11], s37 offen offset:2048 lds
    v_mfma_f32_16x16x32_bf16 a[164:167], a[40:43], v[72:75], a[164:167]
    s_waitcnt lgkmcnt(7)
    v_exp_f32 v219, v219
    v_mfma_f32_16x16x32_bf16 a[164:167], a[44:47], v[76:79], a[164:167]
    ds_read_b128 a[12:15], v83 offset:0
    v_cvt_pk_bf16_f32 v115, v218, v219
    v_mfma_f32_16x16x32_bf16 a[72:75], a[48:51], v[48:51], a[72:75]
    v_exp_f32 v204, v204
    v_mfma_f32_16x16x32_bf16 a[72:75], a[52:55], v[52:55], a[72:75]
    buffer_load_dwordx4 v11, s[8:11], s37 offen offset:3072 lds
    v_mfma_f32_16x16x32_bf16 a[104:107], a[48:51], v[56:59], a[104:107]
    s_add_u32 s37, s37, 16384
    v_exp_f32 v205, v205
    v_mfma_f32_16x16x32_bf16 a[104:107], a[52:55], v[60:63], a[104:107]
    ds_read_b128 a[16:19], v80 offset:1024
    v_cvt_pk_bf16_f32 v120, v204, v205
    v_mfma_f32_16x16x32_bf16 a[136:139], a[48:51], v[64:67], a[136:139]
    v_exp_f32 v206, v206
    v_mfma_f32_16x16x32_bf16 a[136:139], a[52:55], v[68:71], a[136:139]
    v_mfma_f32_16x16x32_bf16 a[168:171], a[48:51], v[72:75], a[168:171]
    s_waitcnt lgkmcnt(5)
    v_exp_f32 v207, v207
    v_mfma_f32_16x16x32_bf16 a[168:171], a[52:55], v[76:79], a[168:171]
    ds_read_b128 a[20:23], v81 offset:1024
    v_cvt_pk_bf16_f32 v121, v206, v207
    v_mfma_f32_16x16x32_bf16 a[76:79], a[56:59], v[48:51], a[76:79]
    v_exp_f32 v220, v220
    v_mfma_f32_16x16x32_bf16 a[76:79], a[60:63], v[52:55], a[76:79]
    v_mfma_f32_16x16x32_bf16 a[108:111], a[56:59], v[56:59], a[108:111]
    v_exp_f32 v221, v221
    v_mfma_f32_16x16x32_bf16 a[108:111], a[60:63], v[60:63], a[108:111]
    ds_read_b128 a[24:27], v82 offset:1024
    v_cvt_pk_bf16_f32 v122, v220, v221
    v_mfma_f32_16x16x32_bf16 a[140:143], a[56:59], v[64:67], a[140:143]
    s_bitset0_b32 s37, 19
    v_exp_f32 v222, v222
    v_mfma_f32_16x16x32_bf16 a[140:143], a[60:63], v[68:71], a[140:143]
    v_mfma_f32_16x16x32_bf16 a[172:175], a[56:59], v[72:75], a[172:175]
    v_exp_f32 v223, v223
    v_mfma_f32_16x16x32_bf16 a[172:175], a[60:63], v[76:79], a[172:175]
    ds_read_b128 a[28:31], v83 offset:1024
    v_cvt_pk_bf16_f32 v123, v222, v223
    v_smfmac_f32_16x16x64_bf16 a[192:195], v[92:95], v[48:55], v15
    v_smfmac_f32_16x16x64_bf16 a[196:199], v[92:95], v[56:63], v15
    s_waitcnt lgkmcnt(4)
    v_mfma_f32_16x16x32_bf16 v[192:195], a[0:3], v[128:131], v[224:227]
    s_add_u32 s60, s60, 2065408
    v_exp_f32 v16, v16
    v_mfma_f32_16x16x32_bf16 v[192:195], a[4:7], v[144:147], v[192:195]
    ds_read_b64_tr_b16 a[32:33], v88 offset:32768
    v_mfma_f32_16x16x32_bf16 v[192:195], a[8:11], v[160:163], v[192:195]
    s_add_u32 s62, s62, 16
    v_exp_f32 v17, v17
    v_mfma_f32_16x16x32_bf16 v[192:195], a[12:15], v[176:179], v[192:195]
    ds_read_b64_tr_b16 a[34:35], v88 offset:33792
    v_cvt_pk_bf16_f32 v244, v16, v17
    v_mfma_f32_16x16x32_bf16 v[196:199], a[0:3], v[132:135], v[228:231]
    s_cmp_ge_u32 s62, 18
    v_exp_f32 v18, v18
    v_mfma_f32_16x16x32_bf16 v[196:199], a[4:7], v[148:151], v[196:199]
    ds_read_b64_tr_b16 a[36:37], v88 offset:34816
    v_mfma_f32_16x16x32_bf16 v[196:199], a[8:11], v[164:167], v[196:199]
    s_cselect_b32 s63, 18, 0
    v_exp_f32 v19, v19
    v_mfma_f32_16x16x32_bf16 v[196:199], a[12:15], v[180:183], v[196:199]
    ds_read_b64_tr_b16 a[38:39], v88 offset:35840
    v_cvt_pk_bf16_f32 v245, v18, v19
    v_mfma_f32_16x16x32_bf16 v[200:203], a[0:3], v[136:139], v[232:235]
    s_cselect_b32 s44, 35712, 0
    v_exp_f32 v32, v32
    v_mfma_f32_16x16x32_bf16 v[200:203], a[4:7], v[152:155], v[200:203]
    ds_read_b64_tr_b16 a[40:41], v89 offset:32768
    v_mfma_f32_16x16x32_bf16 v[200:203], a[8:11], v[168:171], v[200:203]
    s_sub_u32 s62, s62, s63
    v_exp_f32 v33, v33
    v_mfma_f32_16x16x32_bf16 v[200:203], a[12:15], v[184:187], v[200:203]
    ds_read_b64_tr_b16 a[42:43], v89 offset:33792
    v_cvt_pk_bf16_f32 v246, v32, v33
    v_mfma_f32_16x16x32_bf16 v[204:207], a[0:3], v[140:143], v[236:239]
    s_add_u32 s60, s60, s44
    v_exp_f32 v34, v34
    v_mfma_f32_16x16x32_bf16 v[204:207], a[4:7], v[156:159], v[204:207]
    ds_read_b64_tr_b16 a[44:45], v89 offset:34816
    v_mfma_f32_16x16x32_bf16 v[204:207], a[8:11], v[172:175], v[204:207]
    s_waitcnt lgkmcnt(7)
    v_exp_f32 v35, v35
    v_mfma_f32_16x16x32_bf16 v[204:207], a[12:15], v[188:191], v[204:207]
    ds_read_b64_tr_b16 a[46:47], v89 offset:35840
    v_cvt_pk_bf16_f32 v247, v34, v35
    v_mfma_f32_16x16x32_bf16 v[208:211], a[16:19], v[128:131], v[224:227]
    s_cmp_eq_u32 s27, 5
    v_exp_f32 v20, v20
    v_mfma_f32_16x16x32_bf16 v[208:211], a[20:23], v[144:147], v[208:211]
    ds_read_b64_tr_b16 a[48:49], v90 offset:32768
    v_mfma_f32_16x16x32_bf16 v[208:211], a[24:27], v[160:163], v[208:211]
    s_cselect_b32 s60, s33, s60
    v_exp_f32 v21, v21
    v_mfma_f32_16x16x32_bf16 v[208:211], a[28:31], v[176:179], v[208:211]
    ds_read_b64_tr_b16 a[50:51], v90 offset:33792
    v_cvt_pk_bf16_f32 v252, v20, v21
    v_mfma_f32_16x16x32_bf16 v[212:215], a[16:19], v[132:135], v[228:231]
    s_cselect_b32 s62, s3, s62
    v_exp_f32 v22, v22
    v_mfma_f32_16x16x32_bf16 v[212:215], a[20:23], v[148:151], v[212:215]
    ds_read_b64_tr_b16 a[52:53], v90 offset:34816
    v_mfma_f32_16x16x32_bf16 v[212:215], a[24:27], v[164:167], v[212:215]
    s_cselect_b32 s52, s40, s52
    v_exp_f32 v23, v23
    v_mfma_f32_16x16x32_bf16 v[212:215], a[28:31], v[180:183], v[212:215]
    ds_read_b64_tr_b16 a[54:55], v90 offset:35840
    v_cvt_pk_bf16_f32 v253, v22, v23
    v_mfma_f32_16x16x32_bf16 v[216:219], a[16:19], v[136:139], v[232:235]
    s_cselect_b32 s53, s41, s53
    v_exp_f32 v36, v36
    v_mfma_f32_16x16x32_bf16 v[216:219], a[20:23], v[152:155], v[216:219]
    ds_read_b64_tr_b16 a[56:57], v91 offset:32768
    v_mfma_f32_16x16x32_bf16 v[216:219], a[24:27], v[168:171], v[216:219]
    s_cselect_b32 s54, s42, s54
    v_exp_f32 v37, v37
    v_mfma_f32_16x16x32_bf16 v[216:219], a[28:31], v[184:187], v[216:219]
    ds_read_b64_tr_b16 a[58:59], v91 offset:33792
    v_cvt_pk_bf16_f32 v254, v36, v37
    v_mfma_f32_16x16x32_bf16 v[220:223], a[16:19], v[140:143], v[236:239]
    v_exp_f32 v38, v38
    v_mfma_f32_16x16x32_bf16 v[220:223], a[20:23], v[156:159], v[220:223]
    ds_read_b64_tr_b16 a[60:61], v91 offset:34816
    v_mfma_f32_16x16x32_bf16 v[220:223], a[24:27], v[172:175], v[220:223]
    s_waitcnt lgkmcnt(11)
    v_exp_f32 v39, v39
    v_mfma_f32_16x16x32_bf16 v[220:223], a[28:31], v[188:191], v[220:223]
    ds_read_b64_tr_b16 a[62:63], v91 offset:35840
    v_cvt_pk_bf16_f32 v255, v38, v39
    v_mfma_f32_16x16x32_bf16 a[80:83], a[32:35], v[48:51], a[80:83]
    s_add_u32 s61, s61, 2097152
    v_exp_f32 v24, v24
    v_mfma_f32_16x16x32_bf16 a[80:83], a[36:39], v[52:55], a[80:83]
    v_mfma_f32_16x16x32_bf16 a[112:115], a[32:35], v[56:59], a[112:115]
    v_exp_f32 v25, v25
    v_mfma_f32_16x16x32_bf16 a[112:115], a[36:39], v[60:63], a[112:115]
    ds_read_b128 a[0:3], v80 offset:2048
    v_cvt_pk_bf16_f32 v116, v24, v25
    v_mfma_f32_16x16x32_bf16 a[144:147], a[32:35], v[64:67], a[144:147]
    s_add_u32 m0, s29, 49152
    v_exp_f32 v26, v26
    v_mfma_f32_16x16x32_bf16 a[144:147], a[36:39], v[68:71], a[144:147]
    buffer_load_dwordx4 v10, s[4:7], s28 offen offset:0 lds
    v_mfma_f32_16x16x32_bf16 a[176:179], a[32:35], v[72:75], a[176:179]
    s_waitcnt lgkmcnt(9)
    v_exp_f32 v27, v27
    v_mfma_f32_16x16x32_bf16 a[176:179], a[36:39], v[76:79], a[176:179]
    ds_read_b128 a[4:7], v81 offset:2048
    v_cvt_pk_bf16_f32 v117, v26, v27
    v_mfma_f32_16x16x32_bf16 a[84:87], a[40:43], v[48:51], a[84:87]
    v_exp_f32 v40, v40
    v_mfma_f32_16x16x32_bf16 a[84:87], a[44:47], v[52:55], a[84:87]
    buffer_load_dwordx4 v10, s[4:7], s28 offen offset:1024 lds
    v_mfma_f32_16x16x32_bf16 a[116:119], a[40:43], v[56:59], a[116:119]
    v_exp_f32 v41, v41
    v_mfma_f32_16x16x32_bf16 a[116:119], a[44:47], v[60:63], a[116:119]
    ds_read_b128 a[8:11], v82 offset:2048
    v_cvt_pk_bf16_f32 v118, v40, v41
    v_mfma_f32_16x16x32_bf16 a[148:151], a[40:43], v[64:67], a[148:151]
    v_exp_f32 v42, v42
    v_mfma_f32_16x16x32_bf16 a[148:151], a[44:47], v[68:71], a[148:151]
    buffer_load_dwordx4 v10, s[4:7], s28 offen offset:2048 lds
    v_mfma_f32_16x16x32_bf16 a[180:183], a[40:43], v[72:75], a[180:183]
    s_waitcnt lgkmcnt(7)
    v_exp_f32 v43, v43
    v_mfma_f32_16x16x32_bf16 a[180:183], a[44:47], v[76:79], a[180:183]
    ds_read_b128 a[12:15], v83 offset:2048
    v_cvt_pk_bf16_f32 v119, v42, v43
    v_mfma_f32_16x16x32_bf16 a[88:91], a[48:51], v[48:51], a[88:91]
    v_exp_f32 v28, v28
    v_mfma_f32_16x16x32_bf16 a[88:91], a[52:55], v[52:55], a[88:91]
    buffer_load_dwordx4 v10, s[4:7], s28 offen offset:3072 lds
    v_mfma_f32_16x16x32_bf16 a[120:123], a[48:51], v[56:59], a[120:123]
    s_add_u32 s28, s28, 16384
    v_exp_f32 v29, v29
    v_mfma_f32_16x16x32_bf16 a[120:123], a[52:55], v[60:63], a[120:123]
    ds_read_b128 a[16:19], v80 offset:3072
    v_cvt_pk_bf16_f32 v124, v28, v29
    v_mfma_f32_16x16x32_bf16 a[152:155], a[48:51], v[64:67], a[152:155]
    v_exp_f32 v30, v30
    v_mfma_f32_16x16x32_bf16 a[152:155], a[52:55], v[68:71], a[152:155]
    v_mfma_f32_16x16x32_bf16 a[184:187], a[48:51], v[72:75], a[184:187]
    s_waitcnt lgkmcnt(5)
    v_exp_f32 v31, v31
    v_mfma_f32_16x16x32_bf16 a[184:187], a[52:55], v[76:79], a[184:187]
    ds_read_b128 a[20:23], v81 offset:3072
    v_cvt_pk_bf16_f32 v125, v30, v31
    v_mfma_f32_16x16x32_bf16 a[92:95], a[56:59], v[48:51], a[92:95]
    v_exp_f32 v44, v44
    v_mfma_f32_16x16x32_bf16 a[92:95], a[60:63], v[52:55], a[92:95]
    v_mfma_f32_16x16x32_bf16 a[124:127], a[56:59], v[56:59], a[124:127]
    v_exp_f32 v45, v45
    v_mfma_f32_16x16x32_bf16 a[124:127], a[60:63], v[60:63], a[124:127]
    ds_read_b128 a[24:27], v82 offset:3072
    v_cvt_pk_bf16_f32 v126, v44, v45
    v_mfma_f32_16x16x32_bf16 a[156:159], a[56:59], v[64:67], a[156:159]
    s_bitset0_b32 s28, 19
    v_exp_f32 v46, v46
    v_mfma_f32_16x16x32_bf16 a[156:159], a[60:63], v[68:71], a[156:159]
    v_mfma_f32_16x16x32_bf16 a[188:191], a[56:59], v[72:75], a[188:191]
    v_exp_f32 v47, v47
    v_mfma_f32_16x16x32_bf16 a[188:191], a[60:63], v[76:79], a[188:191]
    ds_read_b128 a[28:31], v83 offset:3072
    v_cvt_pk_bf16_f32 v127, v46, v47
    v_smfmac_f32_16x16x64_bf16 a[200:203], v[92:95], v[64:71], v15
    v_smfmac_f32_16x16x64_bf16 a[204:207], v[92:95], v[72:79], v15
    s_waitcnt lgkmcnt(4)
    v_mfma_f32_16x16x32_bf16 v[16:19], a[0:3], v[128:131], v[224:227]
    s_cmp_eq_u32 s27, 1
    v_exp_f32 v192, v192
    v_mfma_f32_16x16x32_bf16 v[16:19], a[4:7], v[144:147], v[16:19]
    ds_read_b64_tr_b16 a[32:33], v84 offset:49152
    v_mfma_f32_16x16x32_bf16 v[16:19], a[8:11], v[160:163], v[16:19]
    s_cselect_b32 s4, s66, s4
    v_exp_f32 v193, v193
    v_mfma_f32_16x16x32_bf16 v[16:19], a[12:15], v[176:179], v[16:19]
    ds_read_b64_tr_b16 a[34:35], v84 offset:50176
    v_cvt_pk_bf16_f32 v48, v192, v193
    v_mfma_f32_16x16x32_bf16 v[20:23], a[0:3], v[132:135], v[228:231]
    s_cselect_b32 s5, s67, s5
    v_exp_f32 v194, v194
    v_mfma_f32_16x16x32_bf16 v[20:23], a[4:7], v[148:151], v[20:23]
    ds_read_b64_tr_b16 a[36:37], v84 offset:51200
    v_mfma_f32_16x16x32_bf16 v[20:23], a[8:11], v[164:167], v[20:23]
    s_cselect_b32 s6, s68, s6
    v_exp_f32 v195, v195
    v_mfma_f32_16x16x32_bf16 v[20:23], a[12:15], v[180:183], v[20:23]
    ds_read_b64_tr_b16 a[38:39], v84 offset:52224
    v_cvt_pk_bf16_f32 v49, v194, v195
    v_mfma_f32_16x16x32_bf16 v[24:27], a[0:3], v[136:139], v[232:235]
    s_cselect_b32 s28, 0, s28
    v_exp_f32 v208, v208
    v_mfma_f32_16x16x32_bf16 v[24:27], a[4:7], v[152:155], v[24:27]
    ds_read_b64_tr_b16 a[40:41], v85 offset:49152
    v_mfma_f32_16x16x32_bf16 v[24:27], a[8:11], v[168:171], v[24:27]
    v_exp_f32 v209, v209
    v_mfma_f32_16x16x32_bf16 v[24:27], a[12:15], v[184:187], v[24:27]
    ds_read_b64_tr_b16 a[42:43], v85 offset:50176
    v_cvt_pk_bf16_f32 v50, v208, v209
    v_mfma_f32_16x16x32_bf16 v[28:31], a[0:3], v[140:143], v[236:239]
    v_exp_f32 v210, v210
    v_mfma_f32_16x16x32_bf16 v[28:31], a[4:7], v[156:159], v[28:31]
    ds_read_b64_tr_b16 a[44:45], v85 offset:51200
    v_mfma_f32_16x16x32_bf16 v[28:31], a[8:11], v[172:175], v[28:31]
    s_waitcnt lgkmcnt(7)
    v_exp_f32 v211, v211
    v_mfma_f32_16x16x32_bf16 v[28:31], a[12:15], v[188:191], v[28:31]
    ds_read_b64_tr_b16 a[46:47], v85 offset:52224
    v_cvt_pk_bf16_f32 v51, v210, v211
    v_mfma_f32_16x16x32_bf16 v[32:35], a[16:19], v[128:131], v[224:227]
    v_exp_f32 v196, v196
    v_mfma_f32_16x16x32_bf16 v[32:35], a[20:23], v[144:147], v[32:35]
    ds_read_b64_tr_b16 a[48:49], v86 offset:49152
    v_mfma_f32_16x16x32_bf16 v[32:35], a[24:27], v[160:163], v[32:35]
    v_exp_f32 v197, v197
    v_mfma_f32_16x16x32_bf16 v[32:35], a[28:31], v[176:179], v[32:35]
    ds_read_b64_tr_b16 a[50:51], v86 offset:50176
    v_cvt_pk_bf16_f32 v56, v196, v197
    v_mfma_f32_16x16x32_bf16 v[36:39], a[16:19], v[132:135], v[228:231]
    v_exp_f32 v198, v198
    v_mfma_f32_16x16x32_bf16 v[36:39], a[20:23], v[148:151], v[36:39]
    ds_read_b64_tr_b16 a[52:53], v86 offset:51200
    v_mfma_f32_16x16x32_bf16 v[36:39], a[24:27], v[164:167], v[36:39]
    v_exp_f32 v199, v199
    v_mfma_f32_16x16x32_bf16 v[36:39], a[28:31], v[180:183], v[36:39]
    ds_read_b64_tr_b16 a[54:55], v86 offset:52224
    v_cvt_pk_bf16_f32 v57, v198, v199
    v_mfma_f32_16x16x32_bf16 v[40:43], a[16:19], v[136:139], v[232:235]
    v_exp_f32 v212, v212
    v_mfma_f32_16x16x32_bf16 v[40:43], a[20:23], v[152:155], v[40:43]
    ds_read_b64_tr_b16 a[56:57], v87 offset:49152
    v_mfma_f32_16x16x32_bf16 v[40:43], a[24:27], v[168:171], v[40:43]
    v_exp_f32 v213, v213
    v_mfma_f32_16x16x32_bf16 v[40:43], a[28:31], v[184:187], v[40:43]
    ds_read_b64_tr_b16 a[58:59], v87 offset:50176
    v_cvt_pk_bf16_f32 v58, v212, v213
    v_mfma_f32_16x16x32_bf16 v[44:47], a[16:19], v[140:143], v[236:239]
    v_exp_f32 v214, v214
    v_mfma_f32_16x16x32_bf16 v[44:47], a[20:23], v[156:159], v[44:47]
    ds_read_b64_tr_b16 a[60:61], v87 offset:51200
    v_mfma_f32_16x16x32_bf16 v[44:47], a[24:27], v[172:175], v[44:47]
    s_waitcnt lgkmcnt(11)
    v_exp_f32 v215, v215
    v_mfma_f32_16x16x32_bf16 v[44:47], a[28:31], v[188:191], v[44:47]
    ds_read_b64_tr_b16 a[62:63], v87 offset:52224
    v_cvt_pk_bf16_f32 v59, v214, v215
    v_mfma_f32_16x16x32_bf16 a[64:67], a[32:35], v[240:243], a[64:67]
    s_waitcnt vmcnt(14)
    v_exp_f32 v200, v200
    v_mfma_f32_16x16x32_bf16 a[64:67], a[36:39], v[244:247], a[64:67]
    s_barrier
    v_mfma_f32_16x16x32_bf16 a[96:99], a[32:35], v[248:251], a[96:99]
    v_exp_f32 v201, v201
    v_mfma_f32_16x16x32_bf16 a[96:99], a[36:39], v[252:255], a[96:99]
    ds_read_b128 a[0:3], v80 offset:16384
    v_cvt_pk_bf16_f32 v64, v200, v201
    v_mfma_f32_16x16x32_bf16 a[128:131], a[32:35], v[112:115], a[128:131]
    s_add_u32 m0, s29, 98304
    v_exp_f32 v202, v202
    v_mfma_f32_16x16x32_bf16 a[128:131], a[36:39], v[116:119], a[128:131]
    buffer_load_dwordx4 v11, s[8:11], s37 offen offset:0 lds
    v_mfma_f32_16x16x32_bf16 a[160:163], a[32:35], v[120:123], a[160:163]
    s_waitcnt lgkmcnt(9)
    v_exp_f32 v203, v203
    v_mfma_f32_16x16x32_bf16 a[160:163], a[36:39], v[124:127], a[160:163]
    ds_read_b128 a[4:7], v81 offset:16384
    v_cvt_pk_bf16_f32 v65, v202, v203
    v_mfma_f32_16x16x32_bf16 a[68:71], a[40:43], v[240:243], a[68:71]
    v_exp_f32 v216, v216
    v_mfma_f32_16x16x32_bf16 a[68:71], a[44:47], v[244:247], a[68:71]
    buffer_load_dwordx4 v11, s[8:11], s37 offen offset:1024 lds
    v_mfma_f32_16x16x32_bf16 a[100:103], a[40:43], v[248:251], a[100:103]
    v_exp_f32 v217, v217
    v_mfma_f32_16x16x32_bf16 a[100:103], a[44:47], v[252:255], a[100:103]
    ds_read_b128 a[8:11], v82 offset:16384
    v_cvt_pk_bf16_f32 v66, v216, v217
    v_mfma_f32_16x16x32_bf16 a[132:135], a[40:43], v[112:115], a[132:135]
    v_exp_f32 v218, v218
    v_mfma_f32_16x16x32_bf16 a[132:135], a[44:47], v[116:119], a[132:135]
    buffer_load_dwordx4 v11, s[8:11], s37 offen offset:2048 lds
    v_mfma_f32_16x16x32_bf16 a[164:167], a[40:43], v[120:123], a[164:167]
    s_waitcnt lgkmcnt(7)
    v_exp_f32 v219, v219
    v_mfma_f32_16x16x32_bf16 a[164:167], a[44:47], v[124:127], a[164:167]
    ds_read_b128 a[12:15], v83 offset:16384
    v_cvt_pk_bf16_f32 v67, v218, v219
    v_mfma_f32_16x16x32_bf16 a[72:75], a[48:51], v[240:243], a[72:75]
    v_exp_f32 v204, v204
    v_mfma_f32_16x16x32_bf16 a[72:75], a[52:55], v[244:247], a[72:75]
    buffer_load_dwordx4 v11, s[8:11], s37 offen offset:3072 lds
    v_mfma_f32_16x16x32_bf16 a[104:107], a[48:51], v[248:251], a[104:107]
    s_add_u32 s37, s37, 16384
    v_exp_f32 v205, v205
    v_mfma_f32_16x16x32_bf16 a[104:107], a[52:55], v[252:255], a[104:107]
    ds_read_b128 a[16:19], v80 offset:17408
    v_cvt_pk_bf16_f32 v72, v204, v205
    v_mfma_f32_16x16x32_bf16 a[136:139], a[48:51], v[112:115], a[136:139]
    v_exp_f32 v206, v206
    v_mfma_f32_16x16x32_bf16 a[136:139], a[52:55], v[116:119], a[136:139]
    buffer_store_dwordx4 v[104:107], v12, s[48:51], s45 offen offset:0 sc1
    v_mfma_f32_16x16x32_bf16 a[168:171], a[48:51], v[120:123], a[168:171]
    s_waitcnt lgkmcnt(5)
    v_exp_f32 v207, v207
    v_mfma_f32_16x16x32_bf16 a[168:171], a[52:55], v[124:127], a[168:171]
    ds_read_b128 a[20:23], v81 offset:17408
    v_cvt_pk_bf16_f32 v73, v206, v207
    v_mfma_f32_16x16x32_bf16 a[76:79], a[56:59], v[240:243], a[76:79]
    s_waitcnt vmcnt(17)
    v_exp_f32 v220, v220
    v_mfma_f32_16x16x32_bf16 a[76:79], a[60:63], v[244:247], a[76:79]
    ds_read_b64_tr_b16 v[96:97], v14 offset:0
    ds_read_b64_tr_b16 v[98:99], v14 offset:1024
    v_mfma_f32_16x16x32_bf16 a[108:111], a[56:59], v[248:251], a[108:111]
    s_add_u32 s45, s45, 1024
    v_exp_f32 v221, v221
    v_mfma_f32_16x16x32_bf16 a[108:111], a[60:63], v[252:255], a[108:111]
    ds_read_b128 a[24:27], v82 offset:17408
    v_cvt_pk_bf16_f32 v74, v220, v221
    v_mfma_f32_16x16x32_bf16 a[140:143], a[56:59], v[112:115], a[140:143]
    s_bitset0_b32 s37, 19
    v_exp_f32 v222, v222
    v_mfma_f32_16x16x32_bf16 a[140:143], a[60:63], v[116:119], a[140:143]
    ds_read_b64_tr_b16 v[100:101], v14 offset:32
    ds_read_b64_tr_b16 v[102:103], v14 offset:1056
    v_mfma_f32_16x16x32_bf16 a[172:175], a[56:59], v[120:123], a[172:175]
    v_exp_f32 v223, v223
    v_mfma_f32_16x16x32_bf16 a[172:175], a[60:63], v[124:127], a[172:175]
    ds_read_b128 a[28:31], v83 offset:17408
    v_cvt_pk_bf16_f32 v75, v222, v223
    v_smfmac_f32_16x16x64_bf16 a[192:195], v[92:95], v[240:247], v15
    v_smfmac_f32_16x16x64_bf16 a[196:199], v[92:95], v[248:255], v15
    s_waitcnt lgkmcnt(8)
    v_mfma_f32_16x16x32_bf16 v[192:195], a[0:3], v[128:131], v[224:227]
    v_exp_f32 v16, v16
    v_mfma_f32_16x16x32_bf16 v[192:195], a[4:7], v[144:147], v[192:195]
    ds_read_b64_tr_b16 a[32:33], v88 offset:49152
    v_mfma_f32_16x16x32_bf16 v[192:195], a[8:11], v[160:163], v[192:195]
    v_exp_f32 v17, v17
    v_mfma_f32_16x16x32_bf16 v[192:195], a[12:15], v[176:179], v[192:195]
    ds_read_b64_tr_b16 a[34:35], v88 offset:50176
    v_cvt_pk_bf16_f32 v52, v16, v17
    v_mfma_f32_16x16x32_bf16 v[196:199], a[0:3], v[132:135], v[228:231]
    v_exp_f32 v18, v18
    v_mfma_f32_16x16x32_bf16 v[196:199], a[4:7], v[148:151], v[196:199]
    ds_read_b64_tr_b16 a[36:37], v88 offset:51200
    v_mfma_f32_16x16x32_bf16 v[196:199], a[8:11], v[164:167], v[196:199]
    v_exp_f32 v19, v19
    v_mfma_f32_16x16x32_bf16 v[196:199], a[12:15], v[180:183], v[196:199]
    ds_read_b64_tr_b16 a[38:39], v88 offset:52224
    v_cvt_pk_bf16_f32 v53, v18, v19
    v_mfma_f32_16x16x32_bf16 v[200:203], a[0:3], v[136:139], v[232:235]
    v_exp_f32 v32, v32
    v_mfma_f32_16x16x32_bf16 v[200:203], a[4:7], v[152:155], v[200:203]
    ds_read_b64_tr_b16 a[40:41], v89 offset:49152
    v_mfma_f32_16x16x32_bf16 v[200:203], a[8:11], v[168:171], v[200:203]
    v_exp_f32 v33, v33
    v_mfma_f32_16x16x32_bf16 v[200:203], a[12:15], v[184:187], v[200:203]
    ds_read_b64_tr_b16 a[42:43], v89 offset:50176
    v_cvt_pk_bf16_f32 v54, v32, v33
    v_mfma_f32_16x16x32_bf16 v[204:207], a[0:3], v[140:143], v[236:239]
    v_exp_f32 v34, v34
    v_mfma_f32_16x16x32_bf16 v[204:207], a[4:7], v[156:159], v[204:207]
    ds_read_b64_tr_b16 a[44:45], v89 offset:51200
    v_mfma_f32_16x16x32_bf16 v[204:207], a[8:11], v[172:175], v[204:207]
    s_waitcnt lgkmcnt(7)
    v_exp_f32 v35, v35
    v_mfma_f32_16x16x32_bf16 v[204:207], a[12:15], v[188:191], v[204:207]
    ds_read_b64_tr_b16 a[46:47], v89 offset:52224
    v_cvt_pk_bf16_f32 v55, v34, v35
    v_mfma_f32_16x16x32_bf16 v[208:211], a[16:19], v[128:131], v[224:227]
    v_exp_f32 v20, v20
    v_mfma_f32_16x16x32_bf16 v[208:211], a[20:23], v[144:147], v[208:211]
    ds_read_b64_tr_b16 a[48:49], v90 offset:49152
    v_mfma_f32_16x16x32_bf16 v[208:211], a[24:27], v[160:163], v[208:211]
    v_exp_f32 v21, v21
    v_mfma_f32_16x16x32_bf16 v[208:211], a[28:31], v[176:179], v[208:211]
    ds_read_b64_tr_b16 a[50:51], v90 offset:50176
    v_cvt_pk_bf16_f32 v60, v20, v21
    v_mfma_f32_16x16x32_bf16 v[212:215], a[16:19], v[132:135], v[228:231]
    v_exp_f32 v22, v22
    v_mfma_f32_16x16x32_bf16 v[212:215], a[20:23], v[148:151], v[212:215]
    ds_read_b64_tr_b16 a[52:53], v90 offset:51200
    v_mfma_f32_16x16x32_bf16 v[212:215], a[24:27], v[164:167], v[212:215]
    v_exp_f32 v23, v23
    v_mfma_f32_16x16x32_bf16 v[212:215], a[28:31], v[180:183], v[212:215]
    ds_read_b64_tr_b16 a[54:55], v90 offset:52224
    v_cvt_pk_bf16_f32 v61, v22, v23
    v_mfma_f32_16x16x32_bf16 v[216:219], a[16:19], v[136:139], v[232:235]
    v_exp_f32 v36, v36
    v_mfma_f32_16x16x32_bf16 v[216:219], a[20:23], v[152:155], v[216:219]
    ds_read_b64_tr_b16 a[56:57], v91 offset:49152
    v_mfma_f32_16x16x32_bf16 v[216:219], a[24:27], v[168:171], v[216:219]
    v_exp_f32 v37, v37
    v_mfma_f32_16x16x32_bf16 v[216:219], a[28:31], v[184:187], v[216:219]
    ds_read_b64_tr_b16 a[58:59], v91 offset:50176
    v_cvt_pk_bf16_f32 v62, v36, v37
    v_mfma_f32_16x16x32_bf16 v[220:223], a[16:19], v[140:143], v[236:239]
    v_exp_f32 v38, v38
    v_mfma_f32_16x16x32_bf16 v[220:223], a[20:23], v[156:159], v[220:223]
    ds_read_b64_tr_b16 a[60:61], v91 offset:51200
    v_mfma_f32_16x16x32_bf16 v[220:223], a[24:27], v[172:175], v[220:223]
    s_waitcnt lgkmcnt(11)
    v_exp_f32 v39, v39
    v_mfma_f32_16x16x32_bf16 v[220:223], a[28:31], v[188:191], v[220:223]
    ds_read_b64_tr_b16 a[62:63], v91 offset:52224
    v_cvt_pk_bf16_f32 v63, v38, v39
    v_mfma_f32_16x16x32_bf16 a[80:83], a[32:35], v[240:243], a[80:83]
    v_exp_f32 v24, v24
    v_mfma_f32_16x16x32_bf16 a[80:83], a[36:39], v[244:247], a[80:83]
    v_mfma_f32_16x16x32_bf16 a[112:115], a[32:35], v[248:251], a[112:115]
    v_exp_f32 v25, v25
    v_mfma_f32_16x16x32_bf16 a[112:115], a[36:39], v[252:255], a[112:115]
    ds_read_b128 a[0:3], v80 offset:18432
    v_cvt_pk_bf16_f32 v68, v24, v25
    v_mfma_f32_16x16x32_bf16 a[144:147], a[32:35], v[112:115], a[144:147]
    s_add_u32 m0, s29, 0
    v_exp_f32 v26, v26
    v_mfma_f32_16x16x32_bf16 a[144:147], a[36:39], v[116:119], a[144:147]
    buffer_load_dwordx4 v10, s[4:7], s28 offen offset:0 lds
    v_mfma_f32_16x16x32_bf16 a[176:179], a[32:35], v[120:123], a[176:179]
    s_waitcnt lgkmcnt(9)
    v_exp_f32 v27, v27
    v_mfma_f32_16x16x32_bf16 a[176:179], a[36:39], v[124:127], a[176:179]
    ds_read_b128 a[4:7], v81 offset:18432
    v_cvt_pk_bf16_f32 v69, v26, v27
    v_mfma_f32_16x16x32_bf16 a[84:87], a[40:43], v[240:243], a[84:87]
    v_exp_f32 v40, v40
    v_mfma_f32_16x16x32_bf16 a[84:87], a[44:47], v[244:247], a[84:87]
    buffer_load_dwordx4 v10, s[4:7], s28 offen offset:1024 lds
    v_mfma_f32_16x16x32_bf16 a[116:119], a[40:43], v[248:251], a[116:119]
    v_exp_f32 v41, v41
    v_mfma_f32_16x16x32_bf16 a[116:119], a[44:47], v[252:255], a[116:119]
    ds_read_b128 a[8:11], v82 offset:18432
    v_cvt_pk_bf16_f32 v70, v40, v41
    v_mfma_f32_16x16x32_bf16 a[148:151], a[40:43], v[112:115], a[148:151]
    v_exp_f32 v42, v42
    v_mfma_f32_16x16x32_bf16 a[148:151], a[44:47], v[116:119], a[148:151]
    buffer_load_dwordx4 v10, s[4:7], s28 offen offset:2048 lds
    v_mfma_f32_16x16x32_bf16 a[180:183], a[40:43], v[120:123], a[180:183]
    s_waitcnt lgkmcnt(7)
    v_exp_f32 v43, v43
    v_mfma_f32_16x16x32_bf16 a[180:183], a[44:47], v[124:127], a[180:183]
    ds_read_b128 a[12:15], v83 offset:18432
    v_cvt_pk_bf16_f32 v71, v42, v43
    v_mfma_f32_16x16x32_bf16 a[88:91], a[48:51], v[240:243], a[88:91]
    v_exp_f32 v28, v28
    v_mfma_f32_16x16x32_bf16 a[88:91], a[52:55], v[244:247], a[88:91]
    buffer_load_dwordx4 v10, s[4:7], s28 offen offset:3072 lds
    v_mfma_f32_16x16x32_bf16 a[120:123], a[48:51], v[248:251], a[120:123]
    s_add_u32 s28, s28, 16384
    v_exp_f32 v29, v29
    v_mfma_f32_16x16x32_bf16 a[120:123], a[52:55], v[252:255], a[120:123]
    ds_read_b128 a[16:19], v80 offset:19456
    v_cvt_pk_bf16_f32 v76, v28, v29
    v_mfma_f32_16x16x32_bf16 a[152:155], a[48:51], v[112:115], a[152:155]
    v_exp_f32 v30, v30
    v_mfma_f32_16x16x32_bf16 a[152:155], a[52:55], v[116:119], a[152:155]
    buffer_store_dwordx4 v[96:99], v12, s[56:59], s61 offen offset:0 sc1
    v_mfma_f32_16x16x32_bf16 a[184:187], a[48:51], v[120:123], a[184:187]
    s_waitcnt lgkmcnt(5)
    v_exp_f32 v31, v31
    v_mfma_f32_16x16x32_bf16 a[184:187], a[52:55], v[124:127], a[184:187]
    ds_read_b128 a[20:23], v81 offset:19456
    v_cvt_pk_bf16_f32 v77, v30, v31
    v_mfma_f32_16x16x32_bf16 a[92:95], a[56:59], v[240:243], a[92:95]
    v_exp_f32 v44, v44
    v_mfma_f32_16x16x32_bf16 a[92:95], a[60:63], v[244:247], a[92:95]
    v_mfma_f32_16x16x32_bf16 a[124:127], a[56:59], v[248:251], a[124:127]
    v_exp_f32 v45, v45
    v_mfma_f32_16x16x32_bf16 a[124:127], a[60:63], v[252:255], a[124:127]
    ds_read_b128 a[24:27], v82 offset:19456
    v_cvt_pk_bf16_f32 v78, v44, v45
    v_mfma_f32_16x16x32_bf16 a[156:159], a[56:59], v[112:115], a[156:159]
    s_bitset0_b32 s28, 19
    v_exp_f32 v46, v46
    v_mfma_f32_16x16x32_bf16 a[156:159], a[60:63], v[116:119], a[156:159]
    buffer_store_dwordx4 v[100:103], v12, s[56:59], s61 offen offset:1024 sc1
    v_mfma_f32_16x16x32_bf16 a[188:191], a[56:59], v[120:123], a[188:191]
    v_exp_f32 v47, v47
    v_mfma_f32_16x16x32_bf16 a[188:191], a[60:63], v[124:127], a[188:191]
    ds_read_b128 a[28:31], v83 offset:19456
    v_cvt_pk_bf16_f32 v79, v46, v47
    v_smfmac_f32_16x16x64_bf16 a[200:203], v[92:95], v[112:119], v15
    v_smfmac_f32_16x16x64_bf16 a[204:207], v[92:95], v[120:127], v15
    s_waitcnt lgkmcnt(4)
    v_mfma_f32_16x16x32_bf16 v[16:19], a[0:3], v[128:131], v[224:227]
    v_exp_f32 v192, v192
    v_mfma_f32_16x16x32_bf16 v[16:19], a[4:7], v[144:147], v[16:19]
    ds_read_b64_tr_b16 a[32:33], v84 offset:0
    v_mfma_f32_16x16x32_bf16 v[16:19], a[8:11], v[160:163], v[16:19]
    v_exp_f32 v193, v193
    v_mfma_f32_16x16x32_bf16 v[16:19], a[12:15], v[176:179], v[16:19]
    ds_read_b64_tr_b16 a[34:35], v84 offset:1024
    v_cvt_pk_bf16_f32 v240, v192, v193
    v_mfma_f32_16x16x32_bf16 v[20:23], a[0:3], v[132:135], v[228:231]
    v_exp_f32 v194, v194
    v_mfma_f32_16x16x32_bf16 v[20:23], a[4:7], v[148:151], v[20:23]
    ds_read_b64_tr_b16 a[36:37], v84 offset:2048
    v_mfma_f32_16x16x32_bf16 v[20:23], a[8:11], v[164:167], v[20:23]
    v_exp_f32 v195, v195
    v_mfma_f32_16x16x32_bf16 v[20:23], a[12:15], v[180:183], v[20:23]
    ds_read_b64_tr_b16 a[38:39], v84 offset:3072
    v_cvt_pk_bf16_f32 v241, v194, v195
    v_mfma_f32_16x16x32_bf16 v[24:27], a[0:3], v[136:139], v[232:235]
    v_exp_f32 v208, v208
    v_mfma_f32_16x16x32_bf16 v[24:27], a[4:7], v[152:155], v[24:27]
    ds_read_b64_tr_b16 a[40:41], v85 offset:0
    v_mfma_f32_16x16x32_bf16 v[24:27], a[8:11], v[168:171], v[24:27]
    v_exp_f32 v209, v209
    v_mfma_f32_16x16x32_bf16 v[24:27], a[12:15], v[184:187], v[24:27]
    ds_read_b64_tr_b16 a[42:43], v85 offset:1024
    v_cvt_pk_bf16_f32 v242, v208, v209
    v_mfma_f32_16x16x32_bf16 v[28:31], a[0:3], v[140:143], v[236:239]
    v_exp_f32 v210, v210
    v_mfma_f32_16x16x32_bf16 v[28:31], a[4:7], v[156:159], v[28:31]
    ds_read_b64_tr_b16 a[44:45], v85 offset:2048
    v_mfma_f32_16x16x32_bf16 v[28:31], a[8:11], v[172:175], v[28:31]
    s_waitcnt lgkmcnt(7)
    v_exp_f32 v211, v211
    v_mfma_f32_16x16x32_bf16 v[28:31], a[12:15], v[188:191], v[28:31]
    ds_read_b64_tr_b16 a[46:47], v85 offset:3072
    v_cvt_pk_bf16_f32 v243, v210, v211
    v_mfma_f32_16x16x32_bf16 v[32:35], a[16:19], v[128:131], v[224:227]
    v_exp_f32 v196, v196
    v_mfma_f32_16x16x32_bf16 v[32:35], a[20:23], v[144:147], v[32:35]
    ds_read_b64_tr_b16 a[48:49], v86 offset:0
    v_mfma_f32_16x16x32_bf16 v[32:35], a[24:27], v[160:163], v[32:35]
    v_exp_f32 v197, v197
    v_mfma_f32_16x16x32_bf16 v[32:35], a[28:31], v[176:179], v[32:35]
    ds_read_b64_tr_b16 a[50:51], v86 offset:1024
    v_cvt_pk_bf16_f32 v248, v196, v197
    v_mfma_f32_16x16x32_bf16 v[36:39], a[16:19], v[132:135], v[228:231]
    v_exp_f32 v198, v198
    v_mfma_f32_16x16x32_bf16 v[36:39], a[20:23], v[148:151], v[36:39]
    ds_read_b64_tr_b16 a[52:53], v86 offset:2048
    v_mfma_f32_16x16x32_bf16 v[36:39], a[24:27], v[164:167], v[36:39]
    v_exp_f32 v199, v199
    v_mfma_f32_16x16x32_bf16 v[36:39], a[28:31], v[180:183], v[36:39]
    ds_read_b64_tr_b16 a[54:55], v86 offset:3072
    v_cvt_pk_bf16_f32 v249, v198, v199
    v_mfma_f32_16x16x32_bf16 v[40:43], a[16:19], v[136:139], v[232:235]
    v_exp_f32 v212, v212
    v_mfma_f32_16x16x32_bf16 v[40:43], a[20:23], v[152:155], v[40:43]
    ds_read_b64_tr_b16 a[56:57], v87 offset:0
    v_mfma_f32_16x16x32_bf16 v[40:43], a[24:27], v[168:171], v[40:43]
    v_exp_f32 v213, v213
    v_mfma_f32_16x16x32_bf16 v[40:43], a[28:31], v[184:187], v[40:43]
    ds_read_b64_tr_b16 a[58:59], v87 offset:1024
    v_cvt_pk_bf16_f32 v250, v212, v213
    v_mfma_f32_16x16x32_bf16 v[44:47], a[16:19], v[140:143], v[236:239]
    v_exp_f32 v214, v214
    v_mfma_f32_16x16x32_bf16 v[44:47], a[20:23], v[156:159], v[44:47]
    ds_read_b64_tr_b16 a[60:61], v87 offset:2048
    v_mfma_f32_16x16x32_bf16 v[44:47], a[24:27], v[172:175], v[44:47]
    s_waitcnt lgkmcnt(11)
    v_exp_f32 v215, v215
    v_mfma_f32_16x16x32_bf16 v[44:47], a[28:31], v[188:191], v[44:47]
    ds_read_b64_tr_b16 a[62:63], v87 offset:3072
    v_cvt_pk_bf16_f32 v251, v214, v215
    v_mfma_f32_16x16x32_bf16 a[64:67], a[32:35], v[48:51], a[64:67]
    s_waitcnt vmcnt(15)
    v_exp_f32 v200, v200
    v_mfma_f32_16x16x32_bf16 a[64:67], a[36:39], v[52:55], a[64:67]
    s_barrier
    v_mfma_f32_16x16x32_bf16 a[96:99], a[32:35], v[56:59], a[96:99]
    v_exp_f32 v201, v201
    v_mfma_f32_16x16x32_bf16 a[96:99], a[36:39], v[60:63], a[96:99]
    ds_read_b128 a[0:3], v80 offset:32768
    v_cvt_pk_bf16_f32 v112, v200, v201
    v_mfma_f32_16x16x32_bf16 a[128:131], a[32:35], v[64:67], a[128:131]
    s_add_u32 m0, s29, 114688
    v_exp_f32 v202, v202
    v_mfma_f32_16x16x32_bf16 a[128:131], a[36:39], v[68:71], a[128:131]
    buffer_load_dwordx4 v11, s[8:11], s37 offen offset:0 lds
    v_mfma_f32_16x16x32_bf16 a[160:163], a[32:35], v[72:75], a[160:163]
    s_waitcnt lgkmcnt(9)
    v_exp_f32 v203, v203
    v_mfma_f32_16x16x32_bf16 a[160:163], a[36:39], v[76:79], a[160:163]
    ds_read_b128 a[4:7], v81 offset:32768
    v_cvt_pk_bf16_f32 v113, v202, v203
    v_mfma_f32_16x16x32_bf16 a[68:71], a[40:43], v[48:51], a[68:71]
    v_exp_f32 v216, v216
    v_mfma_f32_16x16x32_bf16 a[68:71], a[44:47], v[52:55], a[68:71]
    buffer_load_dwordx4 v11, s[8:11], s37 offen offset:1024 lds
    v_mfma_f32_16x16x32_bf16 a[100:103], a[40:43], v[56:59], a[100:103]
    v_exp_f32 v217, v217
    v_mfma_f32_16x16x32_bf16 a[100:103], a[44:47], v[60:63], a[100:103]
    ds_read_b128 a[8:11], v82 offset:32768
    v_cvt_pk_bf16_f32 v114, v216, v217
    v_mfma_f32_16x16x32_bf16 a[132:135], a[40:43], v[64:67], a[132:135]
    v_exp_f32 v218, v218
    v_mfma_f32_16x16x32_bf16 a[132:135], a[44:47], v[68:71], a[132:135]
    buffer_load_dwordx4 v11, s[8:11], s37 offen offset:2048 lds
    v_mfma_f32_16x16x32_bf16 a[164:167], a[40:43], v[72:75], a[164:167]
    s_waitcnt lgkmcnt(7)
    v_exp_f32 v219, v219
    v_mfma_f32_16x16x32_bf16 a[164:167], a[44:47], v[76:79], a[164:167]
    ds_read_b128 a[12:15], v83 offset:32768
    v_cvt_pk_bf16_f32 v115, v218, v219
    v_mfma_f32_16x16x32_bf16 a[72:75], a[48:51], v[48:51], a[72:75]
    v_exp_f32 v204, v204
    v_mfma_f32_16x16x32_bf16 a[72:75], a[52:55], v[52:55], a[72:75]
    buffer_load_dwordx4 v11, s[8:11], s37 offen offset:3072 lds
    v_mfma_f32_16x16x32_bf16 a[104:107], a[48:51], v[56:59], a[104:107]
    s_add_u32 s37, s37, 16384
    v_exp_f32 v205, v205
    v_mfma_f32_16x16x32_bf16 a[104:107], a[52:55], v[60:63], a[104:107]
    ds_read_b128 a[16:19], v80 offset:33792
    v_cvt_pk_bf16_f32 v120, v204, v205
    v_mfma_f32_16x16x32_bf16 a[136:139], a[48:51], v[64:67], a[136:139]
    v_exp_f32 v206, v206
    v_mfma_f32_16x16x32_bf16 a[136:139], a[52:55], v[68:71], a[136:139]
    v_mfma_f32_16x16x32_bf16 a[168:171], a[48:51], v[72:75], a[168:171]
    s_waitcnt lgkmcnt(5)
    v_exp_f32 v207, v207
    v_mfma_f32_16x16x32_bf16 a[168:171], a[52:55], v[76:79], a[168:171]
    ds_read_b128 a[20:23], v81 offset:33792
    v_cvt_pk_bf16_f32 v121, v206, v207
    v_mfma_f32_16x16x32_bf16 a[76:79], a[56:59], v[48:51], a[76:79]
    v_exp_f32 v220, v220
    v_mfma_f32_16x16x32_bf16 a[76:79], a[60:63], v[52:55], a[76:79]
    v_mfma_f32_16x16x32_bf16 a[108:111], a[56:59], v[56:59], a[108:111]
    v_exp_f32 v221, v221
    v_mfma_f32_16x16x32_bf16 a[108:111], a[60:63], v[60:63], a[108:111]
    ds_read_b128 a[24:27], v82 offset:33792
    v_cvt_pk_bf16_f32 v122, v220, v221
    v_mfma_f32_16x16x32_bf16 a[140:143], a[56:59], v[64:67], a[140:143]
    s_bitset0_b32 s37, 19
    v_exp_f32 v222, v222
    v_mfma_f32_16x16x32_bf16 a[140:143], a[60:63], v[68:71], a[140:143]
    v_mfma_f32_16x16x32_bf16 a[172:175], a[56:59], v[72:75], a[172:175]
    v_exp_f32 v223, v223
    v_mfma_f32_16x16x32_bf16 a[172:175], a[60:63], v[76:79], a[172:175]
    ds_read_b128 a[28:31], v83 offset:33792
    v_cvt_pk_bf16_f32 v123, v222, v223
    v_smfmac_f32_16x16x64_bf16 a[192:195], v[92:95], v[48:55], v15
    v_smfmac_f32_16x16x64_bf16 a[196:199], v[92:95], v[56:63], v15
    s_waitcnt lgkmcnt(4)
    v_mfma_f32_16x16x32_bf16 v[192:195], a[0:3], v[128:131], v[224:227]
    s_cmp_eq_u32 s27, 1
    v_exp_f32 v16, v16
    v_mfma_f32_16x16x32_bf16 v[192:195], a[4:7], v[144:147], v[192:195]
    ds_read_b64_tr_b16 a[32:33], v88 offset:0
    v_mfma_f32_16x16x32_bf16 v[192:195], a[8:11], v[160:163], v[192:195]
    s_cselect_b32 s8, s66, s8
    v_exp_f32 v17, v17
    v_mfma_f32_16x16x32_bf16 v[192:195], a[12:15], v[176:179], v[192:195]
    ds_read_b64_tr_b16 a[34:35], v88 offset:1024
    v_cvt_pk_bf16_f32 v244, v16, v17
    v_mfma_f32_16x16x32_bf16 v[196:199], a[0:3], v[132:135], v[228:231]
    s_cselect_b32 s9, s67, s9
    v_exp_f32 v18, v18
    v_mfma_f32_16x16x32_bf16 v[196:199], a[4:7], v[148:151], v[196:199]
    ds_read_b64_tr_b16 a[36:37], v88 offset:2048
    v_mfma_f32_16x16x32_bf16 v[196:199], a[8:11], v[164:167], v[196:199]
    s_cselect_b32 s10, s68, s10
    v_exp_f32 v19, v19
    v_mfma_f32_16x16x32_bf16 v[196:199], a[12:15], v[180:183], v[196:199]
    ds_read_b64_tr_b16 a[38:39], v88 offset:3072
    v_cvt_pk_bf16_f32 v245, v18, v19
    v_mfma_f32_16x16x32_bf16 v[200:203], a[0:3], v[136:139], v[232:235]
    s_cselect_b32 s37, 49152, s37
    v_exp_f32 v32, v32
    v_mfma_f32_16x16x32_bf16 v[200:203], a[4:7], v[152:155], v[200:203]
    ds_read_b64_tr_b16 a[40:41], v89 offset:0
    v_mfma_f32_16x16x32_bf16 v[200:203], a[8:11], v[168:171], v[200:203]
    v_exp_f32 v33, v33
    v_mfma_f32_16x16x32_bf16 v[200:203], a[12:15], v[184:187], v[200:203]
    ds_read_b64_tr_b16 a[42:43], v89 offset:1024
    v_cvt_pk_bf16_f32 v246, v32, v33
    v_mfma_f32_16x16x32_bf16 v[204:207], a[0:3], v[140:143], v[236:239]
    v_exp_f32 v34, v34
    v_mfma_f32_16x16x32_bf16 v[204:207], a[4:7], v[156:159], v[204:207]
    ds_read_b64_tr_b16 a[44:45], v89 offset:2048
    v_mfma_f32_16x16x32_bf16 v[204:207], a[8:11], v[172:175], v[204:207]
    s_waitcnt lgkmcnt(7)
    v_exp_f32 v35, v35
    v_mfma_f32_16x16x32_bf16 v[204:207], a[12:15], v[188:191], v[204:207]
    ds_read_b64_tr_b16 a[46:47], v89 offset:3072
    v_cvt_pk_bf16_f32 v247, v34, v35
    v_mfma_f32_16x16x32_bf16 v[208:211], a[16:19], v[128:131], v[224:227]
    v_exp_f32 v20, v20
    v_mfma_f32_16x16x32_bf16 v[208:211], a[20:23], v[144:147], v[208:211]
    ds_read_b64_tr_b16 a[48:49], v90 offset:0
    v_mfma_f32_16x16x32_bf16 v[208:211], a[24:27], v[160:163], v[208:211]
    v_exp_f32 v21, v21
    v_mfma_f32_16x16x32_bf16 v[208:211], a[28:31], v[176:179], v[208:211]
    ds_read_b64_tr_b16 a[50:51], v90 offset:1024
    v_cvt_pk_bf16_f32 v252, v20, v21
    v_mfma_f32_16x16x32_bf16 v[212:215], a[16:19], v[132:135], v[228:231]
    v_exp_f32 v22, v22
    v_mfma_f32_16x16x32_bf16 v[212:215], a[20:23], v[148:151], v[212:215]
    ds_read_b64_tr_b16 a[52:53], v90 offset:2048
    v_mfma_f32_16x16x32_bf16 v[212:215], a[24:27], v[164:167], v[212:215]
    v_exp_f32 v23, v23
    v_mfma_f32_16x16x32_bf16 v[212:215], a[28:31], v[180:183], v[212:215]
    ds_read_b64_tr_b16 a[54:55], v90 offset:3072
    v_cvt_pk_bf16_f32 v253, v22, v23
    v_mfma_f32_16x16x32_bf16 v[216:219], a[16:19], v[136:139], v[232:235]
    v_exp_f32 v36, v36
    v_mfma_f32_16x16x32_bf16 v[216:219], a[20:23], v[152:155], v[216:219]
    ds_read_b64_tr_b16 a[56:57], v91 offset:0
    v_mfma_f32_16x16x32_bf16 v[216:219], a[24:27], v[168:171], v[216:219]
    v_exp_f32 v37, v37
    v_mfma_f32_16x16x32_bf16 v[216:219], a[28:31], v[184:187], v[216:219]
    ds_read_b64_tr_b16 a[58:59], v91 offset:1024
    v_cvt_pk_bf16_f32 v254, v36, v37
    v_mfma_f32_16x16x32_bf16 v[220:223], a[16:19], v[140:143], v[236:239]
    v_exp_f32 v38, v38
    v_mfma_f32_16x16x32_bf16 v[220:223], a[20:23], v[156:159], v[220:223]
    ds_read_b64_tr_b16 a[60:61], v91 offset:2048
    v_mfma_f32_16x16x32_bf16 v[220:223], a[24:27], v[172:175], v[220:223]
    s_waitcnt lgkmcnt(11)
    v_exp_f32 v39, v39
    v_mfma_f32_16x16x32_bf16 v[220:223], a[28:31], v[188:191], v[220:223]
    ds_read_b64_tr_b16 a[62:63], v91 offset:3072
    v_cvt_pk_bf16_f32 v255, v38, v39
    v_mfma_f32_16x16x32_bf16 a[80:83], a[32:35], v[48:51], a[80:83]
    v_exp_f32 v24, v24
    v_mfma_f32_16x16x32_bf16 a[80:83], a[36:39], v[52:55], a[80:83]
    v_mfma_f32_16x16x32_bf16 a[112:115], a[32:35], v[56:59], a[112:115]
    v_exp_f32 v25, v25
    v_mfma_f32_16x16x32_bf16 a[112:115], a[36:39], v[60:63], a[112:115]
    ds_read_b128 a[0:3], v80 offset:34816
    v_cvt_pk_bf16_f32 v116, v24, v25
    v_mfma_f32_16x16x32_bf16 a[144:147], a[32:35], v[64:67], a[144:147]
    s_add_u32 m0, s29, 16384
    v_exp_f32 v26, v26
    v_mfma_f32_16x16x32_bf16 a[144:147], a[36:39], v[68:71], a[144:147]
    buffer_load_dwordx4 v10, s[4:7], s28 offen offset:0 lds
    v_mfma_f32_16x16x32_bf16 a[176:179], a[32:35], v[72:75], a[176:179]
    s_waitcnt lgkmcnt(9)
    v_exp_f32 v27, v27
    v_mfma_f32_16x16x32_bf16 a[176:179], a[36:39], v[76:79], a[176:179]
    ds_read_b128 a[4:7], v81 offset:34816
    v_cvt_pk_bf16_f32 v117, v26, v27
    v_mfma_f32_16x16x32_bf16 a[84:87], a[40:43], v[48:51], a[84:87]
    v_exp_f32 v40, v40
    v_mfma_f32_16x16x32_bf16 a[84:87], a[44:47], v[52:55], a[84:87]
    buffer_load_dwordx4 v10, s[4:7], s28 offen offset:1024 lds
    v_mfma_f32_16x16x32_bf16 a[116:119], a[40:43], v[56:59], a[116:119]
    v_exp_f32 v41, v41
    v_mfma_f32_16x16x32_bf16 a[116:119], a[44:47], v[60:63], a[116:119]
    ds_read_b128 a[8:11], v82 offset:34816
    v_cvt_pk_bf16_f32 v118, v40, v41
    v_mfma_f32_16x16x32_bf16 a[148:151], a[40:43], v[64:67], a[148:151]
    v_exp_f32 v42, v42
    v_mfma_f32_16x16x32_bf16 a[148:151], a[44:47], v[68:71], a[148:151]
    buffer_load_dwordx4 v10, s[4:7], s28 offen offset:2048 lds
    v_mfma_f32_16x16x32_bf16 a[180:183], a[40:43], v[72:75], a[180:183]
    s_waitcnt lgkmcnt(7)
    v_exp_f32 v43, v43
    v_mfma_f32_16x16x32_bf16 a[180:183], a[44:47], v[76:79], a[180:183]
    ds_read_b128 a[12:15], v83 offset:34816
    v_cvt_pk_bf16_f32 v119, v42, v43
    v_mfma_f32_16x16x32_bf16 a[88:91], a[48:51], v[48:51], a[88:91]
    v_exp_f32 v28, v28
    v_mfma_f32_16x16x32_bf16 a[88:91], a[52:55], v[52:55], a[88:91]
    buffer_load_dwordx4 v10, s[4:7], s28 offen offset:3072 lds
    v_mfma_f32_16x16x32_bf16 a[120:123], a[48:51], v[56:59], a[120:123]
    s_add_u32 s28, s28, 16384
    v_exp_f32 v29, v29
    v_mfma_f32_16x16x32_bf16 a[120:123], a[52:55], v[60:63], a[120:123]
    ds_read_b128 a[16:19], v80 offset:35840
    v_cvt_pk_bf16_f32 v124, v28, v29
    v_mfma_f32_16x16x32_bf16 a[152:155], a[48:51], v[64:67], a[152:155]
    v_exp_f32 v30, v30
    v_mfma_f32_16x16x32_bf16 a[152:155], a[52:55], v[68:71], a[152:155]
    v_mfma_f32_16x16x32_bf16 a[184:187], a[48:51], v[72:75], a[184:187]
    s_waitcnt lgkmcnt(5)
    v_exp_f32 v31, v31
    v_mfma_f32_16x16x32_bf16 a[184:187], a[52:55], v[76:79], a[184:187]
    ds_read_b128 a[20:23], v81 offset:35840
    v_cvt_pk_bf16_f32 v125, v30, v31
    v_mfma_f32_16x16x32_bf16 a[92:95], a[56:59], v[48:51], a[92:95]
    v_exp_f32 v44, v44
    v_mfma_f32_16x16x32_bf16 a[92:95], a[60:63], v[52:55], a[92:95]
    v_mfma_f32_16x16x32_bf16 a[124:127], a[56:59], v[56:59], a[124:127]
    v_exp_f32 v45, v45
    v_mfma_f32_16x16x32_bf16 a[124:127], a[60:63], v[60:63], a[124:127]
    ds_read_b128 a[24:27], v82 offset:35840
    v_cvt_pk_bf16_f32 v126, v44, v45
    v_mfma_f32_16x16x32_bf16 a[156:159], a[56:59], v[64:67], a[156:159]
    s_bitset0_b32 s28, 19
    v_exp_f32 v46, v46
    v_mfma_f32_16x16x32_bf16 a[156:159], a[60:63], v[68:71], a[156:159]
    v_mfma_f32_16x16x32_bf16 a[188:191], a[56:59], v[72:75], a[188:191]
    v_exp_f32 v47, v47
    v_mfma_f32_16x16x32_bf16 a[188:191], a[60:63], v[76:79], a[188:191]
    ds_read_b128 a[28:31], v83 offset:35840
    v_cvt_pk_bf16_f32 v127, v46, v47
    v_smfmac_f32_16x16x64_bf16 a[200:203], v[92:95], v[64:71], v15
    v_smfmac_f32_16x16x64_bf16 a[204:207], v[92:95], v[72:79], v15
    s_waitcnt lgkmcnt(4)
    s_sub_u32 s27, s27, 1
    s_branch L_attn
L_attn_tail:
    v_mfma_f32_16x16x32_bf16 v[16:19], a[0:3], v[128:131], v[224:227]
    v_exp_f32 v192, v192
    v_mfma_f32_16x16x32_bf16 v[16:19], a[4:7], v[144:147], v[16:19]
    ds_read_b64_tr_b16 a[32:33], v84 offset:32768
    v_mfma_f32_16x16x32_bf16 v[16:19], a[8:11], v[160:163], v[16:19]
    v_exp_f32 v193, v193
    v_mfma_f32_16x16x32_bf16 v[16:19], a[12:15], v[176:179], v[16:19]
    ds_read_b64_tr_b16 a[34:35], v84 offset:33792
    v_cvt_pk_bf16_f32 v240, v192, v193
    v_mfma_f32_16x16x32_bf16 v[20:23], a[0:3], v[132:135], v[228:231]
    v_exp_f32 v194, v194
    v_mfma_f32_16x16x32_bf16 v[20:23], a[4:7], v[148:151], v[20:23]
    ds_read_b64_tr_b16 a[36:37], v84 offset:34816
    v_mfma_f32_16x16x32_bf16 v[20:23], a[8:11], v[164:167], v[20:23]
    v_exp_f32 v195, v195
    v_mfma_f32_16x16x32_bf16 v[20:23], a[12:15], v[180:183], v[20:23]
    ds_read_b64_tr_b16 a[38:39], v84 offset:35840
    v_cvt_pk_bf16_f32 v241, v194, v195
    v_mfma_f32_16x16x32_bf16 v[24:27], a[0:3], v[136:139], v[232:235]
    v_exp_f32 v208, v208
    v_mfma_f32_16x16x32_bf16 v[24:27], a[4:7], v[152:155], v[24:27]
    ds_read_b64_tr_b16 a[40:41], v85 offset:32768
    v_mfma_f32_16x16x32_bf16 v[24:27], a[8:11], v[168:171], v[24:27]
    v_exp_f32 v209, v209
    v_mfma_f32_16x16x32_bf16 v[24:27], a[12:15], v[184:187], v[24:27]
    ds_read_b64_tr_b16 a[42:43], v85 offset:33792
    v_cvt_pk_bf16_f32 v242, v208, v209
    v_mfma_f32_16x16x32_bf16 v[28:31], a[0:3], v[140:143], v[236:239]
    v_exp_f32 v210, v210
    v_mfma_f32_16x16x32_bf16 v[28:31], a[4:7], v[156:159], v[28:31]
    ds_read_b64_tr_b16 a[44:45], v85 offset:34816
    v_mfma_f32_16x16x32_bf16 v[28:31], a[8:11], v[172:175], v[28:31]
    s_waitcnt lgkmcnt(7)
    v_exp_f32 v211, v211
    v_mfma_f32_16x16x32_bf16 v[28:31], a[12:15], v[188:191], v[28:31]
    ds_read_b64_tr_b16 a[46:47], v85 offset:35840
    v_cvt_pk_bf16_f32 v243, v210, v211
    v_mfma_f32_16x16x32_bf16 v[32:35], a[16:19], v[128:131], v[224:227]
    v_exp_f32 v196, v196
    v_mfma_f32_16x16x32_bf16 v[32:35], a[20:23], v[144:147], v[32:35]
    ds_read_b64_tr_b16 a[48:49], v86 offset:32768
    v_mfma_f32_16x16x32_bf16 v[32:35], a[24:27], v[160:163], v[32:35]
    v_exp_f32 v197, v197
    v_mfma_f32_16x16x32_bf16 v[32:35], a[28:31], v[176:179], v[32:35]
    ds_read_b64_tr_b16 a[50:51], v86 offset:33792
    v_cvt_pk_bf16_f32 v248, v196, v197
    v_mfma_f32_16x16x32_bf16 v[36:39], a[16:19], v[132:135], v[228:231]
    v_exp_f32 v198, v198
    v_mfma_f32_16x16x32_bf16 v[36:39], a[20:23], v[148:151], v[36:39]
    ds_read_b64_tr_b16 a[52:53], v86 offset:34816
    v_mfma_f32_16x16x32_bf16 v[36:39], a[24:27], v[164:167], v[36:39]
    v_exp_f32 v199, v199
    v_mfma_f32_16x16x32_bf16 v[36:39], a[28:31], v[180:183], v[36:39]
    ds_read_b64_tr_b16 a[54:55], v86 offset:35840
    v_cvt_pk_bf16_f32 v249, v198, v199
    v_mfma_f32_16x16x32_bf16 v[40:43], a[16:19], v[136:139], v[232:235]
    v_exp_f32 v212, v212
    v_mfma_f32_16x16x32_bf16 v[40:43], a[20:23], v[152:155], v[40:43]
    ds_read_b64_tr_b16 a[56:57], v87 offset:32768
    v_mfma_f32_16x16x32_bf16 v[40:43], a[24:27], v[168:171], v[40:43]
    v_exp_f32 v213, v213
    v_mfma_f32_16x16x32_bf16 v[40:43], a[28:31], v[184:187], v[40:43]
    ds_read_b64_tr_b16 a[58:59], v87 offset:33792
    v_cvt_pk_bf16_f32 v250, v212, v213
    v_mfma_f32_16x16x32_bf16 v[44:47], a[16:19], v[140:143], v[236:239]
    v_exp_f32 v214, v214
    v_mfma_f32_16x16x32_bf16 v[44:47], a[20:23], v[156:159], v[44:47]
    ds_read_b64_tr_b16 a[60:61], v87 offset:34816
    v_mfma_f32_16x16x32_bf16 v[44:47], a[24:27], v[172:175], v[44:47]
    s_waitcnt lgkmcnt(11)
    v_exp_f32 v215, v215
    v_mfma_f32_16x16x32_bf16 v[44:47], a[28:31], v[188:191], v[44:47]
    ds_read_b64_tr_b16 a[62:63], v87 offset:35840
    v_cvt_pk_bf16_f32 v251, v214, v215
    v_mfma_f32_16x16x32_bf16 a[64:67], a[32:35], v[48:51], a[64:67]
    s_waitcnt vmcnt(14)
    v_exp_f32 v200, v200
    v_mfma_f32_16x16x32_bf16 a[64:67], a[36:39], v[52:55], a[64:67]
    s_barrier
    v_mfma_f32_16x16x32_bf16 a[96:99], a[32:35], v[56:59], a[96:99]
    v_exp_f32 v201, v201
    v_mfma_f32_16x16x32_bf16 a[96:99], a[36:39], v[60:63], a[96:99]
    ds_read_b64_tr_b16 a[0:1], v88 offset:32768
    v_cvt_pk_bf16_f32 v112, v200, v201
    v_mfma_f32_16x16x32_bf16 a[128:131], a[32:35], v[64:67], a[128:131]
    v_exp_f32 v202, v202
    v_mfma_f32_16x16x32_bf16 a[128:131], a[36:39], v[68:71], a[128:131]
    ds_read_b64_tr_b16 a[2:3], v88 offset:33792
    ds_read_b64_tr_b16 a[4:5], v88 offset:34816
    v_mfma_f32_16x16x32_bf16 a[160:163], a[32:35], v[72:75], a[160:163]
    s_waitcnt lgkmcnt(11)
    v_exp_f32 v203, v203
    v_mfma_f32_16x16x32_bf16 a[160:163], a[36:39], v[76:79], a[160:163]
    ds_read_b64_tr_b16 a[6:7], v88 offset:35840
    v_cvt_pk_bf16_f32 v113, v202, v203
    v_mfma_f32_16x16x32_bf16 a[68:71], a[40:43], v[48:51], a[68:71]
    v_exp_f32 v216, v216
    v_mfma_f32_16x16x32_bf16 a[68:71], a[44:47], v[52:55], a[68:71]
    ds_read_b64_tr_b16 a[8:9], v89 offset:32768
    ds_read_b64_tr_b16 a[10:11], v89 offset:33792
    v_mfma_f32_16x16x32_bf16 a[100:103], a[40:43], v[56:59], a[100:103]
    v_exp_f32 v217, v217
    v_mfma_f32_16x16x32_bf16 a[100:103], a[44:47], v[60:63], a[100:103]
    ds_read_b64_tr_b16 a[12:13], v89 offset:34816
    v_cvt_pk_bf16_f32 v114, v216, v217
    v_mfma_f32_16x16x32_bf16 a[132:135], a[40:43], v[64:67], a[132:135]
    v_exp_f32 v218, v218
    v_mfma_f32_16x16x32_bf16 a[132:135], a[44:47], v[68:71], a[132:135]
    ds_read_b64_tr_b16 a[14:15], v89 offset:35840
    ds_read_b64_tr_b16 a[16:17], v90 offset:32768
    v_mfma_f32_16x16x32_bf16 a[164:167], a[40:43], v[72:75], a[164:167]
    s_waitcnt lgkmcnt(13)
    v_exp_f32 v219, v219
    v_mfma_f32_16x16x32_bf16 a[164:167], a[44:47], v[76:79], a[164:167]
    ds_read_b64_tr_b16 a[18:19], v90 offset:33792
    v_cvt_pk_bf16_f32 v115, v218, v219
    v_mfma_f32_16x16x32_bf16 a[72:75], a[48:51], v[48:51], a[72:75]
    v_exp_f32 v204, v204
    v_mfma_f32_16x16x32_bf16 a[72:75], a[52:55], v[52:55], a[72:75]
    ds_read_b64_tr_b16 a[20:21], v90 offset:34816
    ds_read_b64_tr_b16 a[22:23], v90 offset:35840
    v_mfma_f32_16x16x32_bf16 a[104:107], a[48:51], v[56:59], a[104:107]
    v_exp_f32 v205, v205
    v_mfma_f32_16x16x32_bf16 a[104:107], a[52:55], v[60:63], a[104:107]
    ds_read_b64_tr_b16 a[24:25], v91 offset:32768
    v_cvt_pk_bf16_f32 v120, v204, v205
    v_mfma_f32_16x16x32_bf16 a[136:139], a[48:51], v[64:67], a[136:139]
    v_exp_f32 v206, v206
    v_mfma_f32_16x16x32_bf16 a[136:139], a[52:55], v[68:71], a[136:139]
    ds_read_b64_tr_b16 a[26:27], v91 offset:33792
    ds_read_b64_tr_b16 a[28:29], v91 offset:34816
    v_mfma_f32_16x16x32_bf16 a[168:171], a[48:51], v[72:75], a[168:171]
    s_waitcnt lgkmcnt(14)
    v_exp_f32 v207, v207
    v_mfma_f32_16x16x32_bf16 a[168:171], a[52:55], v[76:79], a[168:171]
    ds_read_b64_tr_b16 a[30:31], v91 offset:35840
    v_cvt_pk_bf16_f32 v121, v206, v207
    v_mfma_f32_16x16x32_bf16 a[76:79], a[56:59], v[48:51], a[76:79]
    v_exp_f32 v220, v220
    v_mfma_f32_16x16x32_bf16 a[76:79], a[60:63], v[52:55], a[76:79]
    v_mfma_f32_16x16x32_bf16 a[108:111], a[56:59], v[56:59], a[108:111]
    v_exp_f32 v221, v221
    v_mfma_f32_16x16x32_bf16 a[108:111], a[60:63], v[60:63], a[108:111]
    v_cvt_pk_bf16_f32 v122, v220, v221
    v_mfma_f32_16x16x32_bf16 a[140:143], a[56:59], v[64:67], a[140:143]
    v_exp_f32 v222, v222
    v_mfma_f32_16x16x32_bf16 a[140:143], a[60:63], v[68:71], a[140:143]
    v_mfma_f32_16x16x32_bf16 a[172:175], a[56:59], v[72:75], a[172:175]
    v_exp_f32 v223, v223
    v_mfma_f32_16x16x32_bf16 a[172:175], a[60:63], v[76:79], a[172:175]
    v_cvt_pk_bf16_f32 v123, v222, v223
    v_smfmac_f32_16x16x64_bf16 a[192:195], v[92:95], v[48:55], v15
    global_load_dword v100, v[108:109], off
    v_smfmac_f32_16x16x64_bf16 a[196:199], v[92:95], v[56:63], v15
    s_waitcnt lgkmcnt(12)
    v_mfma_f32_16x16x32_bf16 a[80:83], a[0:3], v[48:51], a[80:83]
    ds_read_b64_tr_b16 a[32:33], v84 offset:49152
    v_exp_f32 v16, v16
    v_mfma_f32_16x16x32_bf16 a[80:83], a[4:7], v[52:55], a[80:83]
    v_exp_f32 v17, v17
    v_mfma_f32_16x16x32_bf16 a[112:115], a[0:3], v[56:59], a[112:115]
    ds_read_b64_tr_b16 a[34:35], v84 offset:50176
    v_cvt_pk_bf16_f32 v244, v16, v17
    v_exp_f32 v18, v18
    v_mfma_f32_16x16x32_bf16 a[112:115], a[4:7], v[60:63], a[112:115]
    v_exp_f32 v19, v19
    v_mfma_f32_16x16x32_bf16 a[144:147], a[0:3], v[64:67], a[144:147]
    ds_read_b64_tr_b16 a[36:37], v84 offset:51200
    v_cvt_pk_bf16_f32 v245, v18, v19
    v_exp_f32 v32, v32
    v_mfma_f32_16x16x32_bf16 a[144:147], a[4:7], v[68:71], a[144:147]
    v_exp_f32 v33, v33
    v_mfma_f32_16x16x32_bf16 a[176:179], a[0:3], v[72:75], a[176:179]
    ds_read_b64_tr_b16 a[38:39], v84 offset:52224
    v_cvt_pk_bf16_f32 v246, v32, v33
    v_exp_f32 v34, v34
    v_mfma_f32_16x16x32_bf16 a[176:179], a[4:7], v[76:79], a[176:179]
    s_waitcnt lgkmcnt(12)
    v_exp_f32 v35, v35
    v_mfma_f32_16x16x32_bf16 a[84:87], a[8:11], v[48:51], a[84:87]
    ds_read_b64_tr_b16 a[40:41], v85 offset:49152
    v_cvt_pk_bf16_f32 v247, v34, v35
    v_exp_f32 v20, v20
    v_mfma_f32_16x16x32_bf16 a[84:87], a[12:15], v[52:55], a[84:87]
    v_exp_f32 v21, v21
    v_mfma_f32_16x16x32_bf16 a[116:119], a[8:11], v[56:59], a[116:119]
    ds_read_b64_tr_b16 a[42:43], v85 offset:50176
    v_cvt_pk_bf16_f32 v252, v20, v21
    v_exp_f32 v22, v22
    v_mfma_f32_16x16x32_bf16 a[116:119], a[12:15], v[60:63], a[116:119]
    v_exp_f32 v23, v23
    v_mfma_f32_16x16x32_bf16 a[148:151], a[8:11], v[64:67], a[148:151]
    ds_read_b64_tr_b16 a[44:45], v85 offset:51200
    v_cvt_pk_bf16_f32 v253, v22, v23
    v_exp_f32 v36, v36
    v_mfma_f32_16x16x32_bf16 a[148:151], a[12:15], v[68:71], a[148:151]
    v_exp_f32 v37, v37
    v_mfma_f32_16x16x32_bf16 a[180:183], a[8:11], v[72:75], a[180:183]
    ds_read_b64_tr_b16 a[46:47], v85 offset:52224
    v_cvt_pk_bf16_f32 v254, v36, v37
    v_exp_f32 v38, v38
    v_mfma_f32_16x16x32_bf16 a[180:183], a[12:15], v[76:79], a[180:183]
    s_waitcnt lgkmcnt(12)
    v_exp_f32 v39, v39
    v_mfma_f32_16x16x32_bf16 a[88:91], a[16:19], v[48:51], a[88:91]
    ds_read_b64_tr_b16 a[48:49], v86 offset:49152
    v_cvt_pk_bf16_f32 v255, v38, v39
    v_mfma_f32_16x16x32_bf16 a[88:91], a[20:23], v[52:55], a[88:91]
    v_exp_f32 v24, v24
    v_mfma_f32_16x16x32_bf16 a[120:123], a[16:19], v[56:59], a[120:123]
    ds_read_b64_tr_b16 a[50:51], v86 offset:50176
    v_exp_f32 v25, v25
    v_mfma_f32_16x16x32_bf16 a[120:123], a[20:23], v[60:63], a[120:123]
    v_cvt_pk_bf16_f32 v116, v24, v25
    v_exp_f32 v26, v26
    v_mfma_f32_16x16x32_bf16 a[152:155], a[16:19], v[64:67], a[152:155]
    ds_read_b64_tr_b16 a[52:53], v86 offset:51200
    v_exp_f32 v27, v27
    v_mfma_f32_16x16x32_bf16 a[152:155], a[20:23], v[68:71], a[152:155]
    v_cvt_pk_bf16_f32 v117, v26, v27
    v_exp_f32 v40, v40
    v_mfma_f32_16x16x32_bf16 a[184:187], a[16:19], v[72:75], a[184:187]
    ds_read_b64_tr_b16 a[54:55], v86 offset:52224
    v_exp_f32 v41, v41
    v_mfma_f32_16x16x32_bf16 a[184:187], a[20:23], v[76:79], a[184:187]
    s_waitcnt lgkmcnt(12)
    v_cvt_pk_bf16_f32 v118, v40, v41
    v_exp_f32 v42, v42
    v_mfma_f32_16x16x32_bf16 a[92:95], a[24:27], v[48:51], a[92:95]
    ds_read_b64_tr_b16 a[56:57], v87 offset:49152
    v_exp_f32 v43, v43
    v_mfma_f32_16x16x32_bf16 a[92:95], a[28:31], v[52:55], a[92:95]
    v_cvt_pk_bf16_f32 v119, v42, v43
    v_exp_f32 v28, v28
    v_mfma_f32_16x16x32_bf16 a[124:127], a[24:27], v[56:59], a[124:127]
    ds_read_b64_tr_b16 a[58:59], v87 offset:50176
    v_exp_f32 v29, v29
    v_mfma_f32_16x16x32_bf16 a[124:127], a[28:31], v[60:63], a[124:127]
    v_cvt_pk_bf16_f32 v124, v28, v29
    v_exp_f32 v30, v30
    v_mfma_f32_16x16x32_bf16 a[156:159], a[24:27], v[64:67], a[156:159]
    ds_read_b64_tr_b16 a[60:61], v87 offset:51200
    v_exp_f32 v31, v31
    v_mfma_f32_16x16x32_bf16 a[156:159], a[28:31], v[68:71], a[156:159]
    v_cvt_pk_bf16_f32 v125, v30, v31
    v_exp_f32 v44, v44
    v_mfma_f32_16x16x32_bf16 a[188:191], a[24:27], v[72:75], a[188:191]
    ds_read_b64_tr_b16 a[62:63], v87 offset:52224
    v_exp_f32 v45, v45
    v_mfma_f32_16x16x32_bf16 a[188:191], a[28:31], v[76:79], a[188:191]
    v_cvt_pk_bf16_f32 v126, v44, v45
    v_exp_f32 v46, v46
    v_smfmac_f32_16x16x64_bf16 a[200:203], v[92:95], v[64:71], v15
    v_exp_f32 v47, v47
    v_smfmac_f32_16x16x64_bf16 a[204:207], v[92:95], v[72:79], v15
    v_cvt_pk_bf16_f32 v127, v46, v47
    s_nop 1
    s_waitcnt lgkmcnt(0)
    v_smfmac_f32_16x16x64_bf16 a[192:195], v[92:95], v[240:247], v15
    ds_read_b64_tr_b16 a[0:1], v88 offset:49152
    v_add_u32 v108, 0, v12
    v_add_u32 v109, 131072, v12
    v_add_u32 v110, 262144, v12
    v_add_u32 v111, 393216, v12
    s_lshl_b32 s39, s25, 12
    v_smfmac_f32_16x16x64_bf16 a[196:199], v[92:95], v[248:255], v15
    ds_read_b64_tr_b16 a[2:3], v88 offset:50176
    v_smfmac_f32_16x16x64_bf16 a[200:203], v[92:95], v[112:119], v15
    ds_read_b64_tr_b16 a[4:5], v88 offset:51200
    v_smfmac_f32_16x16x64_bf16 a[204:207], v[92:95], v[120:127], v15
    ds_read_b64_tr_b16 a[6:7], v88 offset:52224
    v_mfma_f32_16x16x32_bf16 a[64:67], a[32:35], v[240:243], a[64:67]
    ds_read_b64_tr_b16 a[8:9], v89 offset:49152
    v_mfma_f32_16x16x32_bf16 a[64:67], a[36:39], v[244:247], a[64:67]
    ds_read_b64_tr_b16 a[10:11], v89 offset:50176
    v_mfma_f32_16x16x32_bf16 a[96:99], a[32:35], v[248:251], a[96:99]
    ds_read_b64_tr_b16 a[12:13], v89 offset:51200
    v_mfma_f32_16x16x32_bf16 a[96:99], a[36:39], v[252:255], a[96:99]
    ds_read_b64_tr_b16 a[14:15], v89 offset:52224
    v_mfma_f32_16x16x32_bf16 a[128:131], a[32:35], v[112:115], a[128:131]
    ds_read_b64_tr_b16 a[16:17], v90 offset:49152
    v_accvgpr_read_b32 v96, a192
    v_accvgpr_read_b32 v97, a196
    v_accvgpr_read_b32 v98, a200
    v_accvgpr_read_b32 v99, a204
    v_accvgpr_read_b32 v104, a193
    v_mfma_f32_16x16x32_bf16 a[128:131], a[36:39], v[116:119], a[128:131]
    ds_read_b64_tr_b16 a[18:19], v90 offset:50176
    v_accvgpr_read_b32 v105, a197
    v_accvgpr_read_b32 v106, a201
    v_accvgpr_read_b32 v107, a205
    v_add_f32 v96, v96, v104
    v_add_f32 v97, v97, v105
    v_mfma_f32_16x16x32_bf16 a[160:163], a[32:35], v[120:123], a[160:163]
    ds_read_b64_tr_b16 a[20:21], v90 offset:51200
    v_add_f32 v98, v98, v106
    v_add_f32 v99, v99, v107
    v_add_f32 v101, v96, v97
    v_add_f32 v102, v98, v99
    v_add_f32 v101, v101, v102
    v_mfma_f32_16x16x32_bf16 a[160:163], a[36:39], v[124:127], a[160:163]
    ds_read_b64_tr_b16 a[22:23], v90 offset:52224
    v_cmp_nge_f32 vcc, s30, v101
    v_rcp_f32 v96, v96
    v_rcp_f32 v97, v97
    v_rcp_f32 v98, v98
    v_rcp_f32 v99, v99
    v_mfma_f32_16x16x32_bf16 a[68:71], a[40:43], v[240:243], a[68:71]
    ds_read_b64_tr_b16 a[24:25], v91 offset:49152
    v_mfma_f32_16x16x32_bf16 a[68:71], a[44:47], v[244:247], a[68:71]
    ds_read_b64_tr_b16 a[26:27], v91 offset:50176
    v_mfma_f32_16x16x32_bf16 a[100:103], a[40:43], v[248:251], a[100:103]
    ds_read_b64_tr_b16 a[28:29], v91 offset:51200
    v_mfma_f32_16x16x32_bf16 a[100:103], a[44:47], v[252:255], a[100:103]
    ds_read_b64_tr_b16 a[30:31], v91 offset:52224
    v_mfma_f32_16x16x32_bf16 a[132:135], a[40:43], v[112:115], a[132:135]
    s_nop 1
    v_mfma_f32_16x16x32_bf16 a[132:135], a[44:47], v[116:119], a[132:135]
    v_accvgpr_read_b32 v16, a64
    v_accvgpr_read_b32 v17, a65
    v_accvgpr_read_b32 v18, a66
    v_accvgpr_read_b32 v19, a67
    v_accvgpr_read_b32 v20, a68
    v_mfma_f32_16x16x32_bf16 a[164:167], a[40:43], v[120:123], a[164:167]
    v_accvgpr_read_b32 v21, a69
    v_accvgpr_read_b32 v22, a70
    v_accvgpr_read_b32 v23, a71
    v_mul_f32 v16, v16, v96
    v_mul_f32 v17, v17, v96
    v_mfma_f32_16x16x32_bf16 a[164:167], a[44:47], v[124:127], a[164:167]
    v_mul_f32 v18, v18, v96
    v_mul_f32 v19, v19, v96
    v_mul_f32 v20, v20, v96
    v_mul_f32 v21, v21, v96
    v_mul_f32 v22, v22, v96
    v_mfma_f32_16x16x32_bf16 a[72:75], a[48:51], v[240:243], a[72:75]
    v_mul_f32 v23, v23, v96
    v_cvt_pk_bf16_f32 v24, v16, v17
    v_cvt_pk_bf16_f32 v25, v18, v19
    v_cvt_pk_bf16_f32 v26, v20, v21
    v_cvt_pk_bf16_f32 v27, v22, v23
    v_mfma_f32_16x16x32_bf16 a[72:75], a[52:55], v[244:247], a[72:75]
    buffer_store_dwordx4 v[24:27], v108, s[20:23], s39 offen offset:0 sc1
    v_accvgpr_read_b32 v28, a96
    v_accvgpr_read_b32 v29, a97
    v_accvgpr_read_b32 v30, a98
    v_accvgpr_read_b32 v31, a99
    v_mfma_f32_16x16x32_bf16 a[104:107], a[48:51], v[248:251], a[104:107]
    v_accvgpr_read_b32 v32, a100
    v_accvgpr_read_b32 v33, a101
    v_accvgpr_read_b32 v34, a102
    v_accvgpr_read_b32 v35, a103
    v_mul_f32 v28, v28, v97
    v_mfma_f32_16x16x32_bf16 a[104:107], a[52:55], v[252:255], a[104:107]
    v_mul_f32 v29, v29, v97
    v_mul_f32 v30, v30, v97
    v_mul_f32 v31, v31, v97
    v_mul_f32 v32, v32, v97
    v_mul_f32 v33, v33, v97
    v_mfma_f32_16x16x32_bf16 a[136:139], a[48:51], v[112:115], a[136:139]
    v_mul_f32 v34, v34, v97
    v_mul_f32 v35, v35, v97
    v_cvt_pk_bf16_f32 v36, v28, v29
    v_cvt_pk_bf16_f32 v37, v30, v31
    v_cvt_pk_bf16_f32 v38, v32, v33
    v_mfma_f32_16x16x32_bf16 a[136:139], a[52:55], v[116:119], a[136:139]
    v_cvt_pk_bf16_f32 v39, v34, v35
    buffer_store_dwordx4 v[36:39], v109, s[20:23], s39 offen offset:0 sc1
    v_accvgpr_read_b32 v40, a128
    v_accvgpr_read_b32 v41, a129
    v_accvgpr_read_b32 v42, a130
    v_mfma_f32_16x16x32_bf16 a[168:171], a[48:51], v[120:123], a[168:171]
    v_accvgpr_read_b32 v43, a131
    v_accvgpr_read_b32 v44, a132
    v_accvgpr_read_b32 v45, a133
    v_accvgpr_read_b32 v46, a134
    v_accvgpr_read_b32 v47, a135
    v_mfma_f32_16x16x32_bf16 a[168:171], a[52:55], v[124:127], a[168:171]
    v_mul_f32 v40, v40, v98
    v_mul_f32 v41, v41, v98
    v_mul_f32 v42, v42, v98
    v_mul_f32 v43, v43, v98
    v_mul_f32 v44, v44, v98
    v_mfma_f32_16x16x32_bf16 a[76:79], a[56:59], v[240:243], a[76:79]
    v_mul_f32 v45, v45, v98
    v_mul_f32 v46, v46, v98
    v_mul_f32 v47, v47, v98
    v_cvt_pk_bf16_f32 v48, v40, v41
    v_cvt_pk_bf16_f32 v49, v42, v43
    v_mfma_f32_16x16x32_bf16 a[76:79], a[60:63], v[244:247], a[76:79]
    v_cvt_pk_bf16_f32 v50, v44, v45
    v_cvt_pk_bf16_f32 v51, v46, v47
    buffer_store_dwordx4 v[48:51], v110, s[20:23], s39 offen offset:0 sc1
    v_accvgpr_read_b32 v52, a160
    v_accvgpr_read_b32 v53, a161
    v_mfma_f32_16x16x32_bf16 a[108:111], a[56:59], v[248:251], a[108:111]
    v_accvgpr_read_b32 v54, a162
    v_accvgpr_read_b32 v55, a163
    v_accvgpr_read_b32 v56, a164
    v_accvgpr_read_b32 v57, a165
    v_accvgpr_read_b32 v58, a166
    v_mfma_f32_16x16x32_bf16 a[108:111], a[60:63], v[252:255], a[108:111]
    v_accvgpr_read_b32 v59, a167
    v_mul_f32 v52, v52, v99
    v_mul_f32 v53, v53, v99
    v_mul_f32 v54, v54, v99
    v_mul_f32 v55, v55, v99
    v_mfma_f32_16x16x32_bf16 a[140:143], a[56:59], v[112:115], a[140:143]
    v_mul_f32 v56, v56, v99
    v_mul_f32 v57, v57, v99
    v_mul_f32 v58, v58, v99
    v_mul_f32 v59, v59, v99
    v_cvt_pk_bf16_f32 v60, v52, v53
    v_mfma_f32_16x16x32_bf16 a[140:143], a[60:63], v[116:119], a[140:143]
    v_cvt_pk_bf16_f32 v61, v54, v55
    v_cvt_pk_bf16_f32 v62, v56, v57
    v_cvt_pk_bf16_f32 v63, v58, v59
    buffer_store_dwordx4 v[60:63], v111, s[20:23], s39 offen offset:0 sc1
    v_accvgpr_read_b32 v16, a72
    v_mfma_f32_16x16x32_bf16 a[172:175], a[56:59], v[120:123], a[172:175]
    v_accvgpr_read_b32 v17, a73
    v_accvgpr_read_b32 v18, a74
    v_accvgpr_read_b32 v19, a75
    v_accvgpr_read_b32 v20, a76
    v_accvgpr_read_b32 v21, a77
    v_mfma_f32_16x16x32_bf16 a[172:175], a[60:63], v[124:127], a[172:175]
    s_waitcnt lgkmcnt(12)
    v_accvgpr_read_b32 v22, a78
    v_accvgpr_read_b32 v23, a79
    v_mul_f32 v16, v16, v96
    v_mul_f32 v17, v17, v96
    v_mul_f32 v18, v18, v96
    v_mfma_f32_16x16x32_bf16 a[80:83], a[0:3], v[240:243], a[80:83]
    v_mul_f32 v19, v19, v96
    v_mul_f32 v20, v20, v96
    v_mul_f32 v21, v21, v96
    v_mul_f32 v22, v22, v96
    v_mul_f32 v23, v23, v96
    v_mfma_f32_16x16x32_bf16 a[80:83], a[4:7], v[244:247], a[80:83]
    v_cvt_pk_bf16_f32 v24, v16, v17
    v_cvt_pk_bf16_f32 v25, v18, v19
    v_cvt_pk_bf16_f32 v26, v20, v21
    v_cvt_pk_bf16_f32 v27, v22, v23
    buffer_store_dwordx4 v[24:27], v108, s[20:23], s39 offen offset:1024 sc1
    v_mfma_f32_16x16x32_bf16 a[112:115], a[0:3], v[248:251], a[112:115]
    v_accvgpr_read_b32 v28, a104
    v_accvgpr_read_b32 v29, a105
    v_accvgpr_read_b32 v30, a106
    v_accvgpr_read_b32 v31, a107
    v_accvgpr_read_b32 v32, a108
    v_mfma_f32_16x16x32_bf16 a[112:115], a[4:7], v[252:255], a[112:115]
    v_accvgpr_read_b32 v33, a109
    v_accvgpr_read_b32 v34, a110
    v_accvgpr_read_b32 v35, a111
    v_mul_f32 v28, v28, v97
    v_mul_f32 v29, v29, v97
    v_mfma_f32_16x16x32_bf16 a[144:147], a[0:3], v[112:115], a[144:147]
    v_mul_f32 v30, v30, v97
    v_mul_f32 v31, v31, v97
    v_mul_f32 v32, v32, v97
    v_mul_f32 v33, v33, v97
    v_mul_f32 v34, v34, v97
    v_mfma_f32_16x16x32_bf16 a[144:147], a[4:7], v[116:119], a[144:147]
    v_mul_f32 v35, v35, v97
    v_cvt_pk_bf16_f32 v36, v28, v29
    v_cvt_pk_bf16_f32 v37, v30, v31
    v_cvt_pk_bf16_f32 v38, v32, v33
    v_cvt_pk_bf16_f32 v39, v34, v35
    v_mfma_f32_16x16x32_bf16 a[176:179], a[0:3], v[120:123], a[176:179]
    buffer_store_dwordx4 v[36:39], v109, s[20:23], s39 offen offset:1024 sc1
    v_accvgpr_read_b32 v40, a136
    v_accvgpr_read_b32 v41, a137
    v_accvgpr_read_b32 v42, a138
    v_accvgpr_read_b32 v43, a139
    v_mfma_f32_16x16x32_bf16 a[176:179], a[4:7], v[124:127], a[176:179]
    s_waitcnt lgkmcnt(8)
    v_accvgpr_read_b32 v44, a140
    v_accvgpr_read_b32 v45, a141
    v_accvgpr_read_b32 v46, a142
    v_accvgpr_read_b32 v47, a143
    v_mul_f32 v40, v40, v98
    v_mfma_f32_16x16x32_bf16 a[84:87], a[8:11], v[240:243], a[84:87]
    v_mul_f32 v41, v41, v98
    v_mul_f32 v42, v42, v98
    v_mul_f32 v43, v43, v98
    v_mul_f32 v44, v44, v98
    v_mul_f32 v45, v45, v98
    v_mfma_f32_16x16x32_bf16 a[84:87], a[12:15], v[244:247], a[84:87]
    v_mul_f32 v46, v46, v98
    v_mul_f32 v47, v47, v98
    v_cvt_pk_bf16_f32 v48, v40, v41
    v_cvt_pk_bf16_f32 v49, v42, v43
    v_cvt_pk_bf16_f32 v50, v44, v45
    v_mfma_f32_16x16x32_bf16 a[116:119], a[8:11], v[248:251], a[116:119]
    v_cvt_pk_bf16_f32 v51, v46, v47
    buffer_store_dwordx4 v[48:51], v110, s[20:23], s39 offen offset:1024 sc1
    v_accvgpr_read_b32 v52, a168
    v_accvgpr_read_b32 v53, a169
    v_accvgpr_read_b32 v54, a170
    v_mfma_f32_16x16x32_bf16 a[116:119], a[12:15], v[252:255], a[116:119]
    v_accvgpr_read_b32 v55, a171
    v_accvgpr_read_b32 v56, a172
    v_accvgpr_read_b32 v57, a173
    v_accvgpr_read_b32 v58, a174
    v_accvgpr_read_b32 v59, a175
    v_mfma_f32_16x16x32_bf16 a[148:151], a[8:11], v[112:115], a[148:151]
    v_mul_f32 v52, v52, v99
    v_mul_f32 v53, v53, v99
    v_mul_f32 v54, v54, v99
    v_mul_f32 v55, v55, v99
    v_mul_f32 v56, v56, v99
    v_mfma_f32_16x16x32_bf16 a[148:151], a[12:15], v[116:119], a[148:151]
    v_mul_f32 v57, v57, v99
    v_mul_f32 v58, v58, v99
    v_mul_f32 v59, v59, v99
    v_cvt_pk_bf16_f32 v60, v52, v53
    v_cvt_pk_bf16_f32 v61, v54, v55
    v_mfma_f32_16x16x32_bf16 a[180:183], a[8:11], v[120:123], a[180:183]
    v_cvt_pk_bf16_f32 v62, v56, v57
    v_cvt_pk_bf16_f32 v63, v58, v59
    buffer_store_dwordx4 v[60:63], v111, s[20:23], s39 offen offset:1024 sc1
    v_accvgpr_read_b32 v16, a80
    v_accvgpr_read_b32 v17, a81
    v_mfma_f32_16x16x32_bf16 a[180:183], a[12:15], v[124:127], a[180:183]
    s_waitcnt lgkmcnt(4)
    v_accvgpr_read_b32 v18, a82
    v_accvgpr_read_b32 v19, a83
    v_accvgpr_read_b32 v20, a84
    v_accvgpr_read_b32 v21, a85
    v_accvgpr_read_b32 v22, a86
    v_mfma_f32_16x16x32_bf16 a[88:91], a[16:19], v[240:243], a[88:91]
    v_accvgpr_read_b32 v23, a87
    v_mul_f32 v16, v16, v96
    v_mul_f32 v17, v17, v96
    v_mul_f32 v18, v18, v96
    v_mul_f32 v19, v19, v96
    v_mfma_f32_16x16x32_bf16 a[88:91], a[20:23], v[244:247], a[88:91]
    v_mul_f32 v20, v20, v96
    v_mul_f32 v21, v21, v96
    v_mul_f32 v22, v22, v96
    v_mul_f32 v23, v23, v96
    v_cvt_pk_bf16_f32 v24, v16, v17
    v_mfma_f32_16x16x32_bf16 a[120:123], a[16:19], v[248:251], a[120:123]
    v_cvt_pk_bf16_f32 v25, v18, v19
    v_cvt_pk_bf16_f32 v26, v20, v21
    v_cvt_pk_bf16_f32 v27, v22, v23
    buffer_store_dwordx4 v[24:27], v108, s[20:23], s39 offen offset:2048 sc1
    v_accvgpr_read_b32 v28, a112
    v_mfma_f32_16x16x32_bf16 a[120:123], a[20:23], v[252:255], a[120:123]
    v_accvgpr_read_b32 v29, a113
    v_accvgpr_read_b32 v30, a114
    v_accvgpr_read_b32 v31, a115
    v_accvgpr_read_b32 v32, a116
    v_accvgpr_read_b32 v33, a117
    v_mfma_f32_16x16x32_bf16 a[152:155], a[16:19], v[112:115], a[152:155]
    v_accvgpr_read_b32 v34, a118
    v_accvgpr_read_b32 v35, a119
    v_mul_f32 v28, v28, v97
    v_mul_f32 v29, v29, v97
    v_mul_f32 v30, v30, v97
    v_mfma_f32_16x16x32_bf16 a[152:155], a[20:23], v[116:119], a[152:155]
    v_mul_f32 v31, v31, v97
    v_mul_f32 v32, v32, v97
    v_mul_f32 v33, v33, v97
    v_mul_f32 v34, v34, v97
    v_mul_f32 v35, v35, v97
    v_mfma_f32_16x16x32_bf16 a[184:187], a[16:19], v[120:123], a[184:187]
    v_cvt_pk_bf16_f32 v36, v28, v29
    v_cvt_pk_bf16_f32 v37, v30, v31
    v_cvt_pk_bf16_f32 v38, v32, v33
    v_cvt_pk_bf16_f32 v39, v34, v35
    buffer_store_dwordx4 v[36:39], v109, s[20:23], s39 offen offset:2048 sc1
    v_mfma_f32_16x16x32_bf16 a[184:187], a[20:23], v[124:127], a[184:187]
    s_waitcnt lgkmcnt(0)
    v_accvgpr_read_b32 v40, a144
    v_accvgpr_read_b32 v41, a145
    v_accvgpr_read_b32 v42, a146
    v_accvgpr_read_b32 v43, a147
    v_accvgpr_read_b32 v44, a148
    v_mfma_f32_16x16x32_bf16 a[92:95], a[24:27], v[240:243], a[92:95]
    v_accvgpr_read_b32 v45, a149
    v_accvgpr_read_b32 v46, a150
    v_accvgpr_read_b32 v47, a151
    v_mul_f32 v40, v40, v98
    v_mul_f32 v41, v41, v98
    v_mfma_f32_16x16x32_bf16 a[92:95], a[28:31], v[244:247], a[92:95]
    v_mul_f32 v42, v42, v98
    v_mul_f32 v43, v43, v98
    v_mul_f32 v44, v44, v98
    v_mul_f32 v45, v45, v98
    v_mul_f32 v46, v46, v98
    v_mfma_f32_16x16x32_bf16 a[124:127], a[24:27], v[248:251], a[124:127]
    v_mul_f32 v47, v47, v98
    v_cvt_pk_bf16_f32 v48, v40, v41
    v_cvt_pk_bf16_f32 v49, v42, v43
    v_cvt_pk_bf16_f32 v50, v44, v45
    v_cvt_pk_bf16_f32 v51, v46, v47
    v_mfma_f32_16x16x32_bf16 a[124:127], a[28:31], v[252:255], a[124:127]
    buffer_store_dwordx4 v[48:51], v110, s[20:23], s39 offen offset:2048 sc1
    v_accvgpr_read_b32 v52, a176
    v_accvgpr_read_b32 v53, a177
    v_accvgpr_read_b32 v54, a178
    v_accvgpr_read_b32 v55, a179
    v_mfma_f32_16x16x32_bf16 a[156:159], a[24:27], v[112:115], a[156:159]
    v_accvgpr_read_b32 v56, a180
    v_accvgpr_read_b32 v57, a181
    v_accvgpr_read_b32 v58, a182
    v_accvgpr_read_b32 v59, a183
    v_mul_f32 v52, v52, v99
    v_mfma_f32_16x16x32_bf16 a[156:159], a[28:31], v[116:119], a[156:159]
    v_mul_f32 v53, v53, v99
    v_mul_f32 v54, v54, v99
    v_mul_f32 v55, v55, v99
    v_mul_f32 v56, v56, v99
    v_mul_f32 v57, v57, v99
    v_mfma_f32_16x16x32_bf16 a[188:191], a[24:27], v[120:123], a[188:191]
    v_mul_f32 v58, v58, v99
    v_mul_f32 v59, v59, v99
    v_cvt_pk_bf16_f32 v60, v52, v53
    v_cvt_pk_bf16_f32 v61, v54, v55
    v_cvt_pk_bf16_f32 v62, v56, v57
    v_mfma_f32_16x16x32_bf16 a[188:191], a[28:31], v[124:127], a[188:191]
    v_cvt_pk_bf16_f32 v63, v58, v59
    buffer_store_dwordx4 v[60:63], v111, s[20:23], s39 offen offset:2048 sc1
    v_accvgpr_read_b32 v16, a88
    v_accvgpr_read_b32 v17, a89
    v_accvgpr_read_b32 v18, a90
    s_nop 7
    v_accvgpr_read_b32 v19, a91
    v_accvgpr_read_b32 v20, a92
    v_accvgpr_read_b32 v21, a93
    v_accvgpr_read_b32 v22, a94
    v_accvgpr_read_b32 v23, a95
    v_mul_f32 v16, v16, v96
    v_mul_f32 v17, v17, v96
    v_mul_f32 v18, v18, v96
    v_mul_f32 v19, v19, v96
    v_mul_f32 v20, v20, v96
    v_mul_f32 v21, v21, v96
    v_mul_f32 v22, v22, v96
    v_mul_f32 v23, v23, v96
    v_cvt_pk_bf16_f32 v24, v16, v17
    v_cvt_pk_bf16_f32 v25, v18, v19
    v_cvt_pk_bf16_f32 v26, v20, v21
    v_cvt_pk_bf16_f32 v27, v22, v23
    buffer_store_dwordx4 v[24:27], v108, s[20:23], s39 offen offset:3072 sc1
    v_accvgpr_read_b32 v28, a120
    v_accvgpr_read_b32 v29, a121
    v_accvgpr_read_b32 v30, a122
    v_accvgpr_read_b32 v31, a123
    v_accvgpr_read_b32 v32, a124
    v_accvgpr_read_b32 v33, a125
    v_accvgpr_read_b32 v34, a126
    v_accvgpr_read_b32 v35, a127
    v_mul_f32 v28, v28, v97
    v_mul_f32 v29, v29, v97
    v_mul_f32 v30, v30, v97
    v_mul_f32 v31, v31, v97
    v_mul_f32 v32, v32, v97
    v_mul_f32 v33, v33, v97
    v_mul_f32 v34, v34, v97
    v_mul_f32 v35, v35, v97
    v_cvt_pk_bf16_f32 v36, v28, v29
    v_cvt_pk_bf16_f32 v37, v30, v31
    v_cvt_pk_bf16_f32 v38, v32, v33
    v_cvt_pk_bf16_f32 v39, v34, v35
    buffer_store_dwordx4 v[36:39], v109, s[20:23], s39 offen offset:3072 sc1
    v_accvgpr_read_b32 v40, a152
    v_accvgpr_read_b32 v41, a153
    v_accvgpr_read_b32 v42, a154
    v_accvgpr_read_b32 v43, a155
    v_accvgpr_read_b32 v44, a156
    v_accvgpr_read_b32 v45, a157
    v_accvgpr_read_b32 v46, a158
    v_accvgpr_read_b32 v47, a159
    v_mul_f32 v40, v40, v98
    v_mul_f32 v41, v41, v98
    v_mul_f32 v42, v42, v98
    v_mul_f32 v43, v43, v98
    v_mul_f32 v44, v44, v98
    v_mul_f32 v45, v45, v98
    v_mul_f32 v46, v46, v98
    v_mul_f32 v47, v47, v98
    v_cvt_pk_bf16_f32 v48, v40, v41
    v_cvt_pk_bf16_f32 v49, v42, v43
    v_cvt_pk_bf16_f32 v50, v44, v45
    v_cvt_pk_bf16_f32 v51, v46, v47
    buffer_store_dwordx4 v[48:51], v110, s[20:23], s39 offen offset:3072 sc1
    v_accvgpr_read_b32 v52, a184
    v_accvgpr_read_b32 v53, a185
    v_accvgpr_read_b32 v54, a186
    v_accvgpr_read_b32 v55, a187
    v_accvgpr_read_b32 v56, a188
    v_accvgpr_read_b32 v57, a189
    v_accvgpr_read_b32 v58, a190
    v_accvgpr_read_b32 v59, a191
    v_mul_f32 v52, v52, v99
    v_mul_f32 v53, v53, v99
    v_mul_f32 v54, v54, v99
    v_mul_f32 v55, v55, v99
    v_mul_f32 v56, v56, v99
    v_mul_f32 v57, v57, v99
    v_mul_f32 v58, v58, v99
    v_mul_f32 v59, v59, v99
    v_cvt_pk_bf16_f32 v60, v52, v53
    v_cvt_pk_bf16_f32 v61, v54, v55
    v_cvt_pk_bf16_f32 v62, v56, v57
    v_cvt_pk_bf16_f32 v63, v58, v59
    buffer_store_dwordx4 v[60:63], v111, s[20:23], s39 offen offset:3072 sc1
    s_cbranch_vccz L_noflag
    v_mov_b32 v104, 163808
    v_mov_b32 v105, 1
    ds_write_b32 v104, v105
L_noflag:
    s_waitcnt lgkmcnt(0)
    s_barrier
    v_mov_b32 v104, 163808
    ds_read_b32 v105, v104
    s_waitcnt lgkmcnt(0)
    v_readfirstlane_b32 s38, v105
    s_cmp_lg_u32 s38, 0
    s_cbranch_scc1 L_slow
L_k1_fin:
L_k1_done:
    s_endpgm
.section .rodata,"a"
.p2align 6
.amdhsa_kernel attn_kernel
  .amdhsa_next_free_vgpr 512
  .amdhsa_next_free_sgpr 80
  .amdhsa_accum_offset 256
  .amdhsa_group_segment_fixed_size 0
  .amdhsa_kernarg_size 96
  .amdhsa_user_sgpr_count 2
  .amdhsa_user_sgpr_kernarg_segment_ptr 1
  .amdhsa_system_sgpr_workgroup_id_x 1
  .amdhsa_float_denorm_mode_32 3
.end_amdhsa_kernel
.text

.text
.globl outp_kernel
.p2align 8
.type outp_kernel,@function
outp_kernel:

    s_cmp_ge_u32 s2, 256
    s_cbranch_scc1 L_k2_done
    s_load_dwordx2 s[44:45], s[0:1], 88
    s_load_dwordx2 s[20:21], s[0:1], 0
    s_load_dwordx2 s[52:53], s[0:1], 72
    v_lshrrev_b32 v1, 6, v0
    v_and_b32 v0, 63, v0
    v_readfirstlane_b32 s24, v1
    v_lshlrev_b32 v2, 4, v0
    s_and_b32 s33, s2, 1
    s_xor_b32 s33, s33, 1
    s_lshl_b32 s33, s33, 1
    s_bfe_u32 s25, s2, 65538
    s_add_u32 s25, s25, s33
    s_bfe_u32 s32, s2, 65537
    s_lshl_b32 s32, s32, 3
    s_bfe_u32 s33, s2, 0x30003
    s_add_u32 s26, s32, s33
    s_lshr_b32 s27, s2, 6
    s_mul_i32 s31, s24, 9216
    s_and_b32 s34, s25, 1
    s_cmp_lt_u32 s25, 2
    s_cselect_b32 s36, 16, 18
    s_cselect_b32 s48, 6, 1
    s_cselect_b32 s46, 6291456, 0
    s_cselect_b32 s47, 0, 0
    s_lshl_b32 s47, s47, 8
    s_lshl_b32 s48, s48, 22
    s_lshl_b32 s35, s36, 13
    s_add_u32 s35, s35, s47
    s_mul_i32 s49, s36, 147456
    s_mul_i32 s32, s49, s34
    s_add_u32 s46, s46, s32
    s_mul_i32 s32, s24, 36864
    s_mul_i32 s33, s27, 9216
    s_add_u32 s32, s32, s33
    s_add_u32 s46, s46, s32
    s_add_u32 s46, s46, 46134272
    s_add_u32 s6, s49, 4096
    s_mov_b32 s7, 0x20000
    s_xor_b32 s32, s25, 1
    s_lshl_b32 s32, s32, 10
    v_add_u32 v18, s32, v2
    v_add_u32 v9, 3072, v18
    v_add_u32 v10, 6144, v18
    s_xor_b32 s32, s25, 2
    s_lshl_b32 s32, s32, 10
    v_add_u32 v18, s32, v2
    v_add_u32 v11, 1024, v18
    v_add_u32 v12, 4096, v18
    s_xor_b32 s32, s25, 3
    s_lshl_b32 s32, s32, 10
    v_add_u32 v18, s32, v2
    v_add_u32 v13, 3072, v18
    v_add_u32 v14, 6144, v18
    v_add_u32 v15, 9216, v2
    s_xor_b32 s32, s25, 0
    s_lshl_b32 s32, s32, 10
    v_add_u32 v18, s32, v2
    v_add_u32 v16, 0, v18
    v_add_u32 v17, 7168, v18
    s_lshl_b32 s49, s36, 12
    s_lshl_b32 s32, s26, 3
    s_lshl_b32 s33, s24, 1
    s_add_u32 s32, s32, s33
    s_mul_i32 s32, s32, s35
    s_mul_i32 s33, s49, s34
    s_add_u32 s32, s32, s33
    s_add_u32 s32, s32, s48
    s_add_u32 s10, s35, s49
    s_mov_b32 s11, 0x20000
    v_add_u32 v8, s35, v2
    s_mov_b32 s29, 0
    s_mov_b32 s30, 0
    s_waitcnt lgkmcnt(0)
    s_add_u32 s4, s44, s46
    s_addc_u32 s5, s45, 0
    s_and_b32 s5, s5, 0xffff
    s_add_u32 s8, s44, s32
    s_addc_u32 s9, s45, 0
    s_and_b32 s9, s9, 0xffff
    s_cmp_lt_u32 s25, 2
    s_cbranch_scc1 L_k2_s
    s_add_u32 m0, s31, 0
    s_nop 0
    buffer_load_dwordx4 v9, s[4:7], s29 offen offset:0 lds
    buffer_load_dwordx4 v10, s[4:7], s29 offen offset:1024 lds
    buffer_load_dwordx4 v11, s[4:7], s29 offen offset:2048 lds
    buffer_load_dwordx4 v12, s[4:7], s29 offen offset:3072 lds
    s_add_u32 m0, s31, 4096
    s_nop 0
    buffer_load_dwordx4 v13, s[4:7], s29 offen offset:0 lds
    buffer_load_dwordx4 v14, s[4:7], s29 offen offset:1024 lds
    buffer_load_dwordx4 v15, s[4:7], s29 offen offset:2048 lds
    buffer_load_dwordx4 v16, s[4:7], s29 offen offset:3072 lds
    s_add_u32 m0, s31, 8192
    s_nop 0
    buffer_load_dwordx4 v17, s[4:7], s29 offen offset:0 lds
    s_add_u32 s29, s29, 147456
    buffer_load_dwordx4 a[0:3], v2, s[8:11], s30 offen offset:0
    buffer_load_dwordx4 a[4:7], v2, s[8:11], s30 offen offset:1024
    buffer_load_dwordx4 a[8:11], v2, s[8:11], s30 offen offset:2048
    buffer_load_dwordx4 a[12:15], v2, s[8:11], s30 offen offset:3072
    buffer_load_dwordx4 a[16:19], v8, s[8:11], s30 offen offset:0
    buffer_load_dwordx4 a[20:23], v8, s[8:11], s30 offen offset:1024
    buffer_load_dwordx4 a[24:27], v8, s[8:11], s30 offen offset:2048
    buffer_load_dwordx4 a[28:31], v8, s[8:11], s30 offen offset:3072
    s_add_u32 s30, s30, 4096
    v_add_u32 v3, 0, v2
    v_add_u32 v4, 36864, v2
    v_add_u32 v5, 73728, v2
    v_add_u32 v6, 110592, v2
    v_lshrrev_b32 v18, 4, v0
    v_and_b32 v19, 15, v0
    v_mul_u32_u24 v19, 1152, v19
    v_lshl_add_u32 v7, v18, 3, v19
    s_lshl_b32 s39, s26, 2
    s_add_u32 s39, s39, s27
    s_lshl_b32 s39, s39, 2
    s_add_u32 s39, s39, s24
    s_mul_i32 s39, s39, 28672
    s_add_u32 s39, s39, 58720256
    s_add_u32 s16, s44, s39
    s_addc_u32 s17, s45, 0
    s_and_b32 s17, s17, 0xffff
    s_mov_b32 s18, 28672
    s_mov_b32 s19, 0x20000
    s_mov_b32 s12, s16
    s_mov_b32 s13, s17
    s_lshr_b32 s14, s25, 1
    s_mul_i32 s14, s14, 28672
    s_mov_b32 s15, 0x20000
    s_xor_b32 s32, s25, 1
    s_mul_i32 s32, s32, 6144
    s_add_u32 s56, s32, 0
    s_xor_b32 s32, s25, 2
    s_mul_i32 s32, s32, 6144
    s_add_u32 s57, s32, 2048
    s_xor_b32 s32, s25, 3
    s_mul_i32 s32, s32, 6144
    s_add_u32 s58, s32, 4096
    s_lshl_b32 s59, s25, 10
    s_add_u32 s59, s59, 24576
    s_mul_i32 s60, s25, 6144
    s_lshl_b32 s34, s26, 2
    s_add_u32 s34, s34, s24
    s_mul_i32 s34, s34, 36864
    s_mul_i32 s32, s27, 288
    s_add_u32 s34, s34, s32
    s_lshl_b32 s32, s25, 5
    s_add_u32 s61, s34, s32
    s_add_u32 s62, s61, 18432
    s_and_b32 s32, s25, 1
    s_mul_i32 s40, s32, 18432
    s_add_u32 s40, s40, s34
    s_lshl_b32 s41, s32, 3
    s_add_u32 s41, s41, 24576
    s_mov_b32 s63, 0xffff0000
    s_getpc_b64 s[46:47]
L_k2_pc0:
    s_add_u32 s46, s46, L_k2_post-L_k2_pc0
    s_addc_u32 s47, s47, 0
    v_and_b32 v18, 15, v0
    s_lshl_b32 s32, s24, 4
    v_add_u32 v18, s32, v18
    v_lshlrev_b32 v18, 7, v18
    s_mov_b32 s48, L_k2_done-L_k2_post
    v_min_u32 v18, s48, v18
    v_mov_b32 v19, 0
    s_cmp_lt_u32 s2, 32
    s_cselect_b32 s49, 1, -1
    v_mov_b32 v202, s46
    v_mov_b32 v203, s47
    v_lshl_add_u64 v[200:201], v[18:19], 0, v[202:203]
    s_and_b32 s21, s21, 0xffff
    s_mov_b32 s22, 2359296
    s_mov_b32 s23, 0x20000
    s_and_b32 s53, s53, 0xffff
    s_mov_b32 s54, 2359296
    s_mov_b32 s55, 0x20000
    s_waitcnt vmcnt(8)
    s_barrier
    ds_read_b128 v[20:23], v3 offset:0
    ds_read_b128 v[24:27], v3 offset:9216
    ds_read_b128 v[28:31], v3 offset:18432
    ds_read_b128 v[32:35], v3 offset:27648
    ds_read_b128 v[36:39], v3 offset:1024
    ds_read_b128 v[40:43], v3 offset:10240
    ds_read_b128 v[44:47], v3 offset:19456
    ds_read_b128 v[48:51], v3 offset:28672
    s_add_u32 m0, s31, 36864
    s_nop 0
    buffer_load_dwordx4 v9, s[4:7], s29 offen offset:0 lds
    buffer_load_dwordx4 v10, s[4:7], s29 offen offset:1024 lds
    buffer_load_dwordx4 v11, s[4:7], s29 offen offset:2048 lds
    buffer_load_dwordx4 v12, s[4:7], s29 offen offset:3072 lds
    s_add_u32 m0, s31, 40960
    s_nop 0
    buffer_load_dwordx4 v13, s[4:7], s29 offen offset:0 lds
    buffer_load_dwordx4 v14, s[4:7], s29 offen offset:1024 lds
    buffer_load_dwordx4 v15, s[4:7], s29 offen offset:2048 lds
    buffer_load_dwordx4 v16, s[4:7], s29 offen offset:3072 lds
    s_add_u32 m0, s31, 45056
    s_nop 0
    buffer_load_dwordx4 v17, s[4:7], s29 offen offset:0 lds
    s_add_u32 s29, s29, 147456
    buffer_load_dwordx4 a[32:35], v2, s[8:11], s30 offen offset:0
    buffer_load_dwordx4 a[36:39], v2, s[8:11], s30 offen offset:1024
    buffer_load_dwordx4 a[40:43], v2, s[8:11], s30 offen offset:2048
    buffer_load_dwordx4 a[44:47], v2, s[8:11], s30 offen offset:3072
    buffer_load_dwordx4 a[48:51], v8, s[8:11], s30 offen offset:0
    buffer_load_dwordx4 a[52:55], v8, s[8:11], s30 offen offset:1024
    buffer_load_dwordx4 a[56:59], v8, s[8:11], s30 offen offset:2048
    buffer_load_dwordx4 a[60:63], v8, s[8:11], s30 offen offset:3072
    s_add_u32 s30, s30, 4096
    s_waitcnt vmcnt(17) lgkmcnt(4)
    v_mfma_f32_16x16x32_bf16 v[68:71], v[20:23], a[0:3], 0
    s_add_u32 m0, s31, 73728
    ds_read_b128 v[52:55], v3 offset:2048
    v_mfma_f32_16x16x32_bf16 v[68:71], v[24:27], a[4:7], v[68:71]
    buffer_load_dwordx4 v9, s[4:7], s29 offen offset:0 lds
    v_mfma_f32_16x16x32_bf16 v[68:71], v[28:31], a[8:11], v[68:71]
    ds_read_b128 v[56:59], v3 offset:11264
    v_mfma_f32_16x16x32_bf16 v[68:71], v[32:35], a[12:15], v[68:71]
    buffer_load_dwordx4 v10, s[4:7], s29 offen offset:1024 lds
    v_mfma_f32_16x16x32_bf16 v[72:75], v[20:23], a[16:19], 0
    ds_read_b128 v[60:63], v3 offset:20480
    v_mfma_f32_16x16x32_bf16 v[72:75], v[24:27], a[20:23], v[72:75]
    buffer_load_dwordx4 v11, s[4:7], s29 offen offset:2048 lds
    v_mfma_f32_16x16x32_bf16 v[72:75], v[28:31], a[24:27], v[72:75]
    ds_read_b128 v[64:67], v3 offset:29696
    v_mfma_f32_16x16x32_bf16 v[72:75], v[32:35], a[28:31], v[72:75]
    s_waitcnt lgkmcnt(4)
    buffer_load_dwordx4 v12, s[4:7], s29 offen offset:3072 lds
    v_mfma_f32_16x16x32_bf16 v[76:79], v[36:39], a[0:3], 0
    s_add_u32 m0, s31, 77824
    ds_read_b128 v[20:23], v3 offset:3072
    v_mfma_f32_16x16x32_bf16 v[76:79], v[40:43], a[4:7], v[76:79]
    buffer_load_dwordx4 v13, s[4:7], s29 offen offset:0 lds
    v_mfma_f32_16x16x32_bf16 v[76:79], v[44:47], a[8:11], v[76:79]
    ds_read_b128 v[24:27], v3 offset:12288
    v_mfma_f32_16x16x32_bf16 v[76:79], v[48:51], a[12:15], v[76:79]
    buffer_load_dwordx4 v14, s[4:7], s29 offen offset:1024 lds
    v_mfma_f32_16x16x32_bf16 v[80:83], v[36:39], a[16:19], 0
    ds_read_b128 v[28:31], v3 offset:21504
    v_mfma_f32_16x16x32_bf16 v[80:83], v[40:43], a[20:23], v[80:83]
    buffer_load_dwordx4 v15, s[4:7], s29 offen offset:2048 lds
    v_mfma_f32_16x16x32_bf16 v[80:83], v[44:47], a[24:27], v[80:83]
    ds_read_b128 v[32:35], v3 offset:30720
    v_mfma_f32_16x16x32_bf16 v[80:83], v[48:51], a[28:31], v[80:83]
    s_waitcnt lgkmcnt(4)
    buffer_load_dwordx4 v16, s[4:7], s29 offen offset:3072 lds
    v_mfma_f32_16x16x32_bf16 v[84:87], v[52:55], a[0:3], 0
    s_add_u32 m0, s31, 81920
    ds_read_b128 v[36:39], v3 offset:4096
    v_mfma_f32_16x16x32_bf16 v[84:87], v[56:59], a[4:7], v[84:87]
    buffer_load_dwordx4 v17, s[4:7], s29 offen offset:0 lds
    v_mfma_f32_16x16x32_bf16 v[84:87], v[60:63], a[8:11], v[84:87]
    s_add_u32 s29, s29, 147456
    ds_read_b128 v[40:43], v3 offset:13312
    v_mfma_f32_16x16x32_bf16 v[84:87], v[64:67], a[12:15], v[84:87]
    buffer_load_dwordx4 a[64:67], v2, s[8:11], s30 offen offset:0
    v_mfma_f32_16x16x32_bf16 v[88:91], v[52:55], a[16:19], 0
    ds_read_b128 v[44:47], v3 offset:22528
    v_mfma_f32_16x16x32_bf16 v[88:91], v[56:59], a[20:23], v[88:91]
    buffer_load_dwordx4 a[68:71], v2, s[8:11], s30 offen offset:1024
    v_mfma_f32_16x16x32_bf16 v[88:91], v[60:63], a[24:27], v[88:91]
    ds_read_b128 v[48:51], v3 offset:31744
    v_mfma_f32_16x16x32_bf16 v[88:91], v[64:67], a[28:31], v[88:91]
    s_waitcnt lgkmcnt(4)
    buffer_load_dwordx4 a[72:75], v2, s[8:11], s30 offen offset:2048
    v_mfma_f32_16x16x32_bf16 v[92:95], v[20:23], a[0:3], 0
    ds_read_b128 v[52:55], v3 offset:5120
    v_mfma_f32_16x16x32_bf16 v[92:95], v[24:27], a[4:7], v[92:95]
    buffer_load_dwordx4 a[76:79], v2, s[8:11], s30 offen offset:3072
    v_mfma_f32_16x16x32_bf16 v[92:95], v[28:31], a[8:11], v[92:95]
    ds_read_b128 v[56:59], v3 offset:14336
    v_mfma_f32_16x16x32_bf16 v[92:95], v[32:35], a[12:15], v[92:95]
    buffer_load_dwordx4 a[80:83], v8, s[8:11], s30 offen offset:0
    v_mfma_f32_16x16x32_bf16 v[96:99], v[20:23], a[16:19], 0
    ds_read_b128 v[60:63], v3 offset:23552
    v_mfma_f32_16x16x32_bf16 v[96:99], v[24:27], a[20:23], v[96:99]
    buffer_load_dwordx4 a[84:87], v8, s[8:11], s30 offen offset:1024
    v_mfma_f32_16x16x32_bf16 v[96:99], v[28:31], a[24:27], v[96:99]
    ds_read_b128 v[64:67], v3 offset:32768
    v_mfma_f32_16x16x32_bf16 v[96:99], v[32:35], a[28:31], v[96:99]
    s_waitcnt lgkmcnt(4)
    buffer_load_dwordx4 a[88:91], v8, s[8:11], s30 offen offset:2048
    v_mfma_f32_16x16x32_bf16 v[100:103], v[36:39], a[0:3], 0
    ds_read_b128 v[20:23], v3 offset:6144
    v_mfma_f32_16x16x32_bf16 v[100:103], v[40:43], a[4:7], v[100:103]
    buffer_load_dwordx4 a[92:95], v8, s[8:11], s30 offen offset:3072
    v_mfma_f32_16x16x32_bf16 v[100:103], v[44:47], a[8:11], v[100:103]
    s_add_u32 s30, s30, 4096
    s_add_u32 m0, s31, 110592
    ds_read_b128 v[24:27], v3 offset:15360
    v_mfma_f32_16x16x32_bf16 v[100:103], v[48:51], a[12:15], v[100:103]
    buffer_load_dwordx4 v9, s[4:7], s29 offen offset:0 lds
    v_mfma_f32_16x16x32_bf16 v[104:107], v[36:39], a[16:19], 0
    ds_read_b128 v[28:31], v3 offset:24576
    v_mfma_f32_16x16x32_bf16 v[104:107], v[40:43], a[20:23], v[104:107]
    buffer_load_dwordx4 v10, s[4:7], s29 offen offset:1024 lds
    v_mfma_f32_16x16x32_bf16 v[104:107], v[44:47], a[24:27], v[104:107]
    ds_read_b128 v[32:35], v3 offset:33792
    v_mfma_f32_16x16x32_bf16 v[104:107], v[48:51], a[28:31], v[104:107]
    s_waitcnt lgkmcnt(4)
    buffer_load_dwordx4 v11, s[4:7], s29 offen offset:2048 lds
    v_mfma_f32_16x16x32_bf16 v[108:111], v[52:55], a[0:3], 0
    ds_read_b128 v[36:39], v3 offset:7168
    v_mfma_f32_16x16x32_bf16 v[108:111], v[56:59], a[4:7], v[108:111]
    buffer_load_dwordx4 v12, s[4:7], s29 offen offset:3072 lds
    v_mfma_f32_16x16x32_bf16 v[108:111], v[60:63], a[8:11], v[108:111]
    s_add_u32 m0, s31, 114688
    ds_read_b128 v[40:43], v3 offset:16384
    v_mfma_f32_16x16x32_bf16 v[108:111], v[64:67], a[12:15], v[108:111]
    buffer_load_dwordx4 v13, s[4:7], s29 offen offset:0 lds
    v_mfma_f32_16x16x32_bf16 v[112:115], v[52:55], a[16:19], 0
    ds_read_b128 v[44:47], v3 offset:25600
    v_mfma_f32_16x16x32_bf16 v[112:115], v[56:59], a[20:23], v[112:115]
    buffer_load_dwordx4 v14, s[4:7], s29 offen offset:1024 lds
    v_mfma_f32_16x16x32_bf16 v[112:115], v[60:63], a[24:27], v[112:115]
    ds_read_b128 v[48:51], v3 offset:34816
    v_mfma_f32_16x16x32_bf16 v[112:115], v[64:67], a[28:31], v[112:115]
    s_waitcnt lgkmcnt(4)
    buffer_load_dwordx4 v15, s[4:7], s29 offen offset:2048 lds
    v_mfma_f32_16x16x32_bf16 v[116:119], v[20:23], a[0:3], 0
    ds_read_b128 v[52:55], v3 offset:8192
    v_mfma_f32_16x16x32_bf16 v[116:119], v[24:27], a[4:7], v[116:119]
    ds_read_b128 v[56:59], v3 offset:17408
    v_mfma_f32_16x16x32_bf16 v[116:119], v[28:31], a[8:11], v[116:119]
    ds_read_b128 v[60:63], v3 offset:26624
    v_mfma_f32_16x16x32_bf16 v[116:119], v[32:35], a[12:15], v[116:119]
    ds_read_b128 v[64:67], v3 offset:35840
    v_mfma_f32_16x16x32_bf16 v[120:123], v[20:23], a[16:19], 0
    buffer_load_dwordx4 v16, s[4:7], s29 offen offset:3072 lds
    v_mfma_f32_16x16x32_bf16 v[120:123], v[24:27], a[20:23], v[120:123]
    s_add_u32 m0, s31, 118784
    s_nop 0
    buffer_load_dwordx4 v17, s[4:7], s29 offen offset:0 lds
    v_mfma_f32_16x16x32_bf16 v[120:123], v[28:31], a[24:27], v[120:123]
    s_add_u32 s29, s29, 147456
    buffer_load_dwordx4 a[96:99], v2, s[8:11], s30 offen offset:0
    v_mfma_f32_16x16x32_bf16 v[120:123], v[32:35], a[28:31], v[120:123]
    s_waitcnt lgkmcnt(4)
    buffer_load_dwordx4 a[100:103], v2, s[8:11], s30 offen offset:1024
    v_mfma_f32_16x16x32_bf16 v[124:127], v[36:39], a[0:3], 0
    s_waitcnt vmcnt(36) lgkmcnt(0)
    s_barrier
    v_mfma_f32_16x16x32_bf16 v[124:127], v[40:43], a[4:7], v[124:127]
    ds_read_b128 v[20:23], v4 offset:0
    v_mfma_f32_16x16x32_bf16 v[124:127], v[44:47], a[8:11], v[124:127]
    ds_read_b128 v[24:27], v4 offset:9216
    v_mfma_f32_16x16x32_bf16 v[124:127], v[48:51], a[12:15], v[124:127]
    ds_read_b128 v[28:31], v4 offset:18432
    v_mfma_f32_16x16x32_bf16 v[128:131], v[36:39], a[16:19], 0
    ds_read_b128 v[32:35], v4 offset:27648
    v_mfma_f32_16x16x32_bf16 v[128:131], v[40:43], a[20:23], v[128:131]
    buffer_load_dwordx4 a[104:107], v2, s[8:11], s30 offen offset:2048
    v_mfma_f32_16x16x32_bf16 v[128:131], v[44:47], a[24:27], v[128:131]
    buffer_load_dwordx4 a[108:111], v2, s[8:11], s30 offen offset:3072
    v_mfma_f32_16x16x32_bf16 v[128:131], v[48:51], a[28:31], v[128:131]
    buffer_load_dwordx4 a[112:115], v8, s[8:11], s30 offen offset:0
    v_mfma_f32_16x16x32_bf16 v[132:135], v[52:55], a[0:3], 0
    ds_read_b128 v[36:39], v4 offset:1024
    v_mfma_f32_16x16x32_bf16 v[132:135], v[56:59], a[4:7], v[132:135]
    buffer_load_dwordx4 a[116:119], v8, s[8:11], s30 offen offset:1024
    v_mfma_f32_16x16x32_bf16 v[132:135], v[60:63], a[8:11], v[132:135]
    ds_read_b128 v[40:43], v4 offset:10240
    v_mfma_f32_16x16x32_bf16 v[132:135], v[64:67], a[12:15], v[132:135]
    buffer_load_dwordx4 a[120:123], v8, s[8:11], s30 offen offset:2048
    v_mfma_f32_16x16x32_bf16 v[136:139], v[52:55], a[16:19], 0
    ds_read_b128 v[44:47], v4 offset:19456
    v_mfma_f32_16x16x32_bf16 v[136:139], v[56:59], a[20:23], v[136:139]
    buffer_load_dwordx4 a[124:127], v8, s[8:11], s30 offen offset:3072
    v_mfma_f32_16x16x32_bf16 v[136:139], v[60:63], a[24:27], v[136:139]
    s_waitcnt vmcnt(34)
    ds_read_b128 v[48:51], v4 offset:28672
    v_mfma_f32_16x16x32_bf16 v[136:139], v[64:67], a[28:31], v[136:139]
    s_waitcnt lgkmcnt(4)
    s_add_u32 s30, s30, 4096
    v_mfma_f32_16x16x32_bf16 v[68:71], v[20:23], a[32:35], v[68:71]
    s_add_u32 m0, s31, 0
    ds_read_b128 v[52:55], v4 offset:2048
    v_mfma_f32_16x16x32_bf16 v[68:71], v[24:27], a[36:39], v[68:71]
    buffer_load_dwordx4 v9, s[4:7], s29 offen offset:0 lds
    v_mfma_f32_16x16x32_bf16 v[68:71], v[28:31], a[40:43], v[68:71]
    ds_read_b128 v[56:59], v4 offset:11264
    v_mfma_f32_16x16x32_bf16 v[68:71], v[32:35], a[44:47], v[68:71]
    v_mfma_f32_16x16x32_bf16 v[72:75], v[20:23], a[48:51], v[72:75]
    ds_read_b128 v[60:63], v4 offset:20480
    v_mfma_f32_16x16x32_bf16 v[72:75], v[24:27], a[52:55], v[72:75]
    buffer_load_dwordx4 v10, s[4:7], s29 offen offset:1024 lds
    v_mfma_f32_16x16x32_bf16 v[72:75], v[28:31], a[56:59], v[72:75]
    ds_read_b128 v[64:67], v4 offset:29696
    v_mfma_f32_16x16x32_bf16 v[72:75], v[32:35], a[60:63], v[72:75]
    s_waitcnt lgkmcnt(4)
    v_mfma_f32_16x16x32_bf16 v[76:79], v[36:39], a[32:35], v[76:79]
    ds_read_b128 v[20:23], v4 offset:3072
    v_mfma_f32_16x16x32_bf16 v[76:79], v[40:43], a[36:39], v[76:79]
    buffer_load_dwordx4 v11, s[4:7], s29 offen offset:2048 lds
    v_mfma_f32_16x16x32_bf16 v[76:79], v[44:47], a[40:43], v[76:79]
    ds_read_b128 v[24:27], v4 offset:12288
    v_mfma_f32_16x16x32_bf16 v[76:79], v[48:51], a[44:47], v[76:79]
    v_mfma_f32_16x16x32_bf16 v[80:83], v[36:39], a[48:51], v[80:83]
    ds_read_b128 v[28:31], v4 offset:21504
    v_mfma_f32_16x16x32_bf16 v[80:83], v[40:43], a[52:55], v[80:83]
    buffer_load_dwordx4 v12, s[4:7], s29 offen offset:3072 lds
    v_mfma_f32_16x16x32_bf16 v[80:83], v[44:47], a[56:59], v[80:83]
    s_add_u32 m0, s31, 4096
    ds_read_b128 v[32:35], v4 offset:30720
    v_mfma_f32_16x16x32_bf16 v[80:83], v[48:51], a[60:63], v[80:83]
    s_waitcnt lgkmcnt(4)
    v_mfma_f32_16x16x32_bf16 v[84:87], v[52:55], a[32:35], v[84:87]
    ds_read_b128 v[36:39], v4 offset:4096
    v_mfma_f32_16x16x32_bf16 v[84:87], v[56:59], a[36:39], v[84:87]
    buffer_load_dwordx4 v13, s[4:7], s29 offen offset:0 lds
    v_mfma_f32_16x16x32_bf16 v[84:87], v[60:63], a[40:43], v[84:87]
    ds_read_b128 v[40:43], v4 offset:13312
    v_mfma_f32_16x16x32_bf16 v[84:87], v[64:67], a[44:47], v[84:87]
    v_mfma_f32_16x16x32_bf16 v[88:91], v[52:55], a[48:51], v[88:91]
    ds_read_b128 v[44:47], v4 offset:22528
    v_mfma_f32_16x16x32_bf16 v[88:91], v[56:59], a[52:55], v[88:91]
    buffer_load_dwordx4 v14, s[4:7], s29 offen offset:1024 lds
    v_mfma_f32_16x16x32_bf16 v[88:91], v[60:63], a[56:59], v[88:91]
    ds_read_b128 v[48:51], v4 offset:31744
    v_mfma_f32_16x16x32_bf16 v[88:91], v[64:67], a[60:63], v[88:91]
    s_waitcnt lgkmcnt(4)
    v_mfma_f32_16x16x32_bf16 v[92:95], v[20:23], a[32:35], v[92:95]
    ds_read_b128 v[52:55], v4 offset:5120
    v_mfma_f32_16x16x32_bf16 v[92:95], v[24:27], a[36:39], v[92:95]
    buffer_load_dwordx4 v15, s[4:7], s29 offen offset:2048 lds
    v_mfma_f32_16x16x32_bf16 v[92:95], v[28:31], a[40:43], v[92:95]
    ds_read_b128 v[56:59], v4 offset:14336
    v_mfma_f32_16x16x32_bf16 v[92:95], v[32:35], a[44:47], v[92:95]
    v_mfma_f32_16x16x32_bf16 v[96:99], v[20:23], a[48:51], v[96:99]
    ds_read_b128 v[60:63], v4 offset:23552
    v_mfma_f32_16x16x32_bf16 v[96:99], v[24:27], a[52:55], v[96:99]
    buffer_load_dwordx4 v16, s[4:7], s29 offen offset:3072 lds
    v_mfma_f32_16x16x32_bf16 v[96:99], v[28:31], a[56:59], v[96:99]
    s_add_u32 m0, s31, 8192
    ds_read_b128 v[64:67], v4 offset:32768
    v_mfma_f32_16x16x32_bf16 v[96:99], v[32:35], a[60:63], v[96:99]
    s_waitcnt lgkmcnt(4)
    v_mfma_f32_16x16x32_bf16 v[100:103], v[36:39], a[32:35], v[100:103]
    ds_read_b128 v[20:23], v4 offset:6144
    v_mfma_f32_16x16x32_bf16 v[100:103], v[40:43], a[36:39], v[100:103]
    buffer_load_dwordx4 v17, s[4:7], s29 offen offset:0 lds
    v_mfma_f32_16x16x32_bf16 v[100:103], v[44:47], a[40:43], v[100:103]
    s_add_u32 s29, s29, 147456
    ds_read_b128 v[24:27], v4 offset:15360
    v_mfma_f32_16x16x32_bf16 v[100:103], v[48:51], a[44:47], v[100:103]
    v_mfma_f32_16x16x32_bf16 v[104:107], v[36:39], a[48:51], v[104:107]
    ds_read_b128 v[28:31], v4 offset:24576
    v_mfma_f32_16x16x32_bf16 v[104:107], v[40:43], a[52:55], v[104:107]
    buffer_load_dwordx4 a[0:3], v2, s[8:11], s30 offen offset:0
    v_mfma_f32_16x16x32_bf16 v[104:107], v[44:47], a[56:59], v[104:107]
    ds_read_b128 v[32:35], v4 offset:33792
    v_mfma_f32_16x16x32_bf16 v[104:107], v[48:51], a[60:63], v[104:107]
    s_waitcnt lgkmcnt(4)
    v_mfma_f32_16x16x32_bf16 v[108:111], v[52:55], a[32:35], v[108:111]
    ds_read_b128 v[36:39], v4 offset:7168
    v_mfma_f32_16x16x32_bf16 v[108:111], v[56:59], a[36:39], v[108:111]
    buffer_load_dwordx4 a[4:7], v2, s[8:11], s30 offen offset:1024
    v_mfma_f32_16x16x32_bf16 v[108:111], v[60:63], a[40:43], v[108:111]
    ds_read_b128 v[40:43], v4 offset:16384
    v_mfma_f32_16x16x32_bf16 v[108:111], v[64:67], a[44:47], v[108:111]
    v_mfma_f32_16x16x32_bf16 v[112:115], v[52:55], a[48:51], v[112:115]
    ds_read_b128 v[44:47], v4 offset:25600
    v_mfma_f32_16x16x32_bf16 v[112:115], v[56:59], a[52:55], v[112:115]
    buffer_load_dwordx4 a[8:11], v2, s[8:11], s30 offen offset:2048
    v_mfma_f32_16x16x32_bf16 v[112:115], v[60:63], a[56:59], v[112:115]
    ds_read_b128 v[48:51], v4 offset:34816
    v_mfma_f32_16x16x32_bf16 v[112:115], v[64:67], a[60:63], v[112:115]
    s_waitcnt lgkmcnt(4)
    v_mfma_f32_16x16x32_bf16 v[116:119], v[20:23], a[32:35], v[116:119]
    ds_read_b128 v[52:55], v4 offset:8192
    v_mfma_f32_16x16x32_bf16 v[116:119], v[24:27], a[36:39], v[116:119]
    ds_read_b128 v[56:59], v4 offset:17408
    v_mfma_f32_16x16x32_bf16 v[116:119], v[28:31], a[40:43], v[116:119]
    ds_read_b128 v[60:63], v4 offset:26624
    v_mfma_f32_16x16x32_bf16 v[116:119], v[32:35], a[44:47], v[116:119]
    ds_read_b128 v[64:67], v4 offset:35840
    v_mfma_f32_16x16x32_bf16 v[120:123], v[20:23], a[48:51], v[120:123]
    buffer_load_dwordx4 a[12:15], v2, s[8:11], s30 offen offset:3072
    v_mfma_f32_16x16x32_bf16 v[120:123], v[24:27], a[52:55], v[120:123]
    v_mfma_f32_16x16x32_bf16 v[120:123], v[28:31], a[56:59], v[120:123]
    buffer_load_dwordx4 a[16:19], v8, s[8:11], s30 offen offset:0
    v_mfma_f32_16x16x32_bf16 v[120:123], v[32:35], a[60:63], v[120:123]
    s_waitcnt lgkmcnt(4)
    buffer_load_dwordx4 a[20:23], v8, s[8:11], s30 offen offset:1024
    v_mfma_f32_16x16x32_bf16 v[124:127], v[36:39], a[32:35], v[124:127]
    s_waitcnt vmcnt(40) lgkmcnt(0)
    s_barrier
    v_mfma_f32_16x16x32_bf16 v[124:127], v[40:43], a[36:39], v[124:127]
    ds_read_b128 v[20:23], v5 offset:0
    v_mfma_f32_16x16x32_bf16 v[124:127], v[44:47], a[40:43], v[124:127]
    ds_read_b128 v[24:27], v5 offset:9216
    v_mfma_f32_16x16x32_bf16 v[124:127], v[48:51], a[44:47], v[124:127]
    ds_read_b128 v[28:31], v5 offset:18432
    v_mfma_f32_16x16x32_bf16 v[128:131], v[36:39], a[48:51], v[128:131]
    ds_read_b128 v[32:35], v5 offset:27648
    v_mfma_f32_16x16x32_bf16 v[128:131], v[40:43], a[52:55], v[128:131]
    v_mfma_f32_16x16x32_bf16 v[128:131], v[44:47], a[56:59], v[128:131]
    buffer_load_dwordx4 a[24:27], v8, s[8:11], s30 offen offset:2048
    v_mfma_f32_16x16x32_bf16 v[128:131], v[48:51], a[60:63], v[128:131]
    v_mfma_f32_16x16x32_bf16 v[132:135], v[52:55], a[32:35], v[132:135]
    ds_read_b128 v[36:39], v5 offset:1024
    v_mfma_f32_16x16x32_bf16 v[132:135], v[56:59], a[36:39], v[132:135]
    buffer_load_dwordx4 a[28:31], v8, s[8:11], s30 offen offset:3072
    v_mfma_f32_16x16x32_bf16 v[132:135], v[60:63], a[40:43], v[132:135]
    s_add_u32 s30, s30, 4096
    ds_read_b128 v[40:43], v5 offset:10240
    v_mfma_f32_16x16x32_bf16 v[132:135], v[64:67], a[44:47], v[132:135]
    v_mfma_f32_16x16x32_bf16 v[136:139], v[52:55], a[48:51], v[136:139]
    ds_read_b128 v[44:47], v5 offset:19456
    v_mfma_f32_16x16x32_bf16 v[136:139], v[56:59], a[52:55], v[136:139]
    v_mfma_f32_16x16x32_bf16 v[136:139], v[60:63], a[56:59], v[136:139]
    s_waitcnt vmcnt(34)
    ds_read_b128 v[48:51], v5 offset:28672
    v_mfma_f32_16x16x32_bf16 v[136:139], v[64:67], a[60:63], v[136:139]
    s_waitcnt lgkmcnt(4)
    v_mfma_f32_16x16x32_bf16 v[68:71], v[20:23], a[64:67], v[68:71]
    s_add_u32 m0, s31, 36864
    ds_read_b128 v[52:55], v5 offset:2048
    v_mfma_f32_16x16x32_bf16 v[68:71], v[24:27], a[68:71], v[68:71]
    buffer_load_dwordx4 v9, s[4:7], s29 offen offset:0 lds
    v_mfma_f32_16x16x32_bf16 v[68:71], v[28:31], a[72:75], v[68:71]
    ds_read_b128 v[56:59], v5 offset:11264
    v_mfma_f32_16x16x32_bf16 v[68:71], v[32:35], a[76:79], v[68:71]
    v_mfma_f32_16x16x32_bf16 v[72:75], v[20:23], a[80:83], v[72:75]
    ds_read_b128 v[60:63], v5 offset:20480
    v_mfma_f32_16x16x32_bf16 v[72:75], v[24:27], a[84:87], v[72:75]
    buffer_load_dwordx4 v10, s[4:7], s29 offen offset:1024 lds
    v_mfma_f32_16x16x32_bf16 v[72:75], v[28:31], a[88:91], v[72:75]
    ds_read_b128 v[64:67], v5 offset:29696
    v_mfma_f32_16x16x32_bf16 v[72:75], v[32:35], a[92:95], v[72:75]
    s_waitcnt lgkmcnt(4)
    v_mfma_f32_16x16x32_bf16 v[76:79], v[36:39], a[64:67], v[76:79]
    ds_read_b128 v[20:23], v5 offset:3072
    v_mfma_f32_16x16x32_bf16 v[76:79], v[40:43], a[68:71], v[76:79]
    buffer_load_dwordx4 v11, s[4:7], s29 offen offset:2048 lds
    v_mfma_f32_16x16x32_bf16 v[76:79], v[44:47], a[72:75], v[76:79]
    ds_read_b128 v[24:27], v5 offset:12288
    v_mfma_f32_16x16x32_bf16 v[76:79], v[48:51], a[76:79], v[76:79]
    v_mfma_f32_16x16x32_bf16 v[80:83], v[36:39], a[80:83], v[80:83]
    ds_read_b128 v[28:31], v5 offset:21504
    v_mfma_f32_16x16x32_bf16 v[80:83], v[40:43], a[84:87], v[80:83]
    buffer_load_dwordx4 v12, s[4:7], s29 offen offset:3072 lds
    v_mfma_f32_16x16x32_bf16 v[80:83], v[44:47], a[88:91], v[80:83]
    s_add_u32 m0, s31, 40960
    ds_read_b128 v[32:35], v5 offset:30720
    v_mfma_f32_16x16x32_bf16 v[80:83], v[48:51], a[92:95], v[80:83]
    s_waitcnt lgkmcnt(4)
    v_mfma_f32_16x16x32_bf16 v[84:87], v[52:55], a[64:67], v[84:87]
    ds_read_b128 v[36:39], v5 offset:4096
    v_mfma_f32_16x16x32_bf16 v[84:87], v[56:59], a[68:71], v[84:87]
    buffer_load_dwordx4 v13, s[4:7], s29 offen offset:0 lds
    v_mfma_f32_16x16x32_bf16 v[84:87], v[60:63], a[72:75], v[84:87]
    ds_read_b128 v[40:43], v5 offset:13312
    v_mfma_f32_16x16x32_bf16 v[84:87], v[64:67], a[76:79], v[84:87]
    v_mfma_f32_16x16x32_bf16 v[88:91], v[52:55], a[80:83], v[88:91]
    ds_read_b128 v[44:47], v5 offset:22528
    v_mfma_f32_16x16x32_bf16 v[88:91], v[56:59], a[84:87], v[88:91]
    buffer_load_dwordx4 v14, s[4:7], s29 offen offset:1024 lds
    v_mfma_f32_16x16x32_bf16 v[88:91], v[60:63], a[88:91], v[88:91]
    ds_read_b128 v[48:51], v5 offset:31744
    v_mfma_f32_16x16x32_bf16 v[88:91], v[64:67], a[92:95], v[88:91]
    s_waitcnt lgkmcnt(4)
    v_mfma_f32_16x16x32_bf16 v[92:95], v[20:23], a[64:67], v[92:95]
    ds_read_b128 v[52:55], v5 offset:5120
    v_mfma_f32_16x16x32_bf16 v[92:95], v[24:27], a[68:71], v[92:95]
    buffer_load_dwordx4 v15, s[4:7], s29 offen offset:2048 lds
    v_mfma_f32_16x16x32_bf16 v[92:95], v[28:31], a[72:75], v[92:95]
    ds_read_b128 v[56:59], v5 offset:14336
    v_mfma_f32_16x16x32_bf16 v[92:95], v[32:35], a[76:79], v[92:95]
    v_mfma_f32_16x16x32_bf16 v[96:99], v[20:23], a[80:83], v[96:99]
    ds_read_b128 v[60:63], v5 offset:23552
    v_mfma_f32_16x16x32_bf16 v[96:99], v[24:27], a[84:87], v[96:99]
    buffer_load_dwordx4 v16, s[4:7], s29 offen offset:3072 lds
    v_mfma_f32_16x16x32_bf16 v[96:99], v[28:31], a[88:91], v[96:99]
    s_add_u32 m0, s31, 45056
    ds_read_b128 v[64:67], v5 offset:32768
    v_mfma_f32_16x16x32_bf16 v[96:99], v[32:35], a[92:95], v[96:99]
    s_waitcnt lgkmcnt(4)
    v_mfma_f32_16x16x32_bf16 v[100:103], v[36:39], a[64:67], v[100:103]
    ds_read_b128 v[20:23], v5 offset:6144
    v_mfma_f32_16x16x32_bf16 v[100:103], v[40:43], a[68:71], v[100:103]
    buffer_load_dwordx4 v17, s[4:7], s29 offen offset:0 lds
    v_mfma_f32_16x16x32_bf16 v[100:103], v[44:47], a[72:75], v[100:103]
    s_add_u32 s29, s29, 147456
    ds_read_b128 v[24:27], v5 offset:15360
    v_mfma_f32_16x16x32_bf16 v[100:103], v[48:51], a[76:79], v[100:103]
    v_mfma_f32_16x16x32_bf16 v[104:107], v[36:39], a[80:83], v[104:107]
    ds_read_b128 v[28:31], v5 offset:24576
    v_mfma_f32_16x16x32_bf16 v[104:107], v[40:43], a[84:87], v[104:107]
    buffer_load_dwordx4 a[32:35], v2, s[8:11], s30 offen offset:0
    v_mfma_f32_16x16x32_bf16 v[104:107], v[44:47], a[88:91], v[104:107]
    ds_read_b128 v[32:35], v5 offset:33792
    v_mfma_f32_16x16x32_bf16 v[104:107], v[48:51], a[92:95], v[104:107]
    s_waitcnt lgkmcnt(4)
    v_mfma_f32_16x16x32_bf16 v[108:111], v[52:55], a[64:67], v[108:111]
    ds_read_b128 v[36:39], v5 offset:7168
    v_mfma_f32_16x16x32_bf16 v[108:111], v[56:59], a[68:71], v[108:111]
    buffer_load_dwordx4 a[36:39], v2, s[8:11], s30 offen offset:1024
    v_mfma_f32_16x16x32_bf16 v[108:111], v[60:63], a[72:75], v[108:111]
    ds_read_b128 v[40:43], v5 offset:16384
    v_mfma_f32_16x16x32_bf16 v[108:111], v[64:67], a[76:79], v[108:111]
    v_mfma_f32_16x16x32_bf16 v[112:115], v[52:55], a[80:83], v[112:115]
    ds_read_b128 v[44:47], v5 offset:25600
    v_mfma_f32_16x16x32_bf16 v[112:115], v[56:59], a[84:87], v[112:115]
    buffer_load_dwordx4 a[40:43], v2, s[8:11], s30 offen offset:2048
    v_mfma_f32_16x16x32_bf16 v[112:115], v[60:63], a[88:91], v[112:115]
    ds_read_b128 v[48:51], v5 offset:34816
    v_mfma_f32_16x16x32_bf16 v[112:115], v[64:67], a[92:95], v[112:115]
    s_waitcnt lgkmcnt(4)
    v_mfma_f32_16x16x32_bf16 v[116:119], v[20:23], a[64:67], v[116:119]
    ds_read_b128 v[52:55], v5 offset:8192
    v_mfma_f32_16x16x32_bf16 v[116:119], v[24:27], a[68:71], v[116:119]
    ds_read_b128 v[56:59], v5 offset:17408
    v_mfma_f32_16x16x32_bf16 v[116:119], v[28:31], a[72:75], v[116:119]
    ds_read_b128 v[60:63], v5 offset:26624
    v_mfma_f32_16x16x32_bf16 v[116:119], v[32:35], a[76:79], v[116:119]
    ds_read_b128 v[64:67], v5 offset:35840
    v_mfma_f32_16x16x32_bf16 v[120:123], v[20:23], a[80:83], v[120:123]
    buffer_load_dwordx4 a[44:47], v2, s[8:11], s30 offen offset:3072
    v_mfma_f32_16x16x32_bf16 v[120:123], v[24:27], a[84:87], v[120:123]
    v_mfma_f32_16x16x32_bf16 v[120:123], v[28:31], a[88:91], v[120:123]
    buffer_load_dwordx4 a[48:51], v8, s[8:11], s30 offen offset:0
    v_mfma_f32_16x16x32_bf16 v[120:123], v[32:35], a[92:95], v[120:123]
    s_waitcnt lgkmcnt(4)
    buffer_load_dwordx4 a[52:55], v8, s[8:11], s30 offen offset:1024
    v_mfma_f32_16x16x32_bf16 v[124:127], v[36:39], a[64:67], v[124:127]
    s_waitcnt vmcnt(40) lgkmcnt(0)
    s_barrier
    v_mfma_f32_16x16x32_bf16 v[124:127], v[40:43], a[68:71], v[124:127]
    ds_read_b128 v[20:23], v6 offset:0
    v_mfma_f32_16x16x32_bf16 v[124:127], v[44:47], a[72:75], v[124:127]
    ds_read_b128 v[24:27], v6 offset:9216
    v_mfma_f32_16x16x32_bf16 v[124:127], v[48:51], a[76:79], v[124:127]
    ds_read_b128 v[28:31], v6 offset:18432
    v_mfma_f32_16x16x32_bf16 v[128:131], v[36:39], a[80:83], v[128:131]
    ds_read_b128 v[32:35], v6 offset:27648
    v_mfma_f32_16x16x32_bf16 v[128:131], v[40:43], a[84:87], v[128:131]
    v_mfma_f32_16x16x32_bf16 v[128:131], v[44:47], a[88:91], v[128:131]
    buffer_load_dwordx4 a[56:59], v8, s[8:11], s30 offen offset:2048
    v_mfma_f32_16x16x32_bf16 v[128:131], v[48:51], a[92:95], v[128:131]
    v_mfma_f32_16x16x32_bf16 v[132:135], v[52:55], a[64:67], v[132:135]
    ds_read_b128 v[36:39], v6 offset:1024
    v_mfma_f32_16x16x32_bf16 v[132:135], v[56:59], a[68:71], v[132:135]
    buffer_load_dwordx4 a[60:63], v8, s[8:11], s30 offen offset:3072
    v_mfma_f32_16x16x32_bf16 v[132:135], v[60:63], a[72:75], v[132:135]
    s_add_u32 s30, s30, 4096
    ds_read_b128 v[40:43], v6 offset:10240
    v_mfma_f32_16x16x32_bf16 v[132:135], v[64:67], a[76:79], v[132:135]
    v_mfma_f32_16x16x32_bf16 v[136:139], v[52:55], a[80:83], v[136:139]
    ds_read_b128 v[44:47], v6 offset:19456
    v_mfma_f32_16x16x32_bf16 v[136:139], v[56:59], a[84:87], v[136:139]
    v_mfma_f32_16x16x32_bf16 v[136:139], v[60:63], a[88:91], v[136:139]
    s_waitcnt vmcnt(34)
    ds_read_b128 v[48:51], v6 offset:28672
    v_mfma_f32_16x16x32_bf16 v[136:139], v[64:67], a[92:95], v[136:139]
    s_waitcnt lgkmcnt(4)
    s_branch L_k2_join
L_k2_s:
    s_add_u32 m0, s31, 73728
    s_nop 0
    buffer_load_dwordx4 v9, s[4:7], s29 offen offset:0 lds
    buffer_load_dwordx4 v10, s[4:7], s29 offen offset:1024 lds
    buffer_load_dwordx4 v11, s[4:7], s29 offen offset:2048 lds
    buffer_load_dwordx4 v12, s[4:7], s29 offen offset:3072 lds
    s_add_u32 m0, s31, 77824
    s_nop 0
    buffer_load_dwordx4 v13, s[4:7], s29 offen offset:0 lds
    buffer_load_dwordx4 v14, s[4:7], s29 offen offset:1024 lds
    buffer_load_dwordx4 v15, s[4:7], s29 offen offset:2048 lds
    buffer_load_dwordx4 v16, s[4:7], s29 offen offset:3072 lds
    s_add_u32 m0, s31, 81920
    s_nop 0
    buffer_load_dwordx4 v17, s[4:7], s29 offen offset:0 lds
    s_add_u32 s29, s29, 147456
    buffer_load_dwordx4 a[64:67], v2, s[8:11], s30 offen offset:0
    buffer_load_dwordx4 a[68:71], v2, s[8:11], s30 offen offset:1024
    buffer_load_dwordx4 a[72:75], v2, s[8:11], s30 offen offset:2048
    buffer_load_dwordx4 a[76:79], v2, s[8:11], s30 offen offset:3072
    buffer_load_dwordx4 a[80:83], v8, s[8:11], s30 offen offset:0
    buffer_load_dwordx4 a[84:87], v8, s[8:11], s30 offen offset:1024
    buffer_load_dwordx4 a[88:91], v8, s[8:11], s30 offen offset:2048
    buffer_load_dwordx4 a[92:95], v8, s[8:11], s30 offen offset:3072
    s_add_u32 s30, s30, 4096
    v_add_u32 v3, 0, v2
    v_add_u32 v4, 36864, v2
    v_add_u32 v5, 73728, v2
    v_add_u32 v6, 110592, v2
    v_lshrrev_b32 v18, 4, v0
    v_and_b32 v19, 15, v0
    v_mul_u32_u24 v19, 1152, v19
    v_lshl_add_u32 v7, v18, 3, v19
    s_lshl_b32 s39, s26, 2
    s_add_u32 s39, s39, s27
    s_lshl_b32 s39, s39, 2
    s_add_u32 s39, s39, s24
    s_mul_i32 s39, s39, 28672
    s_add_u32 s39, s39, 58720256
    s_add_u32 s16, s44, s39
    s_addc_u32 s17, s45, 0
    s_and_b32 s17, s17, 0xffff
    s_mov_b32 s18, 28672
    s_mov_b32 s19, 0x20000
    s_mov_b32 s12, s16
    s_mov_b32 s13, s17
    s_lshr_b32 s14, s25, 1
    s_mul_i32 s14, s14, 28672
    s_mov_b32 s15, 0x20000
    s_xor_b32 s32, s25, 1
    s_mul_i32 s32, s32, 6144
    s_add_u32 s56, s32, 0
    s_xor_b32 s32, s25, 2
    s_mul_i32 s32, s32, 6144
    s_add_u32 s57, s32, 2048
    s_xor_b32 s32, s25, 3
    s_mul_i32 s32, s32, 6144
    s_add_u32 s58, s32, 4096
    s_lshl_b32 s59, s25, 10
    s_add_u32 s59, s59, 24576
    s_mul_i32 s60, s25, 6144
    s_lshl_b32 s34, s26, 2
    s_add_u32 s34, s34, s24
    s_mul_i32 s34, s34, 36864
    s_mul_i32 s32, s27, 288
    s_add_u32 s34, s34, s32
    s_lshl_b32 s32, s25, 5
    s_add_u32 s61, s34, s32
    s_add_u32 s62, s61, 18432
    s_and_b32 s32, s25, 1
    s_mul_i32 s40, s32, 18432
    s_add_u32 s40, s40, s34
    s_lshl_b32 s41, s32, 3
    s_add_u32 s41, s41, 24576
    s_mov_b32 s63, 0xffff0000
    s_getpc_b64 s[46:47]
L_k2_pc1:
    s_add_u32 s46, s46, L_k2_post-L_k2_pc1
    s_addc_u32 s47, s47, 0
    v_and_b32 v18, 15, v0
    s_lshl_b32 s32, s24, 4
    v_add_u32 v18, s32, v18
    v_lshlrev_b32 v18, 7, v18
    s_mov_b32 s48, L_k2_done-L_k2_post
    v_min_u32 v18, s48, v18
    v_mov_b32 v19, 0
    s_cmp_lt_u32 s2, 32
    s_cselect_b32 s49, 1, -1
    v_mov_b32 v202, s46
    v_mov_b32 v203, s47
    v_lshl_add_u64 v[200:201], v[18:19], 0, v[202:203]
    s_and_b32 s21, s21, 0xffff
    s_mov_b32 s22, 2359296
    s_mov_b32 s23, 0x20000
    s_and_b32 s53, s53, 0xffff
    s_mov_b32 s54, 2359296
    s_mov_b32 s55, 0x20000
    s_waitcnt vmcnt(8)
    s_barrier
    ds_read_b128 v[20:23], v5 offset:0
    ds_read_b128 v[24:27], v5 offset:9216
    ds_read_b128 v[28:31], v5 offset:18432
    ds_read_b128 v[32:35], v5 offset:27648
    ds_read_b128 v[36:39], v5 offset:1024
    ds_read_b128 v[40:43], v5 offset:10240
    ds_read_b128 v[44:47], v5 offset:19456
    ds_read_b128 v[48:51], v5 offset:28672
    s_add_u32 m0, s31, 110592
    s_nop 0
    buffer_load_dwordx4 v9, s[4:7], s29 offen offset:0 lds
    buffer_load_dwordx4 v10, s[4:7], s29 offen offset:1024 lds
    buffer_load_dwordx4 v11, s[4:7], s29 offen offset:2048 lds
    buffer_load_dwordx4 v12, s[4:7], s29 offen offset:3072 lds
    s_add_u32 m0, s31, 114688
    s_nop 0
    buffer_load_dwordx4 v13, s[4:7], s29 offen offset:0 lds
    buffer_load_dwordx4 v14, s[4:7], s29 offen offset:1024 lds
    buffer_load_dwordx4 v15, s[4:7], s29 offen offset:2048 lds
    buffer_load_dwordx4 v16, s[4:7], s29 offen offset:3072 lds
    s_add_u32 m0, s31, 118784
    s_nop 0
    buffer_load_dwordx4 v17, s[4:7], s29 offen offset:0 lds
    s_add_u32 s29, s29, 147456
    buffer_load_dwordx4 a[96:99], v2, s[8:11], s30 offen offset:0
    buffer_load_dwordx4 a[100:103], v2, s[8:11], s30 offen offset:1024
    buffer_load_dwordx4 a[104:107], v2, s[8:11], s30 offen offset:2048
    buffer_load_dwordx4 a[108:111], v2, s[8:11], s30 offen offset:3072
    buffer_load_dwordx4 a[112:115], v8, s[8:11], s30 offen offset:0
    buffer_load_dwordx4 a[116:119], v8, s[8:11], s30 offen offset:1024
    buffer_load_dwordx4 a[120:123], v8, s[8:11], s30 offen offset:2048
    buffer_load_dwordx4 a[124:127], v8, s[8:11], s30 offen offset:3072
    s_add_u32 s30, s30, 4096
    s_waitcnt vmcnt(17) lgkmcnt(4)
    v_mfma_f32_16x16x32_bf16 v[68:71], v[20:23], a[64:67], 0
    s_add_u32 m0, s31, 0
    ds_read_b128 v[52:55], v5 offset:2048
    v_mfma_f32_16x16x32_bf16 v[68:71], v[24:27], a[68:71], v[68:71]
    buffer_load_dwordx4 v9, s[4:7], s29 offen offset:0 lds
    v_mfma_f32_16x16x32_bf16 v[68:71], v[28:31], a[72:75], v[68:71]
    ds_read_b128 v[56:59], v5 offset:11264
    v_mfma_f32_16x16x32_bf16 v[68:71], v[32:35], a[76:79], v[68:71]
    buffer_load_dwordx4 v10, s[4:7], s29 offen offset:1024 lds
    v_mfma_f32_16x16x32_bf16 v[72:75], v[20:23], a[80:83], 0
    ds_read_b128 v[60:63], v5 offset:20480
    v_mfma_f32_16x16x32_bf16 v[72:75], v[24:27], a[84:87], v[72:75]
    buffer_load_dwordx4 v11, s[4:7], s29 offen offset:2048 lds
    v_mfma_f32_16x16x32_bf16 v[72:75], v[28:31], a[88:91], v[72:75]
    ds_read_b128 v[64:67], v5 offset:29696
    v_mfma_f32_16x16x32_bf16 v[72:75], v[32:35], a[92:95], v[72:75]
    s_waitcnt lgkmcnt(4)
    buffer_load_dwordx4 v12, s[4:7], s29 offen offset:3072 lds
    v_mfma_f32_16x16x32_bf16 v[76:79], v[36:39], a[64:67], 0
    s_add_u32 m0, s31, 4096
    ds_read_b128 v[20:23], v5 offset:3072
    v_mfma_f32_16x16x32_bf16 v[76:79], v[40:43], a[68:71], v[76:79]
    buffer_load_dwordx4 v13, s[4:7], s29 offen offset:0 lds
    v_mfma_f32_16x16x32_bf16 v[76:79], v[44:47], a[72:75], v[76:79]
    ds_read_b128 v[24:27], v5 offset:12288
    v_mfma_f32_16x16x32_bf16 v[76:79], v[48:51], a[76:79], v[76:79]
    buffer_load_dwordx4 v14, s[4:7], s29 offen offset:1024 lds
    v_mfma_f32_16x16x32_bf16 v[80:83], v[36:39], a[80:83], 0
    ds_read_b128 v[28:31], v5 offset:21504
    v_mfma_f32_16x16x32_bf16 v[80:83], v[40:43], a[84:87], v[80:83]
    buffer_load_dwordx4 v15, s[4:7], s29 offen offset:2048 lds
    v_mfma_f32_16x16x32_bf16 v[80:83], v[44:47], a[88:91], v[80:83]
    ds_read_b128 v[32:35], v5 offset:30720
    v_mfma_f32_16x16x32_bf16 v[80:83], v[48:51], a[92:95], v[80:83]
    s_waitcnt lgkmcnt(4)
    buffer_load_dwordx4 v16, s[4:7], s29 offen offset:3072 lds
    v_mfma_f32_16x16x32_bf16 v[84:87], v[52:55], a[64:67], 0
    s_add_u32 m0, s31, 8192
    ds_read_b128 v[36:39], v5 offset:4096
    v_mfma_f32_16x16x32_bf16 v[84:87], v[56:59], a[68:71], v[84:87]
    buffer_load_dwordx4 v17, s[4:7], s29 offen offset:0 lds
    v_mfma_f32_16x16x32_bf16 v[84:87], v[60:63], a[72:75], v[84:87]
    s_add_u32 s29, s29, 147456
    ds_read_b128 v[40:43], v5 offset:13312
    v_mfma_f32_16x16x32_bf16 v[84:87], v[64:67], a[76:79], v[84:87]
    buffer_load_dwordx4 a[0:3], v2, s[8:11], s30 offen offset:0
    v_mfma_f32_16x16x32_bf16 v[88:91], v[52:55], a[80:83], 0
    ds_read_b128 v[44:47], v5 offset:22528
    v_mfma_f32_16x16x32_bf16 v[88:91], v[56:59], a[84:87], v[88:91]
    buffer_load_dwordx4 a[4:7], v2, s[8:11], s30 offen offset:1024
    v_mfma_f32_16x16x32_bf16 v[88:91], v[60:63], a[88:91], v[88:91]
    ds_read_b128 v[48:51], v5 offset:31744
    v_mfma_f32_16x16x32_bf16 v[88:91], v[64:67], a[92:95], v[88:91]
    s_waitcnt lgkmcnt(4)
    buffer_load_dwordx4 a[8:11], v2, s[8:11], s30 offen offset:2048
    v_mfma_f32_16x16x32_bf16 v[92:95], v[20:23], a[64:67], 0
    ds_read_b128 v[52:55], v5 offset:5120
    v_mfma_f32_16x16x32_bf16 v[92:95], v[24:27], a[68:71], v[92:95]
    buffer_load_dwordx4 a[12:15], v2, s[8:11], s30 offen offset:3072
    v_mfma_f32_16x16x32_bf16 v[92:95], v[28:31], a[72:75], v[92:95]
    ds_read_b128 v[56:59], v5 offset:14336
    v_mfma_f32_16x16x32_bf16 v[92:95], v[32:35], a[76:79], v[92:95]
    buffer_load_dwordx4 a[16:19], v8, s[8:11], s30 offen offset:0
    v_mfma_f32_16x16x32_bf16 v[96:99], v[20:23], a[80:83], 0
    ds_read_b128 v[60:63], v5 offset:23552
    v_mfma_f32_16x16x32_bf16 v[96:99], v[24:27], a[84:87], v[96:99]
    buffer_load_dwordx4 a[20:23], v8, s[8:11], s30 offen offset:1024
    v_mfma_f32_16x16x32_bf16 v[96:99], v[28:31], a[88:91], v[96:99]
    ds_read_b128 v[64:67], v5 offset:32768
    v_mfma_f32_16x16x32_bf16 v[96:99], v[32:35], a[92:95], v[96:99]
    s_waitcnt lgkmcnt(4)
    buffer_load_dwordx4 a[24:27], v8, s[8:11], s30 offen offset:2048
    v_mfma_f32_16x16x32_bf16 v[100:103], v[36:39], a[64:67], 0
    ds_read_b128 v[20:23], v5 offset:6144
    v_mfma_f32_16x16x32_bf16 v[100:103], v[40:43], a[68:71], v[100:103]
    buffer_load_dwordx4 a[28:31], v8, s[8:11], s30 offen offset:3072
    v_mfma_f32_16x16x32_bf16 v[100:103], v[44:47], a[72:75], v[100:103]
    s_add_u32 s30, s30, 4096
    s_add_u32 m0, s31, 36864
    ds_read_b128 v[24:27], v5 offset:15360
    v_mfma_f32_16x16x32_bf16 v[100:103], v[48:51], a[76:79], v[100:103]
    buffer_load_dwordx4 v9, s[4:7], s29 offen offset:0 lds
    v_mfma_f32_16x16x32_bf16 v[104:107], v[36:39], a[80:83], 0
    ds_read_b128 v[28:31], v5 offset:24576
    v_mfma_f32_16x16x32_bf16 v[104:107], v[40:43], a[84:87], v[104:107]
    buffer_load_dwordx4 v10, s[4:7], s29 offen offset:1024 lds
    v_mfma_f32_16x16x32_bf16 v[104:107], v[44:47], a[88:91], v[104:107]
    ds_read_b128 v[32:35], v5 offset:33792
    v_mfma_f32_16x16x32_bf16 v[104:107], v[48:51], a[92:95], v[104:107]
    s_waitcnt lgkmcnt(4)
    buffer_load_dwordx4 v11, s[4:7], s29 offen offset:2048 lds
    v_mfma_f32_16x16x32_bf16 v[108:111], v[52:55], a[64:67], 0
    ds_read_b128 v[36:39], v5 offset:7168
    v_mfma_f32_16x16x32_bf16 v[108:111], v[56:59], a[68:71], v[108:111]
    buffer_load_dwordx4 v12, s[4:7], s29 offen offset:3072 lds
    v_mfma_f32_16x16x32_bf16 v[108:111], v[60:63], a[72:75], v[108:111]
    s_add_u32 m0, s31, 40960
    ds_read_b128 v[40:43], v5 offset:16384
    v_mfma_f32_16x16x32_bf16 v[108:111], v[64:67], a[76:79], v[108:111]
    buffer_load_dwordx4 v13, s[4:7], s29 offen offset:0 lds
    v_mfma_f32_16x16x32_bf16 v[112:115], v[52:55], a[80:83], 0
    ds_read_b128 v[44:47], v5 offset:25600
    v_mfma_f32_16x16x32_bf16 v[112:115], v[56:59], a[84:87], v[112:115]
    buffer_load_dwordx4 v14, s[4:7], s29 offen offset:1024 lds
    v_mfma_f32_16x16x32_bf16 v[112:115], v[60:63], a[88:91], v[112:115]
    ds_read_b128 v[48:51], v5 offset:34816
    v_mfma_f32_16x16x32_bf16 v[112:115], v[64:67], a[92:95], v[112:115]
    s_waitcnt lgkmcnt(4)
    buffer_load_dwordx4 v15, s[4:7], s29 offen offset:2048 lds
    v_mfma_f32_16x16x32_bf16 v[116:119], v[20:23], a[64:67], 0
    ds_read_b128 v[52:55], v5 offset:8192
    v_mfma_f32_16x16x32_bf16 v[116:119], v[24:27], a[68:71], v[116:119]
    ds_read_b128 v[56:59], v5 offset:17408
    v_mfma_f32_16x16x32_bf16 v[116:119], v[28:31], a[72:75], v[116:119]
    ds_read_b128 v[60:63], v5 offset:26624
    v_mfma_f32_16x16x32_bf16 v[116:119], v[32:35], a[76:79], v[116:119]
    ds_read_b128 v[64:67], v5 offset:35840
    v_mfma_f32_16x16x32_bf16 v[120:123], v[20:23], a[80:83], 0
    buffer_load_dwordx4 v16, s[4:7], s29 offen offset:3072 lds
    v_mfma_f32_16x16x32_bf16 v[120:123], v[24:27], a[84:87], v[120:123]
    s_add_u32 m0, s31, 45056
    s_nop 0
    buffer_load_dwordx4 v17, s[4:7], s29 offen offset:0 lds
    v_mfma_f32_16x16x32_bf16 v[120:123], v[28:31], a[88:91], v[120:123]
    s_add_u32 s29, s29, 147456
    buffer_load_dwordx4 a[32:35], v2, s[8:11], s30 offen offset:0
    v_mfma_f32_16x16x32_bf16 v[120:123], v[32:35], a[92:95], v[120:123]
    s_waitcnt lgkmcnt(4)
    buffer_load_dwordx4 a[36:39], v2, s[8:11], s30 offen offset:1024
    v_mfma_f32_16x16x32_bf16 v[124:127], v[36:39], a[64:67], 0
    s_waitcnt vmcnt(36) lgkmcnt(0)
    s_barrier
    v_mfma_f32_16x16x32_bf16 v[124:127], v[40:43], a[68:71], v[124:127]
    ds_read_b128 v[20:23], v6 offset:0
    v_mfma_f32_16x16x32_bf16 v[124:127], v[44:47], a[72:75], v[124:127]
    ds_read_b128 v[24:27], v6 offset:9216
    v_mfma_f32_16x16x32_bf16 v[124:127], v[48:51], a[76:79], v[124:127]
    ds_read_b128 v[28:31], v6 offset:18432
    v_mfma_f32_16x16x32_bf16 v[128:131], v[36:39], a[80:83], 0
    ds_read_b128 v[32:35], v6 offset:27648
    v_mfma_f32_16x16x32_bf16 v[128:131], v[40:43], a[84:87], v[128:131]
    buffer_load_dwordx4 a[40:43], v2, s[8:11], s30 offen offset:2048
    v_mfma_f32_16x16x32_bf16 v[128:131], v[44:47], a[88:91], v[128:131]
    buffer_load_dwordx4 a[44:47], v2, s[8:11], s30 offen offset:3072
    v_mfma_f32_16x16x32_bf16 v[128:131], v[48:51], a[92:95], v[128:131]
    buffer_load_dwordx4 a[48:51], v8, s[8:11], s30 offen offset:0
    v_mfma_f32_16x16x32_bf16 v[132:135], v[52:55], a[64:67], 0
    ds_read_b128 v[36:39], v6 offset:1024
    v_mfma_f32_16x16x32_bf16 v[132:135], v[56:59], a[68:71], v[132:135]
    buffer_load_dwordx4 a[52:55], v8, s[8:11], s30 offen offset:1024
    v_mfma_f32_16x16x32_bf16 v[132:135], v[60:63], a[72:75], v[132:135]
    ds_read_b128 v[40:43], v6 offset:10240
    v_mfma_f32_16x16x32_bf16 v[132:135], v[64:67], a[76:79], v[132:135]
    buffer_load_dwordx4 a[56:59], v8, s[8:11], s30 offen offset:2048
    v_mfma_f32_16x16x32_bf16 v[136:139], v[52:55], a[80:83], 0
    ds_read_b128 v[44:47], v6 offset:19456
    v_mfma_f32_16x16x32_bf16 v[136:139], v[56:59], a[84:87], v[136:139]
    buffer_load_dwordx4 a[60:63], v8, s[8:11], s30 offen offset:3072
    v_mfma_f32_16x16x32_bf16 v[136:139], v[60:63], a[88:91], v[136:139]
    s_waitcnt vmcnt(34)
    ds_read_b128 v[48:51], v6 offset:28672
    v_mfma_f32_16x16x32_bf16 v[136:139], v[64:67], a[92:95], v[136:139]
    s_waitcnt lgkmcnt(4)
    s_add_u32 s30, s30, 4096
L_k2_join:
    s_mov_b32 s28, 3
.p2align 6
L_k2_loop:
    s_cmp_lg_u32 s28, s49
    s_cbranch_scc1 L_k2_noip
    global_load_dword v202, v[200:201], off
L_k2_noip:
    v_mfma_f32_16x16x32_bf16 v[68:71], v[20:23], a[96:99], v[68:71]
    s_add_u32 m0, s31, 73728
    ds_read_b128 v[52:55], v6 offset:2048
    v_mfma_f32_16x16x32_bf16 v[68:71], v[24:27], a[100:103], v[68:71]
    buffer_load_dwordx4 v9, s[4:7], s29 offen offset:0 lds
    v_mfma_f32_16x16x32_bf16 v[68:71], v[28:31], a[104:107], v[68:71]
    ds_read_b128 v[56:59], v6 offset:11264
    v_mfma_f32_16x16x32_bf16 v[68:71], v[32:35], a[108:111], v[68:71]
    v_mfma_f32_16x16x32_bf16 v[72:75], v[20:23], a[112:115], v[72:75]
    ds_read_b128 v[60:63], v6 offset:20480
    v_mfma_f32_16x16x32_bf16 v[72:75], v[24:27], a[116:119], v[72:75]
    buffer_load_dwordx4 v10, s[4:7], s29 offen offset:1024 lds
    v_mfma_f32_16x16x32_bf16 v[72:75], v[28:31], a[120:123], v[72:75]
    ds_read_b128 v[64:67], v6 offset:29696
    v_mfma_f32_16x16x32_bf16 v[72:75], v[32:35], a[124:127], v[72:75]
    s_waitcnt lgkmcnt(4)
    v_mfma_f32_16x16x32_bf16 v[76:79], v[36:39], a[96:99], v[76:79]
    ds_read_b128 v[20:23], v6 offset:3072
    v_mfma_f32_16x16x32_bf16 v[76:79], v[40:43], a[100:103], v[76:79]
    buffer_load_dwordx4 v11, s[4:7], s29 offen offset:2048 lds
    v_mfma_f32_16x16x32_bf16 v[76:79], v[44:47], a[104:107], v[76:79]
    ds_read_b128 v[24:27], v6 offset:12288
    v_mfma_f32_16x16x32_bf16 v[76:79], v[48:51], a[108:111], v[76:79]
    v_mfma_f32_16x16x32_bf16 v[80:83], v[36:39], a[112:115], v[80:83]
    ds_read_b128 v[28:31], v6 offset:21504
    v_mfma_f32_16x16x32_bf16 v[80:83], v[40:43], a[116:119], v[80:83]
    buffer_load_dwordx4 v12, s[4:7], s29 offen offset:3072 lds
    v_mfma_f32_16x16x32_bf16 v[80:83], v[44:47], a[120:123], v[80:83]
    s_add_u32 m0, s31, 77824
    ds_read_b128 v[32:35], v6 offset:30720
    v_mfma_f32_16x16x32_bf16 v[80:83], v[48:51], a[124:127], v[80:83]
    s_waitcnt lgkmcnt(4)
    v_mfma_f32_16x16x32_bf16 v[84:87], v[52:55], a[96:99], v[84:87]
    ds_read_b128 v[36:39], v6 offset:4096
    v_mfma_f32_16x16x32_bf16 v[84:87], v[56:59], a[100:103], v[84:87]
    buffer_load_dwordx4 v13, s[4:7], s29 offen offset:0 lds
    v_mfma_f32_16x16x32_bf16 v[84:87], v[60:63], a[104:107], v[84:87]
    ds_read_b128 v[40:43], v6 offset:13312
    v_mfma_f32_16x16x32_bf16 v[84:87], v[64:67], a[108:111], v[84:87]
    v_mfma_f32_16x16x32_bf16 v[88:91], v[52:55], a[112:115], v[88:91]
    ds_read_b128 v[44:47], v6 offset:22528
    v_mfma_f32_16x16x32_bf16 v[88:91], v[56:59], a[116:119], v[88:91]
    buffer_load_dwordx4 v14, s[4:7], s29 offen offset:1024 lds
    v_mfma_f32_16x16x32_bf16 v[88:91], v[60:63], a[120:123], v[88:91]
    ds_read_b128 v[48:51], v6 offset:31744
    v_mfma_f32_16x16x32_bf16 v[88:91], v[64:67], a[124:127], v[88:91]
    s_waitcnt lgkmcnt(4)
    v_mfma_f32_16x16x32_bf16 v[92:95], v[20:23], a[96:99], v[92:95]
    ds_read_b128 v[52:55], v6 offset:5120
    v_mfma_f32_16x16x32_bf16 v[92:95], v[24:27], a[100:103], v[92:95]
    buffer_load_dwordx4 v15, s[4:7], s29 offen offset:2048 lds
    v_mfma_f32_16x16x32_bf16 v[92:95], v[28:31], a[104:107], v[92:95]
    ds_read_b128 v[56:59], v6 offset:14336
    v_mfma_f32_16x16x32_bf16 v[92:95], v[32:35], a[108:111], v[92:95]
    v_mfma_f32_16x16x32_bf16 v[96:99], v[20:23], a[112:115], v[96:99]
    ds_read_b128 v[60:63], v6 offset:23552
    v_mfma_f32_16x16x32_bf16 v[96:99], v[24:27], a[116:119], v[96:99]
    buffer_load_dwordx4 v16, s[4:7], s29 offen offset:3072 lds
    v_mfma_f32_16x16x32_bf16 v[96:99], v[28:31], a[120:123], v[96:99]
    s_add_u32 m0, s31, 81920
    ds_read_b128 v[64:67], v6 offset:32768
    v_mfma_f32_16x16x32_bf16 v[96:99], v[32:35], a[124:127], v[96:99]
    s_waitcnt lgkmcnt(4)
    v_mfma_f32_16x16x32_bf16 v[100:103], v[36:39], a[96:99], v[100:103]
    ds_read_b128 v[20:23], v6 offset:6144
    v_mfma_f32_16x16x32_bf16 v[100:103], v[40:43], a[100:103], v[100:103]
    buffer_load_dwordx4 v17, s[4:7], s29 offen offset:0 lds
    v_mfma_f32_16x16x32_bf16 v[100:103], v[44:47], a[104:107], v[100:103]
    s_add_u32 s29, s29, 147456
    ds_read_b128 v[24:27], v6 offset:15360
    v_mfma_f32_16x16x32_bf16 v[100:103], v[48:51], a[108:111], v[100:103]
    v_mfma_f32_16x16x32_bf16 v[104:107], v[36:39], a[112:115], v[104:107]
    ds_read_b128 v[28:31], v6 offset:24576
    v_mfma_f32_16x16x32_bf16 v[104:107], v[40:43], a[116:119], v[104:107]
    buffer_load_dwordx4 a[64:67], v2, s[8:11], s30 offen offset:0
    v_mfma_f32_16x16x32_bf16 v[104:107], v[44:47], a[120:123], v[104:107]
    ds_read_b128 v[32:35], v6 offset:33792
    v_mfma_f32_16x16x32_bf16 v[104:107], v[48:51], a[124:127], v[104:107]
    s_waitcnt lgkmcnt(4)
    v_mfma_f32_16x16x32_bf16 v[108:111], v[52:55], a[96:99], v[108:111]
    ds_read_b128 v[36:39], v6 offset:7168
    v_mfma_f32_16x16x32_bf16 v[108:111], v[56:59], a[100:103], v[108:111]
    buffer_load_dwordx4 a[68:71], v2, s[8:11], s30 offen offset:1024
    v_mfma_f32_16x16x32_bf16 v[108:111], v[60:63], a[104:107], v[108:111]
    ds_read_b128 v[40:43], v6 offset:16384
    v_mfma_f32_16x16x32_bf16 v[108:111], v[64:67], a[108:111], v[108:111]
    v_mfma_f32_16x16x32_bf16 v[112:115], v[52:55], a[112:115], v[112:115]
    ds_read_b128 v[44:47], v6 offset:25600
    v_mfma_f32_16x16x32_bf16 v[112:115], v[56:59], a[116:119], v[112:115]
    buffer_load_dwordx4 a[72:75], v2, s[8:11], s30 offen offset:2048
    v_mfma_f32_16x16x32_bf16 v[112:115], v[60:63], a[120:123], v[112:115]
    ds_read_b128 v[48:51], v6 offset:34816
    v_mfma_f32_16x16x32_bf16 v[112:115], v[64:67], a[124:127], v[112:115]
    s_waitcnt lgkmcnt(4)
    v_mfma_f32_16x16x32_bf16 v[116:119], v[20:23], a[96:99], v[116:119]
    ds_read_b128 v[52:55], v6 offset:8192
    v_mfma_f32_16x16x32_bf16 v[116:119], v[24:27], a[100:103], v[116:119]
    ds_read_b128 v[56:59], v6 offset:17408
    v_mfma_f32_16x16x32_bf16 v[116:119], v[28:31], a[104:107], v[116:119]
    ds_read_b128 v[60:63], v6 offset:26624
    v_mfma_f32_16x16x32_bf16 v[116:119], v[32:35], a[108:111], v[116:119]
    ds_read_b128 v[64:67], v6 offset:35840
    v_mfma_f32_16x16x32_bf16 v[120:123], v[20:23], a[112:115], v[120:123]
    buffer_load_dwordx4 a[76:79], v2, s[8:11], s30 offen offset:3072
    v_mfma_f32_16x16x32_bf16 v[120:123], v[24:27], a[116:119], v[120:123]
    v_mfma_f32_16x16x32_bf16 v[120:123], v[28:31], a[120:123], v[120:123]
    buffer_load_dwordx4 a[80:83], v8, s[8:11], s30 offen offset:0
    v_mfma_f32_16x16x32_bf16 v[120:123], v[32:35], a[124:127], v[120:123]
    s_waitcnt lgkmcnt(4)
    buffer_load_dwordx4 a[84:87], v8, s[8:11], s30 offen offset:1024
    v_mfma_f32_16x16x32_bf16 v[124:127], v[36:39], a[96:99], v[124:127]
    s_waitcnt vmcnt(40) lgkmcnt(0)
    s_barrier
    v_mfma_f32_16x16x32_bf16 v[124:127], v[40:43], a[100:103], v[124:127]
    ds_read_b128 v[20:23], v3 offset:0
    v_mfma_f32_16x16x32_bf16 v[124:127], v[44:47], a[104:107], v[124:127]
    ds_read_b128 v[24:27], v3 offset:9216
    v_mfma_f32_16x16x32_bf16 v[124:127], v[48:51], a[108:111], v[124:127]
    ds_read_b128 v[28:31], v3 offset:18432
    v_mfma_f32_16x16x32_bf16 v[128:131], v[36:39], a[112:115], v[128:131]
    ds_read_b128 v[32:35], v3 offset:27648
    v_mfma_f32_16x16x32_bf16 v[128:131], v[40:43], a[116:119], v[128:131]
    v_mfma_f32_16x16x32_bf16 v[128:131], v[44:47], a[120:123], v[128:131]
    buffer_load_dwordx4 a[88:91], v8, s[8:11], s30 offen offset:2048
    v_mfma_f32_16x16x32_bf16 v[128:131], v[48:51], a[124:127], v[128:131]
    v_mfma_f32_16x16x32_bf16 v[132:135], v[52:55], a[96:99], v[132:135]
    ds_read_b128 v[36:39], v3 offset:1024
    v_mfma_f32_16x16x32_bf16 v[132:135], v[56:59], a[100:103], v[132:135]
    buffer_load_dwordx4 a[92:95], v8, s[8:11], s30 offen offset:3072
    v_mfma_f32_16x16x32_bf16 v[132:135], v[60:63], a[104:107], v[132:135]
    s_add_u32 s30, s30, 4096
    ds_read_b128 v[40:43], v3 offset:10240
    v_mfma_f32_16x16x32_bf16 v[132:135], v[64:67], a[108:111], v[132:135]
    v_mfma_f32_16x16x32_bf16 v[136:139], v[52:55], a[112:115], v[136:139]
    ds_read_b128 v[44:47], v3 offset:19456
    v_mfma_f32_16x16x32_bf16 v[136:139], v[56:59], a[116:119], v[136:139]
    v_mfma_f32_16x16x32_bf16 v[136:139], v[60:63], a[120:123], v[136:139]
    s_waitcnt vmcnt(34)
    ds_read_b128 v[48:51], v3 offset:28672
    v_mfma_f32_16x16x32_bf16 v[136:139], v[64:67], a[124:127], v[136:139]
    s_waitcnt lgkmcnt(4)
    v_mfma_f32_16x16x32_bf16 v[68:71], v[20:23], a[0:3], v[68:71]
    s_add_u32 m0, s31, 110592
    ds_read_b128 v[52:55], v3 offset:2048
    v_mfma_f32_16x16x32_bf16 v[68:71], v[24:27], a[4:7], v[68:71]
    buffer_load_dwordx4 v9, s[4:7], s29 offen offset:0 lds
    v_mfma_f32_16x16x32_bf16 v[68:71], v[28:31], a[8:11], v[68:71]
    ds_read_b128 v[56:59], v3 offset:11264
    v_mfma_f32_16x16x32_bf16 v[68:71], v[32:35], a[12:15], v[68:71]
    v_mfma_f32_16x16x32_bf16 v[72:75], v[20:23], a[16:19], v[72:75]
    ds_read_b128 v[60:63], v3 offset:20480
    v_mfma_f32_16x16x32_bf16 v[72:75], v[24:27], a[20:23], v[72:75]
    buffer_load_dwordx4 v10, s[4:7], s29 offen offset:1024 lds
    v_mfma_f32_16x16x32_bf16 v[72:75], v[28:31], a[24:27], v[72:75]
    ds_read_b128 v[64:67], v3 offset:29696
    v_mfma_f32_16x16x32_bf16 v[72:75], v[32:35], a[28:31], v[72:75]
    s_waitcnt lgkmcnt(4)
    v_mfma_f32_16x16x32_bf16 v[76:79], v[36:39], a[0:3], v[76:79]
    ds_read_b128 v[20:23], v3 offset:3072
    v_mfma_f32_16x16x32_bf16 v[76:79], v[40:43], a[4:7], v[76:79]
    buffer_load_dwordx4 v11, s[4:7], s29 offen offset:2048 lds
    v_mfma_f32_16x16x32_bf16 v[76:79], v[44:47], a[8:11], v[76:79]
    ds_read_b128 v[24:27], v3 offset:12288
    v_mfma_f32_16x16x32_bf16 v[76:79], v[48:51], a[12:15], v[76:79]
    v_mfma_f32_16x16x32_bf16 v[80:83], v[36:39], a[16:19], v[80:83]
    ds_read_b128 v[28:31], v3 offset:21504
    v_mfma_f32_16x16x32_bf16 v[80:83], v[40:43], a[20:23], v[80:83]
    buffer_load_dwordx4 v12, s[4:7], s29 offen offset:3072 lds
    v_mfma_f32_16x16x32_bf16 v[80:83], v[44:47], a[24:27], v[80:83]
    s_add_u32 m0, s31, 114688
    ds_read_b128 v[32:35], v3 offset:30720
    v_mfma_f32_16x16x32_bf16 v[80:83], v[48:51], a[28:31], v[80:83]
    s_waitcnt lgkmcnt(4)
    v_mfma_f32_16x16x32_bf16 v[84:87], v[52:55], a[0:3], v[84:87]
    ds_read_b128 v[36:39], v3 offset:4096
    v_mfma_f32_16x16x32_bf16 v[84:87], v[56:59], a[4:7], v[84:87]
    buffer_load_dwordx4 v13, s[4:7], s29 offen offset:0 lds
    v_mfma_f32_16x16x32_bf16 v[84:87], v[60:63], a[8:11], v[84:87]
    ds_read_b128 v[40:43], v3 offset:13312
    v_mfma_f32_16x16x32_bf16 v[84:87], v[64:67], a[12:15], v[84:87]
    v_mfma_f32_16x16x32_bf16 v[88:91], v[52:55], a[16:19], v[88:91]
    ds_read_b128 v[44:47], v3 offset:22528
    v_mfma_f32_16x16x32_bf16 v[88:91], v[56:59], a[20:23], v[88:91]
    buffer_load_dwordx4 v14, s[4:7], s29 offen offset:1024 lds
    v_mfma_f32_16x16x32_bf16 v[88:91], v[60:63], a[24:27], v[88:91]
    ds_read_b128 v[48:51], v3 offset:31744
    v_mfma_f32_16x16x32_bf16 v[88:91], v[64:67], a[28:31], v[88:91]
    s_waitcnt lgkmcnt(4)
    v_mfma_f32_16x16x32_bf16 v[92:95], v[20:23], a[0:3], v[92:95]
    ds_read_b128 v[52:55], v3 offset:5120
    v_mfma_f32_16x16x32_bf16 v[92:95], v[24:27], a[4:7], v[92:95]
    buffer_load_dwordx4 v15, s[4:7], s29 offen offset:2048 lds
    v_mfma_f32_16x16x32_bf16 v[92:95], v[28:31], a[8:11], v[92:95]
    ds_read_b128 v[56:59], v3 offset:14336
    v_mfma_f32_16x16x32_bf16 v[92:95], v[32:35], a[12:15], v[92:95]
    v_mfma_f32_16x16x32_bf16 v[96:99], v[20:23], a[16:19], v[96:99]
    ds_read_b128 v[60:63], v3 offset:23552
    v_mfma_f32_16x16x32_bf16 v[96:99], v[24:27], a[20:23], v[96:99]
    buffer_load_dwordx4 v16, s[4:7], s29 offen offset:3072 lds
    v_mfma_f32_16x16x32_bf16 v[96:99], v[28:31], a[24:27], v[96:99]
    s_add_u32 m0, s31, 118784
    ds_read_b128 v[64:67], v3 offset:32768
    v_mfma_f32_16x16x32_bf16 v[96:99], v[32:35], a[28:31], v[96:99]
    s_waitcnt lgkmcnt(4)
    v_mfma_f32_16x16x32_bf16 v[100:103], v[36:39], a[0:3], v[100:103]
    ds_read_b128 v[20:23], v3 offset:6144
    v_mfma_f32_16x16x32_bf16 v[100:103], v[40:43], a[4:7], v[100:103]
    buffer_load_dwordx4 v17, s[4:7], s29 offen offset:0 lds
    v_mfma_f32_16x16x32_bf16 v[100:103], v[44:47], a[8:11], v[100:103]
    s_add_u32 s29, s29, 147456
    ds_read_b128 v[24:27], v3 offset:15360
    v_mfma_f32_16x16x32_bf16 v[100:103], v[48:51], a[12:15], v[100:103]
    v_mfma_f32_16x16x32_bf16 v[104:107], v[36:39], a[16:19], v[104:107]
    ds_read_b128 v[28:31], v3 offset:24576
    v_mfma_f32_16x16x32_bf16 v[104:107], v[40:43], a[20:23], v[104:107]
    buffer_load_dwordx4 a[96:99], v2, s[8:11], s30 offen offset:0
    v_mfma_f32_16x16x32_bf16 v[104:107], v[44:47], a[24:27], v[104:107]
    ds_read_b128 v[32:35], v3 offset:33792
    v_mfma_f32_16x16x32_bf16 v[104:107], v[48:51], a[28:31], v[104:107]
    s_waitcnt lgkmcnt(4)
    v_mfma_f32_16x16x32_bf16 v[108:111], v[52:55], a[0:3], v[108:111]
    ds_read_b128 v[36:39], v3 offset:7168
    v_mfma_f32_16x16x32_bf16 v[108:111], v[56:59], a[4:7], v[108:111]
    buffer_load_dwordx4 a[100:103], v2, s[8:11], s30 offen offset:1024
    v_mfma_f32_16x16x32_bf16 v[108:111], v[60:63], a[8:11], v[108:111]
    ds_read_b128 v[40:43], v3 offset:16384
    v_mfma_f32_16x16x32_bf16 v[108:111], v[64:67], a[12:15], v[108:111]
    v_mfma_f32_16x16x32_bf16 v[112:115], v[52:55], a[16:19], v[112:115]
    ds_read_b128 v[44:47], v3 offset:25600
    v_mfma_f32_16x16x32_bf16 v[112:115], v[56:59], a[20:23], v[112:115]
    buffer_load_dwordx4 a[104:107], v2, s[8:11], s30 offen offset:2048
    v_mfma_f32_16x16x32_bf16 v[112:115], v[60:63], a[24:27], v[112:115]
    ds_read_b128 v[48:51], v3 offset:34816
    v_mfma_f32_16x16x32_bf16 v[112:115], v[64:67], a[28:31], v[112:115]
    s_waitcnt lgkmcnt(4)
    v_mfma_f32_16x16x32_bf16 v[116:119], v[20:23], a[0:3], v[116:119]
    ds_read_b128 v[52:55], v3 offset:8192
    v_mfma_f32_16x16x32_bf16 v[116:119], v[24:27], a[4:7], v[116:119]
    ds_read_b128 v[56:59], v3 offset:17408
    v_mfma_f32_16x16x32_bf16 v[116:119], v[28:31], a[8:11], v[116:119]
    ds_read_b128 v[60:63], v3 offset:26624
    v_mfma_f32_16x16x32_bf16 v[116:119], v[32:35], a[12:15], v[116:119]
    ds_read_b128 v[64:67], v3 offset:35840
    v_mfma_f32_16x16x32_bf16 v[120:123], v[20:23], a[16:19], v[120:123]
    buffer_load_dwordx4 a[108:111], v2, s[8:11], s30 offen offset:3072
    v_mfma_f32_16x16x32_bf16 v[120:123], v[24:27], a[20:23], v[120:123]
    v_mfma_f32_16x16x32_bf16 v[120:123], v[28:31], a[24:27], v[120:123]
    buffer_load_dwordx4 a[112:115], v8, s[8:11], s30 offen offset:0
    v_mfma_f32_16x16x32_bf16 v[120:123], v[32:35], a[28:31], v[120:123]
    s_waitcnt lgkmcnt(4)
    buffer_load_dwordx4 a[116:119], v8, s[8:11], s30 offen offset:1024
    v_mfma_f32_16x16x32_bf16 v[124:127], v[36:39], a[0:3], v[124:127]
    s_waitcnt vmcnt(40) lgkmcnt(0)
    s_barrier
    v_mfma_f32_16x16x32_bf16 v[124:127], v[40:43], a[4:7], v[124:127]
    ds_read_b128 v[20:23], v4 offset:0
    v_mfma_f32_16x16x32_bf16 v[124:127], v[44:47], a[8:11], v[124:127]
    ds_read_b128 v[24:27], v4 offset:9216
    v_mfma_f32_16x16x32_bf16 v[124:127], v[48:51], a[12:15], v[124:127]
    ds_read_b128 v[28:31], v4 offset:18432
    v_mfma_f32_16x16x32_bf16 v[128:131], v[36:39], a[16:19], v[128:131]
    ds_read_b128 v[32:35], v4 offset:27648
    v_mfma_f32_16x16x32_bf16 v[128:131], v[40:43], a[20:23], v[128:131]
    v_mfma_f32_16x16x32_bf16 v[128:131], v[44:47], a[24:27], v[128:131]
    buffer_load_dwordx4 a[120:123], v8, s[8:11], s30 offen offset:2048
    v_mfma_f32_16x16x32_bf16 v[128:131], v[48:51], a[28:31], v[128:131]
    v_mfma_f32_16x16x32_bf16 v[132:135], v[52:55], a[0:3], v[132:135]
    ds_read_b128 v[36:39], v4 offset:1024
    v_mfma_f32_16x16x32_bf16 v[132:135], v[56:59], a[4:7], v[132:135]
    buffer_load_dwordx4 a[124:127], v8, s[8:11], s30 offen offset:3072
    v_mfma_f32_16x16x32_bf16 v[132:135], v[60:63], a[8:11], v[132:135]
    s_add_u32 s30, s30, 4096
    ds_read_b128 v[40:43], v4 offset:10240
    v_mfma_f32_16x16x32_bf16 v[132:135], v[64:67], a[12:15], v[132:135]
    v_mfma_f32_16x16x32_bf16 v[136:139], v[52:55], a[16:19], v[136:139]
    ds_read_b128 v[44:47], v4 offset:19456
    v_mfma_f32_16x16x32_bf16 v[136:139], v[56:59], a[20:23], v[136:139]
    v_mfma_f32_16x16x32_bf16 v[136:139], v[60:63], a[24:27], v[136:139]
    s_waitcnt vmcnt(34)
    ds_read_b128 v[48:51], v4 offset:28672
    v_mfma_f32_16x16x32_bf16 v[136:139], v[64:67], a[28:31], v[136:139]
    s_waitcnt lgkmcnt(4)
    v_mfma_f32_16x16x32_bf16 v[68:71], v[20:23], a[32:35], v[68:71]
    s_add_u32 m0, s31, 0
    ds_read_b128 v[52:55], v4 offset:2048
    v_mfma_f32_16x16x32_bf16 v[68:71], v[24:27], a[36:39], v[68:71]
    buffer_load_dwordx4 v9, s[4:7], s29 offen offset:0 lds
    v_mfma_f32_16x16x32_bf16 v[68:71], v[28:31], a[40:43], v[68:71]
    ds_read_b128 v[56:59], v4 offset:11264
    v_mfma_f32_16x16x32_bf16 v[68:71], v[32:35], a[44:47], v[68:71]
    v_mfma_f32_16x16x32_bf16 v[72:75], v[20:23], a[48:51], v[72:75]
    ds_read_b128 v[60:63], v4 offset:20480
    v_mfma_f32_16x16x32_bf16 v[72:75], v[24:27], a[52:55], v[72:75]
    buffer_load_dwordx4 v10, s[4:7], s29 offen offset:1024 lds
    v_mfma_f32_16x16x32_bf16 v[72:75], v[28:31], a[56:59], v[72:75]
    ds_read_b128 v[64:67], v4 offset:29696
    v_mfma_f32_16x16x32_bf16 v[72:75], v[32:35], a[60:63], v[72:75]
    s_waitcnt lgkmcnt(4)
    v_mfma_f32_16x16x32_bf16 v[76:79], v[36:39], a[32:35], v[76:79]
    ds_read_b128 v[20:23], v4 offset:3072
    v_mfma_f32_16x16x32_bf16 v[76:79], v[40:43], a[36:39], v[76:79]
    buffer_load_dwordx4 v11, s[4:7], s29 offen offset:2048 lds
    v_mfma_f32_16x16x32_bf16 v[76:79], v[44:47], a[40:43], v[76:79]
    ds_read_b128 v[24:27], v4 offset:12288
    v_mfma_f32_16x16x32_bf16 v[76:79], v[48:51], a[44:47], v[76:79]
    v_mfma_f32_16x16x32_bf16 v[80:83], v[36:39], a[48:51], v[80:83]
    ds_read_b128 v[28:31], v4 offset:21504
    v_mfma_f32_16x16x32_bf16 v[80:83], v[40:43], a[52:55], v[80:83]
    buffer_load_dwordx4 v12, s[4:7], s29 offen offset:3072 lds
    v_mfma_f32_16x16x32_bf16 v[80:83], v[44:47], a[56:59], v[80:83]
    s_add_u32 m0, s31, 4096
    ds_read_b128 v[32:35], v4 offset:30720
    v_mfma_f32_16x16x32_bf16 v[80:83], v[48:51], a[60:63], v[80:83]
    s_waitcnt lgkmcnt(4)
    v_mfma_f32_16x16x32_bf16 v[84:87], v[52:55], a[32:35], v[84:87]
    ds_read_b128 v[36:39], v4 offset:4096
    v_mfma_f32_16x16x32_bf16 v[84:87], v[56:59], a[36:39], v[84:87]
    buffer_load_dwordx4 v13, s[4:7], s29 offen offset:0 lds
    v_mfma_f32_16x16x32_bf16 v[84:87], v[60:63], a[40:43], v[84:87]
    ds_read_b128 v[40:43], v4 offset:13312
    v_mfma_f32_16x16x32_bf16 v[84:87], v[64:67], a[44:47], v[84:87]
    v_mfma_f32_16x16x32_bf16 v[88:91], v[52:55], a[48:51], v[88:91]
    ds_read_b128 v[44:47], v4 offset:22528
    v_mfma_f32_16x16x32_bf16 v[88:91], v[56:59], a[52:55], v[88:91]
    buffer_load_dwordx4 v14, s[4:7], s29 offen offset:1024 lds
    v_mfma_f32_16x16x32_bf16 v[88:91], v[60:63], a[56:59], v[88:91]
    ds_read_b128 v[48:51], v4 offset:31744
    v_mfma_f32_16x16x32_bf16 v[88:91], v[64:67], a[60:63], v[88:91]
    s_waitcnt lgkmcnt(4)
    v_mfma_f32_16x16x32_bf16 v[92:95], v[20:23], a[32:35], v[92:95]
    ds_read_b128 v[52:55], v4 offset:5120
    v_mfma_f32_16x16x32_bf16 v[92:95], v[24:27], a[36:39], v[92:95]
    buffer_load_dwordx4 v15, s[4:7], s29 offen offset:2048 lds
    v_mfma_f32_16x16x32_bf16 v[92:95], v[28:31], a[40:43], v[92:95]
    ds_read_b128 v[56:59], v4 offset:14336
    v_mfma_f32_16x16x32_bf16 v[92:95], v[32:35], a[44:47], v[92:95]
    v_mfma_f32_16x16x32_bf16 v[96:99], v[20:23], a[48:51], v[96:99]
    ds_read_b128 v[60:63], v4 offset:23552
    v_mfma_f32_16x16x32_bf16 v[96:99], v[24:27], a[52:55], v[96:99]
    buffer_load_dwordx4 v16, s[4:7], s29 offen offset:3072 lds
    v_mfma_f32_16x16x32_bf16 v[96:99], v[28:31], a[56:59], v[96:99]
    s_add_u32 m0, s31, 8192
    ds_read_b128 v[64:67], v4 offset:32768
    v_mfma_f32_16x16x32_bf16 v[96:99], v[32:35], a[60:63], v[96:99]
    s_waitcnt lgkmcnt(4)
    v_mfma_f32_16x16x32_bf16 v[100:103], v[36:39], a[32:35], v[100:103]
    ds_read_b128 v[20:23], v4 offset:6144
    v_mfma_f32_16x16x32_bf16 v[100:103], v[40:43], a[36:39], v[100:103]
    buffer_load_dwordx4 v17, s[4:7], s29 offen offset:0 lds
    v_mfma_f32_16x16x32_bf16 v[100:103], v[44:47], a[40:43], v[100:103]
    s_add_u32 s29, s29, 147456
    ds_read_b128 v[24:27], v4 offset:15360
    v_mfma_f32_16x16x32_bf16 v[100:103], v[48:51], a[44:47], v[100:103]
    v_mfma_f32_16x16x32_bf16 v[104:107], v[36:39], a[48:51], v[104:107]
    ds_read_b128 v[28:31], v4 offset:24576
    v_mfma_f32_16x16x32_bf16 v[104:107], v[40:43], a[52:55], v[104:107]
    buffer_load_dwordx4 a[0:3], v2, s[8:11], s30 offen offset:0
    v_mfma_f32_16x16x32_bf16 v[104:107], v[44:47], a[56:59], v[104:107]
    ds_read_b128 v[32:35], v4 offset:33792
    v_mfma_f32_16x16x32_bf16 v[104:107], v[48:51], a[60:63], v[104:107]
    s_waitcnt lgkmcnt(4)
    v_mfma_f32_16x16x32_bf16 v[108:111], v[52:55], a[32:35], v[108:111]
    ds_read_b128 v[36:39], v4 offset:7168
    v_mfma_f32_16x16x32_bf16 v[108:111], v[56:59], a[36:39], v[108:111]
    buffer_load_dwordx4 a[4:7], v2, s[8:11], s30 offen offset:1024
    v_mfma_f32_16x16x32_bf16 v[108:111], v[60:63], a[40:43], v[108:111]
    ds_read_b128 v[40:43], v4 offset:16384
    v_mfma_f32_16x16x32_bf16 v[108:111], v[64:67], a[44:47], v[108:111]
    v_mfma_f32_16x16x32_bf16 v[112:115], v[52:55], a[48:51], v[112:115]
    ds_read_b128 v[44:47], v4 offset:25600
    v_mfma_f32_16x16x32_bf16 v[112:115], v[56:59], a[52:55], v[112:115]
    buffer_load_dwordx4 a[8:11], v2, s[8:11], s30 offen offset:2048
    v_mfma_f32_16x16x32_bf16 v[112:115], v[60:63], a[56:59], v[112:115]
    ds_read_b128 v[48:51], v4 offset:34816
    v_mfma_f32_16x16x32_bf16 v[112:115], v[64:67], a[60:63], v[112:115]
    s_waitcnt lgkmcnt(4)
    v_mfma_f32_16x16x32_bf16 v[116:119], v[20:23], a[32:35], v[116:119]
    ds_read_b128 v[52:55], v4 offset:8192
    v_mfma_f32_16x16x32_bf16 v[116:119], v[24:27], a[36:39], v[116:119]
    ds_read_b128 v[56:59], v4 offset:17408
    v_mfma_f32_16x16x32_bf16 v[116:119], v[28:31], a[40:43], v[116:119]
    ds_read_b128 v[60:63], v4 offset:26624
    v_mfma_f32_16x16x32_bf16 v[116:119], v[32:35], a[44:47], v[116:119]
    ds_read_b128 v[64:67], v4 offset:35840
    v_mfma_f32_16x16x32_bf16 v[120:123], v[20:23], a[48:51], v[120:123]
    buffer_load_dwordx4 a[12:15], v2, s[8:11], s30 offen offset:3072
    v_mfma_f32_16x16x32_bf16 v[120:123], v[24:27], a[52:55], v[120:123]
    v_mfma_f32_16x16x32_bf16 v[120:123], v[28:31], a[56:59], v[120:123]
    buffer_load_dwordx4 a[16:19], v8, s[8:11], s30 offen offset:0
    v_mfma_f32_16x16x32_bf16 v[120:123], v[32:35], a[60:63], v[120:123]
    s_waitcnt lgkmcnt(4)
    buffer_load_dwordx4 a[20:23], v8, s[8:11], s30 offen offset:1024
    v_mfma_f32_16x16x32_bf16 v[124:127], v[36:39], a[32:35], v[124:127]
    s_waitcnt vmcnt(40) lgkmcnt(0)
    s_barrier
    v_mfma_f32_16x16x32_bf16 v[124:127], v[40:43], a[36:39], v[124:127]
    ds_read_b128 v[20:23], v5 offset:0
    v_mfma_f32_16x16x32_bf16 v[124:127], v[44:47], a[40:43], v[124:127]
    ds_read_b128 v[24:27], v5 offset:9216
    v_mfma_f32_16x16x32_bf16 v[124:127], v[48:51], a[44:47], v[124:127]
    ds_read_b128 v[28:31], v5 offset:18432
    v_mfma_f32_16x16x32_bf16 v[128:131], v[36:39], a[48:51], v[128:131]
    ds_read_b128 v[32:35], v5 offset:27648
    v_mfma_f32_16x16x32_bf16 v[128:131], v[40:43], a[52:55], v[128:131]
    v_mfma_f32_16x16x32_bf16 v[128:131], v[44:47], a[56:59], v[128:131]
    buffer_load_dwordx4 a[24:27], v8, s[8:11], s30 offen offset:2048
    v_mfma_f32_16x16x32_bf16 v[128:131], v[48:51], a[60:63], v[128:131]
    v_mfma_f32_16x16x32_bf16 v[132:135], v[52:55], a[32:35], v[132:135]
    ds_read_b128 v[36:39], v5 offset:1024
    v_mfma_f32_16x16x32_bf16 v[132:135], v[56:59], a[36:39], v[132:135]
    buffer_load_dwordx4 a[28:31], v8, s[8:11], s30 offen offset:3072
    v_mfma_f32_16x16x32_bf16 v[132:135], v[60:63], a[40:43], v[132:135]
    s_add_u32 s30, s30, 4096
    ds_read_b128 v[40:43], v5 offset:10240
    v_mfma_f32_16x16x32_bf16 v[132:135], v[64:67], a[44:47], v[132:135]
    v_mfma_f32_16x16x32_bf16 v[136:139], v[52:55], a[48:51], v[136:139]
    ds_read_b128 v[44:47], v5 offset:19456
    v_mfma_f32_16x16x32_bf16 v[136:139], v[56:59], a[52:55], v[136:139]
    v_mfma_f32_16x16x32_bf16 v[136:139], v[60:63], a[56:59], v[136:139]
    s_waitcnt vmcnt(34)
    ds_read_b128 v[48:51], v5 offset:28672
    v_mfma_f32_16x16x32_bf16 v[136:139], v[64:67], a[60:63], v[136:139]
    s_waitcnt lgkmcnt(4)
    v_mfma_f32_16x16x32_bf16 v[68:71], v[20:23], a[64:67], v[68:71]
    s_add_u32 m0, s31, 36864
    ds_read_b128 v[52:55], v5 offset:2048
    v_mfma_f32_16x16x32_bf16 v[68:71], v[24:27], a[68:71], v[68:71]
    buffer_load_dwordx4 v9, s[4:7], s29 offen offset:0 lds
    v_mfma_f32_16x16x32_bf16 v[68:71], v[28:31], a[72:75], v[68:71]
    ds_read_b128 v[56:59], v5 offset:11264
    v_mfma_f32_16x16x32_bf16 v[68:71], v[32:35], a[76:79], v[68:71]
    v_mfma_f32_16x16x32_bf16 v[72:75], v[20:23], a[80:83], v[72:75]
    ds_read_b128 v[60:63], v5 offset:20480
    v_mfma_f32_16x16x32_bf16 v[72:75], v[24:27], a[84:87], v[72:75]
    buffer_load_dwordx4 v10, s[4:7], s29 offen offset:1024 lds
    v_mfma_f32_16x16x32_bf16 v[72:75], v[28:31], a[88:91], v[72:75]
    ds_read_b128 v[64:67], v5 offset:29696
    v_mfma_f32_16x16x32_bf16 v[72:75], v[32:35], a[92:95], v[72:75]
    s_waitcnt lgkmcnt(4)
    v_mfma_f32_16x16x32_bf16 v[76:79], v[36:39], a[64:67], v[76:79]
    ds_read_b128 v[20:23], v5 offset:3072
    v_mfma_f32_16x16x32_bf16 v[76:79], v[40:43], a[68:71], v[76:79]
    buffer_load_dwordx4 v11, s[4:7], s29 offen offset:2048 lds
    v_mfma_f32_16x16x32_bf16 v[76:79], v[44:47], a[72:75], v[76:79]
    ds_read_b128 v[24:27], v5 offset:12288
    v_mfma_f32_16x16x32_bf16 v[76:79], v[48:51], a[76:79], v[76:79]
    v_mfma_f32_16x16x32_bf16 v[80:83], v[36:39], a[80:83], v[80:83]
    ds_read_b128 v[28:31], v5 offset:21504
    v_mfma_f32_16x16x32_bf16 v[80:83], v[40:43], a[84:87], v[80:83]
    buffer_load_dwordx4 v12, s[4:7], s29 offen offset:3072 lds
    v_mfma_f32_16x16x32_bf16 v[80:83], v[44:47], a[88:91], v[80:83]
    s_add_u32 m0, s31, 40960
    ds_read_b128 v[32:35], v5 offset:30720
    v_mfma_f32_16x16x32_bf16 v[80:83], v[48:51], a[92:95], v[80:83]
    s_waitcnt lgkmcnt(4)
    v_mfma_f32_16x16x32_bf16 v[84:87], v[52:55], a[64:67], v[84:87]
    ds_read_b128 v[36:39], v5 offset:4096
    v_mfma_f32_16x16x32_bf16 v[84:87], v[56:59], a[68:71], v[84:87]
    buffer_load_dwordx4 v13, s[4:7], s29 offen offset:0 lds
    v_mfma_f32_16x16x32_bf16 v[84:87], v[60:63], a[72:75], v[84:87]
    ds_read_b128 v[40:43], v5 offset:13312
    v_mfma_f32_16x16x32_bf16 v[84:87], v[64:67], a[76:79], v[84:87]
    v_mfma_f32_16x16x32_bf16 v[88:91], v[52:55], a[80:83], v[88:91]
    ds_read_b128 v[44:47], v5 offset:22528
    v_mfma_f32_16x16x32_bf16 v[88:91], v[56:59], a[84:87], v[88:91]
    buffer_load_dwordx4 v14, s[4:7], s29 offen offset:1024 lds
    v_mfma_f32_16x16x32_bf16 v[88:91], v[60:63], a[88:91], v[88:91]
    ds_read_b128 v[48:51], v5 offset:31744
    v_mfma_f32_16x16x32_bf16 v[88:91], v[64:67], a[92:95], v[88:91]
    s_waitcnt lgkmcnt(4)
    v_mfma_f32_16x16x32_bf16 v[92:95], v[20:23], a[64:67], v[92:95]
    ds_read_b128 v[52:55], v5 offset:5120
    v_mfma_f32_16x16x32_bf16 v[92:95], v[24:27], a[68:71], v[92:95]
    buffer_load_dwordx4 v15, s[4:7], s29 offen offset:2048 lds
    v_mfma_f32_16x16x32_bf16 v[92:95], v[28:31], a[72:75], v[92:95]
    ds_read_b128 v[56:59], v5 offset:14336
    v_mfma_f32_16x16x32_bf16 v[92:95], v[32:35], a[76:79], v[92:95]
    v_mfma_f32_16x16x32_bf16 v[96:99], v[20:23], a[80:83], v[96:99]
    ds_read_b128 v[60:63], v5 offset:23552
    v_mfma_f32_16x16x32_bf16 v[96:99], v[24:27], a[84:87], v[96:99]
    buffer_load_dwordx4 v16, s[4:7], s29 offen offset:3072 lds
    v_mfma_f32_16x16x32_bf16 v[96:99], v[28:31], a[88:91], v[96:99]
    s_add_u32 m0, s31, 45056
    ds_read_b128 v[64:67], v5 offset:32768
    v_mfma_f32_16x16x32_bf16 v[96:99], v[32:35], a[92:95], v[96:99]
    s_waitcnt lgkmcnt(4)
    v_mfma_f32_16x16x32_bf16 v[100:103], v[36:39], a[64:67], v[100:103]
    ds_read_b128 v[20:23], v5 offset:6144
    v_mfma_f32_16x16x32_bf16 v[100:103], v[40:43], a[68:71], v[100:103]
    buffer_load_dwordx4 v17, s[4:7], s29 offen offset:0 lds
    v_mfma_f32_16x16x32_bf16 v[100:103], v[44:47], a[72:75], v[100:103]
    s_add_u32 s29, s29, 147456
    ds_read_b128 v[24:27], v5 offset:15360
    v_mfma_f32_16x16x32_bf16 v[100:103], v[48:51], a[76:79], v[100:103]
    v_mfma_f32_16x16x32_bf16 v[104:107], v[36:39], a[80:83], v[104:107]
    ds_read_b128 v[28:31], v5 offset:24576
    v_mfma_f32_16x16x32_bf16 v[104:107], v[40:43], a[84:87], v[104:107]
    buffer_load_dwordx4 a[32:35], v2, s[8:11], s30 offen offset:0
    v_mfma_f32_16x16x32_bf16 v[104:107], v[44:47], a[88:91], v[104:107]
    ds_read_b128 v[32:35], v5 offset:33792
    v_mfma_f32_16x16x32_bf16 v[104:107], v[48:51], a[92:95], v[104:107]
    s_waitcnt lgkmcnt(4)
    v_mfma_f32_16x16x32_bf16 v[108:111], v[52:55], a[64:67], v[108:111]
    ds_read_b128 v[36:39], v5 offset:7168
    v_mfma_f32_16x16x32_bf16 v[108:111], v[56:59], a[68:71], v[108:111]
    buffer_load_dwordx4 a[36:39], v2, s[8:11], s30 offen offset:1024
    v_mfma_f32_16x16x32_bf16 v[108:111], v[60:63], a[72:75], v[108:111]
    ds_read_b128 v[40:43], v5 offset:16384
    v_mfma_f32_16x16x32_bf16 v[108:111], v[64:67], a[76:79], v[108:111]
    v_mfma_f32_16x16x32_bf16 v[112:115], v[52:55], a[80:83], v[112:115]
    ds_read_b128 v[44:47], v5 offset:25600
    v_mfma_f32_16x16x32_bf16 v[112:115], v[56:59], a[84:87], v[112:115]
    buffer_load_dwordx4 a[40:43], v2, s[8:11], s30 offen offset:2048
    v_mfma_f32_16x16x32_bf16 v[112:115], v[60:63], a[88:91], v[112:115]
    ds_read_b128 v[48:51], v5 offset:34816
    v_mfma_f32_16x16x32_bf16 v[112:115], v[64:67], a[92:95], v[112:115]
    s_waitcnt lgkmcnt(4)
    v_mfma_f32_16x16x32_bf16 v[116:119], v[20:23], a[64:67], v[116:119]
    ds_read_b128 v[52:55], v5 offset:8192
    v_mfma_f32_16x16x32_bf16 v[116:119], v[24:27], a[68:71], v[116:119]
    ds_read_b128 v[56:59], v5 offset:17408
    v_mfma_f32_16x16x32_bf16 v[116:119], v[28:31], a[72:75], v[116:119]
    ds_read_b128 v[60:63], v5 offset:26624
    v_mfma_f32_16x16x32_bf16 v[116:119], v[32:35], a[76:79], v[116:119]
    ds_read_b128 v[64:67], v5 offset:35840
    v_mfma_f32_16x16x32_bf16 v[120:123], v[20:23], a[80:83], v[120:123]
    buffer_load_dwordx4 a[44:47], v2, s[8:11], s30 offen offset:3072
    v_mfma_f32_16x16x32_bf16 v[120:123], v[24:27], a[84:87], v[120:123]
    v_mfma_f32_16x16x32_bf16 v[120:123], v[28:31], a[88:91], v[120:123]
    buffer_load_dwordx4 a[48:51], v8, s[8:11], s30 offen offset:0
    v_mfma_f32_16x16x32_bf16 v[120:123], v[32:35], a[92:95], v[120:123]
    s_waitcnt lgkmcnt(4)
    buffer_load_dwordx4 a[52:55], v8, s[8:11], s30 offen offset:1024
    v_mfma_f32_16x16x32_bf16 v[124:127], v[36:39], a[64:67], v[124:127]
    s_waitcnt vmcnt(40) lgkmcnt(0)
    s_barrier
    v_mfma_f32_16x16x32_bf16 v[124:127], v[40:43], a[68:71], v[124:127]
    ds_read_b128 v[20:23], v6 offset:0
    v_mfma_f32_16x16x32_bf16 v[124:127], v[44:47], a[72:75], v[124:127]
    ds_read_b128 v[24:27], v6 offset:9216
    v_mfma_f32_16x16x32_bf16 v[124:127], v[48:51], a[76:79], v[124:127]
    ds_read_b128 v[28:31], v6 offset:18432
    v_mfma_f32_16x16x32_bf16 v[128:131], v[36:39], a[80:83], v[128:131]
    ds_read_b128 v[32:35], v6 offset:27648
    v_mfma_f32_16x16x32_bf16 v[128:131], v[40:43], a[84:87], v[128:131]
    v_mfma_f32_16x16x32_bf16 v[128:131], v[44:47], a[88:91], v[128:131]
    buffer_load_dwordx4 a[56:59], v8, s[8:11], s30 offen offset:2048
    v_mfma_f32_16x16x32_bf16 v[128:131], v[48:51], a[92:95], v[128:131]
    v_mfma_f32_16x16x32_bf16 v[132:135], v[52:55], a[64:67], v[132:135]
    ds_read_b128 v[36:39], v6 offset:1024
    v_mfma_f32_16x16x32_bf16 v[132:135], v[56:59], a[68:71], v[132:135]
    buffer_load_dwordx4 a[60:63], v8, s[8:11], s30 offen offset:3072
    v_mfma_f32_16x16x32_bf16 v[132:135], v[60:63], a[72:75], v[132:135]
    s_add_u32 s30, s30, 4096
    ds_read_b128 v[40:43], v6 offset:10240
    v_mfma_f32_16x16x32_bf16 v[132:135], v[64:67], a[76:79], v[132:135]
    v_mfma_f32_16x16x32_bf16 v[136:139], v[52:55], a[80:83], v[136:139]
    ds_read_b128 v[44:47], v6 offset:19456
    v_mfma_f32_16x16x32_bf16 v[136:139], v[56:59], a[84:87], v[136:139]
    v_mfma_f32_16x16x32_bf16 v[136:139], v[60:63], a[88:91], v[136:139]
    s_waitcnt vmcnt(34)
    ds_read_b128 v[48:51], v6 offset:28672
    v_mfma_f32_16x16x32_bf16 v[136:139], v[64:67], a[92:95], v[136:139]
    s_waitcnt lgkmcnt(4)
    s_sub_u32 s28, s28, 1
    s_cmp_lg_u32 s28, 0
    s_cbranch_scc1 L_k2_loop
L_k2_post:
    v_mfma_f32_16x16x32_bf16 v[68:71], v[20:23], a[96:99], v[68:71]
    ds_read_b128 v[52:55], v6 offset:2048
    v_mfma_f32_16x16x32_bf16 v[68:71], v[24:27], a[100:103], v[68:71]
    v_mfma_f32_16x16x32_bf16 v[68:71], v[28:31], a[104:107], v[68:71]
    ds_read_b128 v[56:59], v6 offset:11264
    v_mfma_f32_16x16x32_bf16 v[68:71], v[32:35], a[108:111], v[68:71]
    v_mfma_f32_16x16x32_bf16 v[72:75], v[20:23], a[112:115], v[72:75]
    ds_read_b128 v[60:63], v6 offset:20480
    v_mfma_f32_16x16x32_bf16 v[72:75], v[24:27], a[116:119], v[72:75]
    v_mfma_f32_16x16x32_bf16 v[72:75], v[28:31], a[120:123], v[72:75]
    ds_read_b128 v[64:67], v6 offset:29696
    v_mfma_f32_16x16x32_bf16 v[72:75], v[32:35], a[124:127], v[72:75]
    s_waitcnt lgkmcnt(4)
    v_mfma_f32_16x16x32_bf16 v[76:79], v[36:39], a[96:99], v[76:79]
    ds_read_b128 v[20:23], v6 offset:3072
    v_mfma_f32_16x16x32_bf16 v[76:79], v[40:43], a[100:103], v[76:79]
    v_mfma_f32_16x16x32_bf16 v[76:79], v[44:47], a[104:107], v[76:79]
    ds_read_b128 v[24:27], v6 offset:12288
    v_mfma_f32_16x16x32_bf16 v[76:79], v[48:51], a[108:111], v[76:79]
    v_mfma_f32_16x16x32_bf16 v[80:83], v[36:39], a[112:115], v[80:83]
    ds_read_b128 v[28:31], v6 offset:21504
    v_mfma_f32_16x16x32_bf16 v[80:83], v[40:43], a[116:119], v[80:83]
    v_mfma_f32_16x16x32_bf16 v[80:83], v[44:47], a[120:123], v[80:83]
    ds_read_b128 v[32:35], v6 offset:30720
    v_mfma_f32_16x16x32_bf16 v[80:83], v[48:51], a[124:127], v[80:83]
    s_waitcnt lgkmcnt(4)
    v_mfma_f32_16x16x32_bf16 v[84:87], v[52:55], a[96:99], v[84:87]
    ds_read_b128 v[36:39], v6 offset:4096
    v_mfma_f32_16x16x32_bf16 v[84:87], v[56:59], a[100:103], v[84:87]
    v_mfma_f32_16x16x32_bf16 v[84:87], v[60:63], a[104:107], v[84:87]
    ds_read_b128 v[40:43], v6 offset:13312
    v_mfma_f32_16x16x32_bf16 v[84:87], v[64:67], a[108:111], v[84:87]
    v_mfma_f32_16x16x32_bf16 v[88:91], v[52:55], a[112:115], v[88:91]
    ds_read_b128 v[44:47], v6 offset:22528
    v_mfma_f32_16x16x32_bf16 v[88:91], v[56:59], a[116:119], v[88:91]
    v_mfma_f32_16x16x32_bf16 v[88:91], v[60:63], a[120:123], v[88:91]
    ds_read_b128 v[48:51], v6 offset:31744
    v_mfma_f32_16x16x32_bf16 v[88:91], v[64:67], a[124:127], v[88:91]
    s_waitcnt lgkmcnt(4)
    v_mfma_f32_16x16x32_bf16 v[92:95], v[20:23], a[96:99], v[92:95]
    ds_read_b128 v[52:55], v6 offset:5120
    v_mfma_f32_16x16x32_bf16 v[92:95], v[24:27], a[100:103], v[92:95]
    v_mfma_f32_16x16x32_bf16 v[92:95], v[28:31], a[104:107], v[92:95]
    ds_read_b128 v[56:59], v6 offset:14336
    v_mfma_f32_16x16x32_bf16 v[92:95], v[32:35], a[108:111], v[92:95]
    v_mfma_f32_16x16x32_bf16 v[96:99], v[20:23], a[112:115], v[96:99]
    ds_read_b128 v[60:63], v6 offset:23552
    v_mfma_f32_16x16x32_bf16 v[96:99], v[24:27], a[116:119], v[96:99]
    v_mfma_f32_16x16x32_bf16 v[96:99], v[28:31], a[120:123], v[96:99]
    ds_read_b128 v[64:67], v6 offset:32768
    v_mfma_f32_16x16x32_bf16 v[96:99], v[32:35], a[124:127], v[96:99]
    s_waitcnt lgkmcnt(4)
    v_mfma_f32_16x16x32_bf16 v[100:103], v[36:39], a[96:99], v[100:103]
    ds_read_b128 v[20:23], v6 offset:6144
    v_mfma_f32_16x16x32_bf16 v[100:103], v[40:43], a[100:103], v[100:103]
    v_mfma_f32_16x16x32_bf16 v[100:103], v[44:47], a[104:107], v[100:103]
    ds_read_b128 v[24:27], v6 offset:15360
    v_mfma_f32_16x16x32_bf16 v[100:103], v[48:51], a[108:111], v[100:103]
    v_mfma_f32_16x16x32_bf16 v[104:107], v[36:39], a[112:115], v[104:107]
    ds_read_b128 v[28:31], v6 offset:24576
    v_mfma_f32_16x16x32_bf16 v[104:107], v[40:43], a[116:119], v[104:107]
    v_mfma_f32_16x16x32_bf16 v[104:107], v[44:47], a[120:123], v[104:107]
    ds_read_b128 v[32:35], v6 offset:33792
    v_mfma_f32_16x16x32_bf16 v[104:107], v[48:51], a[124:127], v[104:107]
    s_waitcnt lgkmcnt(4)
    v_mfma_f32_16x16x32_bf16 v[108:111], v[52:55], a[96:99], v[108:111]
    ds_read_b128 v[36:39], v6 offset:7168
    v_mfma_f32_16x16x32_bf16 v[108:111], v[56:59], a[100:103], v[108:111]
    v_mfma_f32_16x16x32_bf16 v[108:111], v[60:63], a[104:107], v[108:111]
    ds_read_b128 v[40:43], v6 offset:16384
    v_mfma_f32_16x16x32_bf16 v[108:111], v[64:67], a[108:111], v[108:111]
    v_mfma_f32_16x16x32_bf16 v[112:115], v[52:55], a[112:115], v[112:115]
    ds_read_b128 v[44:47], v6 offset:25600
    v_mfma_f32_16x16x32_bf16 v[112:115], v[56:59], a[116:119], v[112:115]
    v_mfma_f32_16x16x32_bf16 v[112:115], v[60:63], a[120:123], v[112:115]
    ds_read_b128 v[48:51], v6 offset:34816
    v_mfma_f32_16x16x32_bf16 v[112:115], v[64:67], a[124:127], v[112:115]
    s_waitcnt lgkmcnt(4)
    v_mfma_f32_16x16x32_bf16 v[116:119], v[20:23], a[96:99], v[116:119]
    ds_read_b128 v[52:55], v6 offset:8192
    v_mfma_f32_16x16x32_bf16 v[116:119], v[24:27], a[100:103], v[116:119]
    ds_read_b128 v[56:59], v6 offset:17408
    v_mfma_f32_16x16x32_bf16 v[116:119], v[28:31], a[104:107], v[116:119]
    ds_read_b128 v[60:63], v6 offset:26624
    v_mfma_f32_16x16x32_bf16 v[116:119], v[32:35], a[108:111], v[116:119]
    ds_read_b128 v[64:67], v6 offset:35840
    v_mfma_f32_16x16x32_bf16 v[120:123], v[20:23], a[112:115], v[120:123]
    v_mfma_f32_16x16x32_bf16 v[120:123], v[24:27], a[116:119], v[120:123]
    v_mfma_f32_16x16x32_bf16 v[120:123], v[28:31], a[120:123], v[120:123]
    v_mfma_f32_16x16x32_bf16 v[120:123], v[32:35], a[124:127], v[120:123]
    s_waitcnt lgkmcnt(4)
    v_mfma_f32_16x16x32_bf16 v[124:127], v[36:39], a[96:99], v[124:127]
    s_waitcnt vmcnt(8) lgkmcnt(0)
    s_barrier
    v_mfma_f32_16x16x32_bf16 v[124:127], v[40:43], a[100:103], v[124:127]
    ds_read_b128 v[20:23], v3 offset:0
    v_mfma_f32_16x16x32_bf16 v[124:127], v[44:47], a[104:107], v[124:127]
    ds_read_b128 v[24:27], v3 offset:9216
    v_mfma_f32_16x16x32_bf16 v[124:127], v[48:51], a[108:111], v[124:127]
    ds_read_b128 v[28:31], v3 offset:18432
    v_mfma_f32_16x16x32_bf16 v[128:131], v[36:39], a[112:115], v[128:131]
    ds_read_b128 v[32:35], v3 offset:27648
    v_mfma_f32_16x16x32_bf16 v[128:131], v[40:43], a[116:119], v[128:131]
    v_mfma_f32_16x16x32_bf16 v[128:131], v[44:47], a[120:123], v[128:131]
    v_mfma_f32_16x16x32_bf16 v[128:131], v[48:51], a[124:127], v[128:131]
    v_mfma_f32_16x16x32_bf16 v[132:135], v[52:55], a[96:99], v[132:135]
    ds_read_b128 v[36:39], v4 offset:0
    v_mfma_f32_16x16x32_bf16 v[132:135], v[56:59], a[100:103], v[132:135]
    v_mfma_f32_16x16x32_bf16 v[132:135], v[60:63], a[104:107], v[132:135]
    ds_read_b128 v[40:43], v4 offset:9216
    v_mfma_f32_16x16x32_bf16 v[132:135], v[64:67], a[108:111], v[132:135]
    v_mfma_f32_16x16x32_bf16 v[136:139], v[52:55], a[112:115], v[136:139]
    ds_read_b128 v[44:47], v4 offset:18432
    v_mfma_f32_16x16x32_bf16 v[136:139], v[56:59], a[116:119], v[136:139]
    v_mfma_f32_16x16x32_bf16 v[136:139], v[60:63], a[120:123], v[136:139]
    s_waitcnt vmcnt(0)
    ds_read_b128 v[48:51], v4 offset:27648
    v_mfma_f32_16x16x32_bf16 v[136:139], v[64:67], a[124:127], v[136:139]
    s_waitcnt lgkmcnt(4)
    v_mfma_f32_16x16x32_bf16 v[68:71], v[20:23], a[0:3], v[68:71]
    ds_read_b128 v[52:55], v3 offset:1024
    v_mfma_f32_16x16x32_bf16 v[68:71], v[24:27], a[4:7], v[68:71]
    buffer_load_dwordx2 v[140:141], v7, s[20:23], s61 offen offset:0
    v_mfma_f32_16x16x32_bf16 v[68:71], v[28:31], a[8:11], v[68:71]
    ds_read_b128 v[56:59], v3 offset:10240
    v_mfma_f32_16x16x32_bf16 v[68:71], v[32:35], a[12:15], v[68:71]
    buffer_load_dwordx2 v[142:143], v7, s[20:23], s62 offen offset:0
    v_mfma_f32_16x16x32_bf16 v[72:75], v[20:23], a[16:19], v[72:75]
    ds_read_b128 v[60:63], v3 offset:19456
    v_mfma_f32_16x16x32_bf16 v[72:75], v[24:27], a[20:23], v[72:75]
    buffer_load_dwordx2 v[144:145], v7, s[20:23], s61 offen offset:128
    v_mfma_f32_16x16x32_bf16 v[72:75], v[28:31], a[24:27], v[72:75]
    ds_read_b128 v[64:67], v3 offset:28672
    v_mfma_f32_16x16x32_bf16 v[72:75], v[32:35], a[28:31], v[72:75]
    s_waitcnt lgkmcnt(4)
    buffer_load_dwordx2 v[146:147], v7, s[20:23], s62 offen offset:128
    v_mfma_f32_16x16x32_bf16 v[68:71], v[36:39], a[32:35], v[68:71]
    ds_read_b128 v[20:23], v4 offset:1024
    v_mfma_f32_16x16x32_bf16 v[68:71], v[40:43], a[36:39], v[68:71]
    buffer_load_dwordx2 v[148:149], v7, s[20:23], s40 offen offset:256
    v_mfma_f32_16x16x32_bf16 v[68:71], v[44:47], a[40:43], v[68:71]
    ds_read_b128 v[24:27], v4 offset:10240
    v_mfma_f32_16x16x32_bf16 v[68:71], v[48:51], a[44:47], v[68:71]
    v_mfma_f32_16x16x32_bf16 v[72:75], v[36:39], a[48:51], v[72:75]
    ds_read_b128 v[28:31], v4 offset:19456
    v_mfma_f32_16x16x32_bf16 v[72:75], v[40:43], a[52:55], v[72:75]
    v_mfma_f32_16x16x32_bf16 v[72:75], v[44:47], a[56:59], v[72:75]
    ds_read_b128 v[32:35], v4 offset:28672
    v_mfma_f32_16x16x32_bf16 v[72:75], v[48:51], a[60:63], v[72:75]
    s_waitcnt lgkmcnt(4)
    v_mfma_f32_16x16x32_bf16 v[76:79], v[52:55], a[0:3], v[76:79]
    ds_read_b128 v[36:39], v3 offset:2048
    v_mfma_f32_16x16x32_bf16 v[76:79], v[56:59], a[4:7], v[76:79]
    v_mfma_f32_16x16x32_bf16 v[76:79], v[60:63], a[8:11], v[76:79]
    ds_read_b128 v[40:43], v3 offset:11264
    v_mfma_f32_16x16x32_bf16 v[76:79], v[64:67], a[12:15], v[76:79]
    v_mfma_f32_16x16x32_bf16 v[80:83], v[52:55], a[16:19], v[80:83]
    ds_read_b128 v[44:47], v3 offset:20480
    v_mfma_f32_16x16x32_bf16 v[80:83], v[56:59], a[20:23], v[80:83]
    v_cvt_pk_bf16_f32 v156, v68, v69
    v_cvt_pk_bf16_f32 v157, v70, v71
    v_mfma_f32_16x16x32_bf16 v[80:83], v[60:63], a[24:27], v[80:83]
    ds_read_b128 v[48:51], v3 offset:29696
    v_cvt_pk_bf16_f32 v158, v72, v73
    v_mfma_f32_16x16x32_bf16 v[80:83], v[64:67], a[28:31], v[80:83]
    s_waitcnt lgkmcnt(4)
    v_cvt_pk_bf16_f32 v159, v74, v75
    v_mfma_f32_16x16x32_bf16 v[76:79], v[20:23], a[32:35], v[76:79]
    ds_read_b128 v[52:55], v4 offset:2048
    v_mfma_f32_16x16x32_bf16 v[76:79], v[24:27], a[36:39], v[76:79]
    buffer_store_dwordx4 v[156:159], v2, s[16:19], s56 offen offset:0 sc1
    v_mfma_f32_16x16x32_bf16 v[76:79], v[28:31], a[40:43], v[76:79]
    ds_read_b128 v[56:59], v4 offset:11264
    v_mfma_f32_16x16x32_bf16 v[76:79], v[32:35], a[44:47], v[76:79]
    v_mfma_f32_16x16x32_bf16 v[80:83], v[20:23], a[48:51], v[80:83]
    ds_read_b128 v[60:63], v4 offset:20480
    v_mfma_f32_16x16x32_bf16 v[80:83], v[24:27], a[52:55], v[80:83]
    v_mfma_f32_16x16x32_bf16 v[80:83], v[28:31], a[56:59], v[80:83]
    ds_read_b128 v[64:67], v4 offset:29696
    v_mfma_f32_16x16x32_bf16 v[80:83], v[32:35], a[60:63], v[80:83]
    s_waitcnt lgkmcnt(4)
    v_mfma_f32_16x16x32_bf16 v[84:87], v[36:39], a[0:3], v[84:87]
    ds_read_b128 v[20:23], v3 offset:3072
    v_mfma_f32_16x16x32_bf16 v[84:87], v[40:43], a[4:7], v[84:87]
    v_mfma_f32_16x16x32_bf16 v[84:87], v[44:47], a[8:11], v[84:87]
    ds_read_b128 v[24:27], v3 offset:12288
    v_mfma_f32_16x16x32_bf16 v[84:87], v[48:51], a[12:15], v[84:87]
    v_mfma_f32_16x16x32_bf16 v[88:91], v[36:39], a[16:19], v[88:91]
    ds_read_b128 v[28:31], v3 offset:21504
    v_mfma_f32_16x16x32_bf16 v[88:91], v[40:43], a[20:23], v[88:91]
    v_cvt_pk_bf16_f32 v160, v76, v77
    v_cvt_pk_bf16_f32 v161, v78, v79
    v_mfma_f32_16x16x32_bf16 v[88:91], v[44:47], a[24:27], v[88:91]
    ds_read_b128 v[32:35], v3 offset:30720
    v_cvt_pk_bf16_f32 v162, v80, v81
    v_mfma_f32_16x16x32_bf16 v[88:91], v[48:51], a[28:31], v[88:91]
    s_waitcnt lgkmcnt(4)
    v_cvt_pk_bf16_f32 v163, v82, v83
    v_mfma_f32_16x16x32_bf16 v[84:87], v[52:55], a[32:35], v[84:87]
    ds_read_b128 v[36:39], v4 offset:3072
    v_mfma_f32_16x16x32_bf16 v[84:87], v[56:59], a[36:39], v[84:87]
    buffer_store_dwordx4 v[160:163], v2, s[16:19], s56 offen offset:1024 sc1
    v_mfma_f32_16x16x32_bf16 v[84:87], v[60:63], a[40:43], v[84:87]
    ds_read_b128 v[40:43], v4 offset:12288
    v_mfma_f32_16x16x32_bf16 v[84:87], v[64:67], a[44:47], v[84:87]
    v_mfma_f32_16x16x32_bf16 v[88:91], v[52:55], a[48:51], v[88:91]
    ds_read_b128 v[44:47], v4 offset:21504
    v_mfma_f32_16x16x32_bf16 v[88:91], v[56:59], a[52:55], v[88:91]
    v_mfma_f32_16x16x32_bf16 v[88:91], v[60:63], a[56:59], v[88:91]
    ds_read_b128 v[48:51], v4 offset:30720
    v_mfma_f32_16x16x32_bf16 v[88:91], v[64:67], a[60:63], v[88:91]
    s_waitcnt lgkmcnt(4)
    v_mfma_f32_16x16x32_bf16 v[92:95], v[20:23], a[0:3], v[92:95]
    ds_read_b128 v[52:55], v3 offset:4096
    v_mfma_f32_16x16x32_bf16 v[92:95], v[24:27], a[4:7], v[92:95]
    v_mfma_f32_16x16x32_bf16 v[92:95], v[28:31], a[8:11], v[92:95]
    ds_read_b128 v[56:59], v3 offset:13312
    v_mfma_f32_16x16x32_bf16 v[92:95], v[32:35], a[12:15], v[92:95]
    v_mfma_f32_16x16x32_bf16 v[96:99], v[20:23], a[16:19], v[96:99]
    ds_read_b128 v[60:63], v3 offset:22528
    v_mfma_f32_16x16x32_bf16 v[96:99], v[24:27], a[20:23], v[96:99]
    v_cvt_pk_bf16_f32 v164, v84, v85
    v_cvt_pk_bf16_f32 v165, v86, v87
    v_mfma_f32_16x16x32_bf16 v[96:99], v[28:31], a[24:27], v[96:99]
    ds_read_b128 v[64:67], v3 offset:31744
    v_cvt_pk_bf16_f32 v166, v88, v89
    v_mfma_f32_16x16x32_bf16 v[96:99], v[32:35], a[28:31], v[96:99]
    s_waitcnt lgkmcnt(4)
    v_cvt_pk_bf16_f32 v167, v90, v91
    v_mfma_f32_16x16x32_bf16 v[92:95], v[36:39], a[32:35], v[92:95]
    ds_read_b128 v[20:23], v4 offset:4096
    v_mfma_f32_16x16x32_bf16 v[92:95], v[40:43], a[36:39], v[92:95]
    buffer_store_dwordx4 v[164:167], v2, s[16:19], s57 offen offset:0 sc1
    v_mfma_f32_16x16x32_bf16 v[92:95], v[44:47], a[40:43], v[92:95]
    ds_read_b128 v[24:27], v4 offset:13312
    v_mfma_f32_16x16x32_bf16 v[92:95], v[48:51], a[44:47], v[92:95]
    v_mfma_f32_16x16x32_bf16 v[96:99], v[36:39], a[48:51], v[96:99]
    ds_read_b128 v[28:31], v4 offset:22528
    v_mfma_f32_16x16x32_bf16 v[96:99], v[40:43], a[52:55], v[96:99]
    v_mfma_f32_16x16x32_bf16 v[96:99], v[44:47], a[56:59], v[96:99]
    ds_read_b128 v[32:35], v4 offset:31744
    v_mfma_f32_16x16x32_bf16 v[96:99], v[48:51], a[60:63], v[96:99]
    s_waitcnt lgkmcnt(4)
    v_mfma_f32_16x16x32_bf16 v[100:103], v[52:55], a[0:3], v[100:103]
    ds_read_b128 v[36:39], v3 offset:5120
    v_mfma_f32_16x16x32_bf16 v[100:103], v[56:59], a[4:7], v[100:103]
    v_mfma_f32_16x16x32_bf16 v[100:103], v[60:63], a[8:11], v[100:103]
    ds_read_b128 v[40:43], v3 offset:14336
    v_mfma_f32_16x16x32_bf16 v[100:103], v[64:67], a[12:15], v[100:103]
    v_mfma_f32_16x16x32_bf16 v[104:107], v[52:55], a[16:19], v[104:107]
    ds_read_b128 v[44:47], v3 offset:23552
    v_mfma_f32_16x16x32_bf16 v[104:107], v[56:59], a[20:23], v[104:107]
    v_cvt_pk_bf16_f32 v168, v92, v93
    v_cvt_pk_bf16_f32 v169, v94, v95
    v_mfma_f32_16x16x32_bf16 v[104:107], v[60:63], a[24:27], v[104:107]
    ds_read_b128 v[48:51], v3 offset:32768
    v_cvt_pk_bf16_f32 v170, v96, v97
    v_mfma_f32_16x16x32_bf16 v[104:107], v[64:67], a[28:31], v[104:107]
    s_waitcnt lgkmcnt(4)
    v_cvt_pk_bf16_f32 v171, v98, v99
    v_mfma_f32_16x16x32_bf16 v[100:103], v[20:23], a[32:35], v[100:103]
    ds_read_b128 v[52:55], v4 offset:5120
    v_mfma_f32_16x16x32_bf16 v[100:103], v[24:27], a[36:39], v[100:103]
    buffer_store_dwordx4 v[168:171], v2, s[16:19], s57 offen offset:1024 sc1
    v_mfma_f32_16x16x32_bf16 v[100:103], v[28:31], a[40:43], v[100:103]
    ds_read_b128 v[56:59], v4 offset:14336
    v_mfma_f32_16x16x32_bf16 v[100:103], v[32:35], a[44:47], v[100:103]
    v_mfma_f32_16x16x32_bf16 v[104:107], v[20:23], a[48:51], v[104:107]
    ds_read_b128 v[60:63], v4 offset:23552
    v_mfma_f32_16x16x32_bf16 v[104:107], v[24:27], a[52:55], v[104:107]
    v_mfma_f32_16x16x32_bf16 v[104:107], v[28:31], a[56:59], v[104:107]
    ds_read_b128 v[64:67], v4 offset:32768
    v_mfma_f32_16x16x32_bf16 v[104:107], v[32:35], a[60:63], v[104:107]
    s_waitcnt lgkmcnt(4)
    v_mfma_f32_16x16x32_bf16 v[108:111], v[36:39], a[0:3], v[108:111]
    ds_read_b128 v[20:23], v3 offset:6144
    v_mfma_f32_16x16x32_bf16 v[108:111], v[40:43], a[4:7], v[108:111]
    v_mfma_f32_16x16x32_bf16 v[108:111], v[44:47], a[8:11], v[108:111]
    ds_read_b128 v[24:27], v3 offset:15360
    v_mfma_f32_16x16x32_bf16 v[108:111], v[48:51], a[12:15], v[108:111]
    v_mfma_f32_16x16x32_bf16 v[112:115], v[36:39], a[16:19], v[112:115]
    ds_read_b128 v[28:31], v3 offset:24576
    v_mfma_f32_16x16x32_bf16 v[112:115], v[40:43], a[20:23], v[112:115]
    v_cvt_pk_bf16_f32 v172, v100, v101
    v_cvt_pk_bf16_f32 v173, v102, v103
    v_mfma_f32_16x16x32_bf16 v[112:115], v[44:47], a[24:27], v[112:115]
    ds_read_b128 v[32:35], v3 offset:33792
    v_cvt_pk_bf16_f32 v174, v104, v105
    v_mfma_f32_16x16x32_bf16 v[112:115], v[48:51], a[28:31], v[112:115]
    s_waitcnt lgkmcnt(4)
    v_cvt_pk_bf16_f32 v175, v106, v107
    v_mfma_f32_16x16x32_bf16 v[108:111], v[52:55], a[32:35], v[108:111]
    ds_read_b128 v[36:39], v4 offset:6144
    v_mfma_f32_16x16x32_bf16 v[108:111], v[56:59], a[36:39], v[108:111]
    buffer_store_dwordx4 v[172:175], v2, s[16:19], s58 offen offset:0 sc1
    v_mfma_f32_16x16x32_bf16 v[108:111], v[60:63], a[40:43], v[108:111]
    ds_read_b128 v[40:43], v4 offset:15360
    v_mfma_f32_16x16x32_bf16 v[108:111], v[64:67], a[44:47], v[108:111]
    v_mfma_f32_16x16x32_bf16 v[112:115], v[52:55], a[48:51], v[112:115]
    ds_read_b128 v[44:47], v4 offset:24576
    v_mfma_f32_16x16x32_bf16 v[112:115], v[56:59], a[52:55], v[112:115]
    v_mfma_f32_16x16x32_bf16 v[112:115], v[60:63], a[56:59], v[112:115]
    ds_read_b128 v[48:51], v4 offset:33792
    v_mfma_f32_16x16x32_bf16 v[112:115], v[64:67], a[60:63], v[112:115]
    s_waitcnt lgkmcnt(4)
    v_mfma_f32_16x16x32_bf16 v[116:119], v[20:23], a[0:3], v[116:119]
    ds_read_b128 v[52:55], v3 offset:7168
    v_mfma_f32_16x16x32_bf16 v[116:119], v[24:27], a[4:7], v[116:119]
    v_mfma_f32_16x16x32_bf16 v[116:119], v[28:31], a[8:11], v[116:119]
    ds_read_b128 v[56:59], v3 offset:16384
    v_mfma_f32_16x16x32_bf16 v[116:119], v[32:35], a[12:15], v[116:119]
    v_mfma_f32_16x16x32_bf16 v[120:123], v[20:23], a[16:19], v[120:123]
    ds_read_b128 v[60:63], v3 offset:25600
    v_mfma_f32_16x16x32_bf16 v[120:123], v[24:27], a[20:23], v[120:123]
    v_cvt_pk_bf16_f32 v176, v108, v109
    v_cvt_pk_bf16_f32 v177, v110, v111
    v_mfma_f32_16x16x32_bf16 v[120:123], v[28:31], a[24:27], v[120:123]
    ds_read_b128 v[64:67], v3 offset:34816
    v_cvt_pk_bf16_f32 v178, v112, v113
    v_mfma_f32_16x16x32_bf16 v[120:123], v[32:35], a[28:31], v[120:123]
    s_waitcnt lgkmcnt(4)
    v_cvt_pk_bf16_f32 v179, v114, v115
    v_mfma_f32_16x16x32_bf16 v[116:119], v[36:39], a[32:35], v[116:119]
    ds_read_b128 v[20:23], v4 offset:7168
    v_mfma_f32_16x16x32_bf16 v[116:119], v[40:43], a[36:39], v[116:119]
    buffer_store_dwordx4 v[176:179], v2, s[16:19], s58 offen offset:1024 sc1
    v_mfma_f32_16x16x32_bf16 v[116:119], v[44:47], a[40:43], v[116:119]
    ds_read_b128 v[24:27], v4 offset:16384
    v_mfma_f32_16x16x32_bf16 v[116:119], v[48:51], a[44:47], v[116:119]
    v_mfma_f32_16x16x32_bf16 v[120:123], v[36:39], a[48:51], v[120:123]
    ds_read_b128 v[28:31], v4 offset:25600
    v_mfma_f32_16x16x32_bf16 v[120:123], v[40:43], a[52:55], v[120:123]
    v_mfma_f32_16x16x32_bf16 v[120:123], v[44:47], a[56:59], v[120:123]
    ds_read_b128 v[32:35], v4 offset:34816
    v_mfma_f32_16x16x32_bf16 v[120:123], v[48:51], a[60:63], v[120:123]
    s_waitcnt lgkmcnt(4)
    v_mfma_f32_16x16x32_bf16 v[124:127], v[52:55], a[0:3], v[124:127]
    ds_read_b128 v[36:39], v3 offset:8192
    v_mfma_f32_16x16x32_bf16 v[124:127], v[56:59], a[4:7], v[124:127]
    v_mfma_f32_16x16x32_bf16 v[124:127], v[60:63], a[8:11], v[124:127]
    ds_read_b128 v[40:43], v3 offset:17408
    v_mfma_f32_16x16x32_bf16 v[124:127], v[64:67], a[12:15], v[124:127]
    v_mfma_f32_16x16x32_bf16 v[128:131], v[52:55], a[16:19], v[128:131]
    ds_read_b128 v[44:47], v3 offset:26624
    v_mfma_f32_16x16x32_bf16 v[128:131], v[56:59], a[20:23], v[128:131]
    v_cvt_pk_bf16_f32 v180, v116, v117
    v_cvt_pk_bf16_f32 v181, v118, v119
    v_mfma_f32_16x16x32_bf16 v[128:131], v[60:63], a[24:27], v[128:131]
    ds_read_b128 v[48:51], v3 offset:35840
    v_cvt_pk_bf16_f32 v182, v120, v121
    v_mfma_f32_16x16x32_bf16 v[128:131], v[64:67], a[28:31], v[128:131]
    s_waitcnt lgkmcnt(4)
    v_cvt_pk_bf16_f32 v183, v122, v123
    v_mfma_f32_16x16x32_bf16 v[124:127], v[20:23], a[32:35], v[124:127]
    ds_read_b128 v[52:55], v4 offset:8192
    v_mfma_f32_16x16x32_bf16 v[124:127], v[24:27], a[36:39], v[124:127]
    buffer_store_dwordx4 v[180:183], v2, s[16:19], s59 offen offset:0 sc1
    v_mfma_f32_16x16x32_bf16 v[124:127], v[28:31], a[40:43], v[124:127]
    ds_read_b128 v[56:59], v4 offset:17408
    v_mfma_f32_16x16x32_bf16 v[124:127], v[32:35], a[44:47], v[124:127]
    v_mfma_f32_16x16x32_bf16 v[128:131], v[20:23], a[48:51], v[128:131]
    ds_read_b128 v[60:63], v4 offset:26624
    v_mfma_f32_16x16x32_bf16 v[128:131], v[24:27], a[52:55], v[128:131]
    v_mfma_f32_16x16x32_bf16 v[128:131], v[28:31], a[56:59], v[128:131]
    ds_read_b128 v[64:67], v4 offset:35840
    v_mfma_f32_16x16x32_bf16 v[128:131], v[32:35], a[60:63], v[128:131]
    s_waitcnt lgkmcnt(4)
    v_mfma_f32_16x16x32_bf16 v[132:135], v[36:39], a[0:3], v[132:135]
    v_mfma_f32_16x16x32_bf16 v[132:135], v[40:43], a[4:7], v[132:135]
    v_mfma_f32_16x16x32_bf16 v[132:135], v[44:47], a[8:11], v[132:135]
    v_mfma_f32_16x16x32_bf16 v[132:135], v[48:51], a[12:15], v[132:135]
    v_mfma_f32_16x16x32_bf16 v[136:139], v[36:39], a[16:19], v[136:139]
    v_mfma_f32_16x16x32_bf16 v[136:139], v[40:43], a[20:23], v[136:139]
    v_mfma_f32_16x16x32_bf16 v[136:139], v[44:47], a[24:27], v[136:139]
    v_mfma_f32_16x16x32_bf16 v[136:139], v[48:51], a[28:31], v[136:139]
    s_waitcnt lgkmcnt(0)
    v_mfma_f32_16x16x32_bf16 v[132:135], v[52:55], a[32:35], v[132:135]
    v_mfma_f32_16x16x32_bf16 v[132:135], v[56:59], a[36:39], v[132:135]
    v_mfma_f32_16x16x32_bf16 v[132:135], v[60:63], a[40:43], v[132:135]
    v_mfma_f32_16x16x32_bf16 v[132:135], v[64:67], a[44:47], v[132:135]
    v_mfma_f32_16x16x32_bf16 v[136:139], v[52:55], a[48:51], v[136:139]
    v_mfma_f32_16x16x32_bf16 v[136:139], v[56:59], a[52:55], v[136:139]
    v_mfma_f32_16x16x32_bf16 v[136:139], v[60:63], a[56:59], v[136:139]
    v_mfma_f32_16x16x32_bf16 v[136:139], v[64:67], a[60:63], v[136:139]
    s_waitcnt vmcnt(0)
    s_mov_b32 s38, 20000
    s_cmp_lt_u32 s25, 2
    s_cbranch_scc1 L_k2_sfin
L_k2_rd:
    s_add_u32 s37, s60, 0
    buffer_load_dwordx4 v[20:23], v2, s[16:19], s37 offen offset:0 sc1
    buffer_load_dwordx4 v[24:27], v2, s[16:19], s37 offen offset:1024 sc1
    s_add_u32 s37, s60, 2048
    buffer_load_dwordx4 v[28:31], v2, s[16:19], s37 offen offset:0 sc1
    buffer_load_dwordx4 v[32:35], v2, s[16:19], s37 offen offset:1024 sc1
    s_add_u32 s37, s60, 4096
    buffer_load_dwordx4 v[36:39], v2, s[16:19], s37 offen offset:0 sc1
    buffer_load_dwordx4 v[40:43], v2, s[16:19], s37 offen offset:1024 sc1
    s_waitcnt vmcnt(0)
    v_max3_u32 v150, v20, v21, v22
    v_max3_u32 v151, v23, v24, v25
    v_max3_u32 v150, v150, v26, v27
    v_max3_u32 v151, v151, v28, v29
    v_max3_u32 v150, v150, v30, v31
    v_max3_u32 v151, v151, v32, v33
    v_max3_u32 v150, v150, v34, v35
    v_max3_u32 v151, v151, v36, v37
    v_max3_u32 v150, v150, v38, v39
    v_max3_u32 v151, v151, v40, v41
    v_max3_u32 v150, v150, v42, v43
    v_max_u32 v150, v150, v151
    v_cmp_eq_u32 vcc, -1, v150
    s_cbranch_vccz L_k2_rd_d
    s_sleep 8
    s_sub_u32 s38, s38, 1
    s_cmp_gt_i32 s38, 0
    s_cbranch_scc1 L_k2_rd
L_k2_rd_d:
    v_lshlrev_b32 v188, 16, v20
    v_and_b32 v189, s63, v20
    v_lshlrev_b32 v190, 16, v21
    v_and_b32 v191, s63, v21
    v_add_f32 v124, v124, v188
    v_add_f32 v125, v125, v189
    v_add_f32 v126, v126, v190
    v_add_f32 v127, v127, v191
    v_lshlrev_b32 v184, 16, v28
    v_and_b32 v185, s63, v28
    v_lshlrev_b32 v186, 16, v29
    v_and_b32 v187, s63, v29
    v_lshlrev_b32 v188, 16, v36
    v_and_b32 v189, s63, v36
    v_lshlrev_b32 v190, 16, v37
    v_and_b32 v191, s63, v37
    v_add_f32 v184, v184, v188
    v_add_f32 v185, v185, v189
    v_add_f32 v186, v186, v190
    v_add_f32 v187, v187, v191
    v_cvt_pk_bf16_f32 v150, v184, v185
    v_cvt_pk_bf16_f32 v151, v186, v187
    v_lshlrev_b32 v184, 16, v150
    v_and_b32 v185, s63, v150
    v_lshlrev_b32 v186, 16, v151
    v_and_b32 v187, s63, v151
    v_cvt_pk_bf16_f32 v150, v124, v125
    v_cvt_pk_bf16_f32 v151, v126, v127
    v_lshlrev_b32 v124, 16, v150
    v_and_b32 v125, s63, v150
    v_lshlrev_b32 v126, 16, v151
    v_and_b32 v127, s63, v151
    v_mul_f32 v188, 0xbfb8aa3b, v124
    v_mul_f32 v189, 0xbfb8aa3b, v125
    v_mul_f32 v190, 0xbfb8aa3b, v126
    v_mul_f32 v191, 0xbfb8aa3b, v127
    v_exp_f32 v188, v188
    v_exp_f32 v189, v189
    v_exp_f32 v190, v190
    v_exp_f32 v191, v191
    v_add_f32 v188, 1.0, v188
    v_add_f32 v189, 1.0, v189
    v_add_f32 v190, 1.0, v190
    v_add_f32 v191, 1.0, v191
    v_rcp_f32 v188, v188
    v_rcp_f32 v189, v189
    v_rcp_f32 v190, v190
    v_rcp_f32 v191, v191
    v_mul_f32 v124, v124, v188
    v_mul_f32 v125, v125, v189
    v_mul_f32 v126, v126, v190
    v_mul_f32 v127, v127, v191
    v_cvt_pk_bf16_f32 v150, v124, v125
    v_cvt_pk_bf16_f32 v151, v126, v127
    v_lshlrev_b32 v124, 16, v150
    v_and_b32 v125, s63, v150
    v_lshlrev_b32 v126, 16, v151
    v_and_b32 v127, s63, v151
    v_mul_f32 v184, v184, v124
    v_mul_f32 v185, v185, v125
    v_mul_f32 v186, v186, v126
    v_mul_f32 v187, v187, v127
    v_cvt_pk_bf16_f32 v150, v184, v185
    v_cvt_pk_bf16_f32 v151, v186, v187
    v_lshlrev_b32 v184, 16, v150
    v_and_b32 v185, s63, v150
    v_lshlrev_b32 v186, 16, v151
    v_and_b32 v187, s63, v151
    v_lshlrev_b32 v124, 16, v140
    v_and_b32 v125, s63, v140
    v_lshlrev_b32 v126, 16, v141
    v_and_b32 v127, s63, v141
    v_add_f32 v184, v184, v124
    v_add_f32 v185, v185, v125
    v_add_f32 v186, v186, v126
    v_add_f32 v187, v187, v127
    v_cvt_pk_bf16_f32 v140, v184, v185
    v_cvt_pk_bf16_f32 v141, v186, v187
    buffer_store_dwordx2 v[140:141], v7, s[52:55], s61 offen offset:0
    v_lshlrev_b32 v196, 16, v22
    v_and_b32 v197, s63, v22
    v_lshlrev_b32 v198, 16, v23
    v_and_b32 v199, s63, v23
    v_add_f32 v128, v128, v196
    v_add_f32 v129, v129, v197
    v_add_f32 v130, v130, v198
    v_add_f32 v131, v131, v199
    v_lshlrev_b32 v192, 16, v30
    v_and_b32 v193, s63, v30
    v_lshlrev_b32 v194, 16, v31
    v_and_b32 v195, s63, v31
    v_lshlrev_b32 v196, 16, v38
    v_and_b32 v197, s63, v38
    v_lshlrev_b32 v198, 16, v39
    v_and_b32 v199, s63, v39
    v_add_f32 v192, v192, v196
    v_add_f32 v193, v193, v197
    v_add_f32 v194, v194, v198
    v_add_f32 v195, v195, v199
    v_cvt_pk_bf16_f32 v150, v192, v193
    v_cvt_pk_bf16_f32 v151, v194, v195
    v_lshlrev_b32 v192, 16, v150
    v_and_b32 v193, s63, v150
    v_lshlrev_b32 v194, 16, v151
    v_and_b32 v195, s63, v151
    v_cvt_pk_bf16_f32 v150, v128, v129
    v_cvt_pk_bf16_f32 v151, v130, v131
    v_lshlrev_b32 v128, 16, v150
    v_and_b32 v129, s63, v150
    v_lshlrev_b32 v130, 16, v151
    v_and_b32 v131, s63, v151
    v_mul_f32 v196, 0xbfb8aa3b, v128
    v_mul_f32 v197, 0xbfb8aa3b, v129
    v_mul_f32 v198, 0xbfb8aa3b, v130
    v_mul_f32 v199, 0xbfb8aa3b, v131
    v_exp_f32 v196, v196
    v_exp_f32 v197, v197
    v_exp_f32 v198, v198
    v_exp_f32 v199, v199
    v_add_f32 v196, 1.0, v196
    v_add_f32 v197, 1.0, v197
    v_add_f32 v198, 1.0, v198
    v_add_f32 v199, 1.0, v199
    v_rcp_f32 v196, v196
    v_rcp_f32 v197, v197
    v_rcp_f32 v198, v198
    v_rcp_f32 v199, v199
    v_mul_f32 v128, v128, v196
    v_mul_f32 v129, v129, v197
    v_mul_f32 v130, v130, v198
    v_mul_f32 v131, v131, v199
    v_cvt_pk_bf16_f32 v150, v128, v129
    v_cvt_pk_bf16_f32 v151, v130, v131
    v_lshlrev_b32 v128, 16, v150
    v_and_b32 v129, s63, v150
    v_lshlrev_b32 v130, 16, v151
    v_and_b32 v131, s63, v151
    v_mul_f32 v192, v192, v128
    v_mul_f32 v193, v193, v129
    v_mul_f32 v194, v194, v130
    v_mul_f32 v195, v195, v131
    v_cvt_pk_bf16_f32 v150, v192, v193
    v_cvt_pk_bf16_f32 v151, v194, v195
    v_lshlrev_b32 v192, 16, v150
    v_and_b32 v193, s63, v150
    v_lshlrev_b32 v194, 16, v151
    v_and_b32 v195, s63, v151
    v_lshlrev_b32 v128, 16, v142
    v_and_b32 v129, s63, v142
    v_lshlrev_b32 v130, 16, v143
    v_and_b32 v131, s63, v143
    v_add_f32 v192, v192, v128
    v_add_f32 v193, v193, v129
    v_add_f32 v194, v194, v130
    v_add_f32 v195, v195, v131
    v_cvt_pk_bf16_f32 v142, v192, v193
    v_cvt_pk_bf16_f32 v143, v194, v195
    buffer_store_dwordx2 v[142:143], v7, s[52:55], s62 offen offset:0
    v_lshlrev_b32 v188, 16, v24
    v_and_b32 v189, s63, v24
    v_lshlrev_b32 v190, 16, v25
    v_and_b32 v191, s63, v25
    v_add_f32 v132, v132, v188
    v_add_f32 v133, v133, v189
    v_add_f32 v134, v134, v190
    v_add_f32 v135, v135, v191
    v_lshlrev_b32 v184, 16, v32
    v_and_b32 v185, s63, v32
    v_lshlrev_b32 v186, 16, v33
    v_and_b32 v187, s63, v33
    v_lshlrev_b32 v188, 16, v40
    v_and_b32 v189, s63, v40
    v_lshlrev_b32 v190, 16, v41
    v_and_b32 v191, s63, v41
    v_add_f32 v184, v184, v188
    v_add_f32 v185, v185, v189
    v_add_f32 v186, v186, v190
    v_add_f32 v187, v187, v191
    v_cvt_pk_bf16_f32 v150, v184, v185
    v_cvt_pk_bf16_f32 v151, v186, v187
    v_lshlrev_b32 v184, 16, v150
    v_and_b32 v185, s63, v150
    v_lshlrev_b32 v186, 16, v151
    v_and_b32 v187, s63, v151
    v_cvt_pk_bf16_f32 v150, v132, v133
    v_cvt_pk_bf16_f32 v151, v134, v135
    v_lshlrev_b32 v132, 16, v150
    v_and_b32 v133, s63, v150
    v_lshlrev_b32 v134, 16, v151
    v_and_b32 v135, s63, v151
    v_mul_f32 v188, 0xbfb8aa3b, v132
    v_mul_f32 v189, 0xbfb8aa3b, v133
    v_mul_f32 v190, 0xbfb8aa3b, v134
    v_mul_f32 v191, 0xbfb8aa3b, v135
    v_exp_f32 v188, v188
    v_exp_f32 v189, v189
    v_exp_f32 v190, v190
    v_exp_f32 v191, v191
    v_add_f32 v188, 1.0, v188
    v_add_f32 v189, 1.0, v189
    v_add_f32 v190, 1.0, v190
    v_add_f32 v191, 1.0, v191
    v_rcp_f32 v188, v188
    v_rcp_f32 v189, v189
    v_rcp_f32 v190, v190
    v_rcp_f32 v191, v191
    v_mul_f32 v132, v132, v188
    v_mul_f32 v133, v133, v189
    v_mul_f32 v134, v134, v190
    v_mul_f32 v135, v135, v191
    v_cvt_pk_bf16_f32 v150, v132, v133
    v_cvt_pk_bf16_f32 v151, v134, v135
    v_lshlrev_b32 v132, 16, v150
    v_and_b32 v133, s63, v150
    v_lshlrev_b32 v134, 16, v151
    v_and_b32 v135, s63, v151
    v_mul_f32 v184, v184, v132
    v_mul_f32 v185, v185, v133
    v_mul_f32 v186, v186, v134
    v_mul_f32 v187, v187, v135
    v_cvt_pk_bf16_f32 v150, v184, v185
    v_cvt_pk_bf16_f32 v151, v186, v187
    v_lshlrev_b32 v184, 16, v150
    v_and_b32 v185, s63, v150
    v_lshlrev_b32 v186, 16, v151
    v_and_b32 v187, s63, v151
    v_lshlrev_b32 v132, 16, v144
    v_and_b32 v133, s63, v144
    v_lshlrev_b32 v134, 16, v145
    v_and_b32 v135, s63, v145
    v_add_f32 v184, v184, v132
    v_add_f32 v185, v185, v133
    v_add_f32 v186, v186, v134
    v_add_f32 v187, v187, v135
    v_cvt_pk_bf16_f32 v144, v184, v185
    v_cvt_pk_bf16_f32 v145, v186, v187
    buffer_store_dwordx2 v[144:145], v7, s[52:55], s61 offen offset:128
    v_lshlrev_b32 v196, 16, v26
    v_and_b32 v197, s63, v26
    v_lshlrev_b32 v198, 16, v27
    v_and_b32 v199, s63, v27
    v_add_f32 v136, v136, v196
    v_add_f32 v137, v137, v197
    v_add_f32 v138, v138, v198
    v_add_f32 v139, v139, v199
    v_lshlrev_b32 v192, 16, v34
    v_and_b32 v193, s63, v34
    v_lshlrev_b32 v194, 16, v35
    v_and_b32 v195, s63, v35
    v_lshlrev_b32 v196, 16, v42
    v_and_b32 v197, s63, v42
    v_lshlrev_b32 v198, 16, v43
    v_and_b32 v199, s63, v43
    v_add_f32 v192, v192, v196
    v_add_f32 v193, v193, v197
    v_add_f32 v194, v194, v198
    v_add_f32 v195, v195, v199
    v_cvt_pk_bf16_f32 v150, v192, v193
    v_cvt_pk_bf16_f32 v151, v194, v195
    v_lshlrev_b32 v192, 16, v150
    v_and_b32 v193, s63, v150
    v_lshlrev_b32 v194, 16, v151
    v_and_b32 v195, s63, v151
    v_cvt_pk_bf16_f32 v150, v136, v137
    v_cvt_pk_bf16_f32 v151, v138, v139
    v_lshlrev_b32 v136, 16, v150
    v_and_b32 v137, s63, v150
    v_lshlrev_b32 v138, 16, v151
    v_and_b32 v139, s63, v151
    v_mul_f32 v196, 0xbfb8aa3b, v136
    v_mul_f32 v197, 0xbfb8aa3b, v137
    v_mul_f32 v198, 0xbfb8aa3b, v138
    v_mul_f32 v199, 0xbfb8aa3b, v139
    v_exp_f32 v196, v196
    v_exp_f32 v197, v197
    v_exp_f32 v198, v198
    v_exp_f32 v199, v199
    v_add_f32 v196, 1.0, v196
    v_add_f32 v197, 1.0, v197
    v_add_f32 v198, 1.0, v198
    v_add_f32 v199, 1.0, v199
    v_rcp_f32 v196, v196
    v_rcp_f32 v197, v197
    v_rcp_f32 v198, v198
    v_rcp_f32 v199, v199
    v_mul_f32 v136, v136, v196
    v_mul_f32 v137, v137, v197
    v_mul_f32 v138, v138, v198
    v_mul_f32 v139, v139, v199
    v_cvt_pk_bf16_f32 v150, v136, v137
    v_cvt_pk_bf16_f32 v151, v138, v139
    v_lshlrev_b32 v136, 16, v150
    v_and_b32 v137, s63, v150
    v_lshlrev_b32 v138, 16, v151
    v_and_b32 v139, s63, v151
    v_mul_f32 v192, v192, v136
    v_mul_f32 v193, v193, v137
    v_mul_f32 v194, v194, v138
    v_mul_f32 v195, v195, v139
    v_cvt_pk_bf16_f32 v150, v192, v193
    v_cvt_pk_bf16_f32 v151, v194, v195
    v_lshlrev_b32 v192, 16, v150
    v_and_b32 v193, s63, v150
    v_lshlrev_b32 v194, 16, v151
    v_and_b32 v195, s63, v151
    v_lshlrev_b32 v136, 16, v146
    v_and_b32 v137, s63, v146
    v_lshlrev_b32 v138, 16, v147
    v_and_b32 v139, s63, v147
    v_add_f32 v192, v192, v136
    v_add_f32 v193, v193, v137
    v_add_f32 v194, v194, v138
    v_add_f32 v195, v195, v139
    v_cvt_pk_bf16_f32 v146, v192, v193
    v_cvt_pk_bf16_f32 v147, v194, v195
    buffer_store_dwordx2 v[146:147], v7, s[52:55], s62 offen offset:128
    s_branch L_k2_fin
L_k2_sfin:
    v_and_b32 v18, 1, v0
    v_lshlrev_b32 v18, 10, v18
    v_add_u32 v18, 25596, v18
L_k2_l0:
    buffer_load_dword v19, v18, s[16:19], 0 offen sc1
    s_waitcnt vmcnt(0)
    v_cmp_eq_u32 vcc, -1, v19
    s_cbranch_vccz L_k2_l0_d
    s_sleep 4
    s_sub_u32 s38, s38, 1
    s_cmp_gt_u32 s38, 10
    s_cbranch_scc1 L_k2_l0
L_k2_l0_d:
L_k2_rs0:
    s_add_u32 s37, s60, 0
    buffer_load_dwordx4 v[20:23], v2, s[16:19], s37 offen offset:0 sc1
    buffer_load_dwordx4 v[24:27], v2, s[16:19], s37 offen offset:1024 sc1
    buffer_load_dwordx2 v[44:45], v2, s[16:19], s41 offen offset:0 sc1
    buffer_load_dwordx2 v[46:47], v2, s[16:19], s41 offen offset:1024 sc1
    s_waitcnt vmcnt(0)
    v_max3_u32 v150, v20, v21, v22
    v_max3_u32 v151, v23, v24, v25
    v_max3_u32 v150, v150, v26, v27
    v_max3_u32 v151, v151, v44, v45
    v_max3_u32 v150, v150, v46, v47
    v_max_u32 v150, v150, v151
    v_cmp_eq_u32 vcc, -1, v150
    s_cbranch_vccz L_k2_rs0_d
    s_sleep 8
    s_sub_u32 s38, s38, 1
    s_cmp_gt_i32 s38, 0
    s_cbranch_scc1 L_k2_rs0
L_k2_rs0_d:
    v_lshlrev_b32 v188, 16, v20
    v_and_b32 v189, s63, v20
    v_lshlrev_b32 v190, 16, v21
    v_and_b32 v191, s63, v21
    v_add_f32 v124, v124, v188
    v_add_f32 v125, v125, v189
    v_add_f32 v126, v126, v190
    v_add_f32 v127, v127, v191
    v_cvt_pk_bf16_f32 v150, v124, v125
    v_cvt_pk_bf16_f32 v151, v126, v127
    v_lshlrev_b32 v124, 16, v150
    v_and_b32 v125, s63, v150
    v_lshlrev_b32 v126, 16, v151
    v_and_b32 v127, s63, v151
    v_lshlrev_b32 v188, 16, v22
    v_and_b32 v189, s63, v22
    v_lshlrev_b32 v190, 16, v23
    v_and_b32 v191, s63, v23
    v_add_f32 v128, v128, v188
    v_add_f32 v129, v129, v189
    v_add_f32 v130, v130, v190
    v_add_f32 v131, v131, v191
    v_cvt_pk_bf16_f32 v150, v128, v129
    v_cvt_pk_bf16_f32 v151, v130, v131
    v_lshlrev_b32 v128, 16, v150
    v_and_b32 v129, s63, v150
    v_lshlrev_b32 v130, 16, v151
    v_and_b32 v131, s63, v151
    v_lshlrev_b32 v188, 16, v24
    v_and_b32 v189, s63, v24
    v_lshlrev_b32 v190, 16, v25
    v_and_b32 v191, s63, v25
    v_add_f32 v132, v132, v188
    v_add_f32 v133, v133, v189
    v_add_f32 v134, v134, v190
    v_add_f32 v135, v135, v191
    v_cvt_pk_bf16_f32 v150, v132, v133
    v_cvt_pk_bf16_f32 v151, v134, v135
    v_lshlrev_b32 v132, 16, v150
    v_and_b32 v133, s63, v150
    v_lshlrev_b32 v134, 16, v151
    v_and_b32 v135, s63, v151
    v_lshlrev_b32 v188, 16, v26
    v_and_b32 v189, s63, v26
    v_lshlrev_b32 v190, 16, v27
    v_and_b32 v191, s63, v27
    v_add_f32 v136, v136, v188
    v_add_f32 v137, v137, v189
    v_add_f32 v138, v138, v190
    v_add_f32 v139, v139, v191
    v_cvt_pk_bf16_f32 v150, v136, v137
    v_cvt_pk_bf16_f32 v151, v138, v139
    v_lshlrev_b32 v136, 16, v150
    v_and_b32 v137, s63, v150
    v_lshlrev_b32 v138, 16, v151
    v_and_b32 v139, s63, v151
    v_lshlrev_b32 v68, 16, v44
    v_and_b32 v69, s63, v44
    v_lshlrev_b32 v70, 16, v45
    v_and_b32 v71, s63, v45
    v_lshlrev_b32 v188, 16, v46
    v_and_b32 v189, s63, v46
    v_lshlrev_b32 v190, 16, v47
    v_and_b32 v191, s63, v47
    v_add_f32 v68, v68, v188
    v_add_f32 v69, v69, v189
    v_add_f32 v70, v70, v190
    v_add_f32 v71, v71, v191
    v_cvt_pk_bf16_f32 v150, v68, v69
    v_cvt_pk_bf16_f32 v151, v70, v71
    v_lshlrev_b32 v68, 16, v150
    v_and_b32 v69, s63, v150
    v_lshlrev_b32 v70, 16, v151
    v_and_b32 v71, s63, v151
    v_and_b32 v18, 1, v0
    v_lshlrev_b32 v18, 10, v18
    v_add_u32 v18, 27644, v18
L_k2_l1:
    buffer_load_dword v19, v18, s[16:19], 0 offen sc1
    s_waitcnt vmcnt(0)
    v_cmp_eq_u32 vcc, -1, v19
    s_cbranch_vccz L_k2_l1_d
    s_sleep 4
    s_sub_u32 s38, s38, 1
    s_cmp_gt_u32 s38, 10
    s_cbranch_scc1 L_k2_l1
L_k2_l1_d:
L_k2_rs1:
    s_add_u32 s37, s60, 2048
    buffer_load_dwordx4 v[28:31], v2, s[16:19], s37 offen offset:0 sc1
    buffer_load_dwordx4 v[32:35], v2, s[16:19], s37 offen offset:1024 sc1
    s_add_u32 s37, s60, 4096
    buffer_load_dwordx4 v[36:39], v2, s[16:19], s37 offen offset:0 sc1
    buffer_load_dwordx4 v[40:43], v2, s[16:19], s37 offen offset:1024 sc1
    buffer_load_dwordx2 v[48:49], v2, s[16:19], s41 offen offset:2048 sc1
    buffer_load_dwordx2 v[50:51], v2, s[16:19], s41 offen offset:3072 sc1
    s_waitcnt vmcnt(0)
    v_max3_u32 v150, v28, v29, v30
    v_max3_u32 v151, v31, v32, v33
    v_max3_u32 v150, v150, v34, v35
    v_max3_u32 v151, v151, v36, v37
    v_max3_u32 v150, v150, v38, v39
    v_max3_u32 v151, v151, v40, v41
    v_max3_u32 v150, v150, v42, v43
    v_max3_u32 v151, v151, v48, v49
    v_max3_u32 v150, v150, v50, v51
    v_max_u32 v150, v150, v151
    v_cmp_eq_u32 vcc, -1, v150
    s_cbranch_vccz L_k2_rs1_d
    s_sleep 8
    s_sub_u32 s38, s38, 1
    s_cmp_gt_i32 s38, 0
    s_cbranch_scc1 L_k2_rs1
L_k2_rs1_d:
    v_lshlrev_b32 v184, 16, v28
    v_and_b32 v185, s63, v28
    v_lshlrev_b32 v186, 16, v29
    v_and_b32 v187, s63, v29
    v_lshlrev_b32 v188, 16, v36
    v_and_b32 v189, s63, v36
    v_lshlrev_b32 v190, 16, v37
    v_and_b32 v191, s63, v37
    v_add_f32 v184, v184, v188
    v_add_f32 v185, v185, v189
    v_add_f32 v186, v186, v190
    v_add_f32 v187, v187, v191
    v_cvt_pk_bf16_f32 v150, v184, v185
    v_cvt_pk_bf16_f32 v151, v186, v187
    v_lshlrev_b32 v184, 16, v150
    v_and_b32 v185, s63, v150
    v_lshlrev_b32 v186, 16, v151
    v_and_b32 v187, s63, v151
    v_mul_f32 v188, 0xbfb8aa3b, v184
    v_mul_f32 v189, 0xbfb8aa3b, v185
    v_mul_f32 v190, 0xbfb8aa3b, v186
    v_mul_f32 v191, 0xbfb8aa3b, v187
    v_exp_f32 v188, v188
    v_exp_f32 v189, v189
    v_exp_f32 v190, v190
    v_exp_f32 v191, v191
    v_add_f32 v188, 1.0, v188
    v_add_f32 v189, 1.0, v189
    v_add_f32 v190, 1.0, v190
    v_add_f32 v191, 1.0, v191
    v_rcp_f32 v188, v188
    v_rcp_f32 v189, v189
    v_rcp_f32 v190, v190
    v_rcp_f32 v191, v191
    v_mul_f32 v184, v184, v188
    v_mul_f32 v185, v185, v189
    v_mul_f32 v186, v186, v190
    v_mul_f32 v187, v187, v191
    v_cvt_pk_bf16_f32 v150, v184, v185
    v_cvt_pk_bf16_f32 v151, v186, v187
    v_lshlrev_b32 v184, 16, v150
    v_and_b32 v185, s63, v150
    v_lshlrev_b32 v186, 16, v151
    v_and_b32 v187, s63, v151
    v_mul_f32 v124, v124, v184
    v_mul_f32 v125, v125, v185
    v_mul_f32 v126, v126, v186
    v_mul_f32 v127, v127, v187
    v_cvt_pk_bf16_f32 v150, v124, v125
    v_cvt_pk_bf16_f32 v151, v126, v127
    v_lshlrev_b32 v124, 16, v150
    v_and_b32 v125, s63, v150
    v_lshlrev_b32 v126, 16, v151
    v_and_b32 v127, s63, v151
    v_lshlrev_b32 v184, 16, v140
    v_and_b32 v185, s63, v140
    v_lshlrev_b32 v186, 16, v141
    v_and_b32 v187, s63, v141
    v_add_f32 v124, v124, v184
    v_add_f32 v125, v125, v185
    v_add_f32 v126, v126, v186
    v_add_f32 v127, v127, v187
    v_cvt_pk_bf16_f32 v140, v124, v125
    v_cvt_pk_bf16_f32 v141, v126, v127
    buffer_store_dwordx2 v[140:141], v7, s[52:55], s61 offen offset:0
    v_lshlrev_b32 v192, 16, v30
    v_and_b32 v193, s63, v30
    v_lshlrev_b32 v194, 16, v31
    v_and_b32 v195, s63, v31
    v_lshlrev_b32 v196, 16, v38
    v_and_b32 v197, s63, v38
    v_lshlrev_b32 v198, 16, v39
    v_and_b32 v199, s63, v39
    v_add_f32 v192, v192, v196
    v_add_f32 v193, v193, v197
    v_add_f32 v194, v194, v198
    v_add_f32 v195, v195, v199
    v_cvt_pk_bf16_f32 v150, v192, v193
    v_cvt_pk_bf16_f32 v151, v194, v195
    v_lshlrev_b32 v192, 16, v150
    v_and_b32 v193, s63, v150
    v_lshlrev_b32 v194, 16, v151
    v_and_b32 v195, s63, v151
    v_mul_f32 v196, 0xbfb8aa3b, v192
    v_mul_f32 v197, 0xbfb8aa3b, v193
    v_mul_f32 v198, 0xbfb8aa3b, v194
    v_mul_f32 v199, 0xbfb8aa3b, v195
    v_exp_f32 v196, v196
    v_exp_f32 v197, v197
    v_exp_f32 v198, v198
    v_exp_f32 v199, v199
    v_add_f32 v196, 1.0, v196
    v_add_f32 v197, 1.0, v197
    v_add_f32 v198, 1.0, v198
    v_add_f32 v199, 1.0, v199
    v_rcp_f32 v196, v196
    v_rcp_f32 v197, v197
    v_rcp_f32 v198, v198
    v_rcp_f32 v199, v199
    v_mul_f32 v192, v192, v196
    v_mul_f32 v193, v193, v197
    v_mul_f32 v194, v194, v198
    v_mul_f32 v195, v195, v199
    v_cvt_pk_bf16_f32 v150, v192, v193
    v_cvt_pk_bf16_f32 v151, v194, v195
    v_lshlrev_b32 v192, 16, v150
    v_and_b32 v193, s63, v150
    v_lshlrev_b32 v194, 16, v151
    v_and_b32 v195, s63, v151
    v_mul_f32 v128, v128, v192
    v_mul_f32 v129, v129, v193
    v_mul_f32 v130, v130, v194
    v_mul_f32 v131, v131, v195
    v_cvt_pk_bf16_f32 v150, v128, v129
    v_cvt_pk_bf16_f32 v151, v130, v131
    v_lshlrev_b32 v128, 16, v150
    v_and_b32 v129, s63, v150
    v_lshlrev_b32 v130, 16, v151
    v_and_b32 v131, s63, v151
    v_lshlrev_b32 v192, 16, v142
    v_and_b32 v193, s63, v142
    v_lshlrev_b32 v194, 16, v143
    v_and_b32 v195, s63, v143
    v_add_f32 v128, v128, v192
    v_add_f32 v129, v129, v193
    v_add_f32 v130, v130, v194
    v_add_f32 v131, v131, v195
    v_cvt_pk_bf16_f32 v142, v128, v129
    v_cvt_pk_bf16_f32 v143, v130, v131
    buffer_store_dwordx2 v[142:143], v7, s[52:55], s62 offen offset:0
    v_lshlrev_b32 v184, 16, v32
    v_and_b32 v185, s63, v32
    v_lshlrev_b32 v186, 16, v33
    v_and_b32 v187, s63, v33
    v_lshlrev_b32 v188, 16, v40
    v_and_b32 v189, s63, v40
    v_lshlrev_b32 v190, 16, v41
    v_and_b32 v191, s63, v41
    v_add_f32 v184, v184, v188
    v_add_f32 v185, v185, v189
    v_add_f32 v186, v186, v190
    v_add_f32 v187, v187, v191
    v_cvt_pk_bf16_f32 v150, v184, v185
    v_cvt_pk_bf16_f32 v151, v186, v187
    v_lshlrev_b32 v184, 16, v150
    v_and_b32 v185, s63, v150
    v_lshlrev_b32 v186, 16, v151
    v_and_b32 v187, s63, v151
    v_mul_f32 v188, 0xbfb8aa3b, v184
    v_mul_f32 v189, 0xbfb8aa3b, v185
    v_mul_f32 v190, 0xbfb8aa3b, v186
    v_mul_f32 v191, 0xbfb8aa3b, v187
    v_exp_f32 v188, v188
    v_exp_f32 v189, v189
    v_exp_f32 v190, v190
    v_exp_f32 v191, v191
    v_add_f32 v188, 1.0, v188
    v_add_f32 v189, 1.0, v189
    v_add_f32 v190, 1.0, v190
    v_add_f32 v191, 1.0, v191
    v_rcp_f32 v188, v188
    v_rcp_f32 v189, v189
    v_rcp_f32 v190, v190
    v_rcp_f32 v191, v191
    v_mul_f32 v184, v184, v188
    v_mul_f32 v185, v185, v189
    v_mul_f32 v186, v186, v190
    v_mul_f32 v187, v187, v191
    v_cvt_pk_bf16_f32 v150, v184, v185
    v_cvt_pk_bf16_f32 v151, v186, v187
    v_lshlrev_b32 v184, 16, v150
    v_and_b32 v185, s63, v150
    v_lshlrev_b32 v186, 16, v151
    v_and_b32 v187, s63, v151
    v_mul_f32 v132, v132, v184
    v_mul_f32 v133, v133, v185
    v_mul_f32 v134, v134, v186
    v_mul_f32 v135, v135, v187
    v_cvt_pk_bf16_f32 v150, v132, v133
    v_cvt_pk_bf16_f32 v151, v134, v135
    v_lshlrev_b32 v132, 16, v150
    v_and_b32 v133, s63, v150
    v_lshlrev_b32 v134, 16, v151
    v_and_b32 v135, s63, v151
    v_lshlrev_b32 v184, 16, v144
    v_and_b32 v185, s63, v144
    v_lshlrev_b32 v186, 16, v145
    v_and_b32 v187, s63, v145
    v_add_f32 v132, v132, v184
    v_add_f32 v133, v133, v185
    v_add_f32 v134, v134, v186
    v_add_f32 v135, v135, v187
    v_cvt_pk_bf16_f32 v144, v132, v133
    v_cvt_pk_bf16_f32 v145, v134, v135
    buffer_store_dwordx2 v[144:145], v7, s[52:55], s61 offen offset:128
    v_lshlrev_b32 v192, 16, v34
    v_and_b32 v193, s63, v34
    v_lshlrev_b32 v194, 16, v35
    v_and_b32 v195, s63, v35
    v_lshlrev_b32 v196, 16, v42
    v_and_b32 v197, s63, v42
    v_lshlrev_b32 v198, 16, v43
    v_and_b32 v199, s63, v43
    v_add_f32 v192, v192, v196
    v_add_f32 v193, v193, v197
    v_add_f32 v194, v194, v198
    v_add_f32 v195, v195, v199
    v_cvt_pk_bf16_f32 v150, v192, v193
    v_cvt_pk_bf16_f32 v151, v194, v195
    v_lshlrev_b32 v192, 16, v150
    v_and_b32 v193, s63, v150
    v_lshlrev_b32 v194, 16, v151
    v_and_b32 v195, s63, v151
    v_mul_f32 v196, 0xbfb8aa3b, v192
    v_mul_f32 v197, 0xbfb8aa3b, v193
    v_mul_f32 v198, 0xbfb8aa3b, v194
    v_mul_f32 v199, 0xbfb8aa3b, v195
    v_exp_f32 v196, v196
    v_exp_f32 v197, v197
    v_exp_f32 v198, v198
    v_exp_f32 v199, v199
    v_add_f32 v196, 1.0, v196
    v_add_f32 v197, 1.0, v197
    v_add_f32 v198, 1.0, v198
    v_add_f32 v199, 1.0, v199
    v_rcp_f32 v196, v196
    v_rcp_f32 v197, v197
    v_rcp_f32 v198, v198
    v_rcp_f32 v199, v199
    v_mul_f32 v192, v192, v196
    v_mul_f32 v193, v193, v197
    v_mul_f32 v194, v194, v198
    v_mul_f32 v195, v195, v199
    v_cvt_pk_bf16_f32 v150, v192, v193
    v_cvt_pk_bf16_f32 v151, v194, v195
    v_lshlrev_b32 v192, 16, v150
    v_and_b32 v193, s63, v150
    v_lshlrev_b32 v194, 16, v151
    v_and_b32 v195, s63, v151
    v_mul_f32 v136, v136, v192
    v_mul_f32 v137, v137, v193
    v_mul_f32 v138, v138, v194
    v_mul_f32 v139, v139, v195
    v_cvt_pk_bf16_f32 v150, v136, v137
    v_cvt_pk_bf16_f32 v151, v138, v139
    v_lshlrev_b32 v136, 16, v150
    v_and_b32 v137, s63, v150
    v_lshlrev_b32 v138, 16, v151
    v_and_b32 v139, s63, v151
    v_lshlrev_b32 v192, 16, v146
    v_and_b32 v193, s63, v146
    v_lshlrev_b32 v194, 16, v147
    v_and_b32 v195, s63, v147
    v_add_f32 v136, v136, v192
    v_add_f32 v137, v137, v193
    v_add_f32 v138, v138, v194
    v_add_f32 v139, v139, v195
    v_cvt_pk_bf16_f32 v146, v136, v137
    v_cvt_pk_bf16_f32 v147, v138, v139
    buffer_store_dwordx2 v[146:147], v7, s[52:55], s62 offen offset:128
    v_lshlrev_b32 v184, 16, v48
    v_and_b32 v185, s63, v48
    v_lshlrev_b32 v186, 16, v49
    v_and_b32 v187, s63, v49
    v_lshlrev_b32 v188, 16, v50
    v_and_b32 v189, s63, v50
    v_lshlrev_b32 v190, 16, v51
    v_and_b32 v191, s63, v51
    v_add_f32 v184, v184, v188
    v_add_f32 v185, v185, v189
    v_add_f32 v186, v186, v190
    v_add_f32 v187, v187, v191
    v_cvt_pk_bf16_f32 v150, v184, v185
    v_cvt_pk_bf16_f32 v151, v186, v187
    v_lshlrev_b32 v184, 16, v150
    v_and_b32 v185, s63, v150
    v_lshlrev_b32 v186, 16, v151
    v_and_b32 v187, s63, v151
    v_mul_f32 v188, 0xbfb8aa3b, v184
    v_mul_f32 v189, 0xbfb8aa3b, v185
    v_mul_f32 v190, 0xbfb8aa3b, v186
    v_mul_f32 v191, 0xbfb8aa3b, v187
    v_exp_f32 v188, v188
    v_exp_f32 v189, v189
    v_exp_f32 v190, v190
    v_exp_f32 v191, v191
    v_add_f32 v188, 1.0, v188
    v_add_f32 v189, 1.0, v189
    v_add_f32 v190, 1.0, v190
    v_add_f32 v191, 1.0, v191
    v_rcp_f32 v188, v188
    v_rcp_f32 v189, v189
    v_rcp_f32 v190, v190
    v_rcp_f32 v191, v191
    v_mul_f32 v184, v184, v188
    v_mul_f32 v185, v185, v189
    v_mul_f32 v186, v186, v190
    v_mul_f32 v187, v187, v191
    v_cvt_pk_bf16_f32 v150, v184, v185
    v_cvt_pk_bf16_f32 v151, v186, v187
    v_lshlrev_b32 v184, 16, v150
    v_and_b32 v185, s63, v150
    v_lshlrev_b32 v186, 16, v151
    v_and_b32 v187, s63, v151
    v_mul_f32 v68, v68, v184
    v_mul_f32 v69, v69, v185
    v_mul_f32 v70, v70, v186
    v_mul_f32 v71, v71, v187
    v_cvt_pk_bf16_f32 v150, v68, v69
    v_cvt_pk_bf16_f32 v151, v70, v71
    v_lshlrev_b32 v68, 16, v150
    v_and_b32 v69, s63, v150
    v_lshlrev_b32 v70, 16, v151
    v_and_b32 v71, s63, v151
    v_lshlrev_b32 v184, 16, v148
    v_and_b32 v185, s63, v148
    v_lshlrev_b32 v186, 16, v149
    v_and_b32 v187, s63, v149
    v_add_f32 v68, v68, v184
    v_add_f32 v69, v69, v185
    v_add_f32 v70, v70, v186
    v_add_f32 v71, v71, v187
    v_cvt_pk_bf16_f32 v148, v68, v69
    v_cvt_pk_bf16_f32 v149, v70, v71
    buffer_store_dwordx2 v[148:149], v7, s[52:55], s40 offen offset:256
L_k2_fin:
L_k2_done:
    s_endpgm
.section .rodata,"a"
.p2align 6
.amdhsa_kernel outp_kernel
  .amdhsa_next_free_vgpr 332
  .amdhsa_next_free_sgpr 64
  .amdhsa_accum_offset 204
  .amdhsa_group_segment_fixed_size 0
  .amdhsa_kernarg_size 96
  .amdhsa_user_sgpr_count 2
  .amdhsa_user_sgpr_kernarg_segment_ptr 1
  .amdhsa_system_sgpr_workgroup_id_x 1
  .amdhsa_float_denorm_mode_32 3
.end_amdhsa_kernel
.text

.text
L_text_end:
L_slow:
    s_mov_b32 s4, s69
    s_mov_b32 s5, s70
    s_mov_b32 s8, s71
    s_mov_b32 s9, s72
    s_mov_b32 s6, 524288
    s_mov_b32 s10, 524288
    s_waitcnt vmcnt(0)
    v_accvgpr_write_b32 a64, 0
    v_accvgpr_write_b32 a65, 0
    v_accvgpr_write_b32 a66, 0
    v_accvgpr_write_b32 a67, 0
    v_accvgpr_write_b32 a68, 0
    v_accvgpr_write_b32 a69, 0
    v_accvgpr_write_b32 a70, 0
    v_accvgpr_write_b32 a71, 0
    v_accvgpr_write_b32 a72, 0
    v_accvgpr_write_b32 a73, 0
    v_accvgpr_write_b32 a74, 0
    v_accvgpr_write_b32 a75, 0
    v_accvgpr_write_b32 a76, 0
    v_accvgpr_write_b32 a77, 0
    v_accvgpr_write_b32 a78, 0
    v_accvgpr_write_b32 a79, 0
    v_accvgpr_write_b32 a80, 0
    v_accvgpr_write_b32 a81, 0
    v_accvgpr_write_b32 a82, 0
    v_accvgpr_write_b32 a83, 0
    v_accvgpr_write_b32 a84, 0
    v_accvgpr_write_b32 a85, 0
    v_accvgpr_write_b32 a86, 0
    v_accvgpr_write_b32 a87, 0
    v_accvgpr_write_b32 a88, 0
    v_accvgpr_write_b32 a89, 0
    v_accvgpr_write_b32 a90, 0
    v_accvgpr_write_b32 a91, 0
    v_accvgpr_write_b32 a92, 0
    v_accvgpr_write_b32 a93, 0
    v_accvgpr_write_b32 a94, 0
    v_accvgpr_write_b32 a95, 0
    v_accvgpr_write_b32 a96, 0
    v_accvgpr_write_b32 a97, 0
    v_accvgpr_write_b32 a98, 0
    v_accvgpr_write_b32 a99, 0
    v_accvgpr_write_b32 a100, 0
    v_accvgpr_write_b32 a101, 0
    v_accvgpr_write_b32 a102, 0
    v_accvgpr_write_b32 a103, 0
    v_accvgpr_write_b32 a104, 0
    v_accvgpr_write_b32 a105, 0
    v_accvgpr_write_b32 a106, 0
    v_accvgpr_write_b32 a107, 0
    v_accvgpr_write_b32 a108, 0
    v_accvgpr_write_b32 a109, 0
    v_accvgpr_write_b32 a110, 0
    v_accvgpr_write_b32 a111, 0
    v_accvgpr_write_b32 a112, 0
    v_accvgpr_write_b32 a113, 0
    v_accvgpr_write_b32 a114, 0
    v_accvgpr_write_b32 a115, 0
    v_accvgpr_write_b32 a116, 0
    v_accvgpr_write_b32 a117, 0
    v_accvgpr_write_b32 a118, 0
    v_accvgpr_write_b32 a119, 0
    v_accvgpr_write_b32 a120, 0
    v_accvgpr_write_b32 a121, 0
    v_accvgpr_write_b32 a122, 0
    v_accvgpr_write_b32 a123, 0
    v_accvgpr_write_b32 a124, 0
    v_accvgpr_write_b32 a125, 0
    v_accvgpr_write_b32 a126, 0
    v_accvgpr_write_b32 a127, 0
    v_accvgpr_write_b32 a128, 0
    v_accvgpr_write_b32 a129, 0
    v_accvgpr_write_b32 a130, 0
    v_accvgpr_write_b32 a131, 0
    v_accvgpr_write_b32 a132, 0
    v_accvgpr_write_b32 a133, 0
    v_accvgpr_write_b32 a134, 0
    v_accvgpr_write_b32 a135, 0
    v_accvgpr_write_b32 a136, 0
    v_accvgpr_write_b32 a137, 0
    v_accvgpr_write_b32 a138, 0
    v_accvgpr_write_b32 a139, 0
    v_accvgpr_write_b32 a140, 0
    v_accvgpr_write_b32 a141, 0
    v_accvgpr_write_b32 a142, 0
    v_accvgpr_write_b32 a143, 0
    v_accvgpr_write_b32 a144, 0
    v_accvgpr_write_b32 a145, 0
    v_accvgpr_write_b32 a146, 0
    v_accvgpr_write_b32 a147, 0
    v_accvgpr_write_b32 a148, 0
    v_accvgpr_write_b32 a149, 0
    v_accvgpr_write_b32 a150, 0
    v_accvgpr_write_b32 a151, 0
    v_accvgpr_write_b32 a152, 0
    v_accvgpr_write_b32 a153, 0
    v_accvgpr_write_b32 a154, 0
    v_accvgpr_write_b32 a155, 0
    v_accvgpr_write_b32 a156, 0
    v_accvgpr_write_b32 a157, 0
    v_accvgpr_write_b32 a158, 0
    v_accvgpr_write_b32 a159, 0
    v_accvgpr_write_b32 a160, 0
    v_accvgpr_write_b32 a161, 0
    v_accvgpr_write_b32 a162, 0
    v_accvgpr_write_b32 a163, 0
    v_accvgpr_write_b32 a164, 0
    v_accvgpr_write_b32 a165, 0
    v_accvgpr_write_b32 a166, 0
    v_accvgpr_write_b32 a167, 0
    v_accvgpr_write_b32 a168, 0
    v_accvgpr_write_b32 a169, 0
    v_accvgpr_write_b32 a170, 0
    v_accvgpr_write_b32 a171, 0
    v_accvgpr_write_b32 a172, 0
    v_accvgpr_write_b32 a173, 0
    v_accvgpr_write_b32 a174, 0
    v_accvgpr_write_b32 a175, 0
    v_accvgpr_write_b32 a176, 0
    v_accvgpr_write_b32 a177, 0
    v_accvgpr_write_b32 a178, 0
    v_accvgpr_write_b32 a179, 0
    v_accvgpr_write_b32 a180, 0
    v_accvgpr_write_b32 a181, 0
    v_accvgpr_write_b32 a182, 0
    v_accvgpr_write_b32 a183, 0
    v_accvgpr_write_b32 a184, 0
    v_accvgpr_write_b32 a185, 0
    v_accvgpr_write_b32 a186, 0
    v_accvgpr_write_b32 a187, 0
    v_accvgpr_write_b32 a188, 0
    v_accvgpr_write_b32 a189, 0
    v_accvgpr_write_b32 a190, 0
    v_accvgpr_write_b32 a191, 0
    v_accvgpr_write_b32 a192, 0
    v_accvgpr_write_b32 a193, 0
    v_accvgpr_write_b32 a194, 0
    v_accvgpr_write_b32 a195, 0
    v_accvgpr_write_b32 a196, 0
    v_accvgpr_write_b32 a197, 0
    v_accvgpr_write_b32 a198, 0
    v_accvgpr_write_b32 a199, 0
    v_accvgpr_write_b32 a200, 0
    v_accvgpr_write_b32 a201, 0
    v_accvgpr_write_b32 a202, 0
    v_accvgpr_write_b32 a203, 0
    v_accvgpr_write_b32 a204, 0
    v_accvgpr_write_b32 a205, 0
    v_accvgpr_write_b32 a206, 0
    v_accvgpr_write_b32 a207, 0
    v_mov_b32 v224, 0xff7fffff
    v_mov_b32 v225, 0xff7fffff
    v_mov_b32 v226, 0xff7fffff
    v_mov_b32 v227, 0xff7fffff
    s_mov_b32 s28, 0
    s_mov_b32 s37, 0
    s_mov_b32 s27, 32
L_slow_loop:
    s_barrier
    s_add_u32 m0, s29, 0
    s_nop 0
    buffer_load_dwordx4 v10, s[4:7], s28 offen offset:0 lds
    buffer_load_dwordx4 v10, s[4:7], s28 offen offset:1024 lds
    buffer_load_dwordx4 v10, s[4:7], s28 offen offset:2048 lds
    buffer_load_dwordx4 v10, s[4:7], s28 offen offset:3072 lds
    s_add_u32 s28, s28, 16384
    s_bitset0_b32 s28, 19
    s_add_u32 m0, s29, 65536
    s_nop 0
    buffer_load_dwordx4 v11, s[8:11], s37 offen offset:0 lds
    buffer_load_dwordx4 v11, s[8:11], s37 offen offset:1024 lds
    buffer_load_dwordx4 v11, s[8:11], s37 offen offset:2048 lds
    buffer_load_dwordx4 v11, s[8:11], s37 offen offset:3072 lds
    s_add_u32 s37, s37, 16384
    s_bitset0_b32 s37, 19
    s_waitcnt vmcnt(0)
    s_barrier
    ds_read_b128 a[0:3], v80 offset:0
    ds_read_b128 a[4:7], v81 offset:0
    ds_read_b128 a[8:11], v82 offset:0
    ds_read_b128 a[12:15], v83 offset:0
    ds_read_b128 a[16:19], v80 offset:1024
    ds_read_b128 a[20:23], v81 offset:1024
    ds_read_b128 a[24:27], v82 offset:1024
    ds_read_b128 a[28:31], v83 offset:1024
    s_waitcnt lgkmcnt(0)
    ds_read_b64_tr_b16 a[32:33], v84 offset:0
    ds_read_b64_tr_b16 a[34:35], v84 offset:1024
    ds_read_b64_tr_b16 a[36:37], v85 offset:0
    ds_read_b64_tr_b16 a[38:39], v85 offset:1024
    ds_read_b64_tr_b16 a[40:41], v86 offset:0
    ds_read_b64_tr_b16 a[42:43], v86 offset:1024
    ds_read_b64_tr_b16 a[44:45], v87 offset:0
    ds_read_b64_tr_b16 a[46:47], v87 offset:1024
    ds_read_b64_tr_b16 a[48:49], v88 offset:0
    ds_read_b64_tr_b16 a[50:51], v88 offset:1024
    ds_read_b64_tr_b16 a[52:53], v89 offset:0
    ds_read_b64_tr_b16 a[54:55], v89 offset:1024
    ds_read_b64_tr_b16 a[56:57], v90 offset:0
    ds_read_b64_tr_b16 a[58:59], v90 offset:1024
    ds_read_b64_tr_b16 a[60:61], v91 offset:0
    ds_read_b64_tr_b16 a[62:63], v91 offset:1024
    v_mfma_f32_16x16x32_bf16 v[192:195], a[0:3], v[128:131], 0
    v_mfma_f32_16x16x32_bf16 v[192:195], a[4:7], v[144:147], v[192:195]
    v_mfma_f32_16x16x32_bf16 v[192:195], a[8:11], v[160:163], v[192:195]
    v_mfma_f32_16x16x32_bf16 v[192:195], a[12:15], v[176:179], v[192:195]
    v_mfma_f32_16x16x32_bf16 v[196:199], a[0:3], v[132:135], 0
    v_mfma_f32_16x16x32_bf16 v[196:199], a[4:7], v[148:151], v[196:199]
    v_mfma_f32_16x16x32_bf16 v[196:199], a[8:11], v[164:167], v[196:199]
    v_mfma_f32_16x16x32_bf16 v[196:199], a[12:15], v[180:183], v[196:199]
    v_mfma_f32_16x16x32_bf16 v[200:203], a[0:3], v[136:139], 0
    v_mfma_f32_16x16x32_bf16 v[200:203], a[4:7], v[152:155], v[200:203]
    v_mfma_f32_16x16x32_bf16 v[200:203], a[8:11], v[168:171], v[200:203]
    v_mfma_f32_16x16x32_bf16 v[200:203], a[12:15], v[184:187], v[200:203]
    v_mfma_f32_16x16x32_bf16 v[204:207], a[0:3], v[140:143], 0
    v_mfma_f32_16x16x32_bf16 v[204:207], a[4:7], v[156:159], v[204:207]
    v_mfma_f32_16x16x32_bf16 v[204:207], a[8:11], v[172:175], v[204:207]
    v_mfma_f32_16x16x32_bf16 v[204:207], a[12:15], v[188:191], v[204:207]
    v_mfma_f32_16x16x32_bf16 v[208:211], a[16:19], v[128:131], 0
    v_mfma_f32_16x16x32_bf16 v[208:211], a[20:23], v[144:147], v[208:211]
    v_mfma_f32_16x16x32_bf16 v[208:211], a[24:27], v[160:163], v[208:211]
    v_mfma_f32_16x16x32_bf16 v[208:211], a[28:31], v[176:179], v[208:211]
    v_mfma_f32_16x16x32_bf16 v[212:215], a[16:19], v[132:135], 0
    v_mfma_f32_16x16x32_bf16 v[212:215], a[20:23], v[148:151], v[212:215]
    v_mfma_f32_16x16x32_bf16 v[212:215], a[24:27], v[164:167], v[212:215]
    v_mfma_f32_16x16x32_bf16 v[212:215], a[28:31], v[180:183], v[212:215]
    v_mfma_f32_16x16x32_bf16 v[216:219], a[16:19], v[136:139], 0
    v_mfma_f32_16x16x32_bf16 v[216:219], a[20:23], v[152:155], v[216:219]
    v_mfma_f32_16x16x32_bf16 v[216:219], a[24:27], v[168:171], v[216:219]
    v_mfma_f32_16x16x32_bf16 v[216:219], a[28:31], v[184:187], v[216:219]
    v_mfma_f32_16x16x32_bf16 v[220:223], a[16:19], v[140:143], 0
    v_mfma_f32_16x16x32_bf16 v[220:223], a[20:23], v[156:159], v[220:223]
    v_mfma_f32_16x16x32_bf16 v[220:223], a[24:27], v[172:175], v[220:223]
    v_mfma_f32_16x16x32_bf16 v[220:223], a[28:31], v[188:191], v[220:223]
    s_nop 7
    s_nop 7
    v_max3_f32 v96, v192, v193, v194
    v_max3_f32 v96, v96, v195, v208
    v_max3_f32 v96, v96, v209, v210
    v_max3_f32 v96, v96, v211, v224
    v_mov_b32 v97, v96
    s_nop 1
    v_permlane16_swap_b32 v97, v96
    s_nop 1
    v_max_f32 v96, v96, v97
    v_mov_b32 v97, v96
    s_nop 1
    v_permlane32_swap_b32 v97, v96
    s_nop 1
    v_max_f32 v96, v96, v97
    v_sub_f32 v98, v224, v96
    v_exp_f32 v98, v98
    v_mov_b32 v224, v96
    v_sub_f32 v192, v192, v96
    v_sub_f32 v193, v193, v96
    v_sub_f32 v194, v194, v96
    v_sub_f32 v195, v195, v96
    v_exp_f32 v192, v192
    v_exp_f32 v193, v193
    v_exp_f32 v194, v194
    v_exp_f32 v195, v195
    v_sub_f32 v208, v208, v96
    v_sub_f32 v209, v209, v96
    v_sub_f32 v210, v210, v96
    v_sub_f32 v211, v211, v96
    v_exp_f32 v208, v208
    v_exp_f32 v209, v209
    v_exp_f32 v210, v210
    v_exp_f32 v211, v211
    s_nop 0
    v_cvt_pk_bf16_f32 v48, v192, v193
    v_cvt_pk_bf16_f32 v49, v194, v195
    v_cvt_pk_bf16_f32 v50, v208, v209
    v_cvt_pk_bf16_f32 v51, v210, v211
    v_accvgpr_read_b32 v104, a64
    v_accvgpr_read_b32 v105, a65
    v_accvgpr_read_b32 v106, a66
    v_accvgpr_read_b32 v107, a67
    v_accvgpr_read_b32 v108, a68
    v_accvgpr_read_b32 v109, a69
    v_accvgpr_read_b32 v110, a70
    v_accvgpr_read_b32 v111, a71
    v_accvgpr_read_b32 v112, a72
    v_accvgpr_read_b32 v113, a73
    v_accvgpr_read_b32 v114, a74
    v_accvgpr_read_b32 v115, a75
    v_mul_f32 v104, v104, v98
    v_mul_f32 v105, v105, v98
    v_mul_f32 v106, v106, v98
    v_mul_f32 v107, v107, v98
    v_mul_f32 v108, v108, v98
    v_mul_f32 v109, v109, v98
    v_mul_f32 v110, v110, v98
    v_mul_f32 v111, v111, v98
    v_mul_f32 v112, v112, v98
    v_mul_f32 v113, v113, v98
    v_mul_f32 v114, v114, v98
    v_mul_f32 v115, v115, v98
    v_accvgpr_write_b32 a64, v104
    v_accvgpr_write_b32 a65, v105
    v_accvgpr_write_b32 a66, v106
    v_accvgpr_write_b32 a67, v107
    v_accvgpr_write_b32 a68, v108
    v_accvgpr_write_b32 a69, v109
    v_accvgpr_write_b32 a70, v110
    v_accvgpr_write_b32 a71, v111
    v_accvgpr_write_b32 a72, v112
    v_accvgpr_write_b32 a73, v113
    v_accvgpr_write_b32 a74, v114
    v_accvgpr_write_b32 a75, v115
    v_accvgpr_read_b32 v104, a76
    v_accvgpr_read_b32 v105, a77
    v_accvgpr_read_b32 v106, a78
    v_accvgpr_read_b32 v107, a79
    v_accvgpr_read_b32 v108, a80
    v_accvgpr_read_b32 v109, a81
    v_accvgpr_read_b32 v110, a82
    v_accvgpr_read_b32 v111, a83
    v_accvgpr_read_b32 v112, a84
    v_accvgpr_read_b32 v113, a85
    v_accvgpr_read_b32 v114, a86
    v_accvgpr_read_b32 v115, a87
    v_mul_f32 v104, v104, v98
    v_mul_f32 v105, v105, v98
    v_mul_f32 v106, v106, v98
    v_mul_f32 v107, v107, v98
    v_mul_f32 v108, v108, v98
    v_mul_f32 v109, v109, v98
    v_mul_f32 v110, v110, v98
    v_mul_f32 v111, v111, v98
    v_mul_f32 v112, v112, v98
    v_mul_f32 v113, v113, v98
    v_mul_f32 v114, v114, v98
    v_mul_f32 v115, v115, v98
    v_accvgpr_write_b32 a76, v104
    v_accvgpr_write_b32 a77, v105
    v_accvgpr_write_b32 a78, v106
    v_accvgpr_write_b32 a79, v107
    v_accvgpr_write_b32 a80, v108
    v_accvgpr_write_b32 a81, v109
    v_accvgpr_write_b32 a82, v110
    v_accvgpr_write_b32 a83, v111
    v_accvgpr_write_b32 a84, v112
    v_accvgpr_write_b32 a85, v113
    v_accvgpr_write_b32 a86, v114
    v_accvgpr_write_b32 a87, v115
    v_accvgpr_read_b32 v104, a88
    v_accvgpr_read_b32 v105, a89
    v_accvgpr_read_b32 v106, a90
    v_accvgpr_read_b32 v107, a91
    v_accvgpr_read_b32 v108, a92
    v_accvgpr_read_b32 v109, a93
    v_accvgpr_read_b32 v110, a94
    v_accvgpr_read_b32 v111, a95
    v_accvgpr_read_b32 v112, a192
    v_accvgpr_read_b32 v113, a193
    v_accvgpr_read_b32 v114, a194
    v_accvgpr_read_b32 v115, a195
    v_mul_f32 v104, v104, v98
    v_mul_f32 v105, v105, v98
    v_mul_f32 v106, v106, v98
    v_mul_f32 v107, v107, v98
    v_mul_f32 v108, v108, v98
    v_mul_f32 v109, v109, v98
    v_mul_f32 v110, v110, v98
    v_mul_f32 v111, v111, v98
    v_mul_f32 v112, v112, v98
    v_mul_f32 v113, v113, v98
    v_mul_f32 v114, v114, v98
    v_mul_f32 v115, v115, v98
    v_accvgpr_write_b32 a88, v104
    v_accvgpr_write_b32 a89, v105
    v_accvgpr_write_b32 a90, v106
    v_accvgpr_write_b32 a91, v107
    v_accvgpr_write_b32 a92, v108
    v_accvgpr_write_b32 a93, v109
    v_accvgpr_write_b32 a94, v110
    v_accvgpr_write_b32 a95, v111
    v_accvgpr_write_b32 a192, v112
    v_accvgpr_write_b32 a193, v113
    v_accvgpr_write_b32 a194, v114
    v_accvgpr_write_b32 a195, v115
    v_max3_f32 v96, v196, v197, v198
    v_max3_f32 v96, v96, v199, v212
    v_max3_f32 v96, v96, v213, v214
    v_max3_f32 v96, v96, v215, v225
    v_mov_b32 v97, v96
    s_nop 1
    v_permlane16_swap_b32 v97, v96
    s_nop 1
    v_max_f32 v96, v96, v97
    v_mov_b32 v97, v96
    s_nop 1
    v_permlane32_swap_b32 v97, v96
    s_nop 1
    v_max_f32 v96, v96, v97
    v_sub_f32 v98, v225, v96
    v_exp_f32 v98, v98
    v_mov_b32 v225, v96
    v_sub_f32 v196, v196, v96
    v_sub_f32 v197, v197, v96
    v_sub_f32 v198, v198, v96
    v_sub_f32 v199, v199, v96
    v_exp_f32 v196, v196
    v_exp_f32 v197, v197
    v_exp_f32 v198, v198
    v_exp_f32 v199, v199
    v_sub_f32 v212, v212, v96
    v_sub_f32 v213, v213, v96
    v_sub_f32 v214, v214, v96
    v_sub_f32 v215, v215, v96
    v_exp_f32 v212, v212
    v_exp_f32 v213, v213
    v_exp_f32 v214, v214
    v_exp_f32 v215, v215
    s_nop 0
    v_cvt_pk_bf16_f32 v56, v196, v197
    v_cvt_pk_bf16_f32 v57, v198, v199
    v_cvt_pk_bf16_f32 v58, v212, v213
    v_cvt_pk_bf16_f32 v59, v214, v215
    v_accvgpr_read_b32 v104, a96
    v_accvgpr_read_b32 v105, a97
    v_accvgpr_read_b32 v106, a98
    v_accvgpr_read_b32 v107, a99
    v_accvgpr_read_b32 v108, a100
    v_accvgpr_read_b32 v109, a101
    v_accvgpr_read_b32 v110, a102
    v_accvgpr_read_b32 v111, a103
    v_accvgpr_read_b32 v112, a104
    v_accvgpr_read_b32 v113, a105
    v_accvgpr_read_b32 v114, a106
    v_accvgpr_read_b32 v115, a107
    v_mul_f32 v104, v104, v98
    v_mul_f32 v105, v105, v98
    v_mul_f32 v106, v106, v98
    v_mul_f32 v107, v107, v98
    v_mul_f32 v108, v108, v98
    v_mul_f32 v109, v109, v98
    v_mul_f32 v110, v110, v98
    v_mul_f32 v111, v111, v98
    v_mul_f32 v112, v112, v98
    v_mul_f32 v113, v113, v98
    v_mul_f32 v114, v114, v98
    v_mul_f32 v115, v115, v98
    v_accvgpr_write_b32 a96, v104
    v_accvgpr_write_b32 a97, v105
    v_accvgpr_write_b32 a98, v106
    v_accvgpr_write_b32 a99, v107
    v_accvgpr_write_b32 a100, v108
    v_accvgpr_write_b32 a101, v109
    v_accvgpr_write_b32 a102, v110
    v_accvgpr_write_b32 a103, v111
    v_accvgpr_write_b32 a104, v112
    v_accvgpr_write_b32 a105, v113
    v_accvgpr_write_b32 a106, v114
    v_accvgpr_write_b32 a107, v115
    v_accvgpr_read_b32 v104, a108
    v_accvgpr_read_b32 v105, a109
    v_accvgpr_read_b32 v106, a110
    v_accvgpr_read_b32 v107, a111
    v_accvgpr_read_b32 v108, a112
    v_accvgpr_read_b32 v109, a113
    v_accvgpr_read_b32 v110, a114
    v_accvgpr_read_b32 v111, a115
    v_accvgpr_read_b32 v112, a116
    v_accvgpr_read_b32 v113, a117
    v_accvgpr_read_b32 v114, a118
    v_accvgpr_read_b32 v115, a119
    v_mul_f32 v104, v104, v98
    v_mul_f32 v105, v105, v98
    v_mul_f32 v106, v106, v98
    v_mul_f32 v107, v107, v98
    v_mul_f32 v108, v108, v98
    v_mul_f32 v109, v109, v98
    v_mul_f32 v110, v110, v98
    v_mul_f32 v111, v111, v98
    v_mul_f32 v112, v112, v98
    v_mul_f32 v113, v113, v98
    v_mul_f32 v114, v114, v98
    v_mul_f32 v115, v115, v98
    v_accvgpr_write_b32 a108, v104
    v_accvgpr_write_b32 a109, v105
    v_accvgpr_write_b32 a110, v106
    v_accvgpr_write_b32 a111, v107
    v_accvgpr_write_b32 a112, v108
    v_accvgpr_write_b32 a113, v109
    v_accvgpr_write_b32 a114, v110
    v_accvgpr_write_b32 a115, v111
    v_accvgpr_write_b32 a116, v112
    v_accvgpr_write_b32 a117, v113
    v_accvgpr_write_b32 a118, v114
    v_accvgpr_write_b32 a119, v115
    v_accvgpr_read_b32 v104, a120
    v_accvgpr_read_b32 v105, a121
    v_accvgpr_read_b32 v106, a122
    v_accvgpr_read_b32 v107, a123
    v_accvgpr_read_b32 v108, a124
    v_accvgpr_read_b32 v109, a125
    v_accvgpr_read_b32 v110, a126
    v_accvgpr_read_b32 v111, a127
    v_accvgpr_read_b32 v112, a196
    v_accvgpr_read_b32 v113, a197
    v_accvgpr_read_b32 v114, a198
    v_accvgpr_read_b32 v115, a199
    v_mul_f32 v104, v104, v98
    v_mul_f32 v105, v105, v98
    v_mul_f32 v106, v106, v98
    v_mul_f32 v107, v107, v98
    v_mul_f32 v108, v108, v98
    v_mul_f32 v109, v109, v98
    v_mul_f32 v110, v110, v98
    v_mul_f32 v111, v111, v98
    v_mul_f32 v112, v112, v98
    v_mul_f32 v113, v113, v98
    v_mul_f32 v114, v114, v98
    v_mul_f32 v115, v115, v98
    v_accvgpr_write_b32 a120, v104
    v_accvgpr_write_b32 a121, v105
    v_accvgpr_write_b32 a122, v106
    v_accvgpr_write_b32 a123, v107
    v_accvgpr_write_b32 a124, v108
    v_accvgpr_write_b32 a125, v109
    v_accvgpr_write_b32 a126, v110
    v_accvgpr_write_b32 a127, v111
    v_accvgpr_write_b32 a196, v112
    v_accvgpr_write_b32 a197, v113
    v_accvgpr_write_b32 a198, v114
    v_accvgpr_write_b32 a199, v115
    v_max3_f32 v96, v200, v201, v202
    v_max3_f32 v96, v96, v203, v216
    v_max3_f32 v96, v96, v217, v218
    v_max3_f32 v96, v96, v219, v226
    v_mov_b32 v97, v96
    s_nop 1
    v_permlane16_swap_b32 v97, v96
    s_nop 1
    v_max_f32 v96, v96, v97
    v_mov_b32 v97, v96
    s_nop 1
    v_permlane32_swap_b32 v97, v96
    s_nop 1
    v_max_f32 v96, v96, v97
    v_sub_f32 v98, v226, v96
    v_exp_f32 v98, v98
    v_mov_b32 v226, v96
    v_sub_f32 v200, v200, v96
    v_sub_f32 v201, v201, v96
    v_sub_f32 v202, v202, v96
    v_sub_f32 v203, v203, v96
    v_exp_f32 v200, v200
    v_exp_f32 v201, v201
    v_exp_f32 v202, v202
    v_exp_f32 v203, v203
    v_sub_f32 v216, v216, v96
    v_sub_f32 v217, v217, v96
    v_sub_f32 v218, v218, v96
    v_sub_f32 v219, v219, v96
    v_exp_f32 v216, v216
    v_exp_f32 v217, v217
    v_exp_f32 v218, v218
    v_exp_f32 v219, v219
    s_nop 0
    v_cvt_pk_bf16_f32 v64, v200, v201
    v_cvt_pk_bf16_f32 v65, v202, v203
    v_cvt_pk_bf16_f32 v66, v216, v217
    v_cvt_pk_bf16_f32 v67, v218, v219
    v_accvgpr_read_b32 v104, a128
    v_accvgpr_read_b32 v105, a129
    v_accvgpr_read_b32 v106, a130
    v_accvgpr_read_b32 v107, a131
    v_accvgpr_read_b32 v108, a132
    v_accvgpr_read_b32 v109, a133
    v_accvgpr_read_b32 v110, a134
    v_accvgpr_read_b32 v111, a135
    v_accvgpr_read_b32 v112, a136
    v_accvgpr_read_b32 v113, a137
    v_accvgpr_read_b32 v114, a138
    v_accvgpr_read_b32 v115, a139
    v_mul_f32 v104, v104, v98
    v_mul_f32 v105, v105, v98
    v_mul_f32 v106, v106, v98
    v_mul_f32 v107, v107, v98
    v_mul_f32 v108, v108, v98
    v_mul_f32 v109, v109, v98
    v_mul_f32 v110, v110, v98
    v_mul_f32 v111, v111, v98
    v_mul_f32 v112, v112, v98
    v_mul_f32 v113, v113, v98
    v_mul_f32 v114, v114, v98
    v_mul_f32 v115, v115, v98
    v_accvgpr_write_b32 a128, v104
    v_accvgpr_write_b32 a129, v105
    v_accvgpr_write_b32 a130, v106
    v_accvgpr_write_b32 a131, v107
    v_accvgpr_write_b32 a132, v108
    v_accvgpr_write_b32 a133, v109
    v_accvgpr_write_b32 a134, v110
    v_accvgpr_write_b32 a135, v111
    v_accvgpr_write_b32 a136, v112
    v_accvgpr_write_b32 a137, v113
    v_accvgpr_write_b32 a138, v114
    v_accvgpr_write_b32 a139, v115
    v_accvgpr_read_b32 v104, a140
    v_accvgpr_read_b32 v105, a141
    v_accvgpr_read_b32 v106, a142
    v_accvgpr_read_b32 v107, a143
    v_accvgpr_read_b32 v108, a144
    v_accvgpr_read_b32 v109, a145
    v_accvgpr_read_b32 v110, a146
    v_accvgpr_read_b32 v111, a147
    v_accvgpr_read_b32 v112, a148
    v_accvgpr_read_b32 v113, a149
    v_accvgpr_read_b32 v114, a150
    v_accvgpr_read_b32 v115, a151
    v_mul_f32 v104, v104, v98
    v_mul_f32 v105, v105, v98
    v_mul_f32 v106, v106, v98
    v_mul_f32 v107, v107, v98
    v_mul_f32 v108, v108, v98
    v_mul_f32 v109, v109, v98
    v_mul_f32 v110, v110, v98
    v_mul_f32 v111, v111, v98
    v_mul_f32 v112, v112, v98
    v_mul_f32 v113, v113, v98
    v_mul_f32 v114, v114, v98
    v_mul_f32 v115, v115, v98
    v_accvgpr_write_b32 a140, v104
    v_accvgpr_write_b32 a141, v105
    v_accvgpr_write_b32 a142, v106
    v_accvgpr_write_b32 a143, v107
    v_accvgpr_write_b32 a144, v108
    v_accvgpr_write_b32 a145, v109
    v_accvgpr_write_b32 a146, v110
    v_accvgpr_write_b32 a147, v111
    v_accvgpr_write_b32 a148, v112
    v_accvgpr_write_b32 a149, v113
    v_accvgpr_write_b32 a150, v114
    v_accvgpr_write_b32 a151, v115
    v_accvgpr_read_b32 v104, a152
    v_accvgpr_read_b32 v105, a153
    v_accvgpr_read_b32 v106, a154
    v_accvgpr_read_b32 v107, a155
    v_accvgpr_read_b32 v108, a156
    v_accvgpr_read_b32 v109, a157
    v_accvgpr_read_b32 v110, a158
    v_accvgpr_read_b32 v111, a159
    v_accvgpr_read_b32 v112, a200
    v_accvgpr_read_b32 v113, a201
    v_accvgpr_read_b32 v114, a202
    v_accvgpr_read_b32 v115, a203
    v_mul_f32 v104, v104, v98
    v_mul_f32 v105, v105, v98
    v_mul_f32 v106, v106, v98
    v_mul_f32 v107, v107, v98
    v_mul_f32 v108, v108, v98
    v_mul_f32 v109, v109, v98
    v_mul_f32 v110, v110, v98
    v_mul_f32 v111, v111, v98
    v_mul_f32 v112, v112, v98
    v_mul_f32 v113, v113, v98
    v_mul_f32 v114, v114, v98
    v_mul_f32 v115, v115, v98
    v_accvgpr_write_b32 a152, v104
    v_accvgpr_write_b32 a153, v105
    v_accvgpr_write_b32 a154, v106
    v_accvgpr_write_b32 a155, v107
    v_accvgpr_write_b32 a156, v108
    v_accvgpr_write_b32 a157, v109
    v_accvgpr_write_b32 a158, v110
    v_accvgpr_write_b32 a159, v111
    v_accvgpr_write_b32 a200, v112
    v_accvgpr_write_b32 a201, v113
    v_accvgpr_write_b32 a202, v114
    v_accvgpr_write_b32 a203, v115
    v_max3_f32 v96, v204, v205, v206
    v_max3_f32 v96, v96, v207, v220
    v_max3_f32 v96, v96, v221, v222
    v_max3_f32 v96, v96, v223, v227
    v_mov_b32 v97, v96
    s_nop 1
    v_permlane16_swap_b32 v97, v96
    s_nop 1
    v_max_f32 v96, v96, v97
    v_mov_b32 v97, v96
    s_nop 1
    v_permlane32_swap_b32 v97, v96
    s_nop 1
    v_max_f32 v96, v96, v97
    v_sub_f32 v98, v227, v96
    v_exp_f32 v98, v98
    v_mov_b32 v227, v96
    v_sub_f32 v204, v204, v96
    v_sub_f32 v205, v205, v96
    v_sub_f32 v206, v206, v96
    v_sub_f32 v207, v207, v96
    v_exp_f32 v204, v204
    v_exp_f32 v205, v205
    v_exp_f32 v206, v206
    v_exp_f32 v207, v207
    v_sub_f32 v220, v220, v96
    v_sub_f32 v221, v221, v96
    v_sub_f32 v222, v222, v96
    v_sub_f32 v223, v223, v96
    v_exp_f32 v220, v220
    v_exp_f32 v221, v221
    v_exp_f32 v222, v222
    v_exp_f32 v223, v223
    s_nop 0
    v_cvt_pk_bf16_f32 v72, v204, v205
    v_cvt_pk_bf16_f32 v73, v206, v207
    v_cvt_pk_bf16_f32 v74, v220, v221
    v_cvt_pk_bf16_f32 v75, v222, v223
    v_accvgpr_read_b32 v104, a160
    v_accvgpr_read_b32 v105, a161
    v_accvgpr_read_b32 v106, a162
    v_accvgpr_read_b32 v107, a163
    v_accvgpr_read_b32 v108, a164
    v_accvgpr_read_b32 v109, a165
    v_accvgpr_read_b32 v110, a166
    v_accvgpr_read_b32 v111, a167
    v_accvgpr_read_b32 v112, a168
    v_accvgpr_read_b32 v113, a169
    v_accvgpr_read_b32 v114, a170
    v_accvgpr_read_b32 v115, a171
    v_mul_f32 v104, v104, v98
    v_mul_f32 v105, v105, v98
    v_mul_f32 v106, v106, v98
    v_mul_f32 v107, v107, v98
    v_mul_f32 v108, v108, v98
    v_mul_f32 v109, v109, v98
    v_mul_f32 v110, v110, v98
    v_mul_f32 v111, v111, v98
    v_mul_f32 v112, v112, v98
    v_mul_f32 v113, v113, v98
    v_mul_f32 v114, v114, v98
    v_mul_f32 v115, v115, v98
    v_accvgpr_write_b32 a160, v104
    v_accvgpr_write_b32 a161, v105
    v_accvgpr_write_b32 a162, v106
    v_accvgpr_write_b32 a163, v107
    v_accvgpr_write_b32 a164, v108
    v_accvgpr_write_b32 a165, v109
    v_accvgpr_write_b32 a166, v110
    v_accvgpr_write_b32 a167, v111
    v_accvgpr_write_b32 a168, v112
    v_accvgpr_write_b32 a169, v113
    v_accvgpr_write_b32 a170, v114
    v_accvgpr_write_b32 a171, v115
    v_accvgpr_read_b32 v104, a172
    v_accvgpr_read_b32 v105, a173
    v_accvgpr_read_b32 v106, a174
    v_accvgpr_read_b32 v107, a175
    v_accvgpr_read_b32 v108, a176
    v_accvgpr_read_b32 v109, a177
    v_accvgpr_read_b32 v110, a178
    v_accvgpr_read_b32 v111, a179
    v_accvgpr_read_b32 v112, a180
    v_accvgpr_read_b32 v113, a181
    v_accvgpr_read_b32 v114, a182
    v_accvgpr_read_b32 v115, a183
    v_mul_f32 v104, v104, v98
    v_mul_f32 v105, v105, v98
    v_mul_f32 v106, v106, v98
    v_mul_f32 v107, v107, v98
    v_mul_f32 v108, v108, v98
    v_mul_f32 v109, v109, v98
    v_mul_f32 v110, v110, v98
    v_mul_f32 v111, v111, v98
    v_mul_f32 v112, v112, v98
    v_mul_f32 v113, v113, v98
    v_mul_f32 v114, v114, v98
    v_mul_f32 v115, v115, v98
    v_accvgpr_write_b32 a172, v104
    v_accvgpr_write_b32 a173, v105
    v_accvgpr_write_b32 a174, v106
    v_accvgpr_write_b32 a175, v107
    v_accvgpr_write_b32 a176, v108
    v_accvgpr_write_b32 a177, v109
    v_accvgpr_write_b32 a178, v110
    v_accvgpr_write_b32 a179, v111
    v_accvgpr_write_b32 a180, v112
    v_accvgpr_write_b32 a181, v113
    v_accvgpr_write_b32 a182, v114
    v_accvgpr_write_b32 a183, v115
    v_accvgpr_read_b32 v104, a184
    v_accvgpr_read_b32 v105, a185
    v_accvgpr_read_b32 v106, a186
    v_accvgpr_read_b32 v107, a187
    v_accvgpr_read_b32 v108, a188
    v_accvgpr_read_b32 v109, a189
    v_accvgpr_read_b32 v110, a190
    v_accvgpr_read_b32 v111, a191
    v_accvgpr_read_b32 v112, a204
    v_accvgpr_read_b32 v113, a205
    v_accvgpr_read_b32 v114, a206
    v_accvgpr_read_b32 v115, a207
    v_mul_f32 v104, v104, v98
    v_mul_f32 v105, v105, v98
    v_mul_f32 v106, v106, v98
    v_mul_f32 v107, v107, v98
    v_mul_f32 v108, v108, v98
    v_mul_f32 v109, v109, v98
    v_mul_f32 v110, v110, v98
    v_mul_f32 v111, v111, v98
    v_mul_f32 v112, v112, v98
    v_mul_f32 v113, v113, v98
    v_mul_f32 v114, v114, v98
    v_mul_f32 v115, v115, v98
    v_accvgpr_write_b32 a184, v104
    v_accvgpr_write_b32 a185, v105
    v_accvgpr_write_b32 a186, v106
    v_accvgpr_write_b32 a187, v107
    v_accvgpr_write_b32 a188, v108
    v_accvgpr_write_b32 a189, v109
    v_accvgpr_write_b32 a190, v110
    v_accvgpr_write_b32 a191, v111
    v_accvgpr_write_b32 a204, v112
    v_accvgpr_write_b32 a205, v113
    v_accvgpr_write_b32 a206, v114
    v_accvgpr_write_b32 a207, v115
    s_waitcnt lgkmcnt(0)
    s_nop 1
    v_mfma_f32_16x16x32_bf16 a[64:67], a[32:35], v[48:51], a[64:67]
    v_mfma_f32_16x16x32_bf16 a[96:99], a[32:35], v[56:59], a[96:99]
    v_mfma_f32_16x16x32_bf16 a[128:131], a[32:35], v[64:67], a[128:131]
    v_mfma_f32_16x16x32_bf16 a[160:163], a[32:35], v[72:75], a[160:163]
    v_mfma_f32_16x16x32_bf16 a[68:71], a[36:39], v[48:51], a[68:71]
    v_mfma_f32_16x16x32_bf16 a[100:103], a[36:39], v[56:59], a[100:103]
    v_mfma_f32_16x16x32_bf16 a[132:135], a[36:39], v[64:67], a[132:135]
    v_mfma_f32_16x16x32_bf16 a[164:167], a[36:39], v[72:75], a[164:167]
    v_mfma_f32_16x16x32_bf16 a[72:75], a[40:43], v[48:51], a[72:75]
    v_mfma_f32_16x16x32_bf16 a[104:107], a[40:43], v[56:59], a[104:107]
    v_mfma_f32_16x16x32_bf16 a[136:139], a[40:43], v[64:67], a[136:139]
    v_mfma_f32_16x16x32_bf16 a[168:171], a[40:43], v[72:75], a[168:171]
    v_mfma_f32_16x16x32_bf16 a[76:79], a[44:47], v[48:51], a[76:79]
    v_mfma_f32_16x16x32_bf16 a[108:111], a[44:47], v[56:59], a[108:111]
    v_mfma_f32_16x16x32_bf16 a[140:143], a[44:47], v[64:67], a[140:143]
    v_mfma_f32_16x16x32_bf16 a[172:175], a[44:47], v[72:75], a[172:175]
    v_mfma_f32_16x16x32_bf16 a[80:83], a[48:51], v[48:51], a[80:83]
    v_mfma_f32_16x16x32_bf16 a[112:115], a[48:51], v[56:59], a[112:115]
    v_mfma_f32_16x16x32_bf16 a[144:147], a[48:51], v[64:67], a[144:147]
    v_mfma_f32_16x16x32_bf16 a[176:179], a[48:51], v[72:75], a[176:179]
    v_mfma_f32_16x16x32_bf16 a[84:87], a[52:55], v[48:51], a[84:87]
    v_mfma_f32_16x16x32_bf16 a[116:119], a[52:55], v[56:59], a[116:119]
    v_mfma_f32_16x16x32_bf16 a[148:151], a[52:55], v[64:67], a[148:151]
    v_mfma_f32_16x16x32_bf16 a[180:183], a[52:55], v[72:75], a[180:183]
    v_mfma_f32_16x16x32_bf16 a[88:91], a[56:59], v[48:51], a[88:91]
    v_mfma_f32_16x16x32_bf16 a[120:123], a[56:59], v[56:59], a[120:123]
    v_mfma_f32_16x16x32_bf16 a[152:155], a[56:59], v[64:67], a[152:155]
    v_mfma_f32_16x16x32_bf16 a[184:187], a[56:59], v[72:75], a[184:187]
    v_mfma_f32_16x16x32_bf16 a[92:95], a[60:63], v[48:51], a[92:95]
    v_mfma_f32_16x16x32_bf16 a[124:127], a[60:63], v[56:59], a[124:127]
    v_mfma_f32_16x16x32_bf16 a[156:159], a[60:63], v[64:67], a[156:159]
    v_mfma_f32_16x16x32_bf16 a[188:191], a[60:63], v[72:75], a[188:191]
    v_mfma_f32_16x16x32_bf16 a[192:195], v[92:95], v[48:51], a[192:195]
    v_mfma_f32_16x16x32_bf16 a[196:199], v[92:95], v[56:59], a[196:199]
    v_mfma_f32_16x16x32_bf16 a[200:203], v[92:95], v[64:67], a[200:203]
    v_mfma_f32_16x16x32_bf16 a[204:207], v[92:95], v[72:75], a[204:207]
    ds_read_b128 a[0:3], v80 offset:2048
    ds_read_b128 a[4:7], v81 offset:2048
    ds_read_b128 a[8:11], v82 offset:2048
    ds_read_b128 a[12:15], v83 offset:2048
    ds_read_b128 a[16:19], v80 offset:3072
    ds_read_b128 a[20:23], v81 offset:3072
    ds_read_b128 a[24:27], v82 offset:3072
    ds_read_b128 a[28:31], v83 offset:3072
    s_waitcnt lgkmcnt(0)
    ds_read_b64_tr_b16 a[32:33], v84 offset:2048
    ds_read_b64_tr_b16 a[34:35], v84 offset:3072
    ds_read_b64_tr_b16 a[36:37], v85 offset:2048
    ds_read_b64_tr_b16 a[38:39], v85 offset:3072
    ds_read_b64_tr_b16 a[40:41], v86 offset:2048
    ds_read_b64_tr_b16 a[42:43], v86 offset:3072
    ds_read_b64_tr_b16 a[44:45], v87 offset:2048
    ds_read_b64_tr_b16 a[46:47], v87 offset:3072
    ds_read_b64_tr_b16 a[48:49], v88 offset:2048
    ds_read_b64_tr_b16 a[50:51], v88 offset:3072
    ds_read_b64_tr_b16 a[52:53], v89 offset:2048
    ds_read_b64_tr_b16 a[54:55], v89 offset:3072
    ds_read_b64_tr_b16 a[56:57], v90 offset:2048
    ds_read_b64_tr_b16 a[58:59], v90 offset:3072
    ds_read_b64_tr_b16 a[60:61], v91 offset:2048
    ds_read_b64_tr_b16 a[62:63], v91 offset:3072
    v_mfma_f32_16x16x32_bf16 v[192:195], a[0:3], v[128:131], 0
    v_mfma_f32_16x16x32_bf16 v[192:195], a[4:7], v[144:147], v[192:195]
    v_mfma_f32_16x16x32_bf16 v[192:195], a[8:11], v[160:163], v[192:195]
    v_mfma_f32_16x16x32_bf16 v[192:195], a[12:15], v[176:179], v[192:195]
    v_mfma_f32_16x16x32_bf16 v[196:199], a[0:3], v[132:135], 0
    v_mfma_f32_16x16x32_bf16 v[196:199], a[4:7], v[148:151], v[196:199]
    v_mfma_f32_16x16x32_bf16 v[196:199], a[8:11], v[164:167], v[196:199]
    v_mfma_f32_16x16x32_bf16 v[196:199], a[12:15], v[180:183], v[196:199]
    v_mfma_f32_16x16x32_bf16 v[200:203], a[0:3], v[136:139], 0
    v_mfma_f32_16x16x32_bf16 v[200:203], a[4:7], v[152:155], v[200:203]
    v_mfma_f32_16x16x32_bf16 v[200:203], a[8:11], v[168:171], v[200:203]
    v_mfma_f32_16x16x32_bf16 v[200:203], a[12:15], v[184:187], v[200:203]
    v_mfma_f32_16x16x32_bf16 v[204:207], a[0:3], v[140:143], 0
    v_mfma_f32_16x16x32_bf16 v[204:207], a[4:7], v[156:159], v[204:207]
    v_mfma_f32_16x16x32_bf16 v[204:207], a[8:11], v[172:175], v[204:207]
    v_mfma_f32_16x16x32_bf16 v[204:207], a[12:15], v[188:191], v[204:207]
    v_mfma_f32_16x16x32_bf16 v[208:211], a[16:19], v[128:131], 0
    v_mfma_f32_16x16x32_bf16 v[208:211], a[20:23], v[144:147], v[208:211]
    v_mfma_f32_16x16x32_bf16 v[208:211], a[24:27], v[160:163], v[208:211]
    v_mfma_f32_16x16x32_bf16 v[208:211], a[28:31], v[176:179], v[208:211]
    v_mfma_f32_16x16x32_bf16 v[212:215], a[16:19], v[132:135], 0
    v_mfma_f32_16x16x32_bf16 v[212:215], a[20:23], v[148:151], v[212:215]
    v_mfma_f32_16x16x32_bf16 v[212:215], a[24:27], v[164:167], v[212:215]
    v_mfma_f32_16x16x32_bf16 v[212:215], a[28:31], v[180:183], v[212:215]
    v_mfma_f32_16x16x32_bf16 v[216:219], a[16:19], v[136:139], 0
    v_mfma_f32_16x16x32_bf16 v[216:219], a[20:23], v[152:155], v[216:219]
    v_mfma_f32_16x16x32_bf16 v[216:219], a[24:27], v[168:171], v[216:219]
    v_mfma_f32_16x16x32_bf16 v[216:219], a[28:31], v[184:187], v[216:219]
    v_mfma_f32_16x16x32_bf16 v[220:223], a[16:19], v[140:143], 0
    v_mfma_f32_16x16x32_bf16 v[220:223], a[20:23], v[156:159], v[220:223]
    v_mfma_f32_16x16x32_bf16 v[220:223], a[24:27], v[172:175], v[220:223]
    v_mfma_f32_16x16x32_bf16 v[220:223], a[28:31], v[188:191], v[220:223]
    s_nop 7
    s_nop 7
    v_max3_f32 v96, v192, v193, v194
    v_max3_f32 v96, v96, v195, v208
    v_max3_f32 v96, v96, v209, v210
    v_max3_f32 v96, v96, v211, v224
    v_mov_b32 v97, v96
    s_nop 1
    v_permlane16_swap_b32 v97, v96
    s_nop 1
    v_max_f32 v96, v96, v97
    v_mov_b32 v97, v96
    s_nop 1
    v_permlane32_swap_b32 v97, v96
    s_nop 1
    v_max_f32 v96, v96, v97
    v_sub_f32 v98, v224, v96
    v_exp_f32 v98, v98
    v_mov_b32 v224, v96
    v_sub_f32 v192, v192, v96
    v_sub_f32 v193, v193, v96
    v_sub_f32 v194, v194, v96
    v_sub_f32 v195, v195, v96
    v_exp_f32 v192, v192
    v_exp_f32 v193, v193
    v_exp_f32 v194, v194
    v_exp_f32 v195, v195
    v_sub_f32 v208, v208, v96
    v_sub_f32 v209, v209, v96
    v_sub_f32 v210, v210, v96
    v_sub_f32 v211, v211, v96
    v_exp_f32 v208, v208
    v_exp_f32 v209, v209
    v_exp_f32 v210, v210
    v_exp_f32 v211, v211
    s_nop 0
    v_cvt_pk_bf16_f32 v48, v192, v193
    v_cvt_pk_bf16_f32 v49, v194, v195
    v_cvt_pk_bf16_f32 v50, v208, v209
    v_cvt_pk_bf16_f32 v51, v210, v211
    v_accvgpr_read_b32 v104, a64
    v_accvgpr_read_b32 v105, a65
    v_accvgpr_read_b32 v106, a66
    v_accvgpr_read_b32 v107, a67
    v_accvgpr_read_b32 v108, a68
    v_accvgpr_read_b32 v109, a69
    v_accvgpr_read_b32 v110, a70
    v_accvgpr_read_b32 v111, a71
    v_accvgpr_read_b32 v112, a72
    v_accvgpr_read_b32 v113, a73
    v_accvgpr_read_b32 v114, a74
    v_accvgpr_read_b32 v115, a75
    v_mul_f32 v104, v104, v98
    v_mul_f32 v105, v105, v98
    v_mul_f32 v106, v106, v98
    v_mul_f32 v107, v107, v98
    v_mul_f32 v108, v108, v98
    v_mul_f32 v109, v109, v98
    v_mul_f32 v110, v110, v98
    v_mul_f32 v111, v111, v98
    v_mul_f32 v112, v112, v98
    v_mul_f32 v113, v113, v98
    v_mul_f32 v114, v114, v98
    v_mul_f32 v115, v115, v98
    v_accvgpr_write_b32 a64, v104
    v_accvgpr_write_b32 a65, v105
    v_accvgpr_write_b32 a66, v106
    v_accvgpr_write_b32 a67, v107
    v_accvgpr_write_b32 a68, v108
    v_accvgpr_write_b32 a69, v109
    v_accvgpr_write_b32 a70, v110
    v_accvgpr_write_b32 a71, v111
    v_accvgpr_write_b32 a72, v112
    v_accvgpr_write_b32 a73, v113
    v_accvgpr_write_b32 a74, v114
    v_accvgpr_write_b32 a75, v115
    v_accvgpr_read_b32 v104, a76
    v_accvgpr_read_b32 v105, a77
    v_accvgpr_read_b32 v106, a78
    v_accvgpr_read_b32 v107, a79
    v_accvgpr_read_b32 v108, a80
    v_accvgpr_read_b32 v109, a81
    v_accvgpr_read_b32 v110, a82
    v_accvgpr_read_b32 v111, a83
    v_accvgpr_read_b32 v112, a84
    v_accvgpr_read_b32 v113, a85
    v_accvgpr_read_b32 v114, a86
    v_accvgpr_read_b32 v115, a87
    v_mul_f32 v104, v104, v98
    v_mul_f32 v105, v105, v98
    v_mul_f32 v106, v106, v98
    v_mul_f32 v107, v107, v98
    v_mul_f32 v108, v108, v98
    v_mul_f32 v109, v109, v98
    v_mul_f32 v110, v110, v98
    v_mul_f32 v111, v111, v98
    v_mul_f32 v112, v112, v98
    v_mul_f32 v113, v113, v98
    v_mul_f32 v114, v114, v98
    v_mul_f32 v115, v115, v98
    v_accvgpr_write_b32 a76, v104
    v_accvgpr_write_b32 a77, v105
    v_accvgpr_write_b32 a78, v106
    v_accvgpr_write_b32 a79, v107
    v_accvgpr_write_b32 a80, v108
    v_accvgpr_write_b32 a81, v109
    v_accvgpr_write_b32 a82, v110
    v_accvgpr_write_b32 a83, v111
    v_accvgpr_write_b32 a84, v112
    v_accvgpr_write_b32 a85, v113
    v_accvgpr_write_b32 a86, v114
    v_accvgpr_write_b32 a87, v115
    v_accvgpr_read_b32 v104, a88
    v_accvgpr_read_b32 v105, a89
    v_accvgpr_read_b32 v106, a90
    v_accvgpr_read_b32 v107, a91
    v_accvgpr_read_b32 v108, a92
    v_accvgpr_read_b32 v109, a93
    v_accvgpr_read_b32 v110, a94
    v_accvgpr_read_b32 v111, a95
    v_accvgpr_read_b32 v112, a192
    v_accvgpr_read_b32 v113, a193
    v_accvgpr_read_b32 v114, a194
    v_accvgpr_read_b32 v115, a195
    v_mul_f32 v104, v104, v98
    v_mul_f32 v105, v105, v98
    v_mul_f32 v106, v106, v98
    v_mul_f32 v107, v107, v98
    v_mul_f32 v108, v108, v98
    v_mul_f32 v109, v109, v98
    v_mul_f32 v110, v110, v98
    v_mul_f32 v111, v111, v98
    v_mul_f32 v112, v112, v98
    v_mul_f32 v113, v113, v98
    v_mul_f32 v114, v114, v98
    v_mul_f32 v115, v115, v98
    v_accvgpr_write_b32 a88, v104
    v_accvgpr_write_b32 a89, v105
    v_accvgpr_write_b32 a90, v106
    v_accvgpr_write_b32 a91, v107
    v_accvgpr_write_b32 a92, v108
    v_accvgpr_write_b32 a93, v109
    v_accvgpr_write_b32 a94, v110
    v_accvgpr_write_b32 a95, v111
    v_accvgpr_write_b32 a192, v112
    v_accvgpr_write_b32 a193, v113
    v_accvgpr_write_b32 a194, v114
    v_accvgpr_write_b32 a195, v115
    v_max3_f32 v96, v196, v197, v198
    v_max3_f32 v96, v96, v199, v212
    v_max3_f32 v96, v96, v213, v214
    v_max3_f32 v96, v96, v215, v225
    v_mov_b32 v97, v96
    s_nop 1
    v_permlane16_swap_b32 v97, v96
    s_nop 1
    v_max_f32 v96, v96, v97
    v_mov_b32 v97, v96
    s_nop 1
    v_permlane32_swap_b32 v97, v96
    s_nop 1
    v_max_f32 v96, v96, v97
    v_sub_f32 v98, v225, v96
    v_exp_f32 v98, v98
    v_mov_b32 v225, v96
    v_sub_f32 v196, v196, v96
    v_sub_f32 v197, v197, v96
    v_sub_f32 v198, v198, v96
    v_sub_f32 v199, v199, v96
    v_exp_f32 v196, v196
    v_exp_f32 v197, v197
    v_exp_f32 v198, v198
    v_exp_f32 v199, v199
    v_sub_f32 v212, v212, v96
    v_sub_f32 v213, v213, v96
    v_sub_f32 v214, v214, v96
    v_sub_f32 v215, v215, v96
    v_exp_f32 v212, v212
    v_exp_f32 v213, v213
    v_exp_f32 v214, v214
    v_exp_f32 v215, v215
    s_nop 0
    v_cvt_pk_bf16_f32 v56, v196, v197
    v_cvt_pk_bf16_f32 v57, v198, v199
    v_cvt_pk_bf16_f32 v58, v212, v213
    v_cvt_pk_bf16_f32 v59, v214, v215
    v_accvgpr_read_b32 v104, a96
    v_accvgpr_read_b32 v105, a97
    v_accvgpr_read_b32 v106, a98
    v_accvgpr_read_b32 v107, a99
    v_accvgpr_read_b32 v108, a100
    v_accvgpr_read_b32 v109, a101
    v_accvgpr_read_b32 v110, a102
    v_accvgpr_read_b32 v111, a103
    v_accvgpr_read_b32 v112, a104
    v_accvgpr_read_b32 v113, a105
    v_accvgpr_read_b32 v114, a106
    v_accvgpr_read_b32 v115, a107
    v_mul_f32 v104, v104, v98
    v_mul_f32 v105, v105, v98
    v_mul_f32 v106, v106, v98
    v_mul_f32 v107, v107, v98
    v_mul_f32 v108, v108, v98
    v_mul_f32 v109, v109, v98
    v_mul_f32 v110, v110, v98
    v_mul_f32 v111, v111, v98
    v_mul_f32 v112, v112, v98
    v_mul_f32 v113, v113, v98
    v_mul_f32 v114, v114, v98
    v_mul_f32 v115, v115, v98
    v_accvgpr_write_b32 a96, v104
    v_accvgpr_write_b32 a97, v105
    v_accvgpr_write_b32 a98, v106
    v_accvgpr_write_b32 a99, v107
    v_accvgpr_write_b32 a100, v108
    v_accvgpr_write_b32 a101, v109
    v_accvgpr_write_b32 a102, v110
    v_accvgpr_write_b32 a103, v111
    v_accvgpr_write_b32 a104, v112
    v_accvgpr_write_b32 a105, v113
    v_accvgpr_write_b32 a106, v114
    v_accvgpr_write_b32 a107, v115
    v_accvgpr_read_b32 v104, a108
    v_accvgpr_read_b32 v105, a109
    v_accvgpr_read_b32 v106, a110
    v_accvgpr_read_b32 v107, a111
    v_accvgpr_read_b32 v108, a112
    v_accvgpr_read_b32 v109, a113
    v_accvgpr_read_b32 v110, a114
    v_accvgpr_read_b32 v111, a115
    v_accvgpr_read_b32 v112, a116
    v_accvgpr_read_b32 v113, a117
    v_accvgpr_read_b32 v114, a118
    v_accvgpr_read_b32 v115, a119
    v_mul_f32 v104, v104, v98
    v_mul_f32 v105, v105, v98
    v_mul_f32 v106, v106, v98
    v_mul_f32 v107, v107, v98
    v_mul_f32 v108, v108, v98
    v_mul_f32 v109, v109, v98
    v_mul_f32 v110, v110, v98
    v_mul_f32 v111, v111, v98
    v_mul_f32 v112, v112, v98
    v_mul_f32 v113, v113, v98
    v_mul_f32 v114, v114, v98
    v_mul_f32 v115, v115, v98
    v_accvgpr_write_b32 a108, v104
    v_accvgpr_write_b32 a109, v105
    v_accvgpr_write_b32 a110, v106
    v_accvgpr_write_b32 a111, v107
    v_accvgpr_write_b32 a112, v108
    v_accvgpr_write_b32 a113, v109
    v_accvgpr_write_b32 a114, v110
    v_accvgpr_write_b32 a115, v111
    v_accvgpr_write_b32 a116, v112
    v_accvgpr_write_b32 a117, v113
    v_accvgpr_write_b32 a118, v114
    v_accvgpr_write_b32 a119, v115
    v_accvgpr_read_b32 v104, a120
    v_accvgpr_read_b32 v105, a121
    v_accvgpr_read_b32 v106, a122
    v_accvgpr_read_b32 v107, a123
    v_accvgpr_read_b32 v108, a124
    v_accvgpr_read_b32 v109, a125
    v_accvgpr_read_b32 v110, a126
    v_accvgpr_read_b32 v111, a127
    v_accvgpr_read_b32 v112, a196
    v_accvgpr_read_b32 v113, a197
    v_accvgpr_read_b32 v114, a198
    v_accvgpr_read_b32 v115, a199
    v_mul_f32 v104, v104, v98
    v_mul_f32 v105, v105, v98
    v_mul_f32 v106, v106, v98
    v_mul_f32 v107, v107, v98
    v_mul_f32 v108, v108, v98
    v_mul_f32 v109, v109, v98
    v_mul_f32 v110, v110, v98
    v_mul_f32 v111, v111, v98
    v_mul_f32 v112, v112, v98
    v_mul_f32 v113, v113, v98
    v_mul_f32 v114, v114, v98
    v_mul_f32 v115, v115, v98
    v_accvgpr_write_b32 a120, v104
    v_accvgpr_write_b32 a121, v105
    v_accvgpr_write_b32 a122, v106
    v_accvgpr_write_b32 a123, v107
    v_accvgpr_write_b32 a124, v108
    v_accvgpr_write_b32 a125, v109
    v_accvgpr_write_b32 a126, v110
    v_accvgpr_write_b32 a127, v111
    v_accvgpr_write_b32 a196, v112
    v_accvgpr_write_b32 a197, v113
    v_accvgpr_write_b32 a198, v114
    v_accvgpr_write_b32 a199, v115
    v_max3_f32 v96, v200, v201, v202
    v_max3_f32 v96, v96, v203, v216
    v_max3_f32 v96, v96, v217, v218
    v_max3_f32 v96, v96, v219, v226
    v_mov_b32 v97, v96
    s_nop 1
    v_permlane16_swap_b32 v97, v96
    s_nop 1
    v_max_f32 v96, v96, v97
    v_mov_b32 v97, v96
    s_nop 1
    v_permlane32_swap_b32 v97, v96
    s_nop 1
    v_max_f32 v96, v96, v97
    v_sub_f32 v98, v226, v96
    v_exp_f32 v98, v98
    v_mov_b32 v226, v96
    v_sub_f32 v200, v200, v96
    v_sub_f32 v201, v201, v96
    v_sub_f32 v202, v202, v96
    v_sub_f32 v203, v203, v96
    v_exp_f32 v200, v200
    v_exp_f32 v201, v201
    v_exp_f32 v202, v202
    v_exp_f32 v203, v203
    v_sub_f32 v216, v216, v96
    v_sub_f32 v217, v217, v96
    v_sub_f32 v218, v218, v96
    v_sub_f32 v219, v219, v96
    v_exp_f32 v216, v216
    v_exp_f32 v217, v217
    v_exp_f32 v218, v218
    v_exp_f32 v219, v219
    s_nop 0
    v_cvt_pk_bf16_f32 v64, v200, v201
    v_cvt_pk_bf16_f32 v65, v202, v203
    v_cvt_pk_bf16_f32 v66, v216, v217
    v_cvt_pk_bf16_f32 v67, v218, v219
    v_accvgpr_read_b32 v104, a128
    v_accvgpr_read_b32 v105, a129
    v_accvgpr_read_b32 v106, a130
    v_accvgpr_read_b32 v107, a131
    v_accvgpr_read_b32 v108, a132
    v_accvgpr_read_b32 v109, a133
    v_accvgpr_read_b32 v110, a134
    v_accvgpr_read_b32 v111, a135
    v_accvgpr_read_b32 v112, a136
    v_accvgpr_read_b32 v113, a137
    v_accvgpr_read_b32 v114, a138
    v_accvgpr_read_b32 v115, a139
    v_mul_f32 v104, v104, v98
    v_mul_f32 v105, v105, v98
    v_mul_f32 v106, v106, v98
    v_mul_f32 v107, v107, v98
    v_mul_f32 v108, v108, v98
    v_mul_f32 v109, v109, v98
    v_mul_f32 v110, v110, v98
    v_mul_f32 v111, v111, v98
    v_mul_f32 v112, v112, v98
    v_mul_f32 v113, v113, v98
    v_mul_f32 v114, v114, v98
    v_mul_f32 v115, v115, v98
    v_accvgpr_write_b32 a128, v104
    v_accvgpr_write_b32 a129, v105
    v_accvgpr_write_b32 a130, v106
    v_accvgpr_write_b32 a131, v107
    v_accvgpr_write_b32 a132, v108
    v_accvgpr_write_b32 a133, v109
    v_accvgpr_write_b32 a134, v110
    v_accvgpr_write_b32 a135, v111
    v_accvgpr_write_b32 a136, v112
    v_accvgpr_write_b32 a137, v113
    v_accvgpr_write_b32 a138, v114
    v_accvgpr_write_b32 a139, v115
    v_accvgpr_read_b32 v104, a140
    v_accvgpr_read_b32 v105, a141
    v_accvgpr_read_b32 v106, a142
    v_accvgpr_read_b32 v107, a143
    v_accvgpr_read_b32 v108, a144
    v_accvgpr_read_b32 v109, a145
    v_accvgpr_read_b32 v110, a146
    v_accvgpr_read_b32 v111, a147
    v_accvgpr_read_b32 v112, a148
    v_accvgpr_read_b32 v113, a149
    v_accvgpr_read_b32 v114, a150
    v_accvgpr_read_b32 v115, a151
    v_mul_f32 v104, v104, v98
    v_mul_f32 v105, v105, v98
    v_mul_f32 v106, v106, v98
    v_mul_f32 v107, v107, v98
    v_mul_f32 v108, v108, v98
    v_mul_f32 v109, v109, v98
    v_mul_f32 v110, v110, v98
    v_mul_f32 v111, v111, v98
    v_mul_f32 v112, v112, v98
    v_mul_f32 v113, v113, v98
    v_mul_f32 v114, v114, v98
    v_mul_f32 v115, v115, v98
    v_accvgpr_write_b32 a140, v104
    v_accvgpr_write_b32 a141, v105
    v_accvgpr_write_b32 a142, v106
    v_accvgpr_write_b32 a143, v107
    v_accvgpr_write_b32 a144, v108
    v_accvgpr_write_b32 a145, v109
    v_accvgpr_write_b32 a146, v110
    v_accvgpr_write_b32 a147, v111
    v_accvgpr_write_b32 a148, v112
    v_accvgpr_write_b32 a149, v113
    v_accvgpr_write_b32 a150, v114
    v_accvgpr_write_b32 a151, v115
    v_accvgpr_read_b32 v104, a152
    v_accvgpr_read_b32 v105, a153
    v_accvgpr_read_b32 v106, a154
    v_accvgpr_read_b32 v107, a155
    v_accvgpr_read_b32 v108, a156
    v_accvgpr_read_b32 v109, a157
    v_accvgpr_read_b32 v110, a158
    v_accvgpr_read_b32 v111, a159
    v_accvgpr_read_b32 v112, a200
    v_accvgpr_read_b32 v113, a201
    v_accvgpr_read_b32 v114, a202
    v_accvgpr_read_b32 v115, a203
    v_mul_f32 v104, v104, v98
    v_mul_f32 v105, v105, v98
    v_mul_f32 v106, v106, v98
    v_mul_f32 v107, v107, v98
    v_mul_f32 v108, v108, v98
    v_mul_f32 v109, v109, v98
    v_mul_f32 v110, v110, v98
    v_mul_f32 v111, v111, v98
    v_mul_f32 v112, v112, v98
    v_mul_f32 v113, v113, v98
    v_mul_f32 v114, v114, v98
    v_mul_f32 v115, v115, v98
    v_accvgpr_write_b32 a152, v104
    v_accvgpr_write_b32 a153, v105
    v_accvgpr_write_b32 a154, v106
    v_accvgpr_write_b32 a155, v107
    v_accvgpr_write_b32 a156, v108
    v_accvgpr_write_b32 a157, v109
    v_accvgpr_write_b32 a158, v110
    v_accvgpr_write_b32 a159, v111
    v_accvgpr_write_b32 a200, v112
    v_accvgpr_write_b32 a201, v113
    v_accvgpr_write_b32 a202, v114
    v_accvgpr_write_b32 a203, v115
    v_max3_f32 v96, v204, v205, v206
    v_max3_f32 v96, v96, v207, v220
    v_max3_f32 v96, v96, v221, v222
    v_max3_f32 v96, v96, v223, v227
    v_mov_b32 v97, v96
    s_nop 1
    v_permlane16_swap_b32 v97, v96
    s_nop 1
    v_max_f32 v96, v96, v97
    v_mov_b32 v97, v96
    s_nop 1
    v_permlane32_swap_b32 v97, v96
    s_nop 1
    v_max_f32 v96, v96, v97
    v_sub_f32 v98, v227, v96
    v_exp_f32 v98, v98
    v_mov_b32 v227, v96
    v_sub_f32 v204, v204, v96
    v_sub_f32 v205, v205, v96
    v_sub_f32 v206, v206, v96
    v_sub_f32 v207, v207, v96
    v_exp_f32 v204, v204
    v_exp_f32 v205, v205
    v_exp_f32 v206, v206
    v_exp_f32 v207, v207
    v_sub_f32 v220, v220, v96
    v_sub_f32 v221, v221, v96
    v_sub_f32 v222, v222, v96
    v_sub_f32 v223, v223, v96
    v_exp_f32 v220, v220
    v_exp_f32 v221, v221
    v_exp_f32 v222, v222
    v_exp_f32 v223, v223
    s_nop 0
    v_cvt_pk_bf16_f32 v72, v204, v205
    v_cvt_pk_bf16_f32 v73, v206, v207
    v_cvt_pk_bf16_f32 v74, v220, v221
    v_cvt_pk_bf16_f32 v75, v222, v223
    v_accvgpr_read_b32 v104, a160
    v_accvgpr_read_b32 v105, a161
    v_accvgpr_read_b32 v106, a162
    v_accvgpr_read_b32 v107, a163
    v_accvgpr_read_b32 v108, a164
    v_accvgpr_read_b32 v109, a165
    v_accvgpr_read_b32 v110, a166
    v_accvgpr_read_b32 v111, a167
    v_accvgpr_read_b32 v112, a168
    v_accvgpr_read_b32 v113, a169
    v_accvgpr_read_b32 v114, a170
    v_accvgpr_read_b32 v115, a171
    v_mul_f32 v104, v104, v98
    v_mul_f32 v105, v105, v98
    v_mul_f32 v106, v106, v98
    v_mul_f32 v107, v107, v98
    v_mul_f32 v108, v108, v98
    v_mul_f32 v109, v109, v98
    v_mul_f32 v110, v110, v98
    v_mul_f32 v111, v111, v98
    v_mul_f32 v112, v112, v98
    v_mul_f32 v113, v113, v98
    v_mul_f32 v114, v114, v98
    v_mul_f32 v115, v115, v98
    v_accvgpr_write_b32 a160, v104
    v_accvgpr_write_b32 a161, v105
    v_accvgpr_write_b32 a162, v106
    v_accvgpr_write_b32 a163, v107
    v_accvgpr_write_b32 a164, v108
    v_accvgpr_write_b32 a165, v109
    v_accvgpr_write_b32 a166, v110
    v_accvgpr_write_b32 a167, v111
    v_accvgpr_write_b32 a168, v112
    v_accvgpr_write_b32 a169, v113
    v_accvgpr_write_b32 a170, v114
    v_accvgpr_write_b32 a171, v115
    v_accvgpr_read_b32 v104, a172
    v_accvgpr_read_b32 v105, a173
    v_accvgpr_read_b32 v106, a174
    v_accvgpr_read_b32 v107, a175
    v_accvgpr_read_b32 v108, a176
    v_accvgpr_read_b32 v109, a177
    v_accvgpr_read_b32 v110, a178
    v_accvgpr_read_b32 v111, a179
    v_accvgpr_read_b32 v112, a180
    v_accvgpr_read_b32 v113, a181
    v_accvgpr_read_b32 v114, a182
    v_accvgpr_read_b32 v115, a183
    v_mul_f32 v104, v104, v98
    v_mul_f32 v105, v105, v98
    v_mul_f32 v106, v106, v98
    v_mul_f32 v107, v107, v98
    v_mul_f32 v108, v108, v98
    v_mul_f32 v109, v109, v98
    v_mul_f32 v110, v110, v98
    v_mul_f32 v111, v111, v98
    v_mul_f32 v112, v112, v98
    v_mul_f32 v113, v113, v98
    v_mul_f32 v114, v114, v98
    v_mul_f32 v115, v115, v98
    v_accvgpr_write_b32 a172, v104
    v_accvgpr_write_b32 a173, v105
    v_accvgpr_write_b32 a174, v106
    v_accvgpr_write_b32 a175, v107
    v_accvgpr_write_b32 a176, v108
    v_accvgpr_write_b32 a177, v109
    v_accvgpr_write_b32 a178, v110
    v_accvgpr_write_b32 a179, v111
    v_accvgpr_write_b32 a180, v112
    v_accvgpr_write_b32 a181, v113
    v_accvgpr_write_b32 a182, v114
    v_accvgpr_write_b32 a183, v115
    v_accvgpr_read_b32 v104, a184
    v_accvgpr_read_b32 v105, a185
    v_accvgpr_read_b32 v106, a186
    v_accvgpr_read_b32 v107, a187
    v_accvgpr_read_b32 v108, a188
    v_accvgpr_read_b32 v109, a189
    v_accvgpr_read_b32 v110, a190
    v_accvgpr_read_b32 v111, a191
    v_accvgpr_read_b32 v112, a204
    v_accvgpr_read_b32 v113, a205
    v_accvgpr_read_b32 v114, a206
    v_accvgpr_read_b32 v115, a207
    v_mul_f32 v104, v104, v98
    v_mul_f32 v105, v105, v98
    v_mul_f32 v106, v106, v98
    v_mul_f32 v107, v107, v98
    v_mul_f32 v108, v108, v98
    v_mul_f32 v109, v109, v98
    v_mul_f32 v110, v110, v98
    v_mul_f32 v111, v111, v98
    v_mul_f32 v112, v112, v98
    v_mul_f32 v113, v113, v98
    v_mul_f32 v114, v114, v98
    v_mul_f32 v115, v115, v98
    v_accvgpr_write_b32 a184, v104
    v_accvgpr_write_b32 a185, v105
    v_accvgpr_write_b32 a186, v106
    v_accvgpr_write_b32 a187, v107
    v_accvgpr_write_b32 a188, v108
    v_accvgpr_write_b32 a189, v109
    v_accvgpr_write_b32 a190, v110
    v_accvgpr_write_b32 a191, v111
    v_accvgpr_write_b32 a204, v112
    v_accvgpr_write_b32 a205, v113
    v_accvgpr_write_b32 a206, v114
    v_accvgpr_write_b32 a207, v115
    s_waitcnt lgkmcnt(0)
    s_nop 1
    v_mfma_f32_16x16x32_bf16 a[64:67], a[32:35], v[48:51], a[64:67]
    v_mfma_f32_16x16x32_bf16 a[96:99], a[32:35], v[56:59], a[96:99]
    v_mfma_f32_16x16x32_bf16 a[128:131], a[32:35], v[64:67], a[128:131]
    v_mfma_f32_16x16x32_bf16 a[160:163], a[32:35], v[72:75], a[160:163]
    v_mfma_f32_16x16x32_bf16 a[68:71], a[36:39], v[48:51], a[68:71]
    v_mfma_f32_16x16x32_bf16 a[100:103], a[36:39], v[56:59], a[100:103]
    v_mfma_f32_16x16x32_bf16 a[132:135], a[36:39], v[64:67], a[132:135]
    v_mfma_f32_16x16x32_bf16 a[164:167], a[36:39], v[72:75], a[164:167]
    v_mfma_f32_16x16x32_bf16 a[72:75], a[40:43], v[48:51], a[72:75]
    v_mfma_f32_16x16x32_bf16 a[104:107], a[40:43], v[56:59], a[104:107]
    v_mfma_f32_16x16x32_bf16 a[136:139], a[40:43], v[64:67], a[136:139]
    v_mfma_f32_16x16x32_bf16 a[168:171], a[40:43], v[72:75], a[168:171]
    v_mfma_f32_16x16x32_bf16 a[76:79], a[44:47], v[48:51], a[76:79]
    v_mfma_f32_16x16x32_bf16 a[108:111], a[44:47], v[56:59], a[108:111]
    v_mfma_f32_16x16x32_bf16 a[140:143], a[44:47], v[64:67], a[140:143]
    v_mfma_f32_16x16x32_bf16 a[172:175], a[44:47], v[72:75], a[172:175]
    v_mfma_f32_16x16x32_bf16 a[80:83], a[48:51], v[48:51], a[80:83]
    v_mfma_f32_16x16x32_bf16 a[112:115], a[48:51], v[56:59], a[112:115]
    v_mfma_f32_16x16x32_bf16 a[144:147], a[48:51], v[64:67], a[144:147]
    v_mfma_f32_16x16x32_bf16 a[176:179], a[48:51], v[72:75], a[176:179]
    v_mfma_f32_16x16x32_bf16 a[84:87], a[52:55], v[48:51], a[84:87]
    v_mfma_f32_16x16x32_bf16 a[116:119], a[52:55], v[56:59], a[116:119]
    v_mfma_f32_16x16x32_bf16 a[148:151], a[52:55], v[64:67], a[148:151]
    v_mfma_f32_16x16x32_bf16 a[180:183], a[52:55], v[72:75], a[180:183]
    v_mfma_f32_16x16x32_bf16 a[88:91], a[56:59], v[48:51], a[88:91]
    v_mfma_f32_16x16x32_bf16 a[120:123], a[56:59], v[56:59], a[120:123]
    v_mfma_f32_16x16x32_bf16 a[152:155], a[56:59], v[64:67], a[152:155]
    v_mfma_f32_16x16x32_bf16 a[184:187], a[56:59], v[72:75], a[184:187]
    v_mfma_f32_16x16x32_bf16 a[92:95], a[60:63], v[48:51], a[92:95]
    v_mfma_f32_16x16x32_bf16 a[124:127], a[60:63], v[56:59], a[124:127]
    v_mfma_f32_16x16x32_bf16 a[156:159], a[60:63], v[64:67], a[156:159]
    v_mfma_f32_16x16x32_bf16 a[188:191], a[60:63], v[72:75], a[188:191]
    v_mfma_f32_16x16x32_bf16 a[192:195], v[92:95], v[48:51], a[192:195]
    v_mfma_f32_16x16x32_bf16 a[196:199], v[92:95], v[56:59], a[196:199]
    v_mfma_f32_16x16x32_bf16 a[200:203], v[92:95], v[64:67], a[200:203]
    v_mfma_f32_16x16x32_bf16 a[204:207], v[92:95], v[72:75], a[204:207]
    s_sub_u32 s27, s27, 1
    s_cmp_lg_u32 s27, 0
    s_cbranch_scc1 L_slow_loop
    s_nop 7
    v_accvgpr_read_b32 v96, a192
    v_accvgpr_read_b32 v97, a196
    v_accvgpr_read_b32 v98, a200
    v_accvgpr_read_b32 v99, a204
    v_add_f32 v101, v96, v97
    v_add_f32 v102, v98, v99
    v_add_f32 v101, v101, v102
    v_cmp_nge_f32 vcc, s30, v101
    v_rcp_f32 v96, v96
    v_rcp_f32 v97, v97
    v_rcp_f32 v98, v98
    v_rcp_f32 v99, v99
    v_add_u32 v108, 0, v12
    v_add_u32 v109, 131072, v12
    v_add_u32 v110, 262144, v12
    v_add_u32 v111, 393216, v12
    s_lshl_b32 s39, s25, 12
    v_accvgpr_read_b32 v16, a64
    v_accvgpr_read_b32 v17, a65
    v_accvgpr_read_b32 v18, a66
    v_accvgpr_read_b32 v19, a67
    v_accvgpr_read_b32 v20, a68
    v_accvgpr_read_b32 v21, a69
    v_accvgpr_read_b32 v22, a70
    v_accvgpr_read_b32 v23, a71
    v_mul_f32 v16, v16, v96
    v_mul_f32 v17, v17, v96
    v_mul_f32 v18, v18, v96
    v_mul_f32 v19, v19, v96
    v_mul_f32 v20, v20, v96
    v_mul_f32 v21, v21, v96
    v_mul_f32 v22, v22, v96
    v_mul_f32 v23, v23, v96
    v_cvt_pk_bf16_f32 v24, v16, v17
    v_cvt_pk_bf16_f32 v25, v18, v19
    v_cvt_pk_bf16_f32 v26, v20, v21
    v_cvt_pk_bf16_f32 v27, v22, v23
    buffer_store_dwordx4 v[24:27], v108, s[20:23], s39 offen offset:0 sc1
    v_accvgpr_read_b32 v28, a72
    v_accvgpr_read_b32 v29, a73
    v_accvgpr_read_b32 v30, a74
    v_accvgpr_read_b32 v31, a75
    v_accvgpr_read_b32 v32, a76
    v_accvgpr_read_b32 v33, a77
    v_accvgpr_read_b32 v34, a78
    v_accvgpr_read_b32 v35, a79
    v_mul_f32 v28, v28, v96
    v_mul_f32 v29, v29, v96
    v_mul_f32 v30, v30, v96
    v_mul_f32 v31, v31, v96
    v_mul_f32 v32, v32, v96
    v_mul_f32 v33, v33, v96
    v_mul_f32 v34, v34, v96
    v_mul_f32 v35, v35, v96
    v_cvt_pk_bf16_f32 v36, v28, v29
    v_cvt_pk_bf16_f32 v37, v30, v31
    v_cvt_pk_bf16_f32 v38, v32, v33
    v_cvt_pk_bf16_f32 v39, v34, v35
    buffer_store_dwordx4 v[36:39], v108, s[20:23], s39 offen offset:1024 sc1
    v_accvgpr_read_b32 v40, a80
    v_accvgpr_read_b32 v41, a81
    v_accvgpr_read_b32 v42, a82
    v_accvgpr_read_b32 v43, a83
    v_accvgpr_read_b32 v44, a84
    v_accvgpr_read_b32 v45, a85
    v_accvgpr_read_b32 v46, a86
    v_accvgpr_read_b32 v47, a87
    v_mul_f32 v40, v40, v96
    v_mul_f32 v41, v41, v96
    v_mul_f32 v42, v42, v96
    v_mul_f32 v43, v43, v96
    v_mul_f32 v44, v44, v96
    v_mul_f32 v45, v45, v96
    v_mul_f32 v46, v46, v96
    v_mul_f32 v47, v47, v96
    v_cvt_pk_bf16_f32 v48, v40, v41
    v_cvt_pk_bf16_f32 v49, v42, v43
    v_cvt_pk_bf16_f32 v50, v44, v45
    v_cvt_pk_bf16_f32 v51, v46, v47
    buffer_store_dwordx4 v[48:51], v108, s[20:23], s39 offen offset:2048 sc1
    v_accvgpr_read_b32 v52, a88
    v_accvgpr_read_b32 v53, a89
    v_accvgpr_read_b32 v54, a90
    v_accvgpr_read_b32 v55, a91
    v_accvgpr_read_b32 v56, a92
    v_accvgpr_read_b32 v57, a93
    v_accvgpr_read_b32 v58, a94
    v_accvgpr_read_b32 v59, a95
    v_mul_f32 v52, v52, v96
    v_mul_f32 v53, v53, v96
    v_mul_f32 v54, v54, v96
    v_mul_f32 v55, v55, v96
    v_mul_f32 v56, v56, v96
    v_mul_f32 v57, v57, v96
    v_mul_f32 v58, v58, v96
    v_mul_f32 v59, v59, v96
    v_cvt_pk_bf16_f32 v60, v52, v53
    v_cvt_pk_bf16_f32 v61, v54, v55
    v_cvt_pk_bf16_f32 v62, v56, v57
    v_cvt_pk_bf16_f32 v63, v58, v59
    buffer_store_dwordx4 v[60:63], v108, s[20:23], s39 offen offset:3072 sc1
    v_accvgpr_read_b32 v16, a96
    v_accvgpr_read_b32 v17, a97
    v_accvgpr_read_b32 v18, a98
    v_accvgpr_read_b32 v19, a99
    v_accvgpr_read_b32 v20, a100
    v_accvgpr_read_b32 v21, a101
    v_accvgpr_read_b32 v22, a102
    v_accvgpr_read_b32 v23, a103
    v_mul_f32 v16, v16, v97
    v_mul_f32 v17, v17, v97
    v_mul_f32 v18, v18, v97
    v_mul_f32 v19, v19, v97
    v_mul_f32 v20, v20, v97
    v_mul_f32 v21, v21, v97
    v_mul_f32 v22, v22, v97
    v_mul_f32 v23, v23, v97
    v_cvt_pk_bf16_f32 v24, v16, v17
    v_cvt_pk_bf16_f32 v25, v18, v19
    v_cvt_pk_bf16_f32 v26, v20, v21
    v_cvt_pk_bf16_f32 v27, v22, v23
    buffer_store_dwordx4 v[24:27], v109, s[20:23], s39 offen offset:0 sc1
    v_accvgpr_read_b32 v28, a104
    v_accvgpr_read_b32 v29, a105
    v_accvgpr_read_b32 v30, a106
    v_accvgpr_read_b32 v31, a107
    v_accvgpr_read_b32 v32, a108
    v_accvgpr_read_b32 v33, a109
    v_accvgpr_read_b32 v34, a110
    v_accvgpr_read_b32 v35, a111
    v_mul_f32 v28, v28, v97
    v_mul_f32 v29, v29, v97
    v_mul_f32 v30, v30, v97
    v_mul_f32 v31, v31, v97
    v_mul_f32 v32, v32, v97
    v_mul_f32 v33, v33, v97
    v_mul_f32 v34, v34, v97
    v_mul_f32 v35, v35, v97
    v_cvt_pk_bf16_f32 v36, v28, v29
    v_cvt_pk_bf16_f32 v37, v30, v31
    v_cvt_pk_bf16_f32 v38, v32, v33
    v_cvt_pk_bf16_f32 v39, v34, v35
    buffer_store_dwordx4 v[36:39], v109, s[20:23], s39 offen offset:1024 sc1
    v_accvgpr_read_b32 v40, a112
    v_accvgpr_read_b32 v41, a113
    v_accvgpr_read_b32 v42, a114
    v_accvgpr_read_b32 v43, a115
    v_accvgpr_read_b32 v44, a116
    v_accvgpr_read_b32 v45, a117
    v_accvgpr_read_b32 v46, a118
    v_accvgpr_read_b32 v47, a119
    v_mul_f32 v40, v40, v97
    v_mul_f32 v41, v41, v97
    v_mul_f32 v42, v42, v97
    v_mul_f32 v43, v43, v97
    v_mul_f32 v44, v44, v97
    v_mul_f32 v45, v45, v97
    v_mul_f32 v46, v46, v97
    v_mul_f32 v47, v47, v97
    v_cvt_pk_bf16_f32 v48, v40, v41
    v_cvt_pk_bf16_f32 v49, v42, v43
    v_cvt_pk_bf16_f32 v50, v44, v45
    v_cvt_pk_bf16_f32 v51, v46, v47
    buffer_store_dwordx4 v[48:51], v109, s[20:23], s39 offen offset:2048 sc1
    v_accvgpr_read_b32 v52, a120
    v_accvgpr_read_b32 v53, a121
    v_accvgpr_read_b32 v54, a122
    v_accvgpr_read_b32 v55, a123
    v_accvgpr_read_b32 v56, a124
    v_accvgpr_read_b32 v57, a125
    v_accvgpr_read_b32 v58, a126
    v_accvgpr_read_b32 v59, a127
    v_mul_f32 v52, v52, v97
    v_mul_f32 v53, v53, v97
    v_mul_f32 v54, v54, v97
    v_mul_f32 v55, v55, v97
    v_mul_f32 v56, v56, v97
    v_mul_f32 v57, v57, v97
    v_mul_f32 v58, v58, v97
    v_mul_f32 v59, v59, v97
    v_cvt_pk_bf16_f32 v60, v52, v53
    v_cvt_pk_bf16_f32 v61, v54, v55
    v_cvt_pk_bf16_f32 v62, v56, v57
    v_cvt_pk_bf16_f32 v63, v58, v59
    buffer_store_dwordx4 v[60:63], v109, s[20:23], s39 offen offset:3072 sc1
    v_accvgpr_read_b32 v16, a128
    v_accvgpr_read_b32 v17, a129
    v_accvgpr_read_b32 v18, a130
    v_accvgpr_read_b32 v19, a131
    v_accvgpr_read_b32 v20, a132
    v_accvgpr_read_b32 v21, a133
    v_accvgpr_read_b32 v22, a134
    v_accvgpr_read_b32 v23, a135
    v_mul_f32 v16, v16, v98
    v_mul_f32 v17, v17, v98
    v_mul_f32 v18, v18, v98
    v_mul_f32 v19, v19, v98
    v_mul_f32 v20, v20, v98
    v_mul_f32 v21, v21, v98
    v_mul_f32 v22, v22, v98
    v_mul_f32 v23, v23, v98
    v_cvt_pk_bf16_f32 v24, v16, v17
    v_cvt_pk_bf16_f32 v25, v18, v19
    v_cvt_pk_bf16_f32 v26, v20, v21
    v_cvt_pk_bf16_f32 v27, v22, v23
    buffer_store_dwordx4 v[24:27], v110, s[20:23], s39 offen offset:0 sc1
    v_accvgpr_read_b32 v28, a136
    v_accvgpr_read_b32 v29, a137
    v_accvgpr_read_b32 v30, a138
    v_accvgpr_read_b32 v31, a139
    v_accvgpr_read_b32 v32, a140
    v_accvgpr_read_b32 v33, a141
    v_accvgpr_read_b32 v34, a142
    v_accvgpr_read_b32 v35, a143
    v_mul_f32 v28, v28, v98
    v_mul_f32 v29, v29, v98
    v_mul_f32 v30, v30, v98
    v_mul_f32 v31, v31, v98
    v_mul_f32 v32, v32, v98
    v_mul_f32 v33, v33, v98
    v_mul_f32 v34, v34, v98
    v_mul_f32 v35, v35, v98
    v_cvt_pk_bf16_f32 v36, v28, v29
    v_cvt_pk_bf16_f32 v37, v30, v31
    v_cvt_pk_bf16_f32 v38, v32, v33
    v_cvt_pk_bf16_f32 v39, v34, v35
    buffer_store_dwordx4 v[36:39], v110, s[20:23], s39 offen offset:1024 sc1
    v_accvgpr_read_b32 v40, a144
    v_accvgpr_read_b32 v41, a145
    v_accvgpr_read_b32 v42, a146
    v_accvgpr_read_b32 v43, a147
    v_accvgpr_read_b32 v44, a148
    v_accvgpr_read_b32 v45, a149
    v_accvgpr_read_b32 v46, a150
    v_accvgpr_read_b32 v47, a151
    v_mul_f32 v40, v40, v98
    v_mul_f32 v41, v41, v98
    v_mul_f32 v42, v42, v98
    v_mul_f32 v43, v43, v98
    v_mul_f32 v44, v44, v98
    v_mul_f32 v45, v45, v98
    v_mul_f32 v46, v46, v98
    v_mul_f32 v47, v47, v98
    v_cvt_pk_bf16_f32 v48, v40, v41
    v_cvt_pk_bf16_f32 v49, v42, v43
    v_cvt_pk_bf16_f32 v50, v44, v45
    v_cvt_pk_bf16_f32 v51, v46, v47
    buffer_store_dwordx4 v[48:51], v110, s[20:23], s39 offen offset:2048 sc1
    v_accvgpr_read_b32 v52, a152
    v_accvgpr_read_b32 v53, a153
    v_accvgpr_read_b32 v54, a154
    v_accvgpr_read_b32 v55, a155
    v_accvgpr_read_b32 v56, a156
    v_accvgpr_read_b32 v57, a157
    v_accvgpr_read_b32 v58, a158
    v_accvgpr_read_b32 v59, a159
    v_mul_f32 v52, v52, v98
    v_mul_f32 v53, v53, v98
    v_mul_f32 v54, v54, v98
    v_mul_f32 v55, v55, v98
    v_mul_f32 v56, v56, v98
    v_mul_f32 v57, v57, v98
    v_mul_f32 v58, v58, v98
    v_mul_f32 v59, v59, v98
    v_cvt_pk_bf16_f32 v60, v52, v53
    v_cvt_pk_bf16_f32 v61, v54, v55
    v_cvt_pk_bf16_f32 v62, v56, v57
    v_cvt_pk_bf16_f32 v63, v58, v59
    buffer_store_dwordx4 v[60:63], v110, s[20:23], s39 offen offset:3072 sc1
    v_accvgpr_read_b32 v16, a160
    v_accvgpr_read_b32 v17, a161
    v_accvgpr_read_b32 v18, a162
    v_accvgpr_read_b32 v19, a163
    v_accvgpr_read_b32 v20, a164
    v_accvgpr_read_b32 v21, a165
    v_accvgpr_read_b32 v22, a166
    v_accvgpr_read_b32 v23, a167
    v_mul_f32 v16, v16, v99
    v_mul_f32 v17, v17, v99
    v_mul_f32 v18, v18, v99
    v_mul_f32 v19, v19, v99
    v_mul_f32 v20, v20, v99
    v_mul_f32 v21, v21, v99
    v_mul_f32 v22, v22, v99
    v_mul_f32 v23, v23, v99
    v_cvt_pk_bf16_f32 v24, v16, v17
    v_cvt_pk_bf16_f32 v25, v18, v19
    v_cvt_pk_bf16_f32 v26, v20, v21
    v_cvt_pk_bf16_f32 v27, v22, v23
    buffer_store_dwordx4 v[24:27], v111, s[20:23], s39 offen offset:0 sc1
    v_accvgpr_read_b32 v28, a168
    v_accvgpr_read_b32 v29, a169
    v_accvgpr_read_b32 v30, a170
    v_accvgpr_read_b32 v31, a171
    v_accvgpr_read_b32 v32, a172
    v_accvgpr_read_b32 v33, a173
    v_accvgpr_read_b32 v34, a174
    v_accvgpr_read_b32 v35, a175
    v_mul_f32 v28, v28, v99
    v_mul_f32 v29, v29, v99
    v_mul_f32 v30, v30, v99
    v_mul_f32 v31, v31, v99
    v_mul_f32 v32, v32, v99
    v_mul_f32 v33, v33, v99
    v_mul_f32 v34, v34, v99
    v_mul_f32 v35, v35, v99
    v_cvt_pk_bf16_f32 v36, v28, v29
    v_cvt_pk_bf16_f32 v37, v30, v31
    v_cvt_pk_bf16_f32 v38, v32, v33
    v_cvt_pk_bf16_f32 v39, v34, v35
    buffer_store_dwordx4 v[36:39], v111, s[20:23], s39 offen offset:1024 sc1
    v_accvgpr_read_b32 v40, a176
    v_accvgpr_read_b32 v41, a177
    v_accvgpr_read_b32 v42, a178
    v_accvgpr_read_b32 v43, a179
    v_accvgpr_read_b32 v44, a180
    v_accvgpr_read_b32 v45, a181
    v_accvgpr_read_b32 v46, a182
    v_accvgpr_read_b32 v47, a183
    v_mul_f32 v40, v40, v99
    v_mul_f32 v41, v41, v99
    v_mul_f32 v42, v42, v99
    v_mul_f32 v43, v43, v99
    v_mul_f32 v44, v44, v99
    v_mul_f32 v45, v45, v99
    v_mul_f32 v46, v46, v99
    v_mul_f32 v47, v47, v99
    v_cvt_pk_bf16_f32 v48, v40, v41
    v_cvt_pk_bf16_f32 v49, v42, v43
    v_cvt_pk_bf16_f32 v50, v44, v45
    v_cvt_pk_bf16_f32 v51, v46, v47
    buffer_store_dwordx4 v[48:51], v111, s[20:23], s39 offen offset:2048 sc1
    v_accvgpr_read_b32 v52, a184
    v_accvgpr_read_b32 v53, a185
    v_accvgpr_read_b32 v54, a186
    v_accvgpr_read_b32 v55, a187
    v_accvgpr_read_b32 v56, a188
    v_accvgpr_read_b32 v57, a189
    v_accvgpr_read_b32 v58, a190
    v_accvgpr_read_b32 v59, a191
    v_mul_f32 v52, v52, v99
    v_mul_f32 v53, v53, v99
    v_mul_f32 v54, v54, v99
    v_mul_f32 v55, v55, v99
    v_mul_f32 v56, v56, v99
    v_mul_f32 v57, v57, v99
    v_mul_f32 v58, v58, v99
    v_mul_f32 v59, v59, v99
    v_cvt_pk_bf16_f32 v60, v52, v53
    v_cvt_pk_bf16_f32 v61, v54, v55
    v_cvt_pk_bf16_f32 v62, v56, v57
    v_cvt_pk_bf16_f32 v63, v58, v59
    buffer_store_dwordx4 v[60:63], v111, s[20:23], s39 offen offset:3072 sc1
    s_branch L_k1_fin
L_code_end:
```
